```python
import torch

def _softmax(x, axis=-1):
    return torch.softmax(x, dim=axis)

def _gelu(x):
    return torch.nn.functional.gelu(x, approximate='tanh')

def _silu(x):
    return torch.nn.functional.silu(x)

def _sigmoid(x):
    return torch.sigmoid(x)

def _layernorm(x, axis=-1, eps=1e-05):
    m = x.mean(dim=axis, keepdim=True)
    v = x.var(dim=axis, keepdim=True, unbiased=False)
    return (x - m) / torch.sqrt(v + eps)

def _scatter_add(tgt, idx, src, axis=0):
    return tgt.clone().index_add_(axis, idx, src)

def _segment_sum(src, seg, n):
    out = torch.zeros((n,) + src.shape[1:], dtype=src.dtype)
    return out.index_add_(0, seg, src)

def _pad(x, pw):
    flat = tuple((v for pair in reversed(pw) for v in pair))
    return torch.nn.functional.pad(x, flat)
kernel_name = 'parallel_sum__memory_aug_recurrent_mem_tr__dense_activation_squared_relu__prompt'

def setup_inputs():

    _w = lambda a: (lambda t: t.to(torch.bfloat16) if t.is_floating_point() else t)(torch.as_tensor(a))

    def _A_setup():
        B, S, Dm = (1, 2048, 448)
        H, Dh = (16, 256)
        M, seg = (8, 32)
        seg = min(seg, S)
        S = S // seg * seg
        return {'x': _w((lambda *s: torch.randn(*s, dtype=torch.bfloat16) * 0.05)(B, S, Dm)), 'mem0': _w((lambda *s: torch.randn(*s, dtype=torch.bfloat16) * 1.6)(B, M, Dm)), 'Wq': _w((lambda *s: torch.randn(*s, dtype=torch.bfloat16) * 0.8)(Dm, H, Dh) * Dm ** (-0.5)), 'Wk': _w((lambda *s: torch.randn(*s, dtype=torch.bfloat16) * 0.8)(Dm, H, Dh) * Dm ** (-0.5)), 'Wv': _w((lambda *s: torch.randn(*s, dtype=torch.bfloat16) * 1.6)(Dm, H, Dh) * Dm ** (-0.5)), 'Wo': _w((lambda *s: torch.randn(*s, dtype=torch.bfloat16) * 1.6)(H, Dh, Dm) * (H * Dh) ** (-0.5)), 'seg_len': seg}
    _A_in = _A_setup()

    def _B_setup():
        B, S, D, F = (1, 2048, 448, 1792)
        return {'x': _w((lambda *s: torch.randn(*s, dtype=torch.bfloat16) * 0.05)(B, S, D)), 'w1': _w((lambda *s: torch.randn(*s, dtype=torch.bfloat16) * 0.05)(D, F)), 'b1': _w((lambda *s: torch.randn(*s, dtype=torch.bfloat16) * 0.4)(F)), 'w2': _w((lambda *s: torch.randn(*s, dtype=torch.bfloat16) * 0.05)(F, D)), 'b2': _w((lambda *s: torch.randn(*s, dtype=torch.bfloat16) * 0.8)(D))}
    _B_in = _B_setup()
    return {'A_x': _A_in['x'], 'A_mem0': _A_in['mem0'], 'A_Wq': _A_in['Wq'], 'A_Wk': _A_in['Wk'], 'A_Wv': _A_in['Wv'], 'A_Wo': _A_in['Wo'], 'A_seg_len': _A_in['seg_len'], 'B_x': _B_in['x'], 'B_w1': _B_in['w1'], 'B_b1': _B_in['b1'], 'B_w2': _B_in['w2'], 'B_b2': _B_in['b2']}

def reference(A_x, A_mem0, A_Wq, A_Wk, A_Wv, A_Wo, A_seg_len, B_x, B_w1, B_b1, B_w2, B_b2):

    def _A_ref(x, mem0, Wq, Wk, Wv, Wo, seg_len):
        B, S, Dm = x.shape
        H, Dh = (Wq.shape[1], Wq.shape[2])
        M = mem0.shape[1]
        scale = Dh ** (-0.5)
        n_seg = S // seg_len
        L = M + seg_len
        idx = torch.arange(L)
        mask = (idx[:, None] < M) | (idx[:, None] >= idx[None, :])
        mem = mem0
        outs = []
        for s in range(n_seg):
            xs = x[:, s * seg_len:(s + 1) * seg_len, :].clone()
            h = torch.concatenate([mem, xs], axis=1)
            q = torch.einsum('btd,dhe->bhte', h, Wq)
            k = torch.einsum('btd,dhe->bhte', h, Wk)
            v = torch.einsum('btd,dhe->bhte', h, Wv)
            scores = torch.einsum('bhqe,bhke->bhqk', q, k) * scale
            scores = torch.where(mask[None, None], scores, -1000000000.0)
            p = _softmax(scores, axis=-1)
            o = torch.einsum('bhqk,bhke->bhqe', p, v)
            o = torch.einsum('bhte,hed->btd', o, Wo)
            mem = o[:, :M, :].clone()
            outs.append(o[:, M:, :])
        return torch.concatenate(outs, axis=1)

    def _B_ref(x, w1, b1, w2, b2):
        h = torch.einsum('bsd,df->bsf', x, w1) + b1
        zero = torch.zeros_like(h)
        r = torch.where(h > zero, h, zero)
        h = r * r
        out = torch.einsum('bsf,fd->bsd', h, w2) + b2
        return out
    x = A_x
    xn = _layernorm(x, axis=-1)
    return x + _A_ref(xn, A_mem0, A_Wq, A_Wk, A_Wv, A_Wo, A_seg_len) + _B_ref(xn, B_w1, B_b1, B_w2, B_b2)
```

```asm
; @launch grid=(256,1,1) block=(256,1,1) lds=151616
.amdgcn_target "amdgcn-amd-amdhsa--gfx950"
.text
.globl parallel_sum__memory_aug_recurrent_mem_tr__dense_activation_squared_relu__prompt_kernel
.p2align 8
.type parallel_sum__memory_aug_recurrent_mem_tr__dense_activation_squared_relu__prompt_kernel,@function
parallel_sum__memory_aug_recurrent_mem_tr__dense_activation_squared_relu__prompt_kernel:
s_cmp_ge_u32 s2, 256
s_cbranch_scc1 EXIT
s_load_dwordx2 s[84:85], s[0:1], 104
s_mov_b32 s86, 256
s_mov_b32 s87, 0x20000
s_load_dwordx2 s[4:5], s[0:1], 112
s_mov_b32 s6, 268435456
s_mov_b32 s7, 0x20000
s_load_dwordx2 s[12:13], s[0:1], 32
s_mov_b32 s14, 3670016
s_mov_b32 s15, 0x20000
s_load_dwordx2 s[16:17], s[0:1], 40
s_mov_b32 s18, 3670016
s_mov_b32 s19, 0x20000
s_load_dwordx2 s[40:41], s[0:1], 16
s_mov_b32 s42, 3670016
s_mov_b32 s43, 0x20000
s_load_dwordx2 s[44:45], s[0:1], 24
s_mov_b32 s46, 3670016
s_mov_b32 s47, 0x20000
s_load_dwordx2 s[48:49], s[0:1], 0
s_mov_b32 s50, 1835008
s_mov_b32 s51, 0x20000
v_lshrrev_b32 v1, 6, v0
s_nop 0
v_readfirstlane_b32 s9, v1
s_getreg_b32 s88, hwreg(HW_REG_XCC_ID)
s_and_b32 s88, s88, 7
s_lshr_b32 s21, s2, 3
s_mov_b32 s66, 0
s_lshl_b32 s20, s88, 2
s_add_u32 s20, s20, 160
s_lshl_b32 s93, 1, s21
v_mov_b32 v249, s93
v_mov_b32 v248, 1073741824
v_mov_b32 v247, s20
v_cmp_eq_u32 vcc, 0, v0
s_nop 1
v_cndmask_b32 v248, v248, v247, vcc
v_mov_b32 v252, 16
v_mov_b32 v253, 0
s_waitcnt lgkmcnt(0)
SLOT:
s_sub_u32 s22, s88, 4
s_and_b32 s22, s22, 7
s_cmp_eq_u32 s22, 7
s_cbranch_scc1 PREP_LN
s_mov_b32 s94, s21
s_mul_i32 s100, s21, 6
s_add_u32 s100, s100, s22
s_add_u32 s100, s100, 32
s_cmp_gt_u32 s22, 6
s_cselect_b32 s20, 1, 0
s_sub_u32 s100, s100, s20
s_add_u32 s20, s21, 224
s_cmp_eq_u32 s22, 6
s_cselect_b32 s100, s20, s100
s_lshl_b32 s20, s22, 5
s_add_u32 s20, s20, s21
s_mul_i32 s10, s20, 4682
s_lshr_b32 s10, s10, 16
s_mul_i32 s21, s10, 14
s_sub_u32 s20, s20, s21
s_lshr_b32 s11, s20, 1
s_and_b32 s33, s20, 1
s_lshl_b32 s89, s10, 8
s_lshl_b32 s20, s20, 2
s_add_u32 s89, s89, s20
s_add_u32 s89, s89, 17408
s_add_u32 s90, s89, 128
v_lshlrev_b32 v1, 7, v0
s_mul_i32 s21, s10, 229376
s_lshl_b32 s23, s20, 12
s_add_u32 s21, s21, s23
v_bfe_u32 v2, v0, 2, 5
v_lshlrev_b32 v2, 13, v2
v_and_b32 v3, 3, v0
v_lshl_add_u32 v2, v3, 7, v2
s_lshl_b32 s23, s20, 16
s_lshl_b32 s24, s10, 9
s_add_u32 s23, s23, s24
s_cmp_ge_u32 s9, 2
s_cbranch_scc1 ET_A
buffer_load_dword v246, v1, s[16:19], s21 offen
s_branch ET_D
ET_A:
buffer_load_dword v246, v2, s[12:15], s23 offen
ET_D:
v_and_b32 v1, 63, v0
v_lshrrev_b32 v2, 4, v1
v_and_b32 v3, 15, v1
v_lshlrev_b32 v6, 4, v1
s_and_b32 s34, s9, 1
s_lshr_b32 s35, s9, 1
v_and_b32 v4, 7, v1
v_xor_b32 v4, v4, v2
v_lshlrev_b32 v4, 4, v4
v_lshrrev_b32 v5, 3, v1
v_lshl_add_u32 v7, v5, 13, v4
v_xor_b32 v8, 64, v7
v_add_u32 v8, 65536, v8
v_lshrrev_b32 v5, 1, v3
v_xor_b32 v5, v5, v2
v_lshlrev_b32 v5, 4, v5
v_lshl_add_u32 v5, v3, 7, v5
s_lshl_b32 s20, s34, 13
v_add_u32 v11, s20, v5
v_xor_b32 v12, 64, v11
s_lshl_b32 s20, s11, 19
s_lshl_b32 s21, s9, 17
s_add_u32 s20, s20, s21
s_lshl_b32 s21, s10, 9
s_add_u32 s20, s20, s21
s_lshl_b32 s22, s9, 13
v_lshrrev_b32 v5, 5, v1
v_and_b32 v4, 31, v1
v_xor_b32 v4, v4, v5
s_lshl_b32 s23, s34, 3
v_xor_b32 v4, s23, v4
v_lshlrev_b32 v4, 4, v4
v_mul_u32_u24 v5, 896, v5
v_add_u32 v9, v4, v5
v_xor_b32 v4, 32, v4
v_add_u32 v10, v4, v5
s_mul_i32 s24, s10, 229376
s_mul_i32 s23, s33, 384
s_add_u32 s24, s24, s23
s_mul_i32 s23, s9, 7168
s_add_u32 s24, s24, s23
s_lshl_b32 s23, s9, 12
s_add_u32 s23, s23, 32768
v_lshrrev_b32 v4, 2, v3
v_lshl_add_u32 v5, v2, 3, v4
v_lshlrev_b32 v13, 9, v5
v_and_b32 v5, 11, v5
v_and_b32 v4, 1, v3
v_lshl_add_u32 v13, v4, 3, v13
v_add_u32 v13, 32768, v13
v_and_b32 v4, 2, v3
v_lshlrev_b32 v4, 1, v4
s_mul_i32 s31, s33, 14
s_mul_i32 s32, s35, 7
s_add_u32 s31, s31, s32
s_add_u32 s31, s31, 0
s_lshr_b32 s32, s31, 2
s_lshl_b32 s32, s32, 3
s_and_b32 s31, s31, 3
s_add_u32 s31, s31, s32
s_mul_i32 s32, s33, 24
s_sub_u32 s31, s31, s32
v_add_u32 v15, s31, v4
v_xor_b32 v15, v15, v5
v_lshl_add_u32 v15, v15, 4, v13
s_mul_i32 s31, s33, 14
s_mul_i32 s32, s35, 7
s_add_u32 s31, s31, s32
s_add_u32 s31, s31, 1
s_lshr_b32 s32, s31, 2
s_lshl_b32 s32, s32, 3
s_and_b32 s31, s31, 3
s_add_u32 s31, s31, s32
s_mul_i32 s32, s33, 24
s_sub_u32 s31, s31, s32
v_add_u32 v16, s31, v4
v_xor_b32 v16, v16, v5
v_lshl_add_u32 v16, v16, 4, v13
s_mul_i32 s31, s33, 14
s_mul_i32 s32, s35, 7
s_add_u32 s31, s31, s32
s_add_u32 s31, s31, 2
s_lshr_b32 s32, s31, 2
s_lshl_b32 s32, s32, 3
s_and_b32 s31, s31, 3
s_add_u32 s31, s31, s32
s_mul_i32 s32, s33, 24
s_sub_u32 s31, s31, s32
v_add_u32 v17, s31, v4
v_xor_b32 v17, v17, v5
v_lshl_add_u32 v17, v17, 4, v13
s_mul_i32 s31, s33, 14
s_mul_i32 s32, s35, 7
s_add_u32 s31, s31, s32
s_add_u32 s31, s31, 3
s_lshr_b32 s32, s31, 2
s_lshl_b32 s32, s32, 3
s_and_b32 s31, s31, 3
s_add_u32 s31, s31, s32
s_mul_i32 s32, s33, 24
s_sub_u32 s31, s31, s32
v_add_u32 v18, s31, v4
v_xor_b32 v18, v18, v5
v_lshl_add_u32 v18, v18, 4, v13
s_mul_i32 s31, s33, 14
s_mul_i32 s32, s35, 7
s_add_u32 s31, s31, s32
s_add_u32 s31, s31, 4
s_lshr_b32 s32, s31, 2
s_lshl_b32 s32, s32, 3
s_and_b32 s31, s31, 3
s_add_u32 s31, s31, s32
s_mul_i32 s32, s33, 24
s_sub_u32 s31, s31, s32
v_add_u32 v19, s31, v4
v_xor_b32 v19, v19, v5
v_lshl_add_u32 v19, v19, 4, v13
s_mul_i32 s31, s33, 14
s_mul_i32 s32, s35, 7
s_add_u32 s31, s31, s32
s_add_u32 s31, s31, 5
s_lshr_b32 s32, s31, 2
s_lshl_b32 s32, s32, 3
s_and_b32 s31, s31, 3
s_add_u32 s31, s31, s32
s_mul_i32 s32, s33, 24
s_sub_u32 s31, s31, s32
v_add_u32 v20, s31, v4
v_xor_b32 v20, v20, v5
v_lshl_add_u32 v20, v20, 4, v13
s_mul_i32 s31, s33, 14
s_mul_i32 s32, s35, 7
s_add_u32 s31, s31, s32
s_add_u32 s31, s31, 6
s_lshr_b32 s32, s31, 2
s_lshl_b32 s32, s32, 3
s_and_b32 s31, s31, 3
s_add_u32 s31, s31, s32
s_mul_i32 s32, s33, 24
s_sub_u32 s31, s31, s32
v_add_u32 v21, s31, v4
v_xor_b32 v21, v21, v5
v_lshl_add_u32 v21, v21, 4, v13
s_add_u32 m0, s22, 0
s_nop 0
buffer_load_dwordx4 v7, s[12:15], s20 offen offset:0 lds
s_add_u32 m0, s22, 1024
s_nop 0
buffer_load_dwordx4 v8, s[12:15], s20 offen offset:0 lds
s_add_u32 m0, s23, 0
s_add_u32 s31, s24, 0
buffer_load_dwordx4 v9, s[16:19], s31 offen lds
s_add_u32 m0, s23, 1024
s_add_u32 s31, s24, 1792
buffer_load_dwordx4 v10, s[16:19], s31 offen lds
s_add_u32 m0, s23, 2048
s_add_u32 s31, s24, 3584
buffer_load_dwordx4 v9, s[16:19], s31 offen lds
s_add_u32 m0, s23, 3072
s_add_u32 s31, s24, 5376
buffer_load_dwordx4 v10, s[16:19], s31 offen lds
s_add_u32 m0, s23, 16384
s_add_u32 s31, s24, 28672
buffer_load_dwordx4 v9, s[16:19], s31 offen lds
s_add_u32 m0, s23, 17408
s_add_u32 s31, s24, 30464
buffer_load_dwordx4 v10, s[16:19], s31 offen lds
s_add_u32 m0, s23, 18432
s_add_u32 s31, s24, 32256
buffer_load_dwordx4 v9, s[16:19], s31 offen lds
s_add_u32 m0, s23, 19456
s_add_u32 s31, s24, 34048
buffer_load_dwordx4 v10, s[16:19], s31 offen lds
s_add_u32 m0, s22, 1920
s_nop 0
buffer_load_dwordx4 v7, s[12:15], s20 offen offset:128 lds
s_add_u32 m0, s22, 2944
s_nop 0
buffer_load_dwordx4 v8, s[12:15], s20 offen offset:128 lds
s_add_u32 m0, s23, 32768
s_add_u32 s31, s24, 57344
buffer_load_dwordx4 v9, s[16:19], s31 offen lds
s_add_u32 m0, s23, 33792
s_add_u32 s31, s24, 59136
buffer_load_dwordx4 v10, s[16:19], s31 offen lds
s_add_u32 m0, s23, 34816
s_add_u32 s31, s24, 60928
buffer_load_dwordx4 v9, s[16:19], s31 offen lds
s_add_u32 m0, s23, 35840
s_add_u32 s31, s24, 62720
buffer_load_dwordx4 v10, s[16:19], s31 offen lds
s_add_u32 m0, s23, 49152
s_add_u32 s31, s24, 86016
buffer_load_dwordx4 v9, s[16:19], s31 offen lds
s_add_u32 m0, s23, 50176
s_add_u32 s31, s24, 87808
buffer_load_dwordx4 v10, s[16:19], s31 offen lds
s_add_u32 m0, s23, 51200
s_add_u32 s31, s24, 89600
buffer_load_dwordx4 v9, s[16:19], s31 offen lds
s_add_u32 m0, s23, 52224
s_add_u32 s31, s24, 91392
buffer_load_dwordx4 v10, s[16:19], s31 offen lds
s_add_u32 m0, s22, 3840
s_nop 0
buffer_load_dwordx4 v7, s[12:15], s20 offen offset:256 lds
s_add_u32 m0, s22, 4864
s_nop 0
buffer_load_dwordx4 v8, s[12:15], s20 offen offset:256 lds
s_add_u32 m0, s23, 65536
s_add_u32 s31, s24, 114688
buffer_load_dwordx4 v9, s[16:19], s31 offen lds
s_add_u32 m0, s23, 66560
s_add_u32 s31, s24, 116480
buffer_load_dwordx4 v10, s[16:19], s31 offen lds
s_add_u32 m0, s23, 67584
s_add_u32 s31, s24, 118272
buffer_load_dwordx4 v9, s[16:19], s31 offen lds
s_add_u32 m0, s23, 68608
s_add_u32 s31, s24, 120064
buffer_load_dwordx4 v10, s[16:19], s31 offen lds
s_add_u32 m0, s23, 81920
s_add_u32 s31, s24, 143360
buffer_load_dwordx4 v9, s[16:19], s31 offen lds
s_add_u32 m0, s23, 82944
s_add_u32 s31, s24, 145152
buffer_load_dwordx4 v10, s[16:19], s31 offen lds
s_add_u32 m0, s23, 83968
s_add_u32 s31, s24, 146944
buffer_load_dwordx4 v9, s[16:19], s31 offen lds
s_add_u32 m0, s23, 84992
s_add_u32 s31, s24, 148736
buffer_load_dwordx4 v10, s[16:19], s31 offen lds
s_add_u32 m0, s22, 5760
s_nop 0
buffer_load_dwordx4 v7, s[12:15], s20 offen offset:384 lds
s_add_u32 m0, s22, 6784
s_nop 0
buffer_load_dwordx4 v8, s[12:15], s20 offen offset:384 lds
s_add_u32 m0, s23, 98304
s_add_u32 s31, s24, 172032
buffer_load_dwordx4 v9, s[16:19], s31 offen lds
s_add_u32 m0, s23, 99328
s_add_u32 s31, s24, 173824
buffer_load_dwordx4 v10, s[16:19], s31 offen lds
s_add_u32 m0, s23, 100352
s_add_u32 s31, s24, 175616
buffer_load_dwordx4 v9, s[16:19], s31 offen lds
s_add_u32 m0, s23, 101376
s_add_u32 s31, s24, 177408
buffer_load_dwordx4 v10, s[16:19], s31 offen lds
s_waitcnt vmcnt(30)
s_barrier
ds_read_b128 v[24:27], v11 offset:0
ds_read_b128 v[28:31], v11 offset:16384
ds_read_b64_tr_b16 v[40:41], v15 offset:0
ds_read_b64_tr_b16 v[42:43], v15 offset:2048
ds_read_b64_tr_b16 v[44:45], v16 offset:0
ds_read_b64_tr_b16 v[46:47], v16 offset:2048
ds_read_b64_tr_b16 v[48:49], v17 offset:0
ds_read_b64_tr_b16 v[50:51], v17 offset:2048
ds_read_b64_tr_b16 v[52:53], v18 offset:0
ds_read_b64_tr_b16 v[54:55], v18 offset:2048
ds_read_b64_tr_b16 v[56:57], v19 offset:0
ds_read_b64_tr_b16 v[58:59], v19 offset:2048
ds_read_b64_tr_b16 v[60:61], v20 offset:0
ds_read_b64_tr_b16 v[62:63], v20 offset:2048
ds_read_b64_tr_b16 v[64:65], v21 offset:0
ds_read_b64_tr_b16 v[66:67], v21 offset:2048
s_waitcnt vmcnt(26) lgkmcnt(0)
s_barrier
s_add_u32 m0, s23, 0
s_add_u32 s31, s24, 200704
buffer_load_dwordx4 v9, s[16:19], s31 offen lds
s_add_u32 m0, s23, 1024
s_add_u32 s31, s24, 202496
buffer_load_dwordx4 v10, s[16:19], s31 offen lds
s_add_u32 m0, s23, 2048
s_add_u32 s31, s24, 204288
buffer_load_dwordx4 v9, s[16:19], s31 offen lds
s_add_u32 m0, s23, 3072
s_add_u32 s31, s24, 206080
buffer_load_dwordx4 v10, s[16:19], s31 offen lds
v_bfe_u32 v4, v1, 2, 3
v_lshlrev_b32 v4, 13, v4
v_and_b32 v5, 3, v1
v_lshl_add_u32 v4, v5, 7, v4
s_lshl_b32 s31, s11, 19
s_lshl_b32 s32, s33, 18
s_add_u32 s31, s31, s32
s_lshl_b32 s32, s9, 16
s_add_u32 s31, s31, s32
s_add_u32 s31, s31, s21
buffer_load_dword v22, v4, s[40:43], s31 offen
buffer_load_dword v22, v4, s[44:47], s31 offen
v_mfma_f32_16x16x32_bf16 v[96:99], v[24:27], v[40:43], 0
ds_read_b128 v[32:35], v12 offset:0
ds_read_b128 v[36:39], v12 offset:16384
v_mfma_f32_16x16x32_bf16 v[100:103], v[28:31], v[40:43], 0
ds_read_b64_tr_b16 v[68:69], v15 offset:16384
ds_read_b64_tr_b16 v[70:71], v15 offset:18432
v_mfma_f32_16x16x32_bf16 v[104:107], v[24:27], v[44:47], 0
ds_read_b64_tr_b16 v[72:73], v16 offset:16384
ds_read_b64_tr_b16 v[74:75], v16 offset:18432
v_mfma_f32_16x16x32_bf16 v[108:111], v[28:31], v[44:47], 0
ds_read_b64_tr_b16 v[76:77], v17 offset:16384
ds_read_b64_tr_b16 v[78:79], v17 offset:18432
v_mfma_f32_16x16x32_bf16 v[112:115], v[24:27], v[48:51], 0
ds_read_b64_tr_b16 v[80:81], v18 offset:16384
ds_read_b64_tr_b16 v[82:83], v18 offset:18432
v_mfma_f32_16x16x32_bf16 v[116:119], v[28:31], v[48:51], 0
ds_read_b64_tr_b16 v[84:85], v19 offset:16384
ds_read_b64_tr_b16 v[86:87], v19 offset:18432
v_mfma_f32_16x16x32_bf16 v[120:123], v[24:27], v[52:55], 0
ds_read_b64_tr_b16 v[88:89], v20 offset:16384
ds_read_b64_tr_b16 v[90:91], v20 offset:18432
v_mfma_f32_16x16x32_bf16 v[124:127], v[28:31], v[52:55], 0
ds_read_b64_tr_b16 v[92:93], v21 offset:16384
ds_read_b64_tr_b16 v[94:95], v21 offset:18432
v_mfma_f32_16x16x32_bf16 v[128:131], v[24:27], v[56:59], 0
v_mfma_f32_16x16x32_bf16 v[132:135], v[28:31], v[56:59], 0
v_mfma_f32_16x16x32_bf16 v[136:139], v[24:27], v[60:63], 0
v_mfma_f32_16x16x32_bf16 v[140:143], v[28:31], v[60:63], 0
v_mfma_f32_16x16x32_bf16 v[144:147], v[24:27], v[64:67], 0
v_mfma_f32_16x16x32_bf16 v[148:151], v[28:31], v[64:67], 0
s_waitcnt vmcnt(26) lgkmcnt(0)
s_barrier
v_mfma_f32_16x16x32_bf16 v[96:99], v[32:35], v[68:71], v[96:99]
ds_read_b128 v[24:27], v11 offset:2048
ds_read_b128 v[28:31], v11 offset:18432
v_mfma_f32_16x16x32_bf16 v[100:103], v[36:39], v[68:71], v[100:103]
ds_read_b64_tr_b16 v[40:41], v15 offset:32768
ds_read_b64_tr_b16 v[42:43], v15 offset:34816
v_mfma_f32_16x16x32_bf16 v[104:107], v[32:35], v[72:75], v[104:107]
ds_read_b64_tr_b16 v[44:45], v16 offset:32768
ds_read_b64_tr_b16 v[46:47], v16 offset:34816
v_mfma_f32_16x16x32_bf16 v[108:111], v[36:39], v[72:75], v[108:111]
ds_read_b64_tr_b16 v[48:49], v17 offset:32768
ds_read_b64_tr_b16 v[50:51], v17 offset:34816
v_mfma_f32_16x16x32_bf16 v[112:115], v[32:35], v[76:79], v[112:115]
ds_read_b64_tr_b16 v[52:53], v18 offset:32768
ds_read_b64_tr_b16 v[54:55], v18 offset:34816
v_mfma_f32_16x16x32_bf16 v[116:119], v[36:39], v[76:79], v[116:119]
ds_read_b64_tr_b16 v[56:57], v19 offset:32768
ds_read_b64_tr_b16 v[58:59], v19 offset:34816
v_mfma_f32_16x16x32_bf16 v[120:123], v[32:35], v[80:83], v[120:123]
ds_read_b64_tr_b16 v[60:61], v20 offset:32768
ds_read_b64_tr_b16 v[62:63], v20 offset:34816
v_mfma_f32_16x16x32_bf16 v[124:127], v[36:39], v[80:83], v[124:127]
ds_read_b64_tr_b16 v[64:65], v21 offset:32768
ds_read_b64_tr_b16 v[66:67], v21 offset:34816
v_mfma_f32_16x16x32_bf16 v[128:131], v[32:35], v[84:87], v[128:131]
v_mfma_f32_16x16x32_bf16 v[132:135], v[36:39], v[84:87], v[132:135]
v_mfma_f32_16x16x32_bf16 v[136:139], v[32:35], v[88:91], v[136:139]
v_mfma_f32_16x16x32_bf16 v[140:143], v[36:39], v[88:91], v[140:143]
v_mfma_f32_16x16x32_bf16 v[144:147], v[32:35], v[92:95], v[144:147]
v_mfma_f32_16x16x32_bf16 v[148:151], v[36:39], v[92:95], v[148:151]
s_waitcnt vmcnt(22) lgkmcnt(0)
s_barrier
v_mfma_f32_16x16x32_bf16 v[96:99], v[24:27], v[40:43], v[96:99]
v_add_u32 v15, 49152, v15
v_add_u32 v16, 49152, v16
v_mfma_f32_16x16x32_bf16 v[100:103], v[28:31], v[40:43], v[100:103]
v_add_u32 v17, 49152, v17
v_add_u32 v18, 49152, v18
v_mfma_f32_16x16x32_bf16 v[104:107], v[24:27], v[44:47], v[104:107]
v_add_u32 v19, 49152, v19
v_add_u32 v20, 49152, v20
v_mfma_f32_16x16x32_bf16 v[108:111], v[28:31], v[44:47], v[108:111]
v_add_u32 v21, 49152, v21
ds_read_b128 v[32:35], v12 offset:2048
v_mfma_f32_16x16x32_bf16 v[112:115], v[24:27], v[48:51], v[112:115]
ds_read_b128 v[36:39], v12 offset:18432
ds_read_b64_tr_b16 v[68:69], v15 offset:0
v_mfma_f32_16x16x32_bf16 v[116:119], v[28:31], v[48:51], v[116:119]
ds_read_b64_tr_b16 v[70:71], v15 offset:2048
ds_read_b64_tr_b16 v[72:73], v16 offset:0
v_mfma_f32_16x16x32_bf16 v[120:123], v[24:27], v[52:55], v[120:123]
ds_read_b64_tr_b16 v[74:75], v16 offset:2048
ds_read_b64_tr_b16 v[76:77], v17 offset:0
v_mfma_f32_16x16x32_bf16 v[124:127], v[28:31], v[52:55], v[124:127]
ds_read_b64_tr_b16 v[78:79], v17 offset:2048
ds_read_b64_tr_b16 v[80:81], v18 offset:0
v_mfma_f32_16x16x32_bf16 v[128:131], v[24:27], v[56:59], v[128:131]
ds_read_b64_tr_b16 v[82:83], v18 offset:2048
ds_read_b64_tr_b16 v[84:85], v19 offset:0
v_mfma_f32_16x16x32_bf16 v[132:135], v[28:31], v[56:59], v[132:135]
ds_read_b64_tr_b16 v[86:87], v19 offset:2048
ds_read_b64_tr_b16 v[88:89], v20 offset:0
v_mfma_f32_16x16x32_bf16 v[136:139], v[24:27], v[60:63], v[136:139]
ds_read_b64_tr_b16 v[90:91], v20 offset:2048
ds_read_b64_tr_b16 v[92:93], v21 offset:0
v_mfma_f32_16x16x32_bf16 v[140:143], v[28:31], v[60:63], v[140:143]
ds_read_b64_tr_b16 v[94:95], v21 offset:2048
v_mfma_f32_16x16x32_bf16 v[144:147], v[24:27], v[64:67], v[144:147]
v_mfma_f32_16x16x32_bf16 v[148:151], v[28:31], v[64:67], v[148:151]
s_waitcnt vmcnt(16) lgkmcnt(0)
s_barrier
v_mfma_f32_16x16x32_bf16 v[96:99], v[32:35], v[68:71], v[96:99]
ds_read_b128 v[24:27], v11 offset:4096
ds_read_b128 v[28:31], v11 offset:20480
v_mfma_f32_16x16x32_bf16 v[100:103], v[36:39], v[68:71], v[100:103]
ds_read_b64_tr_b16 v[40:41], v15 offset:16384
ds_read_b64_tr_b16 v[42:43], v15 offset:18432
v_mfma_f32_16x16x32_bf16 v[104:107], v[32:35], v[72:75], v[104:107]
ds_read_b64_tr_b16 v[44:45], v16 offset:16384
ds_read_b64_tr_b16 v[46:47], v16 offset:18432
v_mfma_f32_16x16x32_bf16 v[108:111], v[36:39], v[72:75], v[108:111]
ds_read_b64_tr_b16 v[48:49], v17 offset:16384
ds_read_b64_tr_b16 v[50:51], v17 offset:18432
v_mfma_f32_16x16x32_bf16 v[112:115], v[32:35], v[76:79], v[112:115]
ds_read_b64_tr_b16 v[52:53], v18 offset:16384
ds_read_b64_tr_b16 v[54:55], v18 offset:18432
v_mfma_f32_16x16x32_bf16 v[116:119], v[36:39], v[76:79], v[116:119]
ds_read_b64_tr_b16 v[56:57], v19 offset:16384
ds_read_b64_tr_b16 v[58:59], v19 offset:18432
v_mfma_f32_16x16x32_bf16 v[120:123], v[32:35], v[80:83], v[120:123]
ds_read_b64_tr_b16 v[60:61], v20 offset:16384
ds_read_b64_tr_b16 v[62:63], v20 offset:18432
v_mfma_f32_16x16x32_bf16 v[124:127], v[36:39], v[80:83], v[124:127]
ds_read_b64_tr_b16 v[64:65], v21 offset:16384
ds_read_b64_tr_b16 v[66:67], v21 offset:18432
v_mfma_f32_16x16x32_bf16 v[128:131], v[32:35], v[84:87], v[128:131]
v_mfma_f32_16x16x32_bf16 v[132:135], v[36:39], v[84:87], v[132:135]
v_mfma_f32_16x16x32_bf16 v[136:139], v[32:35], v[88:91], v[136:139]
v_mfma_f32_16x16x32_bf16 v[140:143], v[36:39], v[88:91], v[140:143]
v_mfma_f32_16x16x32_bf16 v[144:147], v[32:35], v[92:95], v[144:147]
v_mfma_f32_16x16x32_bf16 v[148:151], v[36:39], v[92:95], v[148:151]
s_waitcnt vmcnt(12) lgkmcnt(0)
s_barrier
v_mfma_f32_16x16x32_bf16 v[96:99], v[24:27], v[40:43], v[96:99]
ds_read_b128 v[32:35], v12 offset:4096
ds_read_b128 v[36:39], v12 offset:20480
v_mfma_f32_16x16x32_bf16 v[100:103], v[28:31], v[40:43], v[100:103]
ds_read_b64_tr_b16 v[68:69], v15 offset:32768
ds_read_b64_tr_b16 v[70:71], v15 offset:34816
v_mfma_f32_16x16x32_bf16 v[104:107], v[24:27], v[44:47], v[104:107]
ds_read_b64_tr_b16 v[72:73], v16 offset:32768
ds_read_b64_tr_b16 v[74:75], v16 offset:34816
v_mfma_f32_16x16x32_bf16 v[108:111], v[28:31], v[44:47], v[108:111]
ds_read_b64_tr_b16 v[76:77], v17 offset:32768
ds_read_b64_tr_b16 v[78:79], v17 offset:34816
v_mfma_f32_16x16x32_bf16 v[112:115], v[24:27], v[48:51], v[112:115]
ds_read_b64_tr_b16 v[80:81], v18 offset:32768
ds_read_b64_tr_b16 v[82:83], v18 offset:34816
v_mfma_f32_16x16x32_bf16 v[116:119], v[28:31], v[48:51], v[116:119]
ds_read_b64_tr_b16 v[84:85], v19 offset:32768
ds_read_b64_tr_b16 v[86:87], v19 offset:34816
v_mfma_f32_16x16x32_bf16 v[120:123], v[24:27], v[52:55], v[120:123]
ds_read_b64_tr_b16 v[88:89], v20 offset:32768
ds_read_b64_tr_b16 v[90:91], v20 offset:34816
v_mfma_f32_16x16x32_bf16 v[124:127], v[28:31], v[52:55], v[124:127]
ds_read_b64_tr_b16 v[92:93], v21 offset:32768
ds_read_b64_tr_b16 v[94:95], v21 offset:34816
v_mfma_f32_16x16x32_bf16 v[128:131], v[24:27], v[56:59], v[128:131]
v_mfma_f32_16x16x32_bf16 v[132:135], v[28:31], v[56:59], v[132:135]
v_mfma_f32_16x16x32_bf16 v[136:139], v[24:27], v[60:63], v[136:139]
v_mfma_f32_16x16x32_bf16 v[140:143], v[28:31], v[60:63], v[140:143]
v_mfma_f32_16x16x32_bf16 v[144:147], v[24:27], v[64:67], v[144:147]
v_mfma_f32_16x16x32_bf16 v[148:151], v[28:31], v[64:67], v[148:151]
s_waitcnt vmcnt(6) lgkmcnt(0)
s_barrier
v_mfma_f32_16x16x32_bf16 v[96:99], v[32:35], v[68:71], v[96:99]
v_add_u32 v15, 49152, v15
v_add_u32 v16, 49152, v16
v_mfma_f32_16x16x32_bf16 v[100:103], v[36:39], v[68:71], v[100:103]
v_add_u32 v17, 49152, v17
v_add_u32 v18, 49152, v18
v_mfma_f32_16x16x32_bf16 v[104:107], v[32:35], v[72:75], v[104:107]
v_add_u32 v19, 49152, v19
v_add_u32 v20, 49152, v20
v_mfma_f32_16x16x32_bf16 v[108:111], v[36:39], v[72:75], v[108:111]
v_add_u32 v21, 49152, v21
ds_read_b128 v[24:27], v11 offset:6144
v_mfma_f32_16x16x32_bf16 v[112:115], v[32:35], v[76:79], v[112:115]
ds_read_b128 v[28:31], v11 offset:22528
ds_read_b64_tr_b16 v[40:41], v15 offset:0
v_mfma_f32_16x16x32_bf16 v[116:119], v[36:39], v[76:79], v[116:119]
ds_read_b64_tr_b16 v[42:43], v15 offset:2048
ds_read_b64_tr_b16 v[44:45], v16 offset:0
v_mfma_f32_16x16x32_bf16 v[120:123], v[32:35], v[80:83], v[120:123]
ds_read_b64_tr_b16 v[46:47], v16 offset:2048
ds_read_b64_tr_b16 v[48:49], v17 offset:0
v_mfma_f32_16x16x32_bf16 v[124:127], v[36:39], v[80:83], v[124:127]
ds_read_b64_tr_b16 v[50:51], v17 offset:2048
ds_read_b64_tr_b16 v[52:53], v18 offset:0
v_mfma_f32_16x16x32_bf16 v[128:131], v[32:35], v[84:87], v[128:131]
ds_read_b64_tr_b16 v[54:55], v18 offset:2048
ds_read_b64_tr_b16 v[56:57], v19 offset:0
v_mfma_f32_16x16x32_bf16 v[132:135], v[36:39], v[84:87], v[132:135]
ds_read_b64_tr_b16 v[58:59], v19 offset:2048
ds_read_b64_tr_b16 v[60:61], v20 offset:0
v_mfma_f32_16x16x32_bf16 v[136:139], v[32:35], v[88:91], v[136:139]
ds_read_b64_tr_b16 v[62:63], v20 offset:2048
ds_read_b64_tr_b16 v[64:65], v21 offset:0
v_mfma_f32_16x16x32_bf16 v[140:143], v[36:39], v[88:91], v[140:143]
ds_read_b64_tr_b16 v[66:67], v21 offset:2048
v_mfma_f32_16x16x32_bf16 v[144:147], v[32:35], v[92:95], v[144:147]
v_mfma_f32_16x16x32_bf16 v[148:151], v[36:39], v[92:95], v[148:151]
s_waitcnt vmcnt(2) lgkmcnt(0)
s_barrier
v_mfma_f32_16x16x32_bf16 v[96:99], v[24:27], v[40:43], v[96:99]
v_subrev_u32 v15, 98304, v15
v_subrev_u32 v16, 98304, v16
v_mfma_f32_16x16x32_bf16 v[100:103], v[28:31], v[40:43], v[100:103]
v_subrev_u32 v17, 98304, v17
v_subrev_u32 v18, 98304, v18
v_mfma_f32_16x16x32_bf16 v[104:107], v[24:27], v[44:47], v[104:107]
v_subrev_u32 v19, 98304, v19
v_subrev_u32 v20, 98304, v20
v_mfma_f32_16x16x32_bf16 v[108:111], v[28:31], v[44:47], v[108:111]
v_subrev_u32 v21, 98304, v21
ds_read_b128 v[32:35], v12 offset:6144
v_mfma_f32_16x16x32_bf16 v[112:115], v[24:27], v[48:51], v[112:115]
ds_read_b128 v[36:39], v12 offset:22528
ds_read_b64_tr_b16 v[68:69], v15 offset:0
v_mfma_f32_16x16x32_bf16 v[116:119], v[28:31], v[48:51], v[116:119]
ds_read_b64_tr_b16 v[70:71], v15 offset:2048
ds_read_b64_tr_b16 v[72:73], v16 offset:0
v_mfma_f32_16x16x32_bf16 v[120:123], v[24:27], v[52:55], v[120:123]
ds_read_b64_tr_b16 v[74:75], v16 offset:2048
ds_read_b64_tr_b16 v[76:77], v17 offset:0
v_mfma_f32_16x16x32_bf16 v[124:127], v[28:31], v[52:55], v[124:127]
ds_read_b64_tr_b16 v[78:79], v17 offset:2048
ds_read_b64_tr_b16 v[80:81], v18 offset:0
v_mfma_f32_16x16x32_bf16 v[128:131], v[24:27], v[56:59], v[128:131]
ds_read_b64_tr_b16 v[82:83], v18 offset:2048
ds_read_b64_tr_b16 v[84:85], v19 offset:0
v_mfma_f32_16x16x32_bf16 v[132:135], v[28:31], v[56:59], v[132:135]
ds_read_b64_tr_b16 v[86:87], v19 offset:2048
ds_read_b64_tr_b16 v[88:89], v20 offset:0
v_mfma_f32_16x16x32_bf16 v[136:139], v[24:27], v[60:63], v[136:139]
ds_read_b64_tr_b16 v[90:91], v20 offset:2048
ds_read_b64_tr_b16 v[92:93], v21 offset:0
v_mfma_f32_16x16x32_bf16 v[140:143], v[28:31], v[60:63], v[140:143]
ds_read_b64_tr_b16 v[94:95], v21 offset:2048
v_mfma_f32_16x16x32_bf16 v[144:147], v[24:27], v[64:67], v[144:147]
v_mfma_f32_16x16x32_bf16 v[148:151], v[28:31], v[64:67], v[148:151]
s_waitcnt lgkmcnt(0)
v_mfma_f32_16x16x32_bf16 v[96:99], v[32:35], v[68:71], v[96:99]
v_mfma_f32_16x16x32_bf16 v[100:103], v[36:39], v[68:71], v[100:103]
v_mfma_f32_16x16x32_bf16 v[104:107], v[32:35], v[72:75], v[104:107]
v_mfma_f32_16x16x32_bf16 v[108:111], v[36:39], v[72:75], v[108:111]
v_mfma_f32_16x16x32_bf16 v[112:115], v[32:35], v[76:79], v[112:115]
v_mfma_f32_16x16x32_bf16 v[116:119], v[36:39], v[76:79], v[116:119]
v_mfma_f32_16x16x32_bf16 v[120:123], v[32:35], v[80:83], v[120:123]
v_mfma_f32_16x16x32_bf16 v[124:127], v[36:39], v[80:83], v[124:127]
v_mfma_f32_16x16x32_bf16 v[128:131], v[32:35], v[84:87], v[128:131]
v_mfma_f32_16x16x32_bf16 v[132:135], v[36:39], v[84:87], v[132:135]
v_mfma_f32_16x16x32_bf16 v[136:139], v[32:35], v[88:91], v[136:139]
v_mfma_f32_16x16x32_bf16 v[140:143], v[36:39], v[88:91], v[140:143]
v_mfma_f32_16x16x32_bf16 v[144:147], v[32:35], v[92:95], v[144:147]
v_mfma_f32_16x16x32_bf16 v[148:151], v[36:39], v[92:95], v[148:151]
s_barrier
s_mul_i32 s20, s35, 224
s_lshl_b32 s21, s10, 1
s_add_u32 s20, s20, s21
s_add_u32 s20, s20, s33
s_mul_i32 s20, s20, 7
s_add_u32 s20, s20, s11
s_lshl_b32 s20, s20, 11
s_lshl_b32 s21, s34, 10
s_add_u32 s20, s20, s21
s_add_u32 s20, s20, 7340032
s_mov_b32 s21, 1035512379
v_cvt_pk_bf16_f32 v40, v96, v97
v_cvt_pk_bf16_f32 v42, v98, v99
v_cvt_pk_bf16_f32 v41, v100, v101
v_cvt_pk_bf16_f32 v43, v102, v103
buffer_store_dwordx4 v[40:43], v6, s[4:7], s20 offen sc1
s_add_u32 s20, s20, 458752
v_cvt_pk_bf16_f32 v44, v104, v105
v_cvt_pk_bf16_f32 v46, v106, v107
v_cvt_pk_bf16_f32 v45, v108, v109
v_cvt_pk_bf16_f32 v47, v110, v111
buffer_store_dwordx4 v[44:47], v6, s[4:7], s20 offen sc1
s_add_u32 s20, s20, 458752
v_cvt_pk_bf16_f32 v48, v112, v113
v_cvt_pk_bf16_f32 v50, v114, v115
v_cvt_pk_bf16_f32 v49, v116, v117
v_cvt_pk_bf16_f32 v51, v118, v119
buffer_store_dwordx4 v[48:51], v6, s[4:7], s20 offen sc1
s_add_u32 s20, s20, 458752
v_cvt_pk_bf16_f32 v52, v120, v121
v_cvt_pk_bf16_f32 v54, v122, v123
v_cvt_pk_bf16_f32 v53, v124, v125
v_cvt_pk_bf16_f32 v55, v126, v127
buffer_store_dwordx4 v[52:55], v6, s[4:7], s20 offen sc1
s_add_u32 s20, s20, 458752
v_cvt_pk_bf16_f32 v56, v128, v129
v_cvt_pk_bf16_f32 v58, v130, v131
v_cvt_pk_bf16_f32 v57, v132, v133
v_cvt_pk_bf16_f32 v59, v134, v135
buffer_store_dwordx4 v[56:59], v6, s[4:7], s20 offen sc1
s_add_u32 s20, s20, 458752
v_cvt_pk_bf16_f32 v60, v136, v137
v_cvt_pk_bf16_f32 v62, v138, v139
v_cvt_pk_bf16_f32 v61, v140, v141
v_cvt_pk_bf16_f32 v63, v142, v143
buffer_store_dwordx4 v[60:63], v6, s[4:7], s20 offen sc1
s_add_u32 s20, s20, 458752
v_cvt_pk_bf16_f32 v64, v144, v145
v_cvt_pk_bf16_f32 v66, v146, v147
v_cvt_pk_bf16_f32 v65, v148, v149
v_cvt_pk_bf16_f32 v67, v150, v151
buffer_store_dwordx4 v[64:67], v6, s[4:7], s20 offen sc1
s_add_u32 s20, s20, 458752
buffer_load_dword v253, v252, s[84:87], 0 offen sc1
v_and_b32 v1, 63, v0
v_lshrrev_b32 v2, 4, v1
v_and_b32 v3, 15, v1
v_lshlrev_b32 v6, 4, v1
s_and_b32 s34, s9, 1
s_lshr_b32 s35, s9, 1
v_and_b32 v4, 7, v1
v_xor_b32 v4, v4, v2
v_lshlrev_b32 v4, 4, v4
v_lshrrev_b32 v5, 3, v1
v_lshl_add_u32 v7, v5, 13, v4
v_xor_b32 v8, 64, v7
v_add_u32 v8, 65536, v8
v_lshrrev_b32 v5, 1, v3
v_xor_b32 v5, v5, v2
v_lshlrev_b32 v5, 4, v5
v_lshl_add_u32 v5, v3, 7, v5
s_lshl_b32 s20, s34, 13
v_add_u32 v11, s20, v5
v_xor_b32 v12, 64, v11
s_lshl_b32 s20, s11, 19
s_lshl_b32 s21, s9, 17
s_add_u32 s20, s20, s21
s_lshl_b32 s21, s10, 9
s_add_u32 s20, s20, s21
s_lshl_b32 s22, s9, 13
v_lshrrev_b32 v5, 5, v1
v_bfe_u32 v9, v1, 3, 2
v_lshl_add_u32 v5, v5, 3, v9
v_lshl_add_u32 v9, v5, 13, v4
s_lshl_b32 s23, s34, 6
v_xor_b32 v9, s23, v9
s_lshl_b32 s23, s34, 17
v_add_u32 v9, s23, v9
s_mul_i32 s23, s35, 57344
s_add_u32 s23, s23, 32768
v_and_b32 v5, 0x1fff, v11
v_add_u32 v13, s23, v5
v_xor_b32 v14, 64, v13
s_lshl_b32 s31, s34, 10
s_add_u32 s23, s23, s31
s_mul_i32 s31, s33, 14
s_mul_i32 s32, s35, 7
s_add_u32 s31, s31, s32
s_add_u32 s31, s31, 0
s_lshr_b32 s32, s31, 1
s_lshl_b32 s32, s32, 18
s_and_b32 s31, s31, 1
s_lshl_b32 s31, s31, 15
s_add_u32 s31, s31, s32
s_add_u32 s24, s31, s21
s_mul_i32 s31, s33, 14
s_mul_i32 s32, s35, 7
s_add_u32 s31, s31, s32
s_add_u32 s31, s31, 1
s_lshr_b32 s32, s31, 1
s_lshl_b32 s32, s32, 18
s_and_b32 s31, s31, 1
s_lshl_b32 s31, s31, 15
s_add_u32 s31, s31, s32
s_add_u32 s25, s31, s21
s_mul_i32 s31, s33, 14
s_mul_i32 s32, s35, 7
s_add_u32 s31, s31, s32
s_add_u32 s31, s31, 2
s_lshr_b32 s32, s31, 1
s_lshl_b32 s32, s32, 18
s_and_b32 s31, s31, 1
s_lshl_b32 s31, s31, 15
s_add_u32 s31, s31, s32
s_add_u32 s26, s31, s21
s_mul_i32 s31, s33, 14
s_mul_i32 s32, s35, 7
s_add_u32 s31, s31, s32
s_add_u32 s31, s31, 3
s_lshr_b32 s32, s31, 1
s_lshl_b32 s32, s32, 18
s_and_b32 s31, s31, 1
s_lshl_b32 s31, s31, 15
s_add_u32 s31, s31, s32
s_add_u32 s27, s31, s21
s_mul_i32 s31, s33, 14
s_mul_i32 s32, s35, 7
s_add_u32 s31, s31, s32
s_add_u32 s31, s31, 4
s_lshr_b32 s32, s31, 1
s_lshl_b32 s32, s32, 18
s_and_b32 s31, s31, 1
s_lshl_b32 s31, s31, 15
s_add_u32 s31, s31, s32
s_add_u32 s28, s31, s21
s_mul_i32 s31, s33, 14
s_mul_i32 s32, s35, 7
s_add_u32 s31, s31, s32
s_add_u32 s31, s31, 5
s_lshr_b32 s32, s31, 1
s_lshl_b32 s32, s32, 18
s_and_b32 s31, s31, 1
s_lshl_b32 s31, s31, 15
s_add_u32 s31, s31, s32
s_add_u32 s29, s31, s21
s_mul_i32 s31, s33, 14
s_mul_i32 s32, s35, 7
s_add_u32 s31, s31, s32
s_add_u32 s31, s31, 6
s_lshr_b32 s32, s31, 1
s_lshl_b32 s32, s32, 18
s_and_b32 s31, s31, 1
s_lshl_b32 s31, s31, 15
s_add_u32 s31, s31, s32
s_add_u32 s30, s31, s21
s_add_u32 m0, s22, 0
s_nop 0
buffer_load_dwordx4 v7, s[40:43], s20 offen offset:0 lds
s_add_u32 m0, s22, 1024
s_nop 0
buffer_load_dwordx4 v8, s[40:43], s20 offen offset:0 lds
s_add_u32 m0, s23, 0
s_nop 0
buffer_load_dwordx4 v9, s[44:47], s24 offen offset:0 lds
s_add_u32 m0, s23, 8192
s_nop 0
buffer_load_dwordx4 v9, s[44:47], s25 offen offset:0 lds
s_add_u32 m0, s23, 16384
s_nop 0
buffer_load_dwordx4 v9, s[44:47], s26 offen offset:0 lds
s_add_u32 m0, s23, 24576
s_nop 0
buffer_load_dwordx4 v9, s[44:47], s27 offen offset:0 lds
s_add_u32 m0, s23, 32768
s_nop 0
buffer_load_dwordx4 v9, s[44:47], s28 offen offset:0 lds
s_add_u32 m0, s23, 40960
s_nop 0
buffer_load_dwordx4 v9, s[44:47], s29 offen offset:0 lds
s_add_u32 m0, s23, 49152
s_nop 0
buffer_load_dwordx4 v9, s[44:47], s30 offen offset:0 lds
s_waitcnt vmcnt(9)
s_barrier
s_cmp_lg_u32 s9, 0
s_cbranch_scc1 DW_1
v_readfirstlane_b32 s92, v253
s_nop 0
s_cmp_eq_u32 s92, 1
s_cbranch_scc1 DK_3
v_mov_b32 v250, 1
v_mov_b32 v251, 20
s_mov_b64 exec, 1
buffer_atomic_add v250, v251, s[84:87], 0 offen sc0
s_mov_b64 exec, -1
s_mov_b32 s91, 200000
s_waitcnt vmcnt(0)
v_readfirstlane_b32 s92, v250
s_nop 0
s_cmp_lg_u32 s92, 0
s_cbranch_scc1 DL_2
v_lshlrev_b32 v250, 4, v0
v_mov_b32 v244, 0
v_mov_b32 v245, 0
v_mov_b32 v246, 0
v_mov_b32 v247, 0
s_mov_b32 s92, 71319552
DZ_4:
buffer_store_dwordx4 v[244:247], v250, s[4:7], s92 offen sc1
s_add_u32 s92, s92, 1024
s_cmp_lt_u32 s92, 71344128
s_cbranch_scc1 DZ_4
v_mov_b32 v253, 1
s_waitcnt vmcnt(0)
buffer_store_dword v253, v252, s[84:87], 0 offen sc1
s_branch DK_3
DL_2:
s_sleep 4
buffer_load_dword v253, v252, s[84:87], 0 offen sc1
s_sub_u32 s91, s91, 1
s_waitcnt vmcnt(0)
v_readfirstlane_b32 s92, v253
s_nop 0
s_cmp_eq_u32 s92, 1
s_cbranch_scc1 DK_3
s_cmp_gt_i32 s91, 0
s_cbranch_scc1 DL_2
DK_3:
v_lshlrev_b32 v250, 7, v0
v_add_u32 v250, s90, v250
v_mov_b32 v251, 1073741824
v_cmp_gt_u32 vcc, 1, v0
s_nop 1
v_cndmask_b32 v250, v251, v250, vcc
v_mov_b32 v251, 1
s_mov_b32 s92, 71319552
buffer_store_dword v251, v250, s[4:7], s92 offen sc1
DW_1:
s_add_u32 m0, s22, 1920
s_nop 0
buffer_load_dwordx4 v7, s[40:43], s20 offen offset:128 lds
s_add_u32 m0, s22, 2944
s_nop 0
buffer_load_dwordx4 v8, s[40:43], s20 offen offset:128 lds
s_add_u32 m0, s23, 1920
s_nop 0
buffer_load_dwordx4 v9, s[44:47], s24 offen offset:128 lds
s_add_u32 m0, s23, 10112
s_nop 0
buffer_load_dwordx4 v9, s[44:47], s25 offen offset:128 lds
s_add_u32 m0, s23, 18304
s_nop 0
buffer_load_dwordx4 v9, s[44:47], s26 offen offset:128 lds
s_add_u32 m0, s23, 26496
s_nop 0
buffer_load_dwordx4 v9, s[44:47], s27 offen offset:128 lds
s_add_u32 m0, s23, 34688
s_nop 0
buffer_load_dwordx4 v9, s[44:47], s28 offen offset:128 lds
s_add_u32 m0, s23, 42880
s_nop 0
buffer_load_dwordx4 v9, s[44:47], s29 offen offset:128 lds
s_add_u32 m0, s23, 51072
s_nop 0
buffer_load_dwordx4 v9, s[44:47], s30 offen offset:128 lds
s_add_u32 m0, s22, 3840
s_nop 0
buffer_load_dwordx4 v7, s[40:43], s20 offen offset:256 lds
s_add_u32 m0, s22, 4864
s_nop 0
buffer_load_dwordx4 v8, s[40:43], s20 offen offset:256 lds
s_add_u32 m0, s23, 3840
s_nop 0
buffer_load_dwordx4 v9, s[44:47], s24 offen offset:256 lds
s_add_u32 m0, s23, 12032
s_nop 0
buffer_load_dwordx4 v9, s[44:47], s25 offen offset:256 lds
s_add_u32 m0, s23, 20224
s_nop 0
buffer_load_dwordx4 v9, s[44:47], s26 offen offset:256 lds
s_add_u32 m0, s23, 28416
s_nop 0
buffer_load_dwordx4 v9, s[44:47], s27 offen offset:256 lds
s_add_u32 m0, s23, 36608
s_nop 0
buffer_load_dwordx4 v9, s[44:47], s28 offen offset:256 lds
s_add_u32 m0, s23, 44800
s_nop 0
buffer_load_dwordx4 v9, s[44:47], s29 offen offset:256 lds
s_add_u32 m0, s23, 52992
s_nop 0
buffer_load_dwordx4 v9, s[44:47], s30 offen offset:256 lds
s_add_u32 m0, s22, 5760
s_nop 0
buffer_load_dwordx4 v7, s[40:43], s20 offen offset:384 lds
s_add_u32 m0, s22, 6784
s_nop 0
buffer_load_dwordx4 v8, s[40:43], s20 offen offset:384 lds
s_add_u32 m0, s23, 5760
s_nop 0
buffer_load_dwordx4 v9, s[44:47], s24 offen offset:384 lds
s_add_u32 m0, s23, 13952
s_nop 0
buffer_load_dwordx4 v9, s[44:47], s25 offen offset:384 lds
s_add_u32 m0, s23, 22144
s_nop 0
buffer_load_dwordx4 v9, s[44:47], s26 offen offset:384 lds
s_add_u32 m0, s23, 30336
s_nop 0
buffer_load_dwordx4 v9, s[44:47], s27 offen offset:384 lds
s_add_u32 m0, s23, 38528
s_nop 0
buffer_load_dwordx4 v9, s[44:47], s28 offen offset:384 lds
s_add_u32 m0, s23, 46720
s_nop 0
buffer_load_dwordx4 v9, s[44:47], s29 offen offset:384 lds
s_add_u32 m0, s23, 54912
s_nop 0
buffer_load_dwordx4 v9, s[44:47], s30 offen offset:384 lds
s_waitcnt vmcnt(27)
s_barrier
ds_read_b128 v[24:27], v11 offset:0
ds_read_b128 v[28:31], v11 offset:16384
ds_read_b128 v[40:43], v13 offset:0
ds_read_b128 v[44:47], v13 offset:8192
ds_read_b128 v[48:51], v13 offset:16384
ds_read_b128 v[52:55], v13 offset:24576
ds_read_b128 v[56:59], v13 offset:32768
ds_read_b128 v[60:63], v13 offset:40960
ds_read_b128 v[64:67], v13 offset:49152
s_waitcnt lgkmcnt(0)
v_mfma_f32_16x16x32_bf16 v[96:99], v[24:27], v[40:43], 0
ds_read_b128 v[32:35], v12 offset:0
ds_read_b128 v[36:39], v12 offset:16384
v_mfma_f32_16x16x32_bf16 v[100:103], v[28:31], v[40:43], 0
ds_read_b128 v[68:71], v14 offset:0
ds_read_b128 v[72:75], v14 offset:8192
v_mfma_f32_16x16x32_bf16 v[104:107], v[24:27], v[44:47], 0
ds_read_b128 v[76:79], v14 offset:16384
ds_read_b128 v[80:83], v14 offset:24576
v_mfma_f32_16x16x32_bf16 v[108:111], v[28:31], v[44:47], 0
ds_read_b128 v[84:87], v14 offset:32768
ds_read_b128 v[88:91], v14 offset:40960
v_mfma_f32_16x16x32_bf16 v[112:115], v[24:27], v[48:51], 0
ds_read_b128 v[92:95], v14 offset:49152
v_mfma_f32_16x16x32_bf16 v[116:119], v[28:31], v[48:51], 0
v_mfma_f32_16x16x32_bf16 v[120:123], v[24:27], v[52:55], 0
v_mfma_f32_16x16x32_bf16 v[124:127], v[28:31], v[52:55], 0
v_mfma_f32_16x16x32_bf16 v[128:131], v[24:27], v[56:59], 0
v_mfma_f32_16x16x32_bf16 v[132:135], v[28:31], v[56:59], 0
v_mfma_f32_16x16x32_bf16 v[136:139], v[24:27], v[60:63], 0
v_mfma_f32_16x16x32_bf16 v[140:143], v[28:31], v[60:63], 0
v_mfma_f32_16x16x32_bf16 v[144:147], v[24:27], v[64:67], 0
v_mfma_f32_16x16x32_bf16 v[148:151], v[28:31], v[64:67], 0
s_waitcnt vmcnt(18) lgkmcnt(0)
s_barrier
buffer_atomic_or v249, v248, s[84:87], 0 offen sc0
v_mfma_f32_16x16x32_bf16 v[96:99], v[32:35], v[68:71], v[96:99]
ds_read_b128 v[24:27], v11 offset:2048
ds_read_b128 v[28:31], v11 offset:18432
v_mfma_f32_16x16x32_bf16 v[100:103], v[36:39], v[68:71], v[100:103]
ds_read_b128 v[40:43], v13 offset:2048
ds_read_b128 v[44:47], v13 offset:10240
v_mfma_f32_16x16x32_bf16 v[104:107], v[32:35], v[72:75], v[104:107]
ds_read_b128 v[48:51], v13 offset:18432
ds_read_b128 v[52:55], v13 offset:26624
v_mfma_f32_16x16x32_bf16 v[108:111], v[36:39], v[72:75], v[108:111]
ds_read_b128 v[56:59], v13 offset:34816
ds_read_b128 v[60:63], v13 offset:43008
v_mfma_f32_16x16x32_bf16 v[112:115], v[32:35], v[76:79], v[112:115]
ds_read_b128 v[64:67], v13 offset:51200
v_mfma_f32_16x16x32_bf16 v[116:119], v[36:39], v[76:79], v[116:119]
v_mfma_f32_16x16x32_bf16 v[120:123], v[32:35], v[80:83], v[120:123]
v_mfma_f32_16x16x32_bf16 v[124:127], v[36:39], v[80:83], v[124:127]
v_mfma_f32_16x16x32_bf16 v[128:131], v[32:35], v[84:87], v[128:131]
v_mfma_f32_16x16x32_bf16 v[132:135], v[36:39], v[84:87], v[132:135]
v_mfma_f32_16x16x32_bf16 v[136:139], v[32:35], v[88:91], v[136:139]
v_mfma_f32_16x16x32_bf16 v[140:143], v[36:39], v[88:91], v[140:143]
v_mfma_f32_16x16x32_bf16 v[144:147], v[32:35], v[92:95], v[144:147]
v_mfma_f32_16x16x32_bf16 v[148:151], v[36:39], v[92:95], v[148:151]
s_waitcnt lgkmcnt(0)
v_mfma_f32_16x16x32_bf16 v[96:99], v[24:27], v[40:43], v[96:99]
ds_read_b128 v[32:35], v12 offset:2048
ds_read_b128 v[36:39], v12 offset:18432
v_mfma_f32_16x16x32_bf16 v[100:103], v[28:31], v[40:43], v[100:103]
ds_read_b128 v[68:71], v14 offset:2048
ds_read_b128 v[72:75], v14 offset:10240
v_mfma_f32_16x16x32_bf16 v[104:107], v[24:27], v[44:47], v[104:107]
ds_read_b128 v[76:79], v14 offset:18432
ds_read_b128 v[80:83], v14 offset:26624
v_mfma_f32_16x16x32_bf16 v[108:111], v[28:31], v[44:47], v[108:111]
ds_read_b128 v[84:87], v14 offset:34816
ds_read_b128 v[88:91], v14 offset:43008
v_mfma_f32_16x16x32_bf16 v[112:115], v[24:27], v[48:51], v[112:115]
ds_read_b128 v[92:95], v14 offset:51200
v_mfma_f32_16x16x32_bf16 v[116:119], v[28:31], v[48:51], v[116:119]
v_mfma_f32_16x16x32_bf16 v[120:123], v[24:27], v[52:55], v[120:123]
v_mfma_f32_16x16x32_bf16 v[124:127], v[28:31], v[52:55], v[124:127]
v_mfma_f32_16x16x32_bf16 v[128:131], v[24:27], v[56:59], v[128:131]
v_mfma_f32_16x16x32_bf16 v[132:135], v[28:31], v[56:59], v[132:135]
v_mfma_f32_16x16x32_bf16 v[136:139], v[24:27], v[60:63], v[136:139]
v_mfma_f32_16x16x32_bf16 v[140:143], v[28:31], v[60:63], v[140:143]
v_mfma_f32_16x16x32_bf16 v[144:147], v[24:27], v[64:67], v[144:147]
v_mfma_f32_16x16x32_bf16 v[148:151], v[28:31], v[64:67], v[148:151]
s_waitcnt vmcnt(10) lgkmcnt(0)
s_barrier
v_mfma_f32_16x16x32_bf16 v[96:99], v[32:35], v[68:71], v[96:99]
ds_read_b128 v[24:27], v11 offset:4096
ds_read_b128 v[28:31], v11 offset:20480
v_mfma_f32_16x16x32_bf16 v[100:103], v[36:39], v[68:71], v[100:103]
ds_read_b128 v[40:43], v13 offset:4096
ds_read_b128 v[44:47], v13 offset:12288
v_mfma_f32_16x16x32_bf16 v[104:107], v[32:35], v[72:75], v[104:107]
ds_read_b128 v[48:51], v13 offset:20480
ds_read_b128 v[52:55], v13 offset:28672
v_mfma_f32_16x16x32_bf16 v[108:111], v[36:39], v[72:75], v[108:111]
ds_read_b128 v[56:59], v13 offset:36864
ds_read_b128 v[60:63], v13 offset:45056
v_mfma_f32_16x16x32_bf16 v[112:115], v[32:35], v[76:79], v[112:115]
ds_read_b128 v[64:67], v13 offset:53248
v_mfma_f32_16x16x32_bf16 v[116:119], v[36:39], v[76:79], v[116:119]
v_mfma_f32_16x16x32_bf16 v[120:123], v[32:35], v[80:83], v[120:123]
v_mfma_f32_16x16x32_bf16 v[124:127], v[36:39], v[80:83], v[124:127]
v_mfma_f32_16x16x32_bf16 v[128:131], v[32:35], v[84:87], v[128:131]
v_mfma_f32_16x16x32_bf16 v[132:135], v[36:39], v[84:87], v[132:135]
v_mfma_f32_16x16x32_bf16 v[136:139], v[32:35], v[88:91], v[136:139]
v_mfma_f32_16x16x32_bf16 v[140:143], v[36:39], v[88:91], v[140:143]
v_mfma_f32_16x16x32_bf16 v[144:147], v[32:35], v[92:95], v[144:147]
v_mfma_f32_16x16x32_bf16 v[148:151], v[36:39], v[92:95], v[148:151]
s_waitcnt lgkmcnt(0)
v_mfma_f32_16x16x32_bf16 v[96:99], v[24:27], v[40:43], v[96:99]
ds_read_b128 v[32:35], v12 offset:4096
ds_read_b128 v[36:39], v12 offset:20480
v_mfma_f32_16x16x32_bf16 v[100:103], v[28:31], v[40:43], v[100:103]
ds_read_b128 v[68:71], v14 offset:4096
ds_read_b128 v[72:75], v14 offset:12288
v_mfma_f32_16x16x32_bf16 v[104:107], v[24:27], v[44:47], v[104:107]
ds_read_b128 v[76:79], v14 offset:20480
ds_read_b128 v[80:83], v14 offset:28672
v_mfma_f32_16x16x32_bf16 v[108:111], v[28:31], v[44:47], v[108:111]
ds_read_b128 v[84:87], v14 offset:36864
ds_read_b128 v[88:91], v14 offset:45056
v_mfma_f32_16x16x32_bf16 v[112:115], v[24:27], v[48:51], v[112:115]
ds_read_b128 v[92:95], v14 offset:53248
v_mfma_f32_16x16x32_bf16 v[116:119], v[28:31], v[48:51], v[116:119]
v_mfma_f32_16x16x32_bf16 v[120:123], v[24:27], v[52:55], v[120:123]
v_mfma_f32_16x16x32_bf16 v[124:127], v[28:31], v[52:55], v[124:127]
v_mfma_f32_16x16x32_bf16 v[128:131], v[24:27], v[56:59], v[128:131]
v_mfma_f32_16x16x32_bf16 v[132:135], v[28:31], v[56:59], v[132:135]
v_mfma_f32_16x16x32_bf16 v[136:139], v[24:27], v[60:63], v[136:139]
v_mfma_f32_16x16x32_bf16 v[140:143], v[28:31], v[60:63], v[140:143]
v_mfma_f32_16x16x32_bf16 v[144:147], v[24:27], v[64:67], v[144:147]
v_mfma_f32_16x16x32_bf16 v[148:151], v[28:31], v[64:67], v[148:151]
s_waitcnt vmcnt(1) lgkmcnt(0)
s_barrier
v_mfma_f32_16x16x32_bf16 v[96:99], v[32:35], v[68:71], v[96:99]
ds_read_b128 v[24:27], v11 offset:6144
ds_read_b128 v[28:31], v11 offset:22528
v_mfma_f32_16x16x32_bf16 v[100:103], v[36:39], v[68:71], v[100:103]
ds_read_b128 v[40:43], v13 offset:6144
ds_read_b128 v[44:47], v13 offset:14336
v_mfma_f32_16x16x32_bf16 v[104:107], v[32:35], v[72:75], v[104:107]
ds_read_b128 v[48:51], v13 offset:22528
ds_read_b128 v[52:55], v13 offset:30720
v_mfma_f32_16x16x32_bf16 v[108:111], v[36:39], v[72:75], v[108:111]
ds_read_b128 v[56:59], v13 offset:38912
ds_read_b128 v[60:63], v13 offset:47104
v_mfma_f32_16x16x32_bf16 v[112:115], v[32:35], v[76:79], v[112:115]
ds_read_b128 v[64:67], v13 offset:55296
v_mfma_f32_16x16x32_bf16 v[116:119], v[36:39], v[76:79], v[116:119]
v_mfma_f32_16x16x32_bf16 v[120:123], v[32:35], v[80:83], v[120:123]
v_mfma_f32_16x16x32_bf16 v[124:127], v[36:39], v[80:83], v[124:127]
v_mfma_f32_16x16x32_bf16 v[128:131], v[32:35], v[84:87], v[128:131]
v_mfma_f32_16x16x32_bf16 v[132:135], v[36:39], v[84:87], v[132:135]
v_mfma_f32_16x16x32_bf16 v[136:139], v[32:35], v[88:91], v[136:139]
v_mfma_f32_16x16x32_bf16 v[140:143], v[36:39], v[88:91], v[140:143]
v_mfma_f32_16x16x32_bf16 v[144:147], v[32:35], v[92:95], v[144:147]
v_mfma_f32_16x16x32_bf16 v[148:151], v[36:39], v[92:95], v[148:151]
s_waitcnt lgkmcnt(0)
v_mfma_f32_16x16x32_bf16 v[96:99], v[24:27], v[40:43], v[96:99]
ds_read_b128 v[32:35], v12 offset:6144
ds_read_b128 v[36:39], v12 offset:22528
v_mfma_f32_16x16x32_bf16 v[100:103], v[28:31], v[40:43], v[100:103]
ds_read_b128 v[68:71], v14 offset:6144
ds_read_b128 v[72:75], v14 offset:14336
v_mfma_f32_16x16x32_bf16 v[104:107], v[24:27], v[44:47], v[104:107]
ds_read_b128 v[76:79], v14 offset:22528
ds_read_b128 v[80:83], v14 offset:30720
v_mfma_f32_16x16x32_bf16 v[108:111], v[28:31], v[44:47], v[108:111]
ds_read_b128 v[84:87], v14 offset:38912
ds_read_b128 v[88:91], v14 offset:47104
v_mfma_f32_16x16x32_bf16 v[112:115], v[24:27], v[48:51], v[112:115]
ds_read_b128 v[92:95], v14 offset:55296
v_mfma_f32_16x16x32_bf16 v[116:119], v[28:31], v[48:51], v[116:119]
v_mfma_f32_16x16x32_bf16 v[120:123], v[24:27], v[52:55], v[120:123]
v_mfma_f32_16x16x32_bf16 v[124:127], v[28:31], v[52:55], v[124:127]
v_mfma_f32_16x16x32_bf16 v[128:131], v[24:27], v[56:59], v[128:131]
v_mfma_f32_16x16x32_bf16 v[132:135], v[28:31], v[56:59], v[132:135]
v_mfma_f32_16x16x32_bf16 v[136:139], v[24:27], v[60:63], v[136:139]
v_mfma_f32_16x16x32_bf16 v[140:143], v[28:31], v[60:63], v[140:143]
v_mfma_f32_16x16x32_bf16 v[144:147], v[24:27], v[64:67], v[144:147]
v_mfma_f32_16x16x32_bf16 v[148:151], v[28:31], v[64:67], v[148:151]
s_waitcnt lgkmcnt(0)
v_mfma_f32_16x16x32_bf16 v[96:99], v[32:35], v[68:71], v[96:99]
v_mfma_f32_16x16x32_bf16 v[100:103], v[36:39], v[68:71], v[100:103]
v_mfma_f32_16x16x32_bf16 v[104:107], v[32:35], v[72:75], v[104:107]
v_mfma_f32_16x16x32_bf16 v[108:111], v[36:39], v[72:75], v[108:111]
v_mfma_f32_16x16x32_bf16 v[112:115], v[32:35], v[76:79], v[112:115]
v_mfma_f32_16x16x32_bf16 v[116:119], v[36:39], v[76:79], v[116:119]
v_mfma_f32_16x16x32_bf16 v[120:123], v[32:35], v[80:83], v[120:123]
v_mfma_f32_16x16x32_bf16 v[124:127], v[36:39], v[80:83], v[124:127]
v_mfma_f32_16x16x32_bf16 v[128:131], v[32:35], v[84:87], v[128:131]
v_mfma_f32_16x16x32_bf16 v[132:135], v[36:39], v[84:87], v[132:135]
v_mfma_f32_16x16x32_bf16 v[136:139], v[32:35], v[88:91], v[136:139]
v_mfma_f32_16x16x32_bf16 v[140:143], v[36:39], v[88:91], v[140:143]
v_mfma_f32_16x16x32_bf16 v[144:147], v[32:35], v[92:95], v[144:147]
v_mfma_f32_16x16x32_bf16 v[148:151], v[36:39], v[92:95], v[148:151]
s_barrier
s_mul_i32 s20, s10, 28
s_mul_i32 s21, s33, 14
s_add_u32 s20, s20, s21
s_mul_i32 s21, s35, 7
s_add_u32 s20, s20, s21
s_mul_i32 s20, s20, 7
s_add_u32 s20, s20, s11
s_lshl_b32 s20, s20, 11
s_lshl_b32 s21, s34, 10
s_add_u32 s20, s20, s21
s_add_u32 s20, s20, 0
s_mov_b32 s21, 1035512379
v_mul_f32 v96, s21, v96
v_mul_f32 v97, s21, v97
v_mul_f32 v98, s21, v98
v_mul_f32 v99, s21, v99
v_mul_f32 v100, s21, v100
v_mul_f32 v101, s21, v101
v_mul_f32 v102, s21, v102
v_mul_f32 v103, s21, v103
v_cvt_pk_bf16_f32 v40, v96, v97
v_cvt_pk_bf16_f32 v42, v98, v99
v_cvt_pk_bf16_f32 v41, v100, v101
v_cvt_pk_bf16_f32 v43, v102, v103
buffer_store_dwordx4 v[40:43], v6, s[4:7], s20 offen sc1
s_add_u32 s20, s20, 14336
v_mul_f32 v104, s21, v104
v_mul_f32 v105, s21, v105
v_mul_f32 v106, s21, v106
v_mul_f32 v107, s21, v107
v_mul_f32 v108, s21, v108
v_mul_f32 v109, s21, v109
v_mul_f32 v110, s21, v110
v_mul_f32 v111, s21, v111
v_cvt_pk_bf16_f32 v44, v104, v105
v_cvt_pk_bf16_f32 v46, v106, v107
v_cvt_pk_bf16_f32 v45, v108, v109
v_cvt_pk_bf16_f32 v47, v110, v111
buffer_store_dwordx4 v[44:47], v6, s[4:7], s20 offen sc1
s_add_u32 s20, s20, 14336
v_mul_f32 v112, s21, v112
v_mul_f32 v113, s21, v113
v_mul_f32 v114, s21, v114
v_mul_f32 v115, s21, v115
v_mul_f32 v116, s21, v116
v_mul_f32 v117, s21, v117
v_mul_f32 v118, s21, v118
v_mul_f32 v119, s21, v119
v_cvt_pk_bf16_f32 v48, v112, v113
v_cvt_pk_bf16_f32 v50, v114, v115
v_cvt_pk_bf16_f32 v49, v116, v117
v_cvt_pk_bf16_f32 v51, v118, v119
buffer_store_dwordx4 v[48:51], v6, s[4:7], s20 offen sc1
s_add_u32 s20, s20, 14336
v_mul_f32 v120, s21, v120
v_mul_f32 v121, s21, v121
v_mul_f32 v122, s21, v122
v_mul_f32 v123, s21, v123
v_mul_f32 v124, s21, v124
v_mul_f32 v125, s21, v125
v_mul_f32 v126, s21, v126
v_mul_f32 v127, s21, v127
v_cvt_pk_bf16_f32 v52, v120, v121
v_cvt_pk_bf16_f32 v54, v122, v123
v_cvt_pk_bf16_f32 v53, v124, v125
v_cvt_pk_bf16_f32 v55, v126, v127
buffer_store_dwordx4 v[52:55], v6, s[4:7], s20 offen sc1
s_add_u32 s20, s20, 14336
v_mul_f32 v128, s21, v128
v_mul_f32 v129, s21, v129
v_mul_f32 v130, s21, v130
v_mul_f32 v131, s21, v131
v_mul_f32 v132, s21, v132
v_mul_f32 v133, s21, v133
v_mul_f32 v134, s21, v134
v_mul_f32 v135, s21, v135
v_cvt_pk_bf16_f32 v56, v128, v129
v_cvt_pk_bf16_f32 v58, v130, v131
v_cvt_pk_bf16_f32 v57, v132, v133
v_cvt_pk_bf16_f32 v59, v134, v135
buffer_store_dwordx4 v[56:59], v6, s[4:7], s20 offen sc1
s_add_u32 s20, s20, 14336
v_mul_f32 v136, s21, v136
v_mul_f32 v137, s21, v137
v_mul_f32 v138, s21, v138
v_mul_f32 v139, s21, v139
v_mul_f32 v140, s21, v140
v_mul_f32 v141, s21, v141
v_mul_f32 v142, s21, v142
v_mul_f32 v143, s21, v143
v_cvt_pk_bf16_f32 v60, v136, v137
v_cvt_pk_bf16_f32 v62, v138, v139
v_cvt_pk_bf16_f32 v61, v140, v141
v_cvt_pk_bf16_f32 v63, v142, v143
buffer_store_dwordx4 v[60:63], v6, s[4:7], s20 offen sc1
s_add_u32 s20, s20, 14336
v_mul_f32 v144, s21, v144
v_mul_f32 v145, s21, v145
v_mul_f32 v146, s21, v146
v_mul_f32 v147, s21, v147
v_mul_f32 v148, s21, v148
v_mul_f32 v149, s21, v149
v_mul_f32 v150, s21, v150
v_mul_f32 v151, s21, v151
v_cvt_pk_bf16_f32 v64, v144, v145
v_cvt_pk_bf16_f32 v66, v146, v147
v_cvt_pk_bf16_f32 v65, v148, v149
v_cvt_pk_bf16_f32 v67, v150, v151
buffer_store_dwordx4 v[64:67], v6, s[4:7], s20 offen sc1
s_add_u32 s20, s20, 14336
s_waitcnt vmcnt(0)
s_barrier
s_cmp_lg_u32 s9, 0
s_cbranch_scc1 DW_5
v_readfirstlane_b32 s92, v253
s_nop 0
s_cmp_eq_u32 s92, 1
s_cbranch_scc1 DK_7
v_mov_b32 v250, 1
v_mov_b32 v251, 20
s_mov_b64 exec, 1
buffer_atomic_add v250, v251, s[84:87], 0 offen sc0
s_mov_b64 exec, -1
s_mov_b32 s91, 200000
s_waitcnt vmcnt(0)
v_readfirstlane_b32 s92, v250
s_nop 0
s_cmp_lg_u32 s92, 0
s_cbranch_scc1 DL_6
v_lshlrev_b32 v250, 4, v0
v_mov_b32 v244, 0
v_mov_b32 v245, 0
v_mov_b32 v246, 0
v_mov_b32 v247, 0
s_mov_b32 s92, 71319552
DZ_8:
buffer_store_dwordx4 v[244:247], v250, s[4:7], s92 offen sc1
s_add_u32 s92, s92, 1024
s_cmp_lt_u32 s92, 71344128
s_cbranch_scc1 DZ_8
v_mov_b32 v253, 1
s_waitcnt vmcnt(0)
buffer_store_dword v253, v252, s[84:87], 0 offen sc1
s_branch DK_7
DL_6:
s_sleep 4
buffer_load_dword v253, v252, s[84:87], 0 offen sc1
s_sub_u32 s91, s91, 1
s_waitcnt vmcnt(0)
v_readfirstlane_b32 s92, v253
s_nop 0
s_cmp_eq_u32 s92, 1
s_cbranch_scc1 DK_7
s_cmp_gt_i32 s91, 0
s_cbranch_scc1 DL_6
DK_7:
v_lshlrev_b32 v250, 7, v0
v_add_u32 v250, s89, v250
v_mov_b32 v251, 1073741824
v_cmp_gt_u32 vcc, 1, v0
s_nop 1
v_cndmask_b32 v250, v251, v250, vcc
v_mov_b32 v251, 1
s_mov_b32 s92, 71319552
buffer_store_dword v251, v250, s[4:7], s92 offen sc1
DW_5:
JOB2_SKIP:
s_waitcnt vmcnt(0)
s_branch PREP_DONE
PREP_LN:
s_mov_b32 s100, s21
buffer_atomic_or v249, v248, s[84:87], 0 offen sc0
s_lshl_b32 s89, s21, 2
s_add_u32 s89, s89, 21504
s_lshl_b32 s10, s21, 2
s_add_u32 s10, s10, s9
s_cmp_ge_u32 s21, 16
s_cselect_b32 s90, 0, 8
s_cselect_b32 s10, 0, s10
s_cbranch_scc1 LN_END
LN_LOOP:
v_and_b32 v1, 63, v0
v_lshrrev_b32 v2, 4, v1
v_and_b32 v3, 15, v1
v_lshlrev_b32 v6, 4, v1
v_mul_u32_u24 v7, 896, v3
v_lshl_add_u32 v7, v2, 4, v7
s_mul_i32 s20, s10, 14336
buffer_load_dwordx4 v[12:15], v7, s[48:51], s20 offen offset:0
buffer_load_dwordx4 v[16:19], v7, s[48:51], s20 offen offset:64
buffer_load_dwordx4 v[20:23], v7, s[48:51], s20 offen offset:128
buffer_load_dwordx4 v[24:27], v7, s[48:51], s20 offen offset:192
buffer_load_dwordx4 v[28:31], v7, s[48:51], s20 offen offset:256
buffer_load_dwordx4 v[32:35], v7, s[48:51], s20 offen offset:320
buffer_load_dwordx4 v[36:39], v7, s[48:51], s20 offen offset:384
buffer_load_dwordx4 v[40:43], v7, s[48:51], s20 offen offset:448
buffer_load_dwordx4 v[44:47], v7, s[48:51], s20 offen offset:512
buffer_load_dwordx4 v[48:51], v7, s[48:51], s20 offen offset:576
buffer_load_dwordx4 v[52:55], v7, s[48:51], s20 offen offset:640
buffer_load_dwordx4 v[56:59], v7, s[48:51], s20 offen offset:704
buffer_load_dwordx4 v[60:63], v7, s[48:51], s20 offen offset:768
buffer_load_dwordx4 v[64:67], v7, s[48:51], s20 offen offset:832
v_mov_b32 v4, 0
v_mov_b32 v5, 0
s_waitcnt vmcnt(13)
v_lshlrev_b32 v68, 16, v12
v_and_b32 v69, 0xffff0000, v12
v_add_f32 v4, v4, v68
v_add_f32 v5, v5, v69
v_lshlrev_b32 v70, 16, v13
v_and_b32 v71, 0xffff0000, v13
v_add_f32 v4, v4, v70
v_add_f32 v5, v5, v71
v_lshlrev_b32 v72, 16, v14
v_and_b32 v73, 0xffff0000, v14
v_add_f32 v4, v4, v72
v_add_f32 v5, v5, v73
v_lshlrev_b32 v74, 16, v15
v_and_b32 v75, 0xffff0000, v15
v_add_f32 v4, v4, v74
v_add_f32 v5, v5, v75
s_waitcnt vmcnt(12)
v_lshlrev_b32 v76, 16, v16
v_and_b32 v77, 0xffff0000, v16
v_add_f32 v4, v4, v76
v_add_f32 v5, v5, v77
v_lshlrev_b32 v78, 16, v17
v_and_b32 v79, 0xffff0000, v17
v_add_f32 v4, v4, v78
v_add_f32 v5, v5, v79
v_lshlrev_b32 v80, 16, v18
v_and_b32 v81, 0xffff0000, v18
v_add_f32 v4, v4, v80
v_add_f32 v5, v5, v81
v_lshlrev_b32 v82, 16, v19
v_and_b32 v83, 0xffff0000, v19
v_add_f32 v4, v4, v82
v_add_f32 v5, v5, v83
s_waitcnt vmcnt(11)
v_lshlrev_b32 v84, 16, v20
v_and_b32 v85, 0xffff0000, v20
v_add_f32 v4, v4, v84
v_add_f32 v5, v5, v85
v_lshlrev_b32 v86, 16, v21
v_and_b32 v87, 0xffff0000, v21
v_add_f32 v4, v4, v86
v_add_f32 v5, v5, v87
v_lshlrev_b32 v88, 16, v22
v_and_b32 v89, 0xffff0000, v22
v_add_f32 v4, v4, v88
v_add_f32 v5, v5, v89
v_lshlrev_b32 v90, 16, v23
v_and_b32 v91, 0xffff0000, v23
v_add_f32 v4, v4, v90
v_add_f32 v5, v5, v91
s_waitcnt vmcnt(10)
v_lshlrev_b32 v92, 16, v24
v_and_b32 v93, 0xffff0000, v24
v_add_f32 v4, v4, v92
v_add_f32 v5, v5, v93
v_lshlrev_b32 v94, 16, v25
v_and_b32 v95, 0xffff0000, v25
v_add_f32 v4, v4, v94
v_add_f32 v5, v5, v95
v_lshlrev_b32 v96, 16, v26
v_and_b32 v97, 0xffff0000, v26
v_add_f32 v4, v4, v96
v_add_f32 v5, v5, v97
v_lshlrev_b32 v98, 16, v27
v_and_b32 v99, 0xffff0000, v27
v_add_f32 v4, v4, v98
v_add_f32 v5, v5, v99
s_waitcnt vmcnt(9)
v_lshlrev_b32 v100, 16, v28
v_and_b32 v101, 0xffff0000, v28
v_add_f32 v4, v4, v100
v_add_f32 v5, v5, v101
v_lshlrev_b32 v102, 16, v29
v_and_b32 v103, 0xffff0000, v29
v_add_f32 v4, v4, v102
v_add_f32 v5, v5, v103
v_lshlrev_b32 v104, 16, v30
v_and_b32 v105, 0xffff0000, v30
v_add_f32 v4, v4, v104
v_add_f32 v5, v5, v105
v_lshlrev_b32 v106, 16, v31
v_and_b32 v107, 0xffff0000, v31
v_add_f32 v4, v4, v106
v_add_f32 v5, v5, v107
s_waitcnt vmcnt(8)
v_lshlrev_b32 v108, 16, v32
v_and_b32 v109, 0xffff0000, v32
v_add_f32 v4, v4, v108
v_add_f32 v5, v5, v109
v_lshlrev_b32 v110, 16, v33
v_and_b32 v111, 0xffff0000, v33
v_add_f32 v4, v4, v110
v_add_f32 v5, v5, v111
v_lshlrev_b32 v112, 16, v34
v_and_b32 v113, 0xffff0000, v34
v_add_f32 v4, v4, v112
v_add_f32 v5, v5, v113
v_lshlrev_b32 v114, 16, v35
v_and_b32 v115, 0xffff0000, v35
v_add_f32 v4, v4, v114
v_add_f32 v5, v5, v115
s_waitcnt vmcnt(7)
v_lshlrev_b32 v116, 16, v36
v_and_b32 v117, 0xffff0000, v36
v_add_f32 v4, v4, v116
v_add_f32 v5, v5, v117
v_lshlrev_b32 v118, 16, v37
v_and_b32 v119, 0xffff0000, v37
v_add_f32 v4, v4, v118
v_add_f32 v5, v5, v119
v_lshlrev_b32 v120, 16, v38
v_and_b32 v121, 0xffff0000, v38
v_add_f32 v4, v4, v120
v_add_f32 v5, v5, v121
v_lshlrev_b32 v122, 16, v39
v_and_b32 v123, 0xffff0000, v39
v_add_f32 v4, v4, v122
v_add_f32 v5, v5, v123
s_waitcnt vmcnt(6)
v_lshlrev_b32 v124, 16, v40
v_and_b32 v125, 0xffff0000, v40
v_add_f32 v4, v4, v124
v_add_f32 v5, v5, v125
v_lshlrev_b32 v126, 16, v41
v_and_b32 v127, 0xffff0000, v41
v_add_f32 v4, v4, v126
v_add_f32 v5, v5, v127
v_lshlrev_b32 v128, 16, v42
v_and_b32 v129, 0xffff0000, v42
v_add_f32 v4, v4, v128
v_add_f32 v5, v5, v129
v_lshlrev_b32 v130, 16, v43
v_and_b32 v131, 0xffff0000, v43
v_add_f32 v4, v4, v130
v_add_f32 v5, v5, v131
s_waitcnt vmcnt(5)
v_lshlrev_b32 v132, 16, v44
v_and_b32 v133, 0xffff0000, v44
v_add_f32 v4, v4, v132
v_add_f32 v5, v5, v133
v_lshlrev_b32 v134, 16, v45
v_and_b32 v135, 0xffff0000, v45
v_add_f32 v4, v4, v134
v_add_f32 v5, v5, v135
v_lshlrev_b32 v136, 16, v46
v_and_b32 v137, 0xffff0000, v46
v_add_f32 v4, v4, v136
v_add_f32 v5, v5, v137
v_lshlrev_b32 v138, 16, v47
v_and_b32 v139, 0xffff0000, v47
v_add_f32 v4, v4, v138
v_add_f32 v5, v5, v139
s_waitcnt vmcnt(4)
v_lshlrev_b32 v140, 16, v48
v_and_b32 v141, 0xffff0000, v48
v_add_f32 v4, v4, v140
v_add_f32 v5, v5, v141
v_lshlrev_b32 v142, 16, v49
v_and_b32 v143, 0xffff0000, v49
v_add_f32 v4, v4, v142
v_add_f32 v5, v5, v143
v_lshlrev_b32 v144, 16, v50
v_and_b32 v145, 0xffff0000, v50
v_add_f32 v4, v4, v144
v_add_f32 v5, v5, v145
v_lshlrev_b32 v146, 16, v51
v_and_b32 v147, 0xffff0000, v51
v_add_f32 v4, v4, v146
v_add_f32 v5, v5, v147
s_waitcnt vmcnt(3)
v_lshlrev_b32 v148, 16, v52
v_and_b32 v149, 0xffff0000, v52
v_add_f32 v4, v4, v148
v_add_f32 v5, v5, v149
v_lshlrev_b32 v150, 16, v53
v_and_b32 v151, 0xffff0000, v53
v_add_f32 v4, v4, v150
v_add_f32 v5, v5, v151
v_lshlrev_b32 v152, 16, v54
v_and_b32 v153, 0xffff0000, v54
v_add_f32 v4, v4, v152
v_add_f32 v5, v5, v153
v_lshlrev_b32 v154, 16, v55
v_and_b32 v155, 0xffff0000, v55
v_add_f32 v4, v4, v154
v_add_f32 v5, v5, v155
s_waitcnt vmcnt(2)
v_lshlrev_b32 v156, 16, v56
v_and_b32 v157, 0xffff0000, v56
v_add_f32 v4, v4, v156
v_add_f32 v5, v5, v157
v_lshlrev_b32 v158, 16, v57
v_and_b32 v159, 0xffff0000, v57
v_add_f32 v4, v4, v158
v_add_f32 v5, v5, v159
v_lshlrev_b32 v160, 16, v58
v_and_b32 v161, 0xffff0000, v58
v_add_f32 v4, v4, v160
v_add_f32 v5, v5, v161
v_lshlrev_b32 v162, 16, v59
v_and_b32 v163, 0xffff0000, v59
v_add_f32 v4, v4, v162
v_add_f32 v5, v5, v163
s_waitcnt vmcnt(1)
v_lshlrev_b32 v164, 16, v60
v_and_b32 v165, 0xffff0000, v60
v_add_f32 v4, v4, v164
v_add_f32 v5, v5, v165
v_lshlrev_b32 v166, 16, v61
v_and_b32 v167, 0xffff0000, v61
v_add_f32 v4, v4, v166
v_add_f32 v5, v5, v167
v_lshlrev_b32 v168, 16, v62
v_and_b32 v169, 0xffff0000, v62
v_add_f32 v4, v4, v168
v_add_f32 v5, v5, v169
v_lshlrev_b32 v170, 16, v63
v_and_b32 v171, 0xffff0000, v63
v_add_f32 v4, v4, v170
v_add_f32 v5, v5, v171
s_waitcnt vmcnt(0)
v_lshlrev_b32 v172, 16, v64
v_and_b32 v173, 0xffff0000, v64
v_add_f32 v4, v4, v172
v_add_f32 v5, v5, v173
v_lshlrev_b32 v174, 16, v65
v_and_b32 v175, 0xffff0000, v65
v_add_f32 v4, v4, v174
v_add_f32 v5, v5, v175
v_lshlrev_b32 v176, 16, v66
v_and_b32 v177, 0xffff0000, v66
v_add_f32 v4, v4, v176
v_add_f32 v5, v5, v177
v_lshlrev_b32 v178, 16, v67
v_and_b32 v179, 0xffff0000, v67
v_add_f32 v4, v4, v178
v_add_f32 v5, v5, v179
v_and_b32 v250, 63, v0
v_lshlrev_b32 v250, 4, v250
v_mov_b32 v244, -1
v_mov_b32 v245, -1
v_mov_b32 v246, -1
v_mov_b32 v247, -1
s_lshl_b32 s20, s10, 12
s_add_u32 s20, s20, 56623104
buffer_store_dwordx4 v[244:247], v250, s[4:7], s20 offen offset:0 sc1
buffer_store_dwordx4 v[244:247], v250, s[4:7], s20 offen offset:1024 sc1
buffer_store_dwordx4 v[244:247], v250, s[4:7], s20 offen offset:2048 sc1
buffer_store_dwordx4 v[244:247], v250, s[4:7], s20 offen offset:3072 sc1
v_add_f32 v4, v4, v5
v_mov_b32 v5, v4
s_nop 1
v_permlane16_swap_b32 v4, v5
v_add_f32 v4, v4, v5
v_mov_b32 v5, v4
s_nop 1
v_permlane32_swap_b32 v4, v5
v_add_f32 v4, v4, v5
v_mul_f32 v8, 991054117, v4
v_mov_b32 v4, 0
v_mov_b32 v9, 0
v_sub_f32 v5, v68, v8
v_sub_f32 v7, v69, v8
v_fmac_f32 v4, v5, v5
v_fmac_f32 v9, v7, v7
v_sub_f32 v5, v70, v8
v_sub_f32 v7, v71, v8
v_fmac_f32 v4, v5, v5
v_fmac_f32 v9, v7, v7
v_sub_f32 v5, v72, v8
v_sub_f32 v7, v73, v8
v_fmac_f32 v4, v5, v5
v_fmac_f32 v9, v7, v7
v_sub_f32 v5, v74, v8
v_sub_f32 v7, v75, v8
v_fmac_f32 v4, v5, v5
v_fmac_f32 v9, v7, v7
v_sub_f32 v5, v76, v8
v_sub_f32 v7, v77, v8
v_fmac_f32 v4, v5, v5
v_fmac_f32 v9, v7, v7
v_sub_f32 v5, v78, v8
v_sub_f32 v7, v79, v8
v_fmac_f32 v4, v5, v5
v_fmac_f32 v9, v7, v7
v_sub_f32 v5, v80, v8
v_sub_f32 v7, v81, v8
v_fmac_f32 v4, v5, v5
v_fmac_f32 v9, v7, v7
v_sub_f32 v5, v82, v8
v_sub_f32 v7, v83, v8
v_fmac_f32 v4, v5, v5
v_fmac_f32 v9, v7, v7
v_sub_f32 v5, v84, v8
v_sub_f32 v7, v85, v8
v_fmac_f32 v4, v5, v5
v_fmac_f32 v9, v7, v7
v_sub_f32 v5, v86, v8
v_sub_f32 v7, v87, v8
v_fmac_f32 v4, v5, v5
v_fmac_f32 v9, v7, v7
v_sub_f32 v5, v88, v8
v_sub_f32 v7, v89, v8
v_fmac_f32 v4, v5, v5
v_fmac_f32 v9, v7, v7
v_sub_f32 v5, v90, v8
v_sub_f32 v7, v91, v8
v_fmac_f32 v4, v5, v5
v_fmac_f32 v9, v7, v7
v_sub_f32 v5, v92, v8
v_sub_f32 v7, v93, v8
v_fmac_f32 v4, v5, v5
v_fmac_f32 v9, v7, v7
v_sub_f32 v5, v94, v8
v_sub_f32 v7, v95, v8
v_fmac_f32 v4, v5, v5
v_fmac_f32 v9, v7, v7
v_sub_f32 v5, v96, v8
v_sub_f32 v7, v97, v8
v_fmac_f32 v4, v5, v5
v_fmac_f32 v9, v7, v7
v_sub_f32 v5, v98, v8
v_sub_f32 v7, v99, v8
v_fmac_f32 v4, v5, v5
v_fmac_f32 v9, v7, v7
v_sub_f32 v5, v100, v8
v_sub_f32 v7, v101, v8
v_fmac_f32 v4, v5, v5
v_fmac_f32 v9, v7, v7
v_sub_f32 v5, v102, v8
v_sub_f32 v7, v103, v8
v_fmac_f32 v4, v5, v5
v_fmac_f32 v9, v7, v7
v_sub_f32 v5, v104, v8
v_sub_f32 v7, v105, v8
v_fmac_f32 v4, v5, v5
v_fmac_f32 v9, v7, v7
v_sub_f32 v5, v106, v8
v_sub_f32 v7, v107, v8
v_fmac_f32 v4, v5, v5
v_fmac_f32 v9, v7, v7
v_sub_f32 v5, v108, v8
v_sub_f32 v7, v109, v8
v_fmac_f32 v4, v5, v5
v_fmac_f32 v9, v7, v7
v_sub_f32 v5, v110, v8
v_sub_f32 v7, v111, v8
v_fmac_f32 v4, v5, v5
v_fmac_f32 v9, v7, v7
v_sub_f32 v5, v112, v8
v_sub_f32 v7, v113, v8
v_fmac_f32 v4, v5, v5
v_fmac_f32 v9, v7, v7
v_sub_f32 v5, v114, v8
v_sub_f32 v7, v115, v8
v_fmac_f32 v4, v5, v5
v_fmac_f32 v9, v7, v7
v_sub_f32 v5, v116, v8
v_sub_f32 v7, v117, v8
v_fmac_f32 v4, v5, v5
v_fmac_f32 v9, v7, v7
v_sub_f32 v5, v118, v8
v_sub_f32 v7, v119, v8
v_fmac_f32 v4, v5, v5
v_fmac_f32 v9, v7, v7
v_sub_f32 v5, v120, v8
v_sub_f32 v7, v121, v8
v_fmac_f32 v4, v5, v5
v_fmac_f32 v9, v7, v7
v_sub_f32 v5, v122, v8
v_sub_f32 v7, v123, v8
v_fmac_f32 v4, v5, v5
v_fmac_f32 v9, v7, v7
v_sub_f32 v5, v124, v8
v_sub_f32 v7, v125, v8
v_fmac_f32 v4, v5, v5
v_fmac_f32 v9, v7, v7
v_sub_f32 v5, v126, v8
v_sub_f32 v7, v127, v8
v_fmac_f32 v4, v5, v5
v_fmac_f32 v9, v7, v7
v_sub_f32 v5, v128, v8
v_sub_f32 v7, v129, v8
v_fmac_f32 v4, v5, v5
v_fmac_f32 v9, v7, v7
v_sub_f32 v5, v130, v8
v_sub_f32 v7, v131, v8
v_fmac_f32 v4, v5, v5
v_fmac_f32 v9, v7, v7
v_sub_f32 v5, v132, v8
v_sub_f32 v7, v133, v8
v_fmac_f32 v4, v5, v5
v_fmac_f32 v9, v7, v7
v_sub_f32 v5, v134, v8
v_sub_f32 v7, v135, v8
v_fmac_f32 v4, v5, v5
v_fmac_f32 v9, v7, v7
v_sub_f32 v5, v136, v8
v_sub_f32 v7, v137, v8
v_fmac_f32 v4, v5, v5
v_fmac_f32 v9, v7, v7
v_sub_f32 v5, v138, v8
v_sub_f32 v7, v139, v8
v_fmac_f32 v4, v5, v5
v_fmac_f32 v9, v7, v7
v_sub_f32 v5, v140, v8
v_sub_f32 v7, v141, v8
v_fmac_f32 v4, v5, v5
v_fmac_f32 v9, v7, v7
v_sub_f32 v5, v142, v8
v_sub_f32 v7, v143, v8
v_fmac_f32 v4, v5, v5
v_fmac_f32 v9, v7, v7
v_sub_f32 v5, v144, v8
v_sub_f32 v7, v145, v8
v_fmac_f32 v4, v5, v5
v_fmac_f32 v9, v7, v7
v_sub_f32 v5, v146, v8
v_sub_f32 v7, v147, v8
v_fmac_f32 v4, v5, v5
v_fmac_f32 v9, v7, v7
v_sub_f32 v5, v148, v8
v_sub_f32 v7, v149, v8
v_fmac_f32 v4, v5, v5
v_fmac_f32 v9, v7, v7
v_sub_f32 v5, v150, v8
v_sub_f32 v7, v151, v8
v_fmac_f32 v4, v5, v5
v_fmac_f32 v9, v7, v7
v_sub_f32 v5, v152, v8
v_sub_f32 v7, v153, v8
v_fmac_f32 v4, v5, v5
v_fmac_f32 v9, v7, v7
v_sub_f32 v5, v154, v8
v_sub_f32 v7, v155, v8
v_fmac_f32 v4, v5, v5
v_fmac_f32 v9, v7, v7
v_sub_f32 v5, v156, v8
v_sub_f32 v7, v157, v8
v_fmac_f32 v4, v5, v5
v_fmac_f32 v9, v7, v7
v_sub_f32 v5, v158, v8
v_sub_f32 v7, v159, v8
v_fmac_f32 v4, v5, v5
v_fmac_f32 v9, v7, v7
v_sub_f32 v5, v160, v8
v_sub_f32 v7, v161, v8
v_fmac_f32 v4, v5, v5
v_fmac_f32 v9, v7, v7
v_sub_f32 v5, v162, v8
v_sub_f32 v7, v163, v8
v_fmac_f32 v4, v5, v5
v_fmac_f32 v9, v7, v7
v_sub_f32 v5, v164, v8
v_sub_f32 v7, v165, v8
v_fmac_f32 v4, v5, v5
v_fmac_f32 v9, v7, v7
v_sub_f32 v5, v166, v8
v_sub_f32 v7, v167, v8
v_fmac_f32 v4, v5, v5
v_fmac_f32 v9, v7, v7
v_sub_f32 v5, v168, v8
v_sub_f32 v7, v169, v8
v_fmac_f32 v4, v5, v5
v_fmac_f32 v9, v7, v7
v_sub_f32 v5, v170, v8
v_sub_f32 v7, v171, v8
v_fmac_f32 v4, v5, v5
v_fmac_f32 v9, v7, v7
v_sub_f32 v5, v172, v8
v_sub_f32 v7, v173, v8
v_fmac_f32 v4, v5, v5
v_fmac_f32 v9, v7, v7
v_sub_f32 v5, v174, v8
v_sub_f32 v7, v175, v8
v_fmac_f32 v4, v5, v5
v_fmac_f32 v9, v7, v7
v_sub_f32 v5, v176, v8
v_sub_f32 v7, v177, v8
v_fmac_f32 v4, v5, v5
v_fmac_f32 v9, v7, v7
v_sub_f32 v5, v178, v8
v_sub_f32 v7, v179, v8
v_fmac_f32 v4, v5, v5
v_fmac_f32 v9, v7, v7
v_add_f32 v4, v4, v9
v_mov_b32 v5, v4
s_nop 1
v_permlane16_swap_b32 v4, v5
v_add_f32 v4, v4, v5
v_mov_b32 v5, v4
s_nop 1
v_permlane32_swap_b32 v4, v5
v_add_f32 v4, v4, v5
v_mul_f32 v4, 991054117, v4
v_cvt_pk_bf16_f32 v4, v4, v4
v_and_b32 v4, 0xffff0000, v4
v_add_f32 v4, 925353388, v4
v_cvt_pk_bf16_f32 v4, v4, v4
v_and_b32 v4, 0xffff0000, v4
v_sqrt_f32 v4, v4
s_nop 0
v_cvt_pk_bf16_f32 v4, v4, v4
v_and_b32 v4, 0xffff0000, v4
v_rcp_f32 v9, v4
v_cvt_pk_bf16_f32 v8, v8, v8
v_and_b32 v8, 0xffff0000, v8
v_sub_f32 v68, v68, v8
v_sub_f32 v69, v69, v8
v_cvt_pk_bf16_f32 v12, v68, v69
v_lshlrev_b32 v68, 16, v12
v_and_b32 v69, 0xffff0000, v12
v_mul_f32 v68, v68, v9
v_mul_f32 v69, v69, v9
v_cvt_pk_bf16_f32 v12, v68, v69
v_sub_f32 v70, v70, v8
v_sub_f32 v71, v71, v8
v_cvt_pk_bf16_f32 v13, v70, v71
v_lshlrev_b32 v70, 16, v13
v_and_b32 v71, 0xffff0000, v13
v_mul_f32 v70, v70, v9
v_mul_f32 v71, v71, v9
v_cvt_pk_bf16_f32 v13, v70, v71
v_sub_f32 v72, v72, v8
v_sub_f32 v73, v73, v8
v_cvt_pk_bf16_f32 v14, v72, v73
v_lshlrev_b32 v72, 16, v14
v_and_b32 v73, 0xffff0000, v14
v_mul_f32 v72, v72, v9
v_mul_f32 v73, v73, v9
v_cvt_pk_bf16_f32 v14, v72, v73
v_sub_f32 v74, v74, v8
v_sub_f32 v75, v75, v8
v_cvt_pk_bf16_f32 v15, v74, v75
v_lshlrev_b32 v74, 16, v15
v_and_b32 v75, 0xffff0000, v15
v_mul_f32 v74, v74, v9
v_mul_f32 v75, v75, v9
v_cvt_pk_bf16_f32 v15, v74, v75
v_sub_f32 v76, v76, v8
v_sub_f32 v77, v77, v8
v_cvt_pk_bf16_f32 v16, v76, v77
v_lshlrev_b32 v76, 16, v16
v_and_b32 v77, 0xffff0000, v16
v_mul_f32 v76, v76, v9
v_mul_f32 v77, v77, v9
v_cvt_pk_bf16_f32 v16, v76, v77
v_sub_f32 v78, v78, v8
v_sub_f32 v79, v79, v8
v_cvt_pk_bf16_f32 v17, v78, v79
v_lshlrev_b32 v78, 16, v17
v_and_b32 v79, 0xffff0000, v17
v_mul_f32 v78, v78, v9
v_mul_f32 v79, v79, v9
v_cvt_pk_bf16_f32 v17, v78, v79
v_sub_f32 v80, v80, v8
v_sub_f32 v81, v81, v8
v_cvt_pk_bf16_f32 v18, v80, v81
v_lshlrev_b32 v80, 16, v18
v_and_b32 v81, 0xffff0000, v18
v_mul_f32 v80, v80, v9
v_mul_f32 v81, v81, v9
v_cvt_pk_bf16_f32 v18, v80, v81
v_sub_f32 v82, v82, v8
v_sub_f32 v83, v83, v8
v_cvt_pk_bf16_f32 v19, v82, v83
v_lshlrev_b32 v82, 16, v19
v_and_b32 v83, 0xffff0000, v19
v_mul_f32 v82, v82, v9
v_mul_f32 v83, v83, v9
v_cvt_pk_bf16_f32 v19, v82, v83
v_sub_f32 v84, v84, v8
v_sub_f32 v85, v85, v8
v_cvt_pk_bf16_f32 v20, v84, v85
v_lshlrev_b32 v84, 16, v20
v_and_b32 v85, 0xffff0000, v20
v_mul_f32 v84, v84, v9
v_mul_f32 v85, v85, v9
v_cvt_pk_bf16_f32 v20, v84, v85
v_sub_f32 v86, v86, v8
v_sub_f32 v87, v87, v8
v_cvt_pk_bf16_f32 v21, v86, v87
v_lshlrev_b32 v86, 16, v21
v_and_b32 v87, 0xffff0000, v21
v_mul_f32 v86, v86, v9
v_mul_f32 v87, v87, v9
v_cvt_pk_bf16_f32 v21, v86, v87
v_sub_f32 v88, v88, v8
v_sub_f32 v89, v89, v8
v_cvt_pk_bf16_f32 v22, v88, v89
v_lshlrev_b32 v88, 16, v22
v_and_b32 v89, 0xffff0000, v22
v_mul_f32 v88, v88, v9
v_mul_f32 v89, v89, v9
v_cvt_pk_bf16_f32 v22, v88, v89
v_sub_f32 v90, v90, v8
v_sub_f32 v91, v91, v8
v_cvt_pk_bf16_f32 v23, v90, v91
v_lshlrev_b32 v90, 16, v23
v_and_b32 v91, 0xffff0000, v23
v_mul_f32 v90, v90, v9
v_mul_f32 v91, v91, v9
v_cvt_pk_bf16_f32 v23, v90, v91
v_sub_f32 v92, v92, v8
v_sub_f32 v93, v93, v8
v_cvt_pk_bf16_f32 v24, v92, v93
v_lshlrev_b32 v92, 16, v24
v_and_b32 v93, 0xffff0000, v24
v_mul_f32 v92, v92, v9
v_mul_f32 v93, v93, v9
v_cvt_pk_bf16_f32 v24, v92, v93
v_sub_f32 v94, v94, v8
v_sub_f32 v95, v95, v8
v_cvt_pk_bf16_f32 v25, v94, v95
v_lshlrev_b32 v94, 16, v25
v_and_b32 v95, 0xffff0000, v25
v_mul_f32 v94, v94, v9
v_mul_f32 v95, v95, v9
v_cvt_pk_bf16_f32 v25, v94, v95
v_sub_f32 v96, v96, v8
v_sub_f32 v97, v97, v8
v_cvt_pk_bf16_f32 v26, v96, v97
v_lshlrev_b32 v96, 16, v26
v_and_b32 v97, 0xffff0000, v26
v_mul_f32 v96, v96, v9
v_mul_f32 v97, v97, v9
v_cvt_pk_bf16_f32 v26, v96, v97
v_sub_f32 v98, v98, v8
v_sub_f32 v99, v99, v8
v_cvt_pk_bf16_f32 v27, v98, v99
v_lshlrev_b32 v98, 16, v27
v_and_b32 v99, 0xffff0000, v27
v_mul_f32 v98, v98, v9
v_mul_f32 v99, v99, v9
v_cvt_pk_bf16_f32 v27, v98, v99
v_sub_f32 v100, v100, v8
v_sub_f32 v101, v101, v8
v_cvt_pk_bf16_f32 v28, v100, v101
v_lshlrev_b32 v100, 16, v28
v_and_b32 v101, 0xffff0000, v28
v_mul_f32 v100, v100, v9
v_mul_f32 v101, v101, v9
v_cvt_pk_bf16_f32 v28, v100, v101
v_sub_f32 v102, v102, v8
v_sub_f32 v103, v103, v8
v_cvt_pk_bf16_f32 v29, v102, v103
v_lshlrev_b32 v102, 16, v29
v_and_b32 v103, 0xffff0000, v29
v_mul_f32 v102, v102, v9
v_mul_f32 v103, v103, v9
v_cvt_pk_bf16_f32 v29, v102, v103
v_sub_f32 v104, v104, v8
v_sub_f32 v105, v105, v8
v_cvt_pk_bf16_f32 v30, v104, v105
v_lshlrev_b32 v104, 16, v30
v_and_b32 v105, 0xffff0000, v30
v_mul_f32 v104, v104, v9
v_mul_f32 v105, v105, v9
v_cvt_pk_bf16_f32 v30, v104, v105
v_sub_f32 v106, v106, v8
v_sub_f32 v107, v107, v8
v_cvt_pk_bf16_f32 v31, v106, v107
v_lshlrev_b32 v106, 16, v31
v_and_b32 v107, 0xffff0000, v31
v_mul_f32 v106, v106, v9
v_mul_f32 v107, v107, v9
v_cvt_pk_bf16_f32 v31, v106, v107
v_sub_f32 v108, v108, v8
v_sub_f32 v109, v109, v8
v_cvt_pk_bf16_f32 v32, v108, v109
v_lshlrev_b32 v108, 16, v32
v_and_b32 v109, 0xffff0000, v32
v_mul_f32 v108, v108, v9
v_mul_f32 v109, v109, v9
v_cvt_pk_bf16_f32 v32, v108, v109
v_sub_f32 v110, v110, v8
v_sub_f32 v111, v111, v8
v_cvt_pk_bf16_f32 v33, v110, v111
v_lshlrev_b32 v110, 16, v33
v_and_b32 v111, 0xffff0000, v33
v_mul_f32 v110, v110, v9
v_mul_f32 v111, v111, v9
v_cvt_pk_bf16_f32 v33, v110, v111
v_sub_f32 v112, v112, v8
v_sub_f32 v113, v113, v8
v_cvt_pk_bf16_f32 v34, v112, v113
v_lshlrev_b32 v112, 16, v34
v_and_b32 v113, 0xffff0000, v34
v_mul_f32 v112, v112, v9
v_mul_f32 v113, v113, v9
v_cvt_pk_bf16_f32 v34, v112, v113
v_sub_f32 v114, v114, v8
v_sub_f32 v115, v115, v8
v_cvt_pk_bf16_f32 v35, v114, v115
v_lshlrev_b32 v114, 16, v35
v_and_b32 v115, 0xffff0000, v35
v_mul_f32 v114, v114, v9
v_mul_f32 v115, v115, v9
v_cvt_pk_bf16_f32 v35, v114, v115
v_sub_f32 v116, v116, v8
v_sub_f32 v117, v117, v8
v_cvt_pk_bf16_f32 v36, v116, v117
v_lshlrev_b32 v116, 16, v36
v_and_b32 v117, 0xffff0000, v36
v_mul_f32 v116, v116, v9
v_mul_f32 v117, v117, v9
v_cvt_pk_bf16_f32 v36, v116, v117
v_sub_f32 v118, v118, v8
v_sub_f32 v119, v119, v8
v_cvt_pk_bf16_f32 v37, v118, v119
v_lshlrev_b32 v118, 16, v37
v_and_b32 v119, 0xffff0000, v37
v_mul_f32 v118, v118, v9
v_mul_f32 v119, v119, v9
v_cvt_pk_bf16_f32 v37, v118, v119
v_sub_f32 v120, v120, v8
v_sub_f32 v121, v121, v8
v_cvt_pk_bf16_f32 v38, v120, v121
v_lshlrev_b32 v120, 16, v38
v_and_b32 v121, 0xffff0000, v38
v_mul_f32 v120, v120, v9
v_mul_f32 v121, v121, v9
v_cvt_pk_bf16_f32 v38, v120, v121
v_sub_f32 v122, v122, v8
v_sub_f32 v123, v123, v8
v_cvt_pk_bf16_f32 v39, v122, v123
v_lshlrev_b32 v122, 16, v39
v_and_b32 v123, 0xffff0000, v39
v_mul_f32 v122, v122, v9
v_mul_f32 v123, v123, v9
v_cvt_pk_bf16_f32 v39, v122, v123
v_sub_f32 v124, v124, v8
v_sub_f32 v125, v125, v8
v_cvt_pk_bf16_f32 v40, v124, v125
v_lshlrev_b32 v124, 16, v40
v_and_b32 v125, 0xffff0000, v40
v_mul_f32 v124, v124, v9
v_mul_f32 v125, v125, v9
v_cvt_pk_bf16_f32 v40, v124, v125
v_sub_f32 v126, v126, v8
v_sub_f32 v127, v127, v8
v_cvt_pk_bf16_f32 v41, v126, v127
v_lshlrev_b32 v126, 16, v41
v_and_b32 v127, 0xffff0000, v41
v_mul_f32 v126, v126, v9
v_mul_f32 v127, v127, v9
v_cvt_pk_bf16_f32 v41, v126, v127
v_sub_f32 v128, v128, v8
v_sub_f32 v129, v129, v8
v_cvt_pk_bf16_f32 v42, v128, v129
v_lshlrev_b32 v128, 16, v42
v_and_b32 v129, 0xffff0000, v42
v_mul_f32 v128, v128, v9
v_mul_f32 v129, v129, v9
v_cvt_pk_bf16_f32 v42, v128, v129
v_sub_f32 v130, v130, v8
v_sub_f32 v131, v131, v8
v_cvt_pk_bf16_f32 v43, v130, v131
v_lshlrev_b32 v130, 16, v43
v_and_b32 v131, 0xffff0000, v43
v_mul_f32 v130, v130, v9
v_mul_f32 v131, v131, v9
v_cvt_pk_bf16_f32 v43, v130, v131
v_sub_f32 v132, v132, v8
v_sub_f32 v133, v133, v8
v_cvt_pk_bf16_f32 v44, v132, v133
v_lshlrev_b32 v132, 16, v44
v_and_b32 v133, 0xffff0000, v44
v_mul_f32 v132, v132, v9
v_mul_f32 v133, v133, v9
v_cvt_pk_bf16_f32 v44, v132, v133
v_sub_f32 v134, v134, v8
v_sub_f32 v135, v135, v8
v_cvt_pk_bf16_f32 v45, v134, v135
v_lshlrev_b32 v134, 16, v45
v_and_b32 v135, 0xffff0000, v45
v_mul_f32 v134, v134, v9
v_mul_f32 v135, v135, v9
v_cvt_pk_bf16_f32 v45, v134, v135
v_sub_f32 v136, v136, v8
v_sub_f32 v137, v137, v8
v_cvt_pk_bf16_f32 v46, v136, v137
v_lshlrev_b32 v136, 16, v46
v_and_b32 v137, 0xffff0000, v46
v_mul_f32 v136, v136, v9
v_mul_f32 v137, v137, v9
v_cvt_pk_bf16_f32 v46, v136, v137
v_sub_f32 v138, v138, v8
v_sub_f32 v139, v139, v8
v_cvt_pk_bf16_f32 v47, v138, v139
v_lshlrev_b32 v138, 16, v47
v_and_b32 v139, 0xffff0000, v47
v_mul_f32 v138, v138, v9
v_mul_f32 v139, v139, v9
v_cvt_pk_bf16_f32 v47, v138, v139
v_sub_f32 v140, v140, v8
v_sub_f32 v141, v141, v8
v_cvt_pk_bf16_f32 v48, v140, v141
v_lshlrev_b32 v140, 16, v48
v_and_b32 v141, 0xffff0000, v48
v_mul_f32 v140, v140, v9
v_mul_f32 v141, v141, v9
v_cvt_pk_bf16_f32 v48, v140, v141
v_sub_f32 v142, v142, v8
v_sub_f32 v143, v143, v8
v_cvt_pk_bf16_f32 v49, v142, v143
v_lshlrev_b32 v142, 16, v49
v_and_b32 v143, 0xffff0000, v49
v_mul_f32 v142, v142, v9
v_mul_f32 v143, v143, v9
v_cvt_pk_bf16_f32 v49, v142, v143
v_sub_f32 v144, v144, v8
v_sub_f32 v145, v145, v8
v_cvt_pk_bf16_f32 v50, v144, v145
v_lshlrev_b32 v144, 16, v50
v_and_b32 v145, 0xffff0000, v50
v_mul_f32 v144, v144, v9
v_mul_f32 v145, v145, v9
v_cvt_pk_bf16_f32 v50, v144, v145
v_sub_f32 v146, v146, v8
v_sub_f32 v147, v147, v8
v_cvt_pk_bf16_f32 v51, v146, v147
v_lshlrev_b32 v146, 16, v51
v_and_b32 v147, 0xffff0000, v51
v_mul_f32 v146, v146, v9
v_mul_f32 v147, v147, v9
v_cvt_pk_bf16_f32 v51, v146, v147
v_sub_f32 v148, v148, v8
v_sub_f32 v149, v149, v8
v_cvt_pk_bf16_f32 v52, v148, v149
v_lshlrev_b32 v148, 16, v52
v_and_b32 v149, 0xffff0000, v52
v_mul_f32 v148, v148, v9
v_mul_f32 v149, v149, v9
v_cvt_pk_bf16_f32 v52, v148, v149
v_sub_f32 v150, v150, v8
v_sub_f32 v151, v151, v8
v_cvt_pk_bf16_f32 v53, v150, v151
v_lshlrev_b32 v150, 16, v53
v_and_b32 v151, 0xffff0000, v53
v_mul_f32 v150, v150, v9
v_mul_f32 v151, v151, v9
v_cvt_pk_bf16_f32 v53, v150, v151
v_sub_f32 v152, v152, v8
v_sub_f32 v153, v153, v8
v_cvt_pk_bf16_f32 v54, v152, v153
v_lshlrev_b32 v152, 16, v54
v_and_b32 v153, 0xffff0000, v54
v_mul_f32 v152, v152, v9
v_mul_f32 v153, v153, v9
v_cvt_pk_bf16_f32 v54, v152, v153
v_sub_f32 v154, v154, v8
v_sub_f32 v155, v155, v8
v_cvt_pk_bf16_f32 v55, v154, v155
v_lshlrev_b32 v154, 16, v55
v_and_b32 v155, 0xffff0000, v55
v_mul_f32 v154, v154, v9
v_mul_f32 v155, v155, v9
v_cvt_pk_bf16_f32 v55, v154, v155
v_sub_f32 v156, v156, v8
v_sub_f32 v157, v157, v8
v_cvt_pk_bf16_f32 v56, v156, v157
v_lshlrev_b32 v156, 16, v56
v_and_b32 v157, 0xffff0000, v56
v_mul_f32 v156, v156, v9
v_mul_f32 v157, v157, v9
v_cvt_pk_bf16_f32 v56, v156, v157
v_sub_f32 v158, v158, v8
v_sub_f32 v159, v159, v8
v_cvt_pk_bf16_f32 v57, v158, v159
v_lshlrev_b32 v158, 16, v57
v_and_b32 v159, 0xffff0000, v57
v_mul_f32 v158, v158, v9
v_mul_f32 v159, v159, v9
v_cvt_pk_bf16_f32 v57, v158, v159
v_sub_f32 v160, v160, v8
v_sub_f32 v161, v161, v8
v_cvt_pk_bf16_f32 v58, v160, v161
v_lshlrev_b32 v160, 16, v58
v_and_b32 v161, 0xffff0000, v58
v_mul_f32 v160, v160, v9
v_mul_f32 v161, v161, v9
v_cvt_pk_bf16_f32 v58, v160, v161
v_sub_f32 v162, v162, v8
v_sub_f32 v163, v163, v8
v_cvt_pk_bf16_f32 v59, v162, v163
v_lshlrev_b32 v162, 16, v59
v_and_b32 v163, 0xffff0000, v59
v_mul_f32 v162, v162, v9
v_mul_f32 v163, v163, v9
v_cvt_pk_bf16_f32 v59, v162, v163
v_sub_f32 v164, v164, v8
v_sub_f32 v165, v165, v8
v_cvt_pk_bf16_f32 v60, v164, v165
v_lshlrev_b32 v164, 16, v60
v_and_b32 v165, 0xffff0000, v60
v_mul_f32 v164, v164, v9
v_mul_f32 v165, v165, v9
v_cvt_pk_bf16_f32 v60, v164, v165
v_sub_f32 v166, v166, v8
v_sub_f32 v167, v167, v8
v_cvt_pk_bf16_f32 v61, v166, v167
v_lshlrev_b32 v166, 16, v61
v_and_b32 v167, 0xffff0000, v61
v_mul_f32 v166, v166, v9
v_mul_f32 v167, v167, v9
v_cvt_pk_bf16_f32 v61, v166, v167
v_sub_f32 v168, v168, v8
v_sub_f32 v169, v169, v8
v_cvt_pk_bf16_f32 v62, v168, v169
v_lshlrev_b32 v168, 16, v62
v_and_b32 v169, 0xffff0000, v62
v_mul_f32 v168, v168, v9
v_mul_f32 v169, v169, v9
v_cvt_pk_bf16_f32 v62, v168, v169
v_sub_f32 v170, v170, v8
v_sub_f32 v171, v171, v8
v_cvt_pk_bf16_f32 v63, v170, v171
v_lshlrev_b32 v170, 16, v63
v_and_b32 v171, 0xffff0000, v63
v_mul_f32 v170, v170, v9
v_mul_f32 v171, v171, v9
v_cvt_pk_bf16_f32 v63, v170, v171
v_sub_f32 v172, v172, v8
v_sub_f32 v173, v173, v8
v_cvt_pk_bf16_f32 v64, v172, v173
v_lshlrev_b32 v172, 16, v64
v_and_b32 v173, 0xffff0000, v64
v_mul_f32 v172, v172, v9
v_mul_f32 v173, v173, v9
v_cvt_pk_bf16_f32 v64, v172, v173
v_sub_f32 v174, v174, v8
v_sub_f32 v175, v175, v8
v_cvt_pk_bf16_f32 v65, v174, v175
v_lshlrev_b32 v174, 16, v65
v_and_b32 v175, 0xffff0000, v65
v_mul_f32 v174, v174, v9
v_mul_f32 v175, v175, v9
v_cvt_pk_bf16_f32 v65, v174, v175
v_sub_f32 v176, v176, v8
v_sub_f32 v177, v177, v8
v_cvt_pk_bf16_f32 v66, v176, v177
v_lshlrev_b32 v176, 16, v66
v_and_b32 v177, 0xffff0000, v66
v_mul_f32 v176, v176, v9
v_mul_f32 v177, v177, v9
v_cvt_pk_bf16_f32 v66, v176, v177
v_sub_f32 v178, v178, v8
v_sub_f32 v179, v179, v8
v_cvt_pk_bf16_f32 v67, v178, v179
v_lshlrev_b32 v178, 16, v67
v_and_b32 v179, 0xffff0000, v67
v_mul_f32 v178, v178, v9
v_mul_f32 v179, v179, v9
v_cvt_pk_bf16_f32 v67, v178, v179
s_lshl_b32 s20, s10, 14
s_add_u32 s20, s20, 52428800
buffer_store_dwordx4 v[12:15], v6, s[4:7], s20 offen offset:0 sc1
buffer_store_dwordx4 v[16:19], v6, s[4:7], s20 offen offset:1024 sc1
buffer_store_dwordx4 v[20:23], v6, s[4:7], s20 offen offset:2048 sc1
buffer_store_dwordx4 v[24:27], v6, s[4:7], s20 offen offset:3072 sc1
s_add_u32 s20, s20, 4096
buffer_store_dwordx4 v[28:31], v6, s[4:7], s20 offen offset:0 sc1
buffer_store_dwordx4 v[32:35], v6, s[4:7], s20 offen offset:1024 sc1
buffer_store_dwordx4 v[36:39], v6, s[4:7], s20 offen offset:2048 sc1
buffer_store_dwordx4 v[40:43], v6, s[4:7], s20 offen offset:3072 sc1
s_add_u32 s20, s20, 4096
buffer_store_dwordx4 v[44:47], v6, s[4:7], s20 offen offset:0 sc1
buffer_store_dwordx4 v[48:51], v6, s[4:7], s20 offen offset:1024 sc1
buffer_store_dwordx4 v[52:55], v6, s[4:7], s20 offen offset:2048 sc1
buffer_store_dwordx4 v[56:59], v6, s[4:7], s20 offen offset:3072 sc1
s_add_u32 s20, s20, 4096
buffer_store_dwordx4 v[60:63], v6, s[4:7], s20 offen offset:0 sc1
buffer_store_dwordx4 v[64:67], v6, s[4:7], s20 offen offset:1024 sc1
v_mov_b32 v180, v12
v_mov_b32 v182, v13
v_mov_b32 v184, v14
v_mov_b32 v186, v15
v_mov_b32 v181, v16
v_mov_b32 v183, v17
v_mov_b32 v185, v18
v_mov_b32 v187, v19
v_permlane16_swap_b32 v180, v184
v_permlane16_swap_b32 v181, v185
v_permlane16_swap_b32 v182, v186
v_permlane16_swap_b32 v183, v187
v_permlane32_swap_b32 v180, v184
v_permlane32_swap_b32 v181, v185
v_permlane32_swap_b32 v182, v186
v_permlane32_swap_b32 v183, v187
v_mov_b32 v188, v20
v_mov_b32 v190, v21
v_mov_b32 v192, v22
v_mov_b32 v194, v23
v_mov_b32 v189, v24
v_mov_b32 v191, v25
v_mov_b32 v193, v26
v_mov_b32 v195, v27
v_permlane16_swap_b32 v188, v192
v_permlane16_swap_b32 v189, v193
v_permlane16_swap_b32 v190, v194
v_permlane16_swap_b32 v191, v195
v_permlane32_swap_b32 v188, v192
v_permlane32_swap_b32 v189, v193
v_permlane32_swap_b32 v190, v194
v_permlane32_swap_b32 v191, v195
v_mov_b32 v196, v28
v_mov_b32 v198, v29
v_mov_b32 v200, v30
v_mov_b32 v202, v31
v_mov_b32 v197, v32
v_mov_b32 v199, v33
v_mov_b32 v201, v34
v_mov_b32 v203, v35
v_permlane16_swap_b32 v196, v200
v_permlane16_swap_b32 v197, v201
v_permlane16_swap_b32 v198, v202
v_permlane16_swap_b32 v199, v203
v_permlane32_swap_b32 v196, v200
v_permlane32_swap_b32 v197, v201
v_permlane32_swap_b32 v198, v202
v_permlane32_swap_b32 v199, v203
v_mov_b32 v204, v36
v_mov_b32 v206, v37
v_mov_b32 v208, v38
v_mov_b32 v210, v39
v_mov_b32 v205, v40
v_mov_b32 v207, v41
v_mov_b32 v209, v42
v_mov_b32 v211, v43
v_permlane16_swap_b32 v204, v208
v_permlane16_swap_b32 v205, v209
v_permlane16_swap_b32 v206, v210
v_permlane16_swap_b32 v207, v211
v_permlane32_swap_b32 v204, v208
v_permlane32_swap_b32 v205, v209
v_permlane32_swap_b32 v206, v210
v_permlane32_swap_b32 v207, v211
v_mov_b32 v212, v44
v_mov_b32 v214, v45
v_mov_b32 v216, v46
v_mov_b32 v218, v47
v_mov_b32 v213, v48
v_mov_b32 v215, v49
v_mov_b32 v217, v50
v_mov_b32 v219, v51
v_permlane16_swap_b32 v212, v216
v_permlane16_swap_b32 v213, v217
v_permlane16_swap_b32 v214, v218
v_permlane16_swap_b32 v215, v219
v_permlane32_swap_b32 v212, v216
v_permlane32_swap_b32 v213, v217
v_permlane32_swap_b32 v214, v218
v_permlane32_swap_b32 v215, v219
v_mov_b32 v220, v52
v_mov_b32 v222, v53
v_mov_b32 v224, v54
v_mov_b32 v226, v55
v_mov_b32 v221, v56
v_mov_b32 v223, v57
v_mov_b32 v225, v58
v_mov_b32 v227, v59
v_permlane16_swap_b32 v220, v224
v_permlane16_swap_b32 v221, v225
v_permlane16_swap_b32 v222, v226
v_permlane16_swap_b32 v223, v227
v_permlane32_swap_b32 v220, v224
v_permlane32_swap_b32 v221, v225
v_permlane32_swap_b32 v222, v226
v_permlane32_swap_b32 v223, v227
v_mov_b32 v228, v60
v_mov_b32 v230, v61
v_mov_b32 v232, v62
v_mov_b32 v234, v63
v_mov_b32 v229, v64
v_mov_b32 v231, v65
v_mov_b32 v233, v66
v_mov_b32 v235, v67
v_permlane16_swap_b32 v228, v232
v_permlane16_swap_b32 v229, v233
v_permlane16_swap_b32 v230, v234
v_permlane16_swap_b32 v231, v235
v_permlane32_swap_b32 v228, v232
v_permlane32_swap_b32 v229, v233
v_permlane32_swap_b32 v230, v234
v_permlane32_swap_b32 v231, v235
v_and_b32 v4, 1, v2
v_cmp_eq_u32 vcc, 0, v4
s_nop 1
v_cndmask_b32 v236, v228, v212, vcc
v_cndmask_b32 v237, v229, v221, vcc
v_cndmask_b32 v238, v230, v214, vcc
v_cndmask_b32 v239, v231, v223, vcc
v_cndmask_b32 v240, v232, v216, vcc
v_cndmask_b32 v241, v233, v225, vcc
v_cndmask_b32 v242, v234, v218, vcc
v_cndmask_b32 v243, v235, v227, vcc
s_lshr_b32 s20, s10, 1
s_lshl_b32 s20, s20, 15
s_and_b32 s21, s10, 1
s_lshl_b32 s21, s21, 11
s_add_u32 s20, s20, s21
s_add_u32 s20, s20, 50331648
s_add_u32 s21, s20, 0
buffer_store_dwordx4 v[180:183], v6, s[4:7], s21 offen sc1
buffer_store_dwordx4 v[184:187], v6, s[4:7], s21 offen offset:1024 sc1
s_add_u32 s21, s20, 8192
buffer_store_dwordx4 v[188:191], v6, s[4:7], s21 offen sc1
buffer_store_dwordx4 v[192:195], v6, s[4:7], s21 offen offset:1024 sc1
s_add_u32 s21, s20, 16384
buffer_store_dwordx4 v[196:199], v6, s[4:7], s21 offen sc1
buffer_store_dwordx4 v[200:203], v6, s[4:7], s21 offen offset:1024 sc1
s_add_u32 s21, s20, 24576
buffer_store_dwordx4 v[204:207], v6, s[4:7], s21 offen sc1
buffer_store_dwordx4 v[208:211], v6, s[4:7], s21 offen offset:1024 sc1
s_add_u32 s21, s20, 4096
buffer_store_dwordx4 v[212:215], v6, s[4:7], s21 offen sc1
buffer_store_dwordx4 v[216:219], v6, s[4:7], s21 offen offset:1024 sc1
s_add_u32 s21, s20, 12288
buffer_store_dwordx4 v[220:223], v6, s[4:7], s21 offen sc1
buffer_store_dwordx4 v[224:227], v6, s[4:7], s21 offen offset:1024 sc1
s_add_u32 s21, s20, 20480
buffer_store_dwordx4 v[228:231], v6, s[4:7], s21 offen sc1
buffer_store_dwordx4 v[232:235], v6, s[4:7], s21 offen offset:1024 sc1
s_add_u32 s21, s20, 28672
buffer_store_dwordx4 v[236:239], v6, s[4:7], s21 offen sc1
buffer_store_dwordx4 v[240:243], v6, s[4:7], s21 offen offset:1024 sc1
LN_END:
buffer_load_dword v253, v252, s[84:87], 0 offen sc1
s_waitcnt vmcnt(0)
s_barrier
s_cmp_lg_u32 s9, 0
s_cbranch_scc1 DW_9
v_readfirstlane_b32 s92, v253
s_nop 0
s_cmp_eq_u32 s92, 1
s_cbranch_scc1 DK_11
v_mov_b32 v250, 1
v_mov_b32 v251, 20
s_mov_b64 exec, 1
buffer_atomic_add v250, v251, s[84:87], 0 offen sc0
s_mov_b64 exec, -1
s_mov_b32 s91, 200000
s_waitcnt vmcnt(0)
v_readfirstlane_b32 s92, v250
s_nop 0
s_cmp_lg_u32 s92, 0
s_cbranch_scc1 DL_10
v_lshlrev_b32 v250, 4, v0
v_mov_b32 v244, 0
v_mov_b32 v245, 0
v_mov_b32 v246, 0
v_mov_b32 v247, 0
s_mov_b32 s92, 71319552
DZ_12:
buffer_store_dwordx4 v[244:247], v250, s[4:7], s92 offen sc1
s_add_u32 s92, s92, 1024
s_cmp_lt_u32 s92, 71344128
s_cbranch_scc1 DZ_12
v_mov_b32 v253, 1
s_waitcnt vmcnt(0)
buffer_store_dword v253, v252, s[84:87], 0 offen sc1
s_branch DK_11
DL_10:
s_sleep 4
buffer_load_dword v253, v252, s[84:87], 0 offen sc1
s_sub_u32 s91, s91, 1
s_waitcnt vmcnt(0)
v_readfirstlane_b32 s92, v253
s_nop 0
s_cmp_eq_u32 s92, 1
s_cbranch_scc1 DK_11
s_cmp_gt_i32 s91, 0
s_cbranch_scc1 DL_10
DK_11:
v_lshlrev_b32 v250, 7, v0
v_add_u32 v250, s89, v250
v_mov_b32 v251, 1073741824
v_cmp_gt_u32 vcc, s90, v0
s_nop 1
v_cndmask_b32 v250, v251, v250, vcc
v_mov_b32 v251, 1
s_mov_b32 s92, 71319552
buffer_store_dword v251, v250, s[4:7], s92 offen sc1
DW_9:
s_cmp_ge_u32 s10, 64
s_cbranch_scc1 F_CONT
PREP_DONE:
v_mov_b32 v4, 0
s_cmp_lg_u32 s9, 0
s_cbranch_scc1 EL_WAIT
v_readfirstlane_b32 s20, v249
s_nop 0
s_and_b32 s20, s20, s93
s_mov_b32 s21, -1
s_cbranch_scc0 EL_PUB
s_lshl_b32 s20, s88, 2
s_add_u32 s20, s20, 192
v_mov_b32 v1, 1
v_mov_b32 v2, s20
v_mov_b32 v3, 8
s_mov_b64 exec, 1
buffer_atomic_add v1, v3, s[84:87], 0 offen
buffer_atomic_add v1, v2, s[84:87], 0 offen sc0
s_waitcnt vmcnt(0)
s_mov_b64 exec, -1
v_readfirstlane_b32 s94, v1
v_and_b32 v1, 15, v0
v_lshlrev_b32 v1, 2, v1
s_mov_b32 s22, 200000
EL_SUM:
buffer_load_dword v3, v1, s[84:87], 0 offen offset:160 sc1
s_waitcnt vmcnt(0)
s_mov_b32 s23, 0
v_readlane_b32 s24, v3, 0
v_readlane_b32 s25, v3, 1
v_readlane_b32 s26, v3, 2
v_readlane_b32 s27, v3, 3
v_readlane_b32 s28, v3, 4
v_readlane_b32 s29, v3, 5
v_readlane_b32 s30, v3, 6
v_readlane_b32 s31, v3, 7
v_readlane_b32 s32, v3, 8
v_readlane_b32 s33, v3, 9
v_readlane_b32 s34, v3, 10
v_readlane_b32 s35, v3, 11
v_readlane_b32 s36, v3, 12
v_readlane_b32 s37, v3, 13
v_readlane_b32 s38, v3, 14
v_readlane_b32 s39, v3, 15
s_bcnt1_i32_b32 s20, s24
s_add_u32 s23, s23, s20
s_add_u32 s23, s23, s32
s_bcnt1_i32_b32 s20, s25
s_add_u32 s23, s23, s20
s_add_u32 s23, s23, s33
s_bcnt1_i32_b32 s20, s26
s_add_u32 s23, s23, s20
s_add_u32 s23, s23, s34
s_bcnt1_i32_b32 s20, s27
s_add_u32 s23, s23, s20
s_add_u32 s23, s23, s35
s_bcnt1_i32_b32 s20, s28
s_add_u32 s23, s23, s20
s_add_u32 s23, s23, s36
s_bcnt1_i32_b32 s20, s29
s_add_u32 s23, s23, s20
s_add_u32 s23, s23, s37
s_bcnt1_i32_b32 s20, s30
s_add_u32 s23, s23, s20
s_add_u32 s23, s23, s38
s_bcnt1_i32_b32 s20, s31
s_add_u32 s23, s23, s20
s_add_u32 s23, s23, s39
s_sub_u32 s22, s22, 1
s_cmp_gt_i32 s22, 0
s_cbranch_scc0 EL_BAD
s_cmp_lt_u32 s23, 256
s_cbranch_scc1 EL_SUM
v_readlane_b32 s95, v3, s88
s_mov_b32 s21, 0
s_bcnt0_i32_b32 s20, s95
s_cmp_lt_u32 s94, s20
s_cbranch_scc1 EL_BIT
v_mov_b32 v1, 1
v_mov_b32 v2, 4
s_mov_b64 exec, 1
buffer_atomic_add v1, v2, s[84:87], 0 offen sc0
s_waitcnt vmcnt(0)
s_mov_b64 exec, -1
v_readfirstlane_b32 s22, v1
s_mov_b32 s21, 256
s_bcnt0_i32_b32 s20, s24
s_min_u32 s23, s20, s32
s_sub_u32 s20, s20, s23
s_add_u32 s94, s23, s22
s_mov_b32 s95, s24
s_mov_b32 s88, 0
s_cmp_lt_u32 s22, s20
s_cbranch_scc1 EL_BIT
s_sub_u32 s22, s22, s20
s_bcnt0_i32_b32 s20, s25
s_min_u32 s23, s20, s33
s_sub_u32 s20, s20, s23
s_add_u32 s94, s23, s22
s_mov_b32 s95, s25
s_mov_b32 s88, 1
s_cmp_lt_u32 s22, s20
s_cbranch_scc1 EL_BIT
s_sub_u32 s22, s22, s20
s_bcnt0_i32_b32 s20, s26
s_min_u32 s23, s20, s34
s_sub_u32 s20, s20, s23
s_add_u32 s94, s23, s22
s_mov_b32 s95, s26
s_mov_b32 s88, 2
s_cmp_lt_u32 s22, s20
s_cbranch_scc1 EL_BIT
s_sub_u32 s22, s22, s20
s_bcnt0_i32_b32 s20, s27
s_min_u32 s23, s20, s35
s_sub_u32 s20, s20, s23
s_add_u32 s94, s23, s22
s_mov_b32 s95, s27
s_mov_b32 s88, 3
s_cmp_lt_u32 s22, s20
s_cbranch_scc1 EL_BIT
s_sub_u32 s22, s22, s20
s_bcnt0_i32_b32 s20, s28
s_min_u32 s23, s20, s36
s_sub_u32 s20, s20, s23
s_add_u32 s94, s23, s22
s_mov_b32 s95, s28
s_mov_b32 s88, 4
s_cmp_lt_u32 s22, s20
s_cbranch_scc1 EL_BIT
s_sub_u32 s22, s22, s20
s_bcnt0_i32_b32 s20, s29
s_min_u32 s23, s20, s37
s_sub_u32 s20, s20, s23
s_add_u32 s94, s23, s22
s_mov_b32 s95, s29
s_mov_b32 s88, 5
s_cmp_lt_u32 s22, s20
s_cbranch_scc1 EL_BIT
s_sub_u32 s22, s22, s20
s_bcnt0_i32_b32 s20, s30
s_min_u32 s23, s20, s38
s_sub_u32 s20, s20, s23
s_add_u32 s94, s23, s22
s_mov_b32 s95, s30
s_mov_b32 s88, 6
s_cmp_lt_u32 s22, s20
s_cbranch_scc1 EL_BIT
s_sub_u32 s22, s22, s20
s_bcnt0_i32_b32 s20, s31
s_min_u32 s23, s20, s39
s_sub_u32 s20, s20, s23
s_add_u32 s94, s23, s22
s_mov_b32 s95, s31
s_mov_b32 s88, 7
s_cmp_lt_u32 s22, s20
s_cbranch_scc1 EL_BIT
s_sub_u32 s22, s22, s20
EL_BAD:
s_mov_b32 s21, -2
s_branch EL_PUB
EL_BIT:
s_ff0_i32_b32 s20, s95
s_bitset1_b32 s95, s20
s_sub_u32 s94, s94, 1
s_cbranch_scc0 EL_BIT
s_and_b32 s20, s20, 31
s_add_u32 s21, s21, s20
s_lshl_b32 s20, s88, 16
s_add_u32 s21, s21, s20
EL_PUB:
v_mov_b32 v1, s21
ds_write_b32 v4, v1
s_waitcnt lgkmcnt(0)
EL_WAIT:
s_barrier
ds_read_b32 v1, v4
s_waitcnt lgkmcnt(0)
v_readfirstlane_b32 s21, v1
s_nop 0
s_cmp_eq_u32 s21, -1
s_cbranch_scc1 EL_OK
s_cmp_eq_u32 s21, -2
s_cbranch_scc1 EXIT
s_barrier
s_bfe_u32 s66, s21, 0x10008
s_bfe_u32 s88, s21, 0x30010
s_and_b32 s21, s21, 31
s_mov_b32 s93, 0
v_mov_b32 v248, 1073741824
s_branch SLOT
EL_OK:
s_load_dwordx2 s[16:17], s[0:1], 8
s_mov_b32 s18, 7168
s_mov_b32 s19, 0x20000
s_mov_b32 s8, s100
s_waitcnt lgkmcnt(0)
s_cmp_ge_u32 s8, 32
s_cbranch_scc1 WORKER
s_and_b32 s11, s8, 15
s_cmp_ge_u32 s8, 16
s_cbranch_scc1 ROLE_VO
s_barrier
s_cmp_eq_u32 s9, 0
s_cbranch_scc1 QK0
s_cmp_eq_u32 s9, 1
s_cbranch_scc1 QK1
s_cmp_eq_u32 s9, 2
s_cbranch_scc1 QK2
s_branch QK3
ROLE_VO:
s_cmp_ge_u32 s11, 14
s_cbranch_scc1 ROLE_EN
s_barrier
s_cmp_eq_u32 s9, 0
s_cbranch_scc1 VO0
s_cmp_eq_u32 s9, 1
s_cbranch_scc1 VO1
s_cmp_eq_u32 s9, 2
s_cbranch_scc1 VO2
s_branch VO3
ROLE_EN:
v_lshlrev_b32 v1, 7, v0
s_and_b32 s20, s11, 1
s_mul_i32 s20, s20, 294912
s_add_u32 s20, s20, 54525952
buffer_load_dword v9, v1, s[4:7], s20 offen sc1
s_add_u32 s20, s20, 32768
buffer_load_dword v9, v1, s[4:7], s20 offen sc1
s_add_u32 s20, s20, 32768
buffer_load_dword v9, v1, s[4:7], s20 offen sc1
s_add_u32 s20, s20, 32768
buffer_load_dword v9, v1, s[4:7], s20 offen sc1
s_add_u32 s20, s20, 32768
buffer_load_dword v9, v1, s[4:7], s20 offen sc1
s_add_u32 s20, s20, 32768
buffer_load_dword v9, v1, s[4:7], s20 offen sc1
s_add_u32 s20, s20, 32768
buffer_load_dword v9, v1, s[4:7], s20 offen sc1
s_add_u32 s20, s20, 32768
buffer_load_dword v9, v1, s[4:7], s20 offen sc1
s_add_u32 s20, s20, 32768
buffer_load_dword v9, v1, s[4:7], s20 offen sc1
s_add_u32 s20, s20, 32768
s_waitcnt vmcnt(0)
s_cmp_lg_u32 s9, 0
s_cbranch_scc1 RB_14
s_mov_b32 s23, 71319552
s_and_b32 s22, s8, 7
s_lshl_b32 s22, s22, 7
s_add_u32 s22, s22, 21504
v_and_b32 v1, 15, v0
v_lshlrev_b32 v1, 2, v1
v_add_u32 v1, s22, v1
v_and_b32 v3, 15, v0
v_min_u32 v3, 13, v3
v_lshlrev_b32 v3, 2, v3
s_mov_b32 s22, 200000
RW_13:
buffer_load_dword v3, v1, s[4:7], s23 offen sc1
s_sub_u32 s22, s22, 1
s_cmp_gt_i32 s22, 0
s_cbranch_scc0 RB_14
s_waitcnt vmcnt(0)
v_cmp_ne_u32 vcc, 1, v3
s_cbranch_vccz RB_14
s_sleep 4
s_branch RW_13
RB_14:
s_barrier
s_cmp_eq_u32 s9, 0
s_cbranch_scc1 EN0
s_cmp_eq_u32 s9, 1
s_cbranch_scc1 EN1
s_cmp_eq_u32 s9, 2
s_cbranch_scc1 EN2
s_branch EN3
WORKER:
s_sub_u32 s8, s8, 32
s_cmp_ge_u32 s8, 112
s_cbranch_scc1 ROLE_F
s_cmp_ge_u32 s8, 48
s_cbranch_scc1 ROLE_T
s_mov_b32 s20, s8
s_cmp_ge_u32 s20, 36
s_cbranch_scc1 WK_HIY
s_cmp_ge_u32 s20, 18
s_cselect_b32 s21, 18, 0
s_cselect_b32 s10, 6, 0
s_sub_u32 s20, s20, s21
s_mul_i32 s11, s20, 43
s_lshr_b32 s11, s11, 8
s_mul_i32 s21, s11, 6
s_sub_u32 s20, s20, s21
s_add_u32 s10, s10, s20
s_branch WK_GOY
WK_HIY:
s_sub_u32 s20, s20, 36
s_mul_i32 s10, s20, 86
s_lshr_b32 s10, s10, 8
s_mul_i32 s21, s10, 3
s_sub_u32 s11, s20, s21
s_add_u32 s10, s10, 12
WK_GOY:
s_lshl_b32 s21, s10, 1
s_add_u32 s21, s21, 1
s_cmp_lg_u32 s9, 0
s_cbranch_scc1 RB_16
s_mov_b32 s23, 71319552
s_and_b32 s22, s8, 7
s_lshl_b32 s22, s22, 7
s_add_u32 s22, s22, 21504
v_and_b32 v1, 15, v0
v_lshlrev_b32 v1, 2, v1
v_add_u32 v1, s22, v1
v_and_b32 v3, 15, v0
v_min_u32 v3, 13, v3
v_lshlrev_b32 v3, 2, v3
s_lshl_b32 s21, s21, 7
s_add_u32 s21, s21, 17408
v_add_u32 v3, s21, v3
v_cmp_gt_u32 vcc, 32, v0
s_nop 1
v_cndmask_b32 v1, v3, v1, vcc
s_mov_b32 s22, 200000
RW_15:
buffer_load_dword v3, v1, s[4:7], s23 offen sc1
s_sub_u32 s22, s22, 1
s_cmp_gt_i32 s22, 0
s_cbranch_scc0 RB_16
s_waitcnt vmcnt(0)
v_cmp_ne_u32 vcc, 1, v3
s_cbranch_vccz RB_16
s_sleep 4
s_branch RW_15
RB_16:
s_barrier
v_and_b32 v1, 63, v0
v_lshrrev_b32 v2, 4, v1
v_and_b32 v3, 15, v1
v_lshlrev_b32 v7, 4, v1
v_mov_b32 v8, v7
s_mov_b32 s38, 400000
s_mov_b32 s39, 71319552
s_mov_b32 s12, s11
s_mov_b32 s13, 0
s_mov_b32 s18, 1073741824
s_mul_i32 s14, s9, 7168
s_lshl_b32 s16, s12, 15
s_add_u32 s16, s16, s14
s_add_u32 s16, s16, 50331648
s_add_u32 m0, s13, s14
s_nop 0
buffer_load_dwordx4 v7, s[4:7], s16 offen offset:0 sc1 lds
buffer_load_dwordx4 v7, s[4:7], s16 offen offset:1024 sc1 lds
buffer_load_dwordx4 v7, s[4:7], s16 offen offset:2048 sc1 lds
buffer_load_dwordx4 v7, s[4:7], s16 offen offset:3072 sc1 lds
s_add_u32 s16, s16, 4096
s_add_u32 m0, m0, 4096
s_nop 0
buffer_load_dwordx4 v7, s[4:7], s16 offen offset:0 sc1 lds
buffer_load_dwordx4 v7, s[4:7], s16 offen offset:1024 sc1 lds
buffer_load_dwordx4 v7, s[4:7], s16 offen offset:2048 sc1 lds
s_and_b32 s16, s9, 1
s_mul_i32 s17, s16, 224
s_lshr_b32 s16, s9, 1
s_add_u32 s17, s17, s16
s_lshl_b32 s16, s10, 1
s_add_u32 s17, s17, s16
s_mul_i32 s17, s17, 14336
s_add_u32 s17, s17, 7340032
v_and_b32 v4, 7, v1
v_min_u32 v4, 6, v4
v_mul_u32_u24 v4, 458752, v4
v_bfe_u32 v5, v1, 3, 1
v_mul_u32_u24 v5, 14332, v5
v_add_u32 v4, v4, v5
buffer_load_dword v6, v4, s[4:7], s17 offen sc1
s_add_u32 s16, s17, 0
buffer_load_dwordx4 a[0:3], v7, s[4:7], s16 offen offset:0 sc1
buffer_load_dwordx4 a[4:7], v7, s[4:7], s16 offen offset:1024 sc1
buffer_load_dwordx4 a[8:11], v7, s[4:7], s16 offen offset:2048 sc1
buffer_load_dwordx4 a[12:15], v7, s[4:7], s16 offen offset:3072 sc1
s_add_u32 s16, s17, 4096
buffer_load_dwordx4 a[16:19], v7, s[4:7], s16 offen offset:0 sc1
buffer_load_dwordx4 a[20:23], v7, s[4:7], s16 offen offset:1024 sc1
buffer_load_dwordx4 a[24:27], v7, s[4:7], s16 offen offset:2048 sc1
buffer_load_dwordx4 a[28:31], v7, s[4:7], s16 offen offset:3072 sc1
s_add_u32 s16, s17, 8192
buffer_load_dwordx4 a[32:35], v7, s[4:7], s16 offen offset:0 sc1
buffer_load_dwordx4 a[36:39], v7, s[4:7], s16 offen offset:1024 sc1
buffer_load_dwordx4 a[40:43], v7, s[4:7], s16 offen offset:2048 sc1
buffer_load_dwordx4 a[44:47], v7, s[4:7], s16 offen offset:3072 sc1
s_add_u32 s16, s17, 12288
buffer_load_dwordx4 a[48:51], v7, s[4:7], s16 offen offset:0 sc1
buffer_load_dwordx4 a[52:55], v7, s[4:7], s16 offen offset:1024 sc1
s_add_u32 s16, s17, 458752
buffer_load_dwordx4 a[56:59], v7, s[4:7], s16 offen offset:0 sc1
buffer_load_dwordx4 a[60:63], v7, s[4:7], s16 offen offset:1024 sc1
buffer_load_dwordx4 a[64:67], v7, s[4:7], s16 offen offset:2048 sc1
buffer_load_dwordx4 a[68:71], v7, s[4:7], s16 offen offset:3072 sc1
s_add_u32 s16, s17, 462848
buffer_load_dwordx4 a[72:75], v7, s[4:7], s16 offen offset:0 sc1
buffer_load_dwordx4 a[76:79], v7, s[4:7], s16 offen offset:1024 sc1
buffer_load_dwordx4 a[80:83], v7, s[4:7], s16 offen offset:2048 sc1
buffer_load_dwordx4 a[84:87], v7, s[4:7], s16 offen offset:3072 sc1
s_add_u32 s16, s17, 466944
buffer_load_dwordx4 a[88:91], v7, s[4:7], s16 offen offset:0 sc1
buffer_load_dwordx4 a[92:95], v7, s[4:7], s16 offen offset:1024 sc1
buffer_load_dwordx4 a[96:99], v7, s[4:7], s16 offen offset:2048 sc1
buffer_load_dwordx4 a[100:103], v7, s[4:7], s16 offen offset:3072 sc1
s_add_u32 s16, s17, 471040
buffer_load_dwordx4 a[104:107], v7, s[4:7], s16 offen offset:0 sc1
buffer_load_dwordx4 a[108:111], v7, s[4:7], s16 offen offset:1024 sc1
s_add_u32 s16, s17, 917504
buffer_load_dwordx4 a[112:115], v7, s[4:7], s16 offen offset:0 sc1
buffer_load_dwordx4 a[116:119], v7, s[4:7], s16 offen offset:1024 sc1
buffer_load_dwordx4 a[120:123], v7, s[4:7], s16 offen offset:2048 sc1
buffer_load_dwordx4 a[124:127], v7, s[4:7], s16 offen offset:3072 sc1
s_add_u32 s16, s17, 921600
buffer_load_dwordx4 a[128:131], v7, s[4:7], s16 offen offset:0 sc1
buffer_load_dwordx4 a[132:135], v7, s[4:7], s16 offen offset:1024 sc1
buffer_load_dwordx4 a[136:139], v7, s[4:7], s16 offen offset:2048 sc1
buffer_load_dwordx4 a[140:143], v7, s[4:7], s16 offen offset:3072 sc1
s_add_u32 s16, s17, 925696
buffer_load_dwordx4 a[144:147], v7, s[4:7], s16 offen offset:0 sc1
buffer_load_dwordx4 a[148:151], v7, s[4:7], s16 offen offset:1024 sc1
buffer_load_dwordx4 a[152:155], v7, s[4:7], s16 offen offset:2048 sc1
buffer_load_dwordx4 a[156:159], v7, s[4:7], s16 offen offset:3072 sc1
s_add_u32 s16, s17, 929792
buffer_load_dwordx4 a[160:163], v7, s[4:7], s16 offen offset:0 sc1
buffer_load_dwordx4 a[164:167], v7, s[4:7], s16 offen offset:1024 sc1
s_add_u32 s16, s17, 1376256
buffer_load_dwordx4 a[168:171], v7, s[4:7], s16 offen offset:0 sc1
buffer_load_dwordx4 a[172:175], v7, s[4:7], s16 offen offset:1024 sc1
buffer_load_dwordx4 a[176:179], v7, s[4:7], s16 offen offset:2048 sc1
buffer_load_dwordx4 a[180:183], v7, s[4:7], s16 offen offset:3072 sc1
s_add_u32 s16, s17, 1380352
buffer_load_dwordx4 a[184:187], v7, s[4:7], s16 offen offset:0 sc1
buffer_load_dwordx4 a[188:191], v7, s[4:7], s16 offen offset:1024 sc1
buffer_load_dwordx4 a[192:195], v7, s[4:7], s16 offen offset:2048 sc1
buffer_load_dwordx4 a[196:199], v7, s[4:7], s16 offen offset:3072 sc1
s_add_u32 s16, s17, 1384448
buffer_load_dwordx4 a[200:203], v7, s[4:7], s16 offen offset:0 sc1
buffer_load_dwordx4 a[204:207], v7, s[4:7], s16 offen offset:1024 sc1
s_waitcnt vmcnt(40)
buffer_load_dwordx4 a[208:211], v7, s[4:7], s16 offen offset:2048 sc1
buffer_load_dwordx4 a[212:215], v7, s[4:7], s16 offen offset:3072 sc1
s_add_u32 s16, s17, 1388544
buffer_load_dwordx4 a[216:219], v7, s[4:7], s16 offen offset:0 sc1
buffer_load_dwordx4 a[220:223], v7, s[4:7], s16 offen offset:1024 sc1
s_add_u32 s16, s17, 1835008
buffer_load_dwordx4 a[224:227], v7, s[4:7], s16 offen offset:0 sc1
buffer_load_dwordx4 a[228:231], v7, s[4:7], s16 offen offset:1024 sc1
buffer_load_dwordx4 a[232:235], v7, s[4:7], s16 offen offset:2048 sc1
buffer_load_dwordx4 a[236:239], v7, s[4:7], s16 offen offset:3072 sc1
s_add_u32 s16, s17, 1839104
buffer_load_dwordx4 a[240:243], v7, s[4:7], s16 offen offset:0 sc1
buffer_load_dwordx4 a[244:247], v7, s[4:7], s16 offen offset:1024 sc1
buffer_load_dwordx4 a[248:251], v7, s[4:7], s16 offen offset:2048 sc1
buffer_load_dwordx4 a[252:255], v7, s[4:7], s16 offen offset:3072 sc1
s_add_u32 s16, s17, 1843200
buffer_load_dwordx4 v[104:107], v7, s[4:7], s16 offen offset:0 sc1
buffer_load_dwordx4 v[108:111], v7, s[4:7], s16 offen offset:1024 sc1
buffer_load_dwordx4 v[112:115], v7, s[4:7], s16 offen offset:2048 sc1
buffer_load_dwordx4 v[116:119], v7, s[4:7], s16 offen offset:3072 sc1
s_add_u32 s16, s17, 1847296
buffer_load_dwordx4 v[120:123], v7, s[4:7], s16 offen offset:0 sc1
buffer_load_dwordx4 v[124:127], v7, s[4:7], s16 offen offset:1024 sc1
s_add_u32 s16, s17, 2293760
buffer_load_dwordx4 v[128:131], v7, s[4:7], s16 offen offset:0 sc1
buffer_load_dwordx4 v[132:135], v7, s[4:7], s16 offen offset:1024 sc1
s_waitcnt vmcnt(40)
buffer_load_dwordx4 v[136:139], v7, s[4:7], s16 offen offset:2048 sc1
buffer_load_dwordx4 v[140:143], v7, s[4:7], s16 offen offset:3072 sc1
s_add_u32 s16, s17, 2297856
buffer_load_dwordx4 v[144:147], v7, s[4:7], s16 offen offset:0 sc1
buffer_load_dwordx4 v[148:151], v7, s[4:7], s16 offen offset:1024 sc1
buffer_load_dwordx4 v[152:155], v7, s[4:7], s16 offen offset:2048 sc1
buffer_load_dwordx4 v[156:159], v7, s[4:7], s16 offen offset:3072 sc1
s_add_u32 s16, s17, 2301952
buffer_load_dwordx4 v[160:163], v7, s[4:7], s16 offen offset:0 sc1
buffer_load_dwordx4 v[164:167], v7, s[4:7], s16 offen offset:1024 sc1
buffer_load_dwordx4 v[168:171], v7, s[4:7], s16 offen offset:2048 sc1
buffer_load_dwordx4 v[172:175], v7, s[4:7], s16 offen offset:3072 sc1
s_add_u32 s16, s17, 2306048
buffer_load_dwordx4 v[176:179], v7, s[4:7], s16 offen offset:0 sc1
buffer_load_dwordx4 v[180:183], v7, s[4:7], s16 offen offset:1024 sc1
s_add_u32 s16, s17, 2752512
buffer_load_dwordx4 v[184:187], v7, s[4:7], s16 offen offset:0 sc1
buffer_load_dwordx4 v[188:191], v7, s[4:7], s16 offen offset:1024 sc1
buffer_load_dwordx4 v[192:195], v7, s[4:7], s16 offen offset:2048 sc1
buffer_load_dwordx4 v[196:199], v7, s[4:7], s16 offen offset:3072 sc1
s_add_u32 s16, s17, 2756608
buffer_load_dwordx4 v[200:203], v7, s[4:7], s16 offen offset:0 sc1
buffer_load_dwordx4 v[204:207], v7, s[4:7], s16 offen offset:1024 sc1
buffer_load_dwordx4 v[208:211], v7, s[4:7], s16 offen offset:2048 sc1
buffer_load_dwordx4 v[212:215], v7, s[4:7], s16 offen offset:3072 sc1
s_waitcnt vmcnt(40)
s_add_u32 s16, s17, 2760704
buffer_load_dwordx4 v[216:219], v7, s[4:7], s16 offen offset:0 sc1
buffer_load_dwordx4 v[220:223], v7, s[4:7], s16 offen offset:1024 sc1
buffer_load_dwordx4 v[224:227], v7, s[4:7], s16 offen offset:2048 sc1
buffer_load_dwordx4 v[228:231], v7, s[4:7], s16 offen offset:3072 sc1
s_add_u32 s16, s17, 2764800
buffer_load_dwordx4 v[232:235], v7, s[4:7], s16 offen offset:0 sc1
buffer_load_dwordx4 v[236:239], v7, s[4:7], s16 offen offset:1024 sc1
v_bfe_u32 v4, v3, 1, 1
v_mul_u32_u24 v12, 0xaaaa, v4
v_add_u32 v12, 0x4444, v12
v_lshlrev_b32 v4, 12, v2
v_lshl_add_u32 v4, v3, 4, v4
s_mul_i32 s16, s9, 28672
s_lshl_b32 s17, s10, 8
s_add_u32 s16, s16, s17
v_add_u32 v10, s16, v4
v_add_u32 v4, 16384, v10
v_mov_b32 v5, 1073741824
v_cmp_gt_u32 vcc, 3, v2
s_nop 1
v_cndmask_b32 v11, v5, v4, vcc
v_lshrrev_b32 v4, 3, v1
v_min_u32 v4, 6, v4
v_lshlrev_b32 v4, 14, v4
v_and_b32 v5, 7, v1
v_lshl_add_u32 v13, v5, 7, v4
s_mov_b32 s15, 16891904
s_waitcnt vmcnt(0)
JOB_17:
s_waitcnt vmcnt(7) lgkmcnt(0)
s_barrier
ds_read_b128 v[16:19], v8 offset:0
ds_read_b128 v[20:23], v8 offset:1024
ds_read_b128 v[24:27], v8 offset:2048
ds_read_b128 v[28:31], v8 offset:3072
s_add_u32 s17, s12, 3
s_min_u32 s17, s17, 63
s_xor_b32 s13, s13, 32768
s_lshl_b32 s16, s17, 15
s_add_u32 s16, s16, s14
s_add_u32 s16, s16, 50331648
s_add_u32 m0, s13, s14
s_nop 0
buffer_load_dwordx4 v7, s[4:7], s16 offen offset:0 sc1 lds
buffer_load_dwordx4 v7, s[4:7], s16 offen offset:1024 sc1 lds
buffer_load_dwordx4 v7, s[4:7], s16 offen offset:2048 sc1 lds
buffer_load_dwordx4 v7, s[4:7], s16 offen offset:3072 sc1 lds
s_add_u32 s16, s16, 4096
s_add_u32 m0, m0, 4096
s_nop 0
buffer_load_dwordx4 v7, s[4:7], s16 offen offset:0 sc1 lds
buffer_load_dwordx4 v7, s[4:7], s16 offen offset:1024 sc1 lds
buffer_load_dwordx4 v7, s[4:7], s16 offen offset:2048 sc1 lds
s_waitcnt lgkmcnt(0)
v_mfma_f32_16x16x32_bf16 v[48:51], v[16:19], a[0:3], 0
v_mfma_f32_16x16x32_bf16 v[52:55], v[24:27], a[0:3], 0
ds_read_b128 v[32:35], v8 offset:8192
v_mfma_f32_16x16x32_bf16 v[56:59], v[16:19], a[56:59], 0
v_mfma_f32_16x16x32_bf16 v[60:63], v[24:27], a[56:59], 0
v_mfma_f32_16x16x32_bf16 v[64:67], v[16:19], a[112:115], 0
v_mfma_f32_16x16x32_bf16 v[68:71], v[24:27], a[112:115], 0
ds_read_b128 v[36:39], v8 offset:9216
v_mfma_f32_16x16x32_bf16 v[72:75], v[16:19], a[168:171], 0
v_mfma_f32_16x16x32_bf16 v[76:79], v[24:27], a[168:171], 0
v_mfma_f32_16x16x32_bf16 v[80:83], v[16:19], a[224:227], 0
v_mfma_f32_16x16x32_bf16 v[84:87], v[24:27], a[224:227], 0
ds_read_b128 v[40:43], v8 offset:10240
v_mfma_f32_16x16x32_bf16 v[88:91], v[16:19], v[128:131], 0
v_mfma_f32_16x16x32_bf16 v[92:95], v[24:27], v[128:131], 0
v_mfma_f32_16x16x32_bf16 v[96:99], v[16:19], v[184:187], 0
v_mfma_f32_16x16x32_bf16 v[100:103], v[24:27], v[184:187], 0
ds_read_b128 v[44:47], v8 offset:11264
v_mfma_f32_16x16x32_bf16 v[48:51], v[20:23], a[4:7], v[48:51]
v_mfma_f32_16x16x32_bf16 v[52:55], v[28:31], a[4:7], v[52:55]
v_mfma_f32_16x16x32_bf16 v[56:59], v[20:23], a[60:63], v[56:59]
v_mfma_f32_16x16x32_bf16 v[60:63], v[28:31], a[60:63], v[60:63]
v_mfma_f32_16x16x32_bf16 v[64:67], v[20:23], a[116:119], v[64:67]
v_mfma_f32_16x16x32_bf16 v[68:71], v[28:31], a[116:119], v[68:71]
v_mfma_f32_16x16x32_bf16 v[72:75], v[20:23], a[172:175], v[72:75]
v_mfma_f32_16x16x32_bf16 v[76:79], v[28:31], a[172:175], v[76:79]
v_mfma_f32_16x16x32_bf16 v[80:83], v[20:23], a[228:231], v[80:83]
v_mfma_f32_16x16x32_bf16 v[84:87], v[28:31], a[228:231], v[84:87]
v_mfma_f32_16x16x32_bf16 v[88:91], v[20:23], v[132:135], v[88:91]
v_mfma_f32_16x16x32_bf16 v[92:95], v[28:31], v[132:135], v[92:95]
v_mfma_f32_16x16x32_bf16 v[96:99], v[20:23], v[188:191], v[96:99]
v_mfma_f32_16x16x32_bf16 v[100:103], v[28:31], v[188:191], v[100:103]
s_waitcnt lgkmcnt(0)
v_mfma_f32_16x16x32_bf16 v[48:51], v[32:35], a[8:11], v[48:51]
v_mfma_f32_16x16x32_bf16 v[52:55], v[40:43], a[8:11], v[52:55]
ds_read_b128 v[16:19], v8 offset:16384
v_mfma_f32_16x16x32_bf16 v[56:59], v[32:35], a[64:67], v[56:59]
v_mfma_f32_16x16x32_bf16 v[60:63], v[40:43], a[64:67], v[60:63]
v_mfma_f32_16x16x32_bf16 v[64:67], v[32:35], a[120:123], v[64:67]
v_mfma_f32_16x16x32_bf16 v[68:71], v[40:43], a[120:123], v[68:71]
ds_read_b128 v[20:23], v8 offset:17408
v_mfma_f32_16x16x32_bf16 v[72:75], v[32:35], a[176:179], v[72:75]
v_mfma_f32_16x16x32_bf16 v[76:79], v[40:43], a[176:179], v[76:79]
v_mfma_f32_16x16x32_bf16 v[80:83], v[32:35], a[232:235], v[80:83]
v_mfma_f32_16x16x32_bf16 v[84:87], v[40:43], a[232:235], v[84:87]
ds_read_b128 v[24:27], v8 offset:18432
v_mfma_f32_16x16x32_bf16 v[88:91], v[32:35], v[136:139], v[88:91]
v_mfma_f32_16x16x32_bf16 v[92:95], v[40:43], v[136:139], v[92:95]
v_mfma_f32_16x16x32_bf16 v[96:99], v[32:35], v[192:195], v[96:99]
v_mfma_f32_16x16x32_bf16 v[100:103], v[40:43], v[192:195], v[100:103]
ds_read_b128 v[28:31], v8 offset:19456
v_mfma_f32_16x16x32_bf16 v[48:51], v[36:39], a[12:15], v[48:51]
v_mfma_f32_16x16x32_bf16 v[52:55], v[44:47], a[12:15], v[52:55]
v_mfma_f32_16x16x32_bf16 v[56:59], v[36:39], a[68:71], v[56:59]
v_mfma_f32_16x16x32_bf16 v[60:63], v[44:47], a[68:71], v[60:63]
v_mfma_f32_16x16x32_bf16 v[64:67], v[36:39], a[124:127], v[64:67]
v_mfma_f32_16x16x32_bf16 v[68:71], v[44:47], a[124:127], v[68:71]
v_mfma_f32_16x16x32_bf16 v[72:75], v[36:39], a[180:183], v[72:75]
v_mfma_f32_16x16x32_bf16 v[76:79], v[44:47], a[180:183], v[76:79]
v_mfma_f32_16x16x32_bf16 v[80:83], v[36:39], a[236:239], v[80:83]
v_mfma_f32_16x16x32_bf16 v[84:87], v[44:47], a[236:239], v[84:87]
v_mfma_f32_16x16x32_bf16 v[88:91], v[36:39], v[140:143], v[88:91]
v_mfma_f32_16x16x32_bf16 v[92:95], v[44:47], v[140:143], v[92:95]
v_mfma_f32_16x16x32_bf16 v[96:99], v[36:39], v[196:199], v[96:99]
v_mfma_f32_16x16x32_bf16 v[100:103], v[44:47], v[196:199], v[100:103]
s_waitcnt lgkmcnt(0)
v_mfma_f32_16x16x32_bf16 v[48:51], v[16:19], a[16:19], v[48:51]
v_mfma_f32_16x16x32_bf16 v[52:55], v[24:27], a[16:19], v[52:55]
ds_read_b128 v[32:35], v8 offset:24576
v_mfma_f32_16x16x32_bf16 v[56:59], v[16:19], a[72:75], v[56:59]
v_mfma_f32_16x16x32_bf16 v[60:63], v[24:27], a[72:75], v[60:63]
v_mfma_f32_16x16x32_bf16 v[64:67], v[16:19], a[128:131], v[64:67]
v_mfma_f32_16x16x32_bf16 v[68:71], v[24:27], a[128:131], v[68:71]
ds_read_b128 v[36:39], v8 offset:25600
v_mfma_f32_16x16x32_bf16 v[72:75], v[16:19], a[184:187], v[72:75]
v_mfma_f32_16x16x32_bf16 v[76:79], v[24:27], a[184:187], v[76:79]
v_mfma_f32_16x16x32_bf16 v[80:83], v[16:19], a[240:243], v[80:83]
v_mfma_f32_16x16x32_bf16 v[84:87], v[24:27], a[240:243], v[84:87]
ds_read_b128 v[40:43], v8 offset:26624
v_mfma_f32_16x16x32_bf16 v[88:91], v[16:19], v[144:147], v[88:91]
v_mfma_f32_16x16x32_bf16 v[92:95], v[24:27], v[144:147], v[92:95]
v_mfma_f32_16x16x32_bf16 v[96:99], v[16:19], v[200:203], v[96:99]
v_mfma_f32_16x16x32_bf16 v[100:103], v[24:27], v[200:203], v[100:103]
ds_read_b128 v[44:47], v8 offset:27648
v_mfma_f32_16x16x32_bf16 v[48:51], v[20:23], a[20:23], v[48:51]
v_mfma_f32_16x16x32_bf16 v[52:55], v[28:31], a[20:23], v[52:55]
v_mfma_f32_16x16x32_bf16 v[56:59], v[20:23], a[76:79], v[56:59]
v_mfma_f32_16x16x32_bf16 v[60:63], v[28:31], a[76:79], v[60:63]
v_mfma_f32_16x16x32_bf16 v[64:67], v[20:23], a[132:135], v[64:67]
v_mfma_f32_16x16x32_bf16 v[68:71], v[28:31], a[132:135], v[68:71]
v_mfma_f32_16x16x32_bf16 v[72:75], v[20:23], a[188:191], v[72:75]
v_mfma_f32_16x16x32_bf16 v[76:79], v[28:31], a[188:191], v[76:79]
v_mfma_f32_16x16x32_bf16 v[80:83], v[20:23], a[244:247], v[80:83]
v_mfma_f32_16x16x32_bf16 v[84:87], v[28:31], a[244:247], v[84:87]
v_mfma_f32_16x16x32_bf16 v[88:91], v[20:23], v[148:151], v[88:91]
v_mfma_f32_16x16x32_bf16 v[92:95], v[28:31], v[148:151], v[92:95]
v_mfma_f32_16x16x32_bf16 v[96:99], v[20:23], v[204:207], v[96:99]
v_mfma_f32_16x16x32_bf16 v[100:103], v[28:31], v[204:207], v[100:103]
s_waitcnt lgkmcnt(0)
v_mfma_f32_16x16x32_bf16 v[48:51], v[32:35], a[24:27], v[48:51]
v_mfma_f32_16x16x32_bf16 v[52:55], v[40:43], a[24:27], v[52:55]
ds_read_b128 v[16:19], v8 offset:4096
v_mfma_f32_16x16x32_bf16 v[56:59], v[32:35], a[80:83], v[56:59]
v_mfma_f32_16x16x32_bf16 v[60:63], v[40:43], a[80:83], v[60:63]
v_mfma_f32_16x16x32_bf16 v[64:67], v[32:35], a[136:139], v[64:67]
v_mfma_f32_16x16x32_bf16 v[68:71], v[40:43], a[136:139], v[68:71]
ds_read_b128 v[20:23], v8 offset:5120
v_mfma_f32_16x16x32_bf16 v[72:75], v[32:35], a[192:195], v[72:75]
v_mfma_f32_16x16x32_bf16 v[76:79], v[40:43], a[192:195], v[76:79]
v_mfma_f32_16x16x32_bf16 v[80:83], v[32:35], a[248:251], v[80:83]
v_mfma_f32_16x16x32_bf16 v[84:87], v[40:43], a[248:251], v[84:87]
ds_read_b128 v[24:27], v8 offset:6144
v_mfma_f32_16x16x32_bf16 v[88:91], v[32:35], v[152:155], v[88:91]
v_mfma_f32_16x16x32_bf16 v[92:95], v[40:43], v[152:155], v[92:95]
v_mfma_f32_16x16x32_bf16 v[96:99], v[32:35], v[208:211], v[96:99]
v_mfma_f32_16x16x32_bf16 v[100:103], v[40:43], v[208:211], v[100:103]
ds_read_b128 v[28:31], v8 offset:7168
v_mfma_f32_16x16x32_bf16 v[48:51], v[36:39], a[28:31], v[48:51]
v_mfma_f32_16x16x32_bf16 v[52:55], v[44:47], a[28:31], v[52:55]
v_mfma_f32_16x16x32_bf16 v[56:59], v[36:39], a[84:87], v[56:59]
v_mfma_f32_16x16x32_bf16 v[60:63], v[44:47], a[84:87], v[60:63]
v_mfma_f32_16x16x32_bf16 v[64:67], v[36:39], a[140:143], v[64:67]
v_mfma_f32_16x16x32_bf16 v[68:71], v[44:47], a[140:143], v[68:71]
v_mfma_f32_16x16x32_bf16 v[72:75], v[36:39], a[196:199], v[72:75]
v_mfma_f32_16x16x32_bf16 v[76:79], v[44:47], a[196:199], v[76:79]
v_mfma_f32_16x16x32_bf16 v[80:83], v[36:39], a[252:255], v[80:83]
v_mfma_f32_16x16x32_bf16 v[84:87], v[44:47], a[252:255], v[84:87]
v_mfma_f32_16x16x32_bf16 v[88:91], v[36:39], v[156:159], v[88:91]
v_mfma_f32_16x16x32_bf16 v[92:95], v[44:47], v[156:159], v[92:95]
v_mfma_f32_16x16x32_bf16 v[96:99], v[36:39], v[212:215], v[96:99]
v_mfma_f32_16x16x32_bf16 v[100:103], v[44:47], v[212:215], v[100:103]
s_waitcnt vmcnt(7) lgkmcnt(0)
s_barrier
s_cmp_lg_u32 s9, 0
s_cbranch_scc1 SG_18
v_mov_b32 v4, 1
v_mov_b32 v9, s18
s_mov_b64 exec, 1
buffer_atomic_add v4, v9, s[4:7], s39 offen
s_mov_b64 exec, -1
SG_18:
v_mfma_f32_16x16x32_bf16 v[48:51], v[16:19], a[32:35], v[48:51]
v_mfma_f32_16x16x32_bf16 v[52:55], v[24:27], a[32:35], v[52:55]
ds_read_b128 v[32:35], v8 offset:12288
v_mfma_f32_16x16x32_bf16 v[56:59], v[16:19], a[88:91], v[56:59]
v_mfma_f32_16x16x32_bf16 v[60:63], v[24:27], a[88:91], v[60:63]
v_mfma_f32_16x16x32_bf16 v[64:67], v[16:19], a[144:147], v[64:67]
v_mfma_f32_16x16x32_bf16 v[68:71], v[24:27], a[144:147], v[68:71]
ds_read_b128 v[36:39], v8 offset:13312
v_mfma_f32_16x16x32_bf16 v[72:75], v[16:19], a[200:203], v[72:75]
v_mfma_f32_16x16x32_bf16 v[76:79], v[24:27], a[200:203], v[76:79]
v_mfma_f32_16x16x32_bf16 v[80:83], v[16:19], v[104:107], v[80:83]
v_mfma_f32_16x16x32_bf16 v[84:87], v[24:27], v[104:107], v[84:87]
ds_read_b128 v[40:43], v8 offset:14336
v_mfma_f32_16x16x32_bf16 v[88:91], v[16:19], v[160:163], v[88:91]
v_mfma_f32_16x16x32_bf16 v[92:95], v[24:27], v[160:163], v[92:95]
v_mfma_f32_16x16x32_bf16 v[96:99], v[16:19], v[216:219], v[96:99]
v_mfma_f32_16x16x32_bf16 v[100:103], v[24:27], v[216:219], v[100:103]
ds_read_b128 v[44:47], v8 offset:15360
v_mfma_f32_16x16x32_bf16 v[48:51], v[20:23], a[36:39], v[48:51]
v_mfma_f32_16x16x32_bf16 v[52:55], v[28:31], a[36:39], v[52:55]
v_mfma_f32_16x16x32_bf16 v[56:59], v[20:23], a[92:95], v[56:59]
v_mfma_f32_16x16x32_bf16 v[60:63], v[28:31], a[92:95], v[60:63]
v_mfma_f32_16x16x32_bf16 v[64:67], v[20:23], a[148:151], v[64:67]
v_mfma_f32_16x16x32_bf16 v[68:71], v[28:31], a[148:151], v[68:71]
v_mfma_f32_16x16x32_bf16 v[72:75], v[20:23], a[204:207], v[72:75]
v_mfma_f32_16x16x32_bf16 v[76:79], v[28:31], a[204:207], v[76:79]
v_mfma_f32_16x16x32_bf16 v[80:83], v[20:23], v[108:111], v[80:83]
v_mfma_f32_16x16x32_bf16 v[84:87], v[28:31], v[108:111], v[84:87]
v_mfma_f32_16x16x32_bf16 v[88:91], v[20:23], v[164:167], v[88:91]
v_mfma_f32_16x16x32_bf16 v[92:95], v[28:31], v[164:167], v[92:95]
v_mfma_f32_16x16x32_bf16 v[96:99], v[20:23], v[220:223], v[96:99]
v_mfma_f32_16x16x32_bf16 v[100:103], v[28:31], v[220:223], v[100:103]
s_waitcnt lgkmcnt(0)
v_mfma_f32_16x16x32_bf16 v[48:51], v[32:35], a[40:43], v[48:51]
v_mfma_f32_16x16x32_bf16 v[52:55], v[40:43], a[40:43], v[52:55]
ds_read_b128 v[16:19], v8 offset:20480
v_mfma_f32_16x16x32_bf16 v[56:59], v[32:35], a[96:99], v[56:59]
v_mfma_f32_16x16x32_bf16 v[60:63], v[40:43], a[96:99], v[60:63]
v_mfma_f32_16x16x32_bf16 v[64:67], v[32:35], a[152:155], v[64:67]
v_mfma_f32_16x16x32_bf16 v[68:71], v[40:43], a[152:155], v[68:71]
ds_read_b128 v[20:23], v8 offset:21504
v_mfma_f32_16x16x32_bf16 v[72:75], v[32:35], a[208:211], v[72:75]
v_mfma_f32_16x16x32_bf16 v[76:79], v[40:43], a[208:211], v[76:79]
v_mfma_f32_16x16x32_bf16 v[80:83], v[32:35], v[112:115], v[80:83]
v_mfma_f32_16x16x32_bf16 v[84:87], v[40:43], v[112:115], v[84:87]
ds_read_b128 v[24:27], v8 offset:22528
v_mfma_f32_16x16x32_bf16 v[88:91], v[32:35], v[168:171], v[88:91]
v_mfma_f32_16x16x32_bf16 v[92:95], v[40:43], v[168:171], v[92:95]
v_mfma_f32_16x16x32_bf16 v[96:99], v[32:35], v[224:227], v[96:99]
v_mfma_f32_16x16x32_bf16 v[100:103], v[40:43], v[224:227], v[100:103]
ds_read_b128 v[28:31], v8 offset:23552
v_mfma_f32_16x16x32_bf16 v[48:51], v[36:39], a[44:47], v[48:51]
v_mfma_f32_16x16x32_bf16 v[52:55], v[44:47], a[44:47], v[52:55]
v_mfma_f32_16x16x32_bf16 v[56:59], v[36:39], a[100:103], v[56:59]
v_mfma_f32_16x16x32_bf16 v[60:63], v[44:47], a[100:103], v[60:63]
v_mfma_f32_16x16x32_bf16 v[64:67], v[36:39], a[156:159], v[64:67]
v_mfma_f32_16x16x32_bf16 v[68:71], v[44:47], a[156:159], v[68:71]
v_mfma_f32_16x16x32_bf16 v[72:75], v[36:39], a[212:215], v[72:75]
v_mfma_f32_16x16x32_bf16 v[76:79], v[44:47], a[212:215], v[76:79]
v_mfma_f32_16x16x32_bf16 v[80:83], v[36:39], v[116:119], v[80:83]
v_mfma_f32_16x16x32_bf16 v[84:87], v[44:47], v[116:119], v[84:87]
v_mfma_f32_16x16x32_bf16 v[88:91], v[36:39], v[172:175], v[88:91]
v_mfma_f32_16x16x32_bf16 v[92:95], v[44:47], v[172:175], v[92:95]
v_mfma_f32_16x16x32_bf16 v[96:99], v[36:39], v[228:231], v[96:99]
v_mfma_f32_16x16x32_bf16 v[100:103], v[44:47], v[228:231], v[100:103]
s_waitcnt lgkmcnt(0)
v_mfma_f32_16x16x32_bf16 v[48:51], v[16:19], a[48:51], v[48:51]
v_mfma_f32_16x16x32_bf16 v[52:55], v[24:27], a[48:51], v[52:55]
v_mfma_f32_16x16x32_bf16 v[56:59], v[16:19], a[104:107], v[56:59]
v_mfma_f32_16x16x32_bf16 v[60:63], v[24:27], a[104:107], v[60:63]
v_mfma_f32_16x16x32_bf16 v[64:67], v[16:19], a[160:163], v[64:67]
v_mfma_f32_16x16x32_bf16 v[68:71], v[24:27], a[160:163], v[68:71]
v_mfma_f32_16x16x32_bf16 v[72:75], v[16:19], a[216:219], v[72:75]
v_mfma_f32_16x16x32_bf16 v[76:79], v[24:27], a[216:219], v[76:79]
v_mfma_f32_16x16x32_bf16 v[80:83], v[16:19], v[120:123], v[80:83]
v_mfma_f32_16x16x32_bf16 v[84:87], v[24:27], v[120:123], v[84:87]
v_mfma_f32_16x16x32_bf16 v[88:91], v[16:19], v[176:179], v[88:91]
v_mfma_f32_16x16x32_bf16 v[92:95], v[24:27], v[176:179], v[92:95]
v_mfma_f32_16x16x32_bf16 v[96:99], v[16:19], v[232:235], v[96:99]
v_mfma_f32_16x16x32_bf16 v[100:103], v[24:27], v[232:235], v[100:103]
v_mfma_f32_16x16x32_bf16 v[48:51], v[20:23], a[52:55], v[48:51]
v_mfma_f32_16x16x32_bf16 v[52:55], v[28:31], a[52:55], v[52:55]
v_mfma_f32_16x16x32_bf16 v[56:59], v[20:23], a[108:111], v[56:59]
v_mfma_f32_16x16x32_bf16 v[60:63], v[28:31], a[108:111], v[60:63]
v_mfma_f32_16x16x32_bf16 v[64:67], v[20:23], a[164:167], v[64:67]
v_mfma_f32_16x16x32_bf16 v[68:71], v[28:31], a[164:167], v[68:71]
v_mfma_f32_16x16x32_bf16 v[72:75], v[20:23], a[220:223], v[72:75]
v_mfma_f32_16x16x32_bf16 v[76:79], v[28:31], a[220:223], v[76:79]
v_mfma_f32_16x16x32_bf16 v[80:83], v[20:23], v[124:127], v[80:83]
v_mfma_f32_16x16x32_bf16 v[84:87], v[28:31], v[124:127], v[84:87]
v_mfma_f32_16x16x32_bf16 v[88:91], v[20:23], v[180:183], v[88:91]
v_mfma_f32_16x16x32_bf16 v[92:95], v[28:31], v[180:183], v[92:95]
v_mfma_f32_16x16x32_bf16 v[96:99], v[20:23], v[236:239], v[96:99]
v_mfma_f32_16x16x32_bf16 v[100:103], v[28:31], v[236:239], v[100:103]
v_xor_b32 v8, 32768, v8
s_mul_i32 s15, s12, 458752
s_mul_i32 s16, s9, 114688
s_add_u32 s15, s15, s16
s_lshl_b32 s16, s10, 10
s_add_u32 s15, s15, s16
s_add_u32 s15, s15, 16777216
v_cvt_pk_bf16_f32 v48, v48, v49
v_cvt_pk_bf16_f32 v49, v50, v51
v_cvt_pk_bf16_f32 v50, v52, v53
v_cvt_pk_bf16_f32 v51, v54, v55
buffer_store_dwordx4 v[48:51], v7, s[4:7], s15 offen sc1
s_add_u32 s15, s15, 16384
v_cvt_pk_bf16_f32 v56, v56, v57
v_cvt_pk_bf16_f32 v57, v58, v59
v_cvt_pk_bf16_f32 v58, v60, v61
v_cvt_pk_bf16_f32 v59, v62, v63
buffer_store_dwordx4 v[56:59], v7, s[4:7], s15 offen sc1
s_add_u32 s15, s15, 16384
v_cvt_pk_bf16_f32 v64, v64, v65
v_cvt_pk_bf16_f32 v65, v66, v67
v_cvt_pk_bf16_f32 v66, v68, v69
v_cvt_pk_bf16_f32 v67, v70, v71
buffer_store_dwordx4 v[64:67], v7, s[4:7], s15 offen sc1
s_add_u32 s15, s15, 16384
v_cvt_pk_bf16_f32 v72, v72, v73
v_cvt_pk_bf16_f32 v73, v74, v75
v_cvt_pk_bf16_f32 v74, v76, v77
v_cvt_pk_bf16_f32 v75, v78, v79
buffer_store_dwordx4 v[72:75], v7, s[4:7], s15 offen sc1
s_add_u32 s15, s15, 16384
v_cvt_pk_bf16_f32 v80, v80, v81
v_cvt_pk_bf16_f32 v81, v82, v83
v_cvt_pk_bf16_f32 v82, v84, v85
v_cvt_pk_bf16_f32 v83, v86, v87
buffer_store_dwordx4 v[80:83], v7, s[4:7], s15 offen sc1
s_add_u32 s15, s15, 16384
v_cvt_pk_bf16_f32 v88, v88, v89
v_cvt_pk_bf16_f32 v89, v90, v91
v_cvt_pk_bf16_f32 v90, v92, v93
v_cvt_pk_bf16_f32 v91, v94, v95
buffer_store_dwordx4 v[88:91], v7, s[4:7], s15 offen sc1
s_add_u32 s15, s15, 16384
v_cvt_pk_bf16_f32 v96, v96, v97
v_cvt_pk_bf16_f32 v97, v98, v99
v_cvt_pk_bf16_f32 v98, v100, v101
v_cvt_pk_bf16_f32 v99, v102, v103
buffer_store_dwordx4 v[96:99], v7, s[4:7], s15 offen sc1
s_add_u32 s15, s15, 16384
s_lshl_b32 s18, s12, 2
s_cmp_lg_u32 s12, s11
s_cbranch_scc1 NF_19
v_mov_b32 v9, s18
s_mov_b32 s18, 1073741824
s_waitcnt vmcnt(0) lgkmcnt(0)
s_barrier
s_cmp_lg_u32 s9, 0
s_cbranch_scc1 SG_20
v_mov_b32 v4, 1
s_mov_b64 exec, 1
buffer_atomic_add v4, v9, s[4:7], s39 offen
s_mov_b64 exec, -1
SG_20:
NF_19:
s_sub_u32 s16, s12, s11
s_cmp_lg_u32 s16, 15
s_cbranch_scc1 NF_19x
v_and_b32 v9, 31, v1
v_lshlrev_b32 v9, 2, v9
v_add_u32 v9, 21504, v9
WT_21:
buffer_load_dword v4, v9, s[4:7], s39 offen sc1
s_sub_u32 s38, s38, 1
s_cmp_gt_i32 s38, 0
s_cbranch_scc0 WD_22
s_waitcnt vmcnt(0)
v_cmp_gt_u32 vcc, 1, v4
s_cbranch_vccz WD_22
s_sleep 8
s_branch WT_21
WD_22:
NF_19x:
s_add_u32 s12, s12, 3
s_cmp_lt_u32 s12, 64
s_cbranch_scc1 JOB_17
v_mov_b32 v9, s18
s_waitcnt vmcnt(0) lgkmcnt(0)
s_barrier
s_cmp_lg_u32 s9, 0
s_cbranch_scc1 SG_23
v_mov_b32 v4, 1
s_mov_b64 exec, 1
buffer_atomic_add v4, v9, s[4:7], s39 offen
s_mov_b64 exec, -1
SG_23:
v_mov_b32 v16, -1
v_mov_b32 v17, -1
v_mov_b32 v18, -1
v_mov_b32 v19, -1
s_mov_b32 s15, s11
IL_24:
s_lshl_b32 s16, s15, 17
s_add_u32 s16, s16, 58720256
buffer_store_dwordx4 v[16:19], v10, s[4:7], s16 offen sc1
buffer_store_dwordx4 v[16:19], v11, s[4:7], s16 offen sc1
s_add_u32 s15, s15, 3
s_cmp_lt_u32 s15, 64
s_cbranch_scc1 IL_24
IL_24x:
v_mov_b32 v9, 16384
s_waitcnt vmcnt(0) lgkmcnt(0)
s_barrier
s_cmp_lg_u32 s9, 0
s_cbranch_scc1 SG_25
v_mov_b32 v4, 1
s_mov_b64 exec, 1
buffer_atomic_add v4, v9, s[4:7], s39 offen
s_mov_b64 exec, -1
SG_25:
s_mov_b32 s12, s11
MJ_26:
v_mov_b32 v48, 0
v_mov_b32 v49, 0
v_mov_b32 v50, 0
v_mov_b32 v51, 0
v_mov_b32 v52, 0
v_mov_b32 v53, 0
v_mov_b32 v54, 0
v_mov_b32 v55, 0
v_mov_b32 v56, 0
v_mov_b32 v57, 0
v_mov_b32 v58, 0
v_mov_b32 v59, 0
v_mov_b32 v60, 0
v_mov_b32 v61, 0
v_mov_b32 v62, 0
v_mov_b32 v63, 0
v_mov_b32 v64, 0
v_mov_b32 v65, 0
v_mov_b32 v66, 0
v_mov_b32 v67, 0
v_mov_b32 v68, 0
v_mov_b32 v69, 0
v_mov_b32 v70, 0
v_mov_b32 v71, 0
v_mov_b32 v72, 0
v_mov_b32 v73, 0
v_mov_b32 v74, 0
v_mov_b32 v75, 0
s_lshl_b32 s16, s12, 13
s_add_u32 s16, s16, 56623104
s_add_u32 s17, s16, 4096
LV_27:
buffer_load_dwordx4 v[16:19], v7, s[4:7], s16 offen offset:0 sc1
buffer_load_dwordx4 v[20:23], v7, s[4:7], s16 offen offset:1024 sc1
buffer_load_dwordx4 v[24:27], v7, s[4:7], s16 offen offset:2048 sc1
buffer_load_dwordx4 v[28:31], v7, s[4:7], s16 offen offset:3072 sc1
buffer_load_dwordx4 v[32:35], v7, s[4:7], s17 offen offset:0 sc1
buffer_load_dwordx4 v[36:39], v7, s[4:7], s17 offen offset:1024 sc1
buffer_load_dwordx4 v[40:43], v7, s[4:7], s17 offen offset:2048 sc1
s_sub_u32 s38, s38, 1
s_cmp_gt_i32 s38, 0
s_cbranch_scc0 LD_28
s_waitcnt vmcnt(6)
v_max_u32 v4, v16, v17
v_max3_u32 v4, v4, v18, v19
s_waitcnt vmcnt(5)
v_max3_u32 v4, v4, v20, v21
v_max3_u32 v4, v4, v22, v23
s_waitcnt vmcnt(4)
v_max3_u32 v4, v4, v24, v25
v_max3_u32 v4, v4, v26, v27
s_waitcnt vmcnt(3)
v_max3_u32 v4, v4, v28, v29
v_max3_u32 v4, v4, v30, v31
s_waitcnt vmcnt(2)
v_max3_u32 v4, v4, v32, v33
v_max3_u32 v4, v4, v34, v35
s_waitcnt vmcnt(1)
v_max3_u32 v4, v4, v36, v37
v_max3_u32 v4, v4, v38, v39
s_waitcnt vmcnt(0)
v_max3_u32 v4, v4, v40, v41
v_max3_u32 v4, v4, v42, v43
v_cmp_eq_u32 vcc, -1, v4
s_cbranch_vccz LD_28
s_sleep 3
s_branch LV_27
LD_28:
s_waitcnt vmcnt(0)
v_smfmac_f32_16x16x64_bf16 v[48:51], v[16:19], a[0:7], v12
v_smfmac_f32_16x16x64_bf16 v[52:55], v[16:19], a[56:63], v12
v_smfmac_f32_16x16x64_bf16 v[56:59], v[16:19], a[112:119], v12
v_smfmac_f32_16x16x64_bf16 v[60:63], v[16:19], a[168:175], v12
v_smfmac_f32_16x16x64_bf16 v[64:67], v[16:19], a[224:231], v12
v_smfmac_f32_16x16x64_bf16 v[68:71], v[16:19], v[128:135], v12
v_smfmac_f32_16x16x64_bf16 v[72:75], v[16:19], v[184:191], v12
v_smfmac_f32_16x16x64_bf16 v[48:51], v[20:23], a[8:15], v12
v_smfmac_f32_16x16x64_bf16 v[52:55], v[20:23], a[64:71], v12
v_smfmac_f32_16x16x64_bf16 v[56:59], v[20:23], a[120:127], v12
v_smfmac_f32_16x16x64_bf16 v[60:63], v[20:23], a[176:183], v12
v_smfmac_f32_16x16x64_bf16 v[64:67], v[20:23], a[232:239], v12
v_smfmac_f32_16x16x64_bf16 v[68:71], v[20:23], v[136:143], v12
v_smfmac_f32_16x16x64_bf16 v[72:75], v[20:23], v[192:199], v12
v_smfmac_f32_16x16x64_bf16 v[48:51], v[24:27], a[16:23], v12
v_smfmac_f32_16x16x64_bf16 v[52:55], v[24:27], a[72:79], v12
v_smfmac_f32_16x16x64_bf16 v[56:59], v[24:27], a[128:135], v12
v_smfmac_f32_16x16x64_bf16 v[60:63], v[24:27], a[184:191], v12
v_smfmac_f32_16x16x64_bf16 v[64:67], v[24:27], a[240:247], v12
v_smfmac_f32_16x16x64_bf16 v[68:71], v[24:27], v[144:151], v12
v_smfmac_f32_16x16x64_bf16 v[72:75], v[24:27], v[200:207], v12
v_smfmac_f32_16x16x64_bf16 v[48:51], v[28:31], a[24:31], v12
v_smfmac_f32_16x16x64_bf16 v[52:55], v[28:31], a[80:87], v12
v_smfmac_f32_16x16x64_bf16 v[56:59], v[28:31], a[136:143], v12
v_smfmac_f32_16x16x64_bf16 v[60:63], v[28:31], a[192:199], v12
v_smfmac_f32_16x16x64_bf16 v[64:67], v[28:31], a[248:255], v12
v_smfmac_f32_16x16x64_bf16 v[68:71], v[28:31], v[152:159], v12
v_smfmac_f32_16x16x64_bf16 v[72:75], v[28:31], v[208:215], v12
v_smfmac_f32_16x16x64_bf16 v[48:51], v[32:35], a[32:39], v12
v_smfmac_f32_16x16x64_bf16 v[52:55], v[32:35], a[88:95], v12
v_smfmac_f32_16x16x64_bf16 v[56:59], v[32:35], a[144:151], v12
v_smfmac_f32_16x16x64_bf16 v[60:63], v[32:35], a[200:207], v12
v_smfmac_f32_16x16x64_bf16 v[64:67], v[32:35], v[104:111], v12
v_smfmac_f32_16x16x64_bf16 v[68:71], v[32:35], v[160:167], v12
v_smfmac_f32_16x16x64_bf16 v[72:75], v[32:35], v[216:223], v12
v_smfmac_f32_16x16x64_bf16 v[48:51], v[36:39], a[40:47], v12
v_smfmac_f32_16x16x64_bf16 v[52:55], v[36:39], a[96:103], v12
v_smfmac_f32_16x16x64_bf16 v[56:59], v[36:39], a[152:159], v12
v_smfmac_f32_16x16x64_bf16 v[60:63], v[36:39], a[208:215], v12
v_smfmac_f32_16x16x64_bf16 v[64:67], v[36:39], v[112:119], v12
v_smfmac_f32_16x16x64_bf16 v[68:71], v[36:39], v[168:175], v12
v_smfmac_f32_16x16x64_bf16 v[72:75], v[36:39], v[224:231], v12
v_smfmac_f32_16x16x64_bf16 v[48:51], v[40:43], a[48:55], v12
v_smfmac_f32_16x16x64_bf16 v[52:55], v[40:43], a[104:111], v12
v_smfmac_f32_16x16x64_bf16 v[56:59], v[40:43], a[160:167], v12
v_smfmac_f32_16x16x64_bf16 v[60:63], v[40:43], a[216:223], v12
v_smfmac_f32_16x16x64_bf16 v[64:67], v[40:43], v[120:127], v12
v_smfmac_f32_16x16x64_bf16 v[68:71], v[40:43], v[176:183], v12
v_smfmac_f32_16x16x64_bf16 v[72:75], v[40:43], v[232:239], v12
v_add_f32 v48, v48, v50
v_add_f32 v49, v49, v51
v_cvt_pk_bf16_f32 v80, v48, v49
v_add_f32 v52, v52, v54
v_add_f32 v53, v53, v55
v_cvt_pk_bf16_f32 v81, v52, v53
v_add_f32 v56, v56, v58
v_add_f32 v57, v57, v59
v_cvt_pk_bf16_f32 v82, v56, v57
v_add_f32 v60, v60, v62
v_add_f32 v61, v61, v63
v_cvt_pk_bf16_f32 v83, v60, v61
v_add_f32 v64, v64, v66
v_add_f32 v65, v65, v67
v_cvt_pk_bf16_f32 v84, v64, v65
v_add_f32 v68, v68, v70
v_add_f32 v69, v69, v71
v_cvt_pk_bf16_f32 v85, v68, v69
v_add_f32 v72, v72, v74
v_add_f32 v73, v73, v75
v_cvt_pk_bf16_f32 v86, v72, v73
v_mov_b32 v87, 0
s_lshl_b32 s15, s12, 17
s_add_u32 s15, s15, 58720256
v_permlane32_swap_b32 v80, v82
v_permlane32_swap_b32 v81, v83
s_nop 1
v_permlane16_swap_b32 v80, v81
v_permlane16_swap_b32 v82, v83
buffer_store_dwordx4 v[80:83], v10, s[4:7], s15 offen sc1
v_permlane32_swap_b32 v84, v86
v_permlane32_swap_b32 v85, v87
s_nop 1
v_permlane16_swap_b32 v84, v85
v_permlane16_swap_b32 v86, v87
buffer_store_dwordx4 v[84:87], v11, s[4:7], s15 offen sc1
s_add_u32 s12, s12, 3
s_cmp_lt_u32 s12, 64
s_cbranch_scc1 MJ_26
s_endpgm
EXIT:
s_endpgm
ROLE_T:
s_sub_u32 s20, s8, 48
s_cmp_ge_u32 s20, 48
s_cbranch_scc1 WK_HIT
s_cmp_ge_u32 s20, 24
s_cselect_b32 s21, 24, 0
s_cselect_b32 s10, 6, 0
s_sub_u32 s20, s20, s21
s_mul_i32 s11, s20, 43
s_lshr_b32 s11, s11, 8
s_mul_i32 s21, s11, 6
s_sub_u32 s20, s20, s21
s_add_u32 s10, s10, s20
s_branch WK_GOT
WK_HIT:
s_sub_u32 s20, s20, 48
s_mul_i32 s10, s20, 64
s_lshr_b32 s10, s10, 8
s_mul_i32 s21, s10, 4
s_sub_u32 s11, s20, s21
s_add_u32 s10, s10, 12
WK_GOT:
s_lshl_b32 s21, s10, 1
s_cmp_lg_u32 s9, 0
s_cbranch_scc1 RB_30
s_mov_b32 s23, 71319552
s_and_b32 s22, s8, 7
s_lshl_b32 s22, s22, 7
s_add_u32 s22, s22, 21504
v_and_b32 v1, 31, v0
v_lshlrev_b32 v1, 2, v1
v_add_u32 v1, s22, v1
v_and_b32 v3, 15, v0
v_min_u32 v3, 13, v3
v_lshlrev_b32 v3, 2, v3
s_lshl_b32 s21, s21, 7
s_add_u32 s21, s21, 17408
v_add_u32 v3, s21, v3
v_cmp_gt_u32 vcc, 32, v0
s_nop 1
v_cndmask_b32 v1, v3, v1, vcc
s_mov_b32 s22, 200000
RW_29:
buffer_load_dword v3, v1, s[4:7], s23 offen sc1
s_sub_u32 s22, s22, 1
s_cmp_gt_i32 s22, 0
s_cbranch_scc0 RB_30
s_waitcnt vmcnt(0)
v_cmp_ne_u32 vcc, 1, v3
s_cbranch_vccz RB_30
s_sleep 4
s_branch RW_29
RB_30:
s_barrier
v_and_b32 v1, 63, v0
v_lshrrev_b32 v2, 4, v1
v_and_b32 v3, 15, v1
v_lshlrev_b32 v7, 4, v1
v_mov_b32 v8, v7
s_mov_b32 s38, 400000
s_mov_b32 s39, 71319552
s_mov_b32 s12, s11
s_mov_b32 s13, 0
s_mov_b32 s18, 1073741824
s_mul_i32 s14, s9, 7168
s_cmp_lg_u32 s9, 0
s_cbranch_scc1 GW_31
s_and_b32 s16, s8, 7
s_lshl_b32 s16, s16, 7
s_add_u32 s16, s16, 22528
v_mov_b32 v9, s16
WT_32:
buffer_load_dword v4, v9, s[4:7], s39 offen sc1
s_sub_u32 s38, s38, 1
s_cmp_gt_i32 s38, 0
s_cbranch_scc0 WD_33
s_waitcnt vmcnt(0)
v_cmp_gt_u32 vcc, 2, v4
s_cbranch_vccz WD_33
s_sleep 16
s_branch WT_32
WD_33:
GW_31:
s_barrier
s_lshl_b32 s16, s12, 15
s_add_u32 s16, s16, s14
s_add_u32 s16, s16, 50331648
s_add_u32 m0, s13, s14
s_nop 0
buffer_load_dwordx4 v7, s[4:7], s16 offen offset:0 sc1 lds
buffer_load_dwordx4 v7, s[4:7], s16 offen offset:1024 sc1 lds
buffer_load_dwordx4 v7, s[4:7], s16 offen offset:2048 sc1 lds
buffer_load_dwordx4 v7, s[4:7], s16 offen offset:3072 sc1 lds
s_add_u32 s16, s16, 4096
s_add_u32 m0, m0, 4096
s_nop 0
buffer_load_dwordx4 v7, s[4:7], s16 offen offset:0 sc1 lds
buffer_load_dwordx4 v7, s[4:7], s16 offen offset:1024 sc1 lds
buffer_load_dwordx4 v7, s[4:7], s16 offen offset:2048 sc1 lds
s_mul_i32 s17, s10, 28
s_mul_i32 s16, s9, 7
s_add_u32 s17, s17, s16
s_mul_i32 s17, s17, 14336
s_add_u32 s17, s17, 0
s_add_u32 s16, s17, 0
buffer_load_dwordx4 a[0:3], v7, s[4:7], s16 offen offset:0 sc1
buffer_load_dwordx4 a[4:7], v7, s[4:7], s16 offen offset:1024 sc1
buffer_load_dwordx4 a[8:11], v7, s[4:7], s16 offen offset:2048 sc1
buffer_load_dwordx4 a[12:15], v7, s[4:7], s16 offen offset:3072 sc1
s_add_u32 s16, s17, 4096
buffer_load_dwordx4 a[16:19], v7, s[4:7], s16 offen offset:0 sc1
buffer_load_dwordx4 a[20:23], v7, s[4:7], s16 offen offset:1024 sc1
buffer_load_dwordx4 a[24:27], v7, s[4:7], s16 offen offset:2048 sc1
buffer_load_dwordx4 a[28:31], v7, s[4:7], s16 offen offset:3072 sc1
s_add_u32 s16, s17, 8192
buffer_load_dwordx4 a[32:35], v7, s[4:7], s16 offen offset:0 sc1
buffer_load_dwordx4 a[36:39], v7, s[4:7], s16 offen offset:1024 sc1
buffer_load_dwordx4 a[40:43], v7, s[4:7], s16 offen offset:2048 sc1
buffer_load_dwordx4 a[44:47], v7, s[4:7], s16 offen offset:3072 sc1
s_add_u32 s16, s17, 12288
buffer_load_dwordx4 a[48:51], v7, s[4:7], s16 offen offset:0 sc1
buffer_load_dwordx4 a[52:55], v7, s[4:7], s16 offen offset:1024 sc1
s_add_u32 s16, s17, 14336
buffer_load_dwordx4 a[56:59], v7, s[4:7], s16 offen offset:0 sc1
buffer_load_dwordx4 a[60:63], v7, s[4:7], s16 offen offset:1024 sc1
buffer_load_dwordx4 a[64:67], v7, s[4:7], s16 offen offset:2048 sc1
buffer_load_dwordx4 a[68:71], v7, s[4:7], s16 offen offset:3072 sc1
s_add_u32 s16, s17, 18432
buffer_load_dwordx4 a[72:75], v7, s[4:7], s16 offen offset:0 sc1
buffer_load_dwordx4 a[76:79], v7, s[4:7], s16 offen offset:1024 sc1
buffer_load_dwordx4 a[80:83], v7, s[4:7], s16 offen offset:2048 sc1
buffer_load_dwordx4 a[84:87], v7, s[4:7], s16 offen offset:3072 sc1
s_add_u32 s16, s17, 22528
buffer_load_dwordx4 a[88:91], v7, s[4:7], s16 offen offset:0 sc1
buffer_load_dwordx4 a[92:95], v7, s[4:7], s16 offen offset:1024 sc1
buffer_load_dwordx4 a[96:99], v7, s[4:7], s16 offen offset:2048 sc1
buffer_load_dwordx4 a[100:103], v7, s[4:7], s16 offen offset:3072 sc1
s_add_u32 s16, s17, 26624
buffer_load_dwordx4 a[104:107], v7, s[4:7], s16 offen offset:0 sc1
buffer_load_dwordx4 a[108:111], v7, s[4:7], s16 offen offset:1024 sc1
s_add_u32 s16, s17, 28672
buffer_load_dwordx4 a[112:115], v7, s[4:7], s16 offen offset:0 sc1
buffer_load_dwordx4 a[116:119], v7, s[4:7], s16 offen offset:1024 sc1
buffer_load_dwordx4 a[120:123], v7, s[4:7], s16 offen offset:2048 sc1
buffer_load_dwordx4 a[124:127], v7, s[4:7], s16 offen offset:3072 sc1
s_add_u32 s16, s17, 32768
buffer_load_dwordx4 a[128:131], v7, s[4:7], s16 offen offset:0 sc1
buffer_load_dwordx4 a[132:135], v7, s[4:7], s16 offen offset:1024 sc1
buffer_load_dwordx4 a[136:139], v7, s[4:7], s16 offen offset:2048 sc1
buffer_load_dwordx4 a[140:143], v7, s[4:7], s16 offen offset:3072 sc1
s_add_u32 s16, s17, 36864
buffer_load_dwordx4 a[144:147], v7, s[4:7], s16 offen offset:0 sc1
buffer_load_dwordx4 a[148:151], v7, s[4:7], s16 offen offset:1024 sc1
buffer_load_dwordx4 a[152:155], v7, s[4:7], s16 offen offset:2048 sc1
buffer_load_dwordx4 a[156:159], v7, s[4:7], s16 offen offset:3072 sc1
s_add_u32 s16, s17, 40960
buffer_load_dwordx4 a[160:163], v7, s[4:7], s16 offen offset:0 sc1
buffer_load_dwordx4 a[164:167], v7, s[4:7], s16 offen offset:1024 sc1
s_add_u32 s16, s17, 43008
buffer_load_dwordx4 a[168:171], v7, s[4:7], s16 offen offset:0 sc1
buffer_load_dwordx4 a[172:175], v7, s[4:7], s16 offen offset:1024 sc1
buffer_load_dwordx4 a[176:179], v7, s[4:7], s16 offen offset:2048 sc1
buffer_load_dwordx4 a[180:183], v7, s[4:7], s16 offen offset:3072 sc1
s_add_u32 s16, s17, 47104
buffer_load_dwordx4 a[184:187], v7, s[4:7], s16 offen offset:0 sc1
buffer_load_dwordx4 a[188:191], v7, s[4:7], s16 offen offset:1024 sc1
buffer_load_dwordx4 a[192:195], v7, s[4:7], s16 offen offset:2048 sc1
buffer_load_dwordx4 a[196:199], v7, s[4:7], s16 offen offset:3072 sc1
s_add_u32 s16, s17, 51200
buffer_load_dwordx4 a[200:203], v7, s[4:7], s16 offen offset:0 sc1
buffer_load_dwordx4 a[204:207], v7, s[4:7], s16 offen offset:1024 sc1
s_waitcnt vmcnt(40)
buffer_load_dwordx4 a[208:211], v7, s[4:7], s16 offen offset:2048 sc1
buffer_load_dwordx4 a[212:215], v7, s[4:7], s16 offen offset:3072 sc1
s_add_u32 s16, s17, 55296
buffer_load_dwordx4 a[216:219], v7, s[4:7], s16 offen offset:0 sc1
buffer_load_dwordx4 a[220:223], v7, s[4:7], s16 offen offset:1024 sc1
s_add_u32 s16, s17, 57344
buffer_load_dwordx4 a[224:227], v7, s[4:7], s16 offen offset:0 sc1
buffer_load_dwordx4 a[228:231], v7, s[4:7], s16 offen offset:1024 sc1
buffer_load_dwordx4 a[232:235], v7, s[4:7], s16 offen offset:2048 sc1
buffer_load_dwordx4 a[236:239], v7, s[4:7], s16 offen offset:3072 sc1
s_add_u32 s16, s17, 61440
buffer_load_dwordx4 a[240:243], v7, s[4:7], s16 offen offset:0 sc1
buffer_load_dwordx4 a[244:247], v7, s[4:7], s16 offen offset:1024 sc1
buffer_load_dwordx4 a[248:251], v7, s[4:7], s16 offen offset:2048 sc1
buffer_load_dwordx4 a[252:255], v7, s[4:7], s16 offen offset:3072 sc1
s_add_u32 s16, s17, 65536
buffer_load_dwordx4 v[116:119], v7, s[4:7], s16 offen offset:0 sc1
buffer_load_dwordx4 v[120:123], v7, s[4:7], s16 offen offset:1024 sc1
buffer_load_dwordx4 v[124:127], v7, s[4:7], s16 offen offset:2048 sc1
buffer_load_dwordx4 v[128:131], v7, s[4:7], s16 offen offset:3072 sc1
s_add_u32 s16, s17, 69632
buffer_load_dwordx4 v[132:135], v7, s[4:7], s16 offen offset:0 sc1
buffer_load_dwordx4 v[136:139], v7, s[4:7], s16 offen offset:1024 sc1
s_add_u32 s16, s17, 71680
buffer_load_dwordx4 v[140:143], v7, s[4:7], s16 offen offset:0 sc1
buffer_load_dwordx4 v[144:147], v7, s[4:7], s16 offen offset:1024 sc1
s_waitcnt vmcnt(40)
buffer_load_dwordx4 v[148:151], v7, s[4:7], s16 offen offset:2048 sc1
buffer_load_dwordx4 v[152:155], v7, s[4:7], s16 offen offset:3072 sc1
s_add_u32 s16, s17, 75776
buffer_load_dwordx4 v[156:159], v7, s[4:7], s16 offen offset:0 sc1
buffer_load_dwordx4 v[160:163], v7, s[4:7], s16 offen offset:1024 sc1
buffer_load_dwordx4 v[164:167], v7, s[4:7], s16 offen offset:2048 sc1
buffer_load_dwordx4 v[168:171], v7, s[4:7], s16 offen offset:3072 sc1
s_add_u32 s16, s17, 79872
buffer_load_dwordx4 v[172:175], v7, s[4:7], s16 offen offset:0 sc1
buffer_load_dwordx4 v[176:179], v7, s[4:7], s16 offen offset:1024 sc1
buffer_load_dwordx4 v[180:183], v7, s[4:7], s16 offen offset:2048 sc1
buffer_load_dwordx4 v[184:187], v7, s[4:7], s16 offen offset:3072 sc1
s_add_u32 s16, s17, 83968
buffer_load_dwordx4 v[188:191], v7, s[4:7], s16 offen offset:0 sc1
buffer_load_dwordx4 v[192:195], v7, s[4:7], s16 offen offset:1024 sc1
s_add_u32 s16, s17, 86016
buffer_load_dwordx4 v[196:199], v7, s[4:7], s16 offen offset:0 sc1
buffer_load_dwordx4 v[200:203], v7, s[4:7], s16 offen offset:1024 sc1
buffer_load_dwordx4 v[204:207], v7, s[4:7], s16 offen offset:2048 sc1
buffer_load_dwordx4 v[208:211], v7, s[4:7], s16 offen offset:3072 sc1
s_add_u32 s16, s17, 90112
buffer_load_dwordx4 v[212:215], v7, s[4:7], s16 offen offset:0 sc1
buffer_load_dwordx4 v[216:219], v7, s[4:7], s16 offen offset:1024 sc1
buffer_load_dwordx4 v[220:223], v7, s[4:7], s16 offen offset:2048 sc1
buffer_load_dwordx4 v[224:227], v7, s[4:7], s16 offen offset:3072 sc1
s_waitcnt vmcnt(40)
s_add_u32 s16, s17, 94208
buffer_load_dwordx4 v[228:231], v7, s[4:7], s16 offen offset:0 sc1
buffer_load_dwordx4 v[232:235], v7, s[4:7], s16 offen offset:1024 sc1
buffer_load_dwordx4 v[236:239], v7, s[4:7], s16 offen offset:2048 sc1
buffer_load_dwordx4 v[240:243], v7, s[4:7], s16 offen offset:3072 sc1
s_add_u32 s16, s17, 98304
buffer_load_dwordx4 v[244:247], v7, s[4:7], s16 offen offset:0 sc1
buffer_load_dwordx4 v[248:251], v7, s[4:7], s16 offen offset:1024 sc1
s_mul_i32 s16, s9, 7
s_add_u32 s16, s16, 0
s_lshr_b32 s17, s16, 1
s_lshl_b32 s17, s17, 10
s_and_b32 s16, s16, 1
s_lshl_b32 s16, s16, 3
s_add_u32 s16, s16, s17
s_add_u32 s16, s16, 65536
v_add_u32 v10, s16, v7
s_mul_i32 s16, s9, 7
s_add_u32 s16, s16, 1
s_lshr_b32 s17, s16, 1
s_lshl_b32 s17, s17, 10
s_and_b32 s16, s16, 1
s_lshl_b32 s16, s16, 3
s_add_u32 s16, s16, s17
s_add_u32 s16, s16, 65536
v_add_u32 v11, s16, v7
s_and_b32 s16, s9, 1
s_lshl_b32 s16, s16, 4
v_add_u32 v4, s16, v3
v_lshlrev_b32 v5, 2, v2
v_add_u32 v6, 0, v5
v_cmp_le_u32 s[40:41], v6, v4
v_add_u32 v6, 1, v5
v_cmp_le_u32 s[42:43], v6, v4
v_add_u32 v6, 2, v5
v_cmp_le_u32 s[44:45], v6, v4
v_add_u32 v6, 3, v5
v_cmp_le_u32 s[46:47], v6, v4
v_add_u32 v6, 16, v5
v_cmp_le_u32 s[48:49], v6, v4
v_add_u32 v6, 17, v5
v_cmp_le_u32 s[50:51], v6, v4
v_add_u32 v6, 18, v5
v_cmp_le_u32 s[52:53], v6, v4
v_add_u32 v6, 19, v5
v_cmp_le_u32 s[54:55], v6, v4
s_waitcnt vmcnt(0)
v_mov_b32 v28, -1
v_mov_b32 v29, -1
v_mov_b32 v30, -1
v_mov_b32 v31, -1
s_mov_b32 s15, s11
v_lshlrev_b32 v4, 2, v1
s_cmp_ge_u32 s9, 2
s_cbranch_scc1 IL_34x
IL_34:
s_lshl_b32 s16, s15, 1
s_add_u32 s16, s16, s9
s_lshl_b32 s16, s16, 4
s_add_u32 s16, s16, s10
s_lshl_b32 s17, s16, 10
s_add_u32 s17, s17, 67108864
s_lshl_b32 s16, s16, 8
s_add_u32 s16, s16, 69206016
buffer_store_dwordx4 v[28:31], v7, s[4:7], s17 offen sc1
buffer_store_dword v28, v4, s[4:7], s16 offen sc1
s_add_u32 s15, s15, 4
s_cmp_lt_u32 s15, 64
s_cbranch_scc1 IL_34
IL_34x:
v_mov_b32 v9, 16384
s_waitcnt vmcnt(0) lgkmcnt(0)
s_barrier
s_cmp_lg_u32 s9, 0
s_cbranch_scc1 SG_35
v_mov_b32 v4, 1
s_mov_b64 exec, 1
buffer_atomic_add v4, v9, s[4:7], s39 offen
s_mov_b64 exec, -1
SG_35:
JOB_36:
s_waitcnt vmcnt(2) lgkmcnt(0)
s_barrier
ds_read_b128 v[28:31], v8 offset:0
ds_read_b128 v[32:35], v8 offset:1024
ds_read_b128 v[36:39], v8 offset:2048
ds_read_b128 v[40:43], v8 offset:3072
s_lshl_b32 s16, s12, 15
s_lshr_b32 s17, s9, 1
s_lshl_b32 s17, s17, 11
s_add_u32 s16, s16, s17
s_add_u32 s16, s16, s14
s_add_u32 s16, s16, 52428800
s_add_u32 m0, s14, 98304
s_nop 0
buffer_load_dwordx4 v7, s[4:7], s16 offen offset:0 sc1 lds
buffer_load_dwordx4 v7, s[4:7], s16 offen offset:1024 sc1 lds
buffer_load_dwordx4 v7, s[4:7], s16 offen offset:2048 sc1 lds
buffer_load_dwordx4 v7, s[4:7], s16 offen offset:3072 sc1 lds
s_add_u32 s16, s16, 4096
s_add_u32 m0, m0, 4096
s_nop 0
buffer_load_dwordx4 v7, s[4:7], s16 offen offset:0 sc1 lds
buffer_load_dwordx4 v7, s[4:7], s16 offen offset:1024 sc1 lds
buffer_load_dwordx4 v7, s[4:7], s16 offen offset:2048 sc1 lds
s_add_u32 s17, s12, 4
s_min_u32 s17, s17, 63
s_xor_b32 s13, s13, 32768
s_lshl_b32 s16, s17, 15
s_add_u32 s16, s16, s14
s_add_u32 s16, s16, 50331648
s_add_u32 m0, s13, s14
s_nop 0
buffer_load_dwordx4 v7, s[4:7], s16 offen offset:0 sc1 lds
buffer_load_dwordx4 v7, s[4:7], s16 offen offset:1024 sc1 lds
buffer_load_dwordx4 v7, s[4:7], s16 offen offset:2048 sc1 lds
buffer_load_dwordx4 v7, s[4:7], s16 offen offset:3072 sc1 lds
s_add_u32 s16, s16, 4096
s_add_u32 m0, m0, 4096
s_nop 0
buffer_load_dwordx4 v7, s[4:7], s16 offen offset:0 sc1 lds
buffer_load_dwordx4 v7, s[4:7], s16 offen offset:1024 sc1 lds
buffer_load_dwordx4 v7, s[4:7], s16 offen offset:2048 sc1 lds
s_waitcnt lgkmcnt(0)
v_mfma_f32_16x16x32_bf16 v[60:63], a[0:3], v[28:31], 0
v_mfma_f32_16x16x32_bf16 v[64:67], a[0:3], v[36:39], 0
ds_read_b128 v[44:47], v8 offset:8192
v_mfma_f32_16x16x32_bf16 v[68:71], a[56:59], v[28:31], 0
v_mfma_f32_16x16x32_bf16 v[72:75], a[56:59], v[36:39], 0
v_mfma_f32_16x16x32_bf16 v[76:79], a[112:115], v[28:31], 0
v_mfma_f32_16x16x32_bf16 v[80:83], a[112:115], v[36:39], 0
ds_read_b128 v[48:51], v8 offset:9216
v_mfma_f32_16x16x32_bf16 v[84:87], a[168:171], v[28:31], 0
v_mfma_f32_16x16x32_bf16 v[88:91], a[168:171], v[36:39], 0
v_mfma_f32_16x16x32_bf16 v[92:95], a[224:227], v[28:31], 0
v_mfma_f32_16x16x32_bf16 v[96:99], a[224:227], v[36:39], 0
ds_read_b128 v[52:55], v8 offset:10240
v_mfma_f32_16x16x32_bf16 v[100:103], v[140:143], v[28:31], 0
v_mfma_f32_16x16x32_bf16 v[104:107], v[140:143], v[36:39], 0
v_mfma_f32_16x16x32_bf16 v[108:111], v[196:199], v[28:31], 0
v_mfma_f32_16x16x32_bf16 v[112:115], v[196:199], v[36:39], 0
ds_read_b128 v[56:59], v8 offset:11264
v_mfma_f32_16x16x32_bf16 v[60:63], a[4:7], v[32:35], v[60:63]
v_mfma_f32_16x16x32_bf16 v[64:67], a[4:7], v[40:43], v[64:67]
v_mfma_f32_16x16x32_bf16 v[68:71], a[60:63], v[32:35], v[68:71]
v_mfma_f32_16x16x32_bf16 v[72:75], a[60:63], v[40:43], v[72:75]
v_mfma_f32_16x16x32_bf16 v[76:79], a[116:119], v[32:35], v[76:79]
v_mfma_f32_16x16x32_bf16 v[80:83], a[116:119], v[40:43], v[80:83]
v_mfma_f32_16x16x32_bf16 v[84:87], a[172:175], v[32:35], v[84:87]
v_mfma_f32_16x16x32_bf16 v[88:91], a[172:175], v[40:43], v[88:91]
v_mfma_f32_16x16x32_bf16 v[92:95], a[228:231], v[32:35], v[92:95]
v_mfma_f32_16x16x32_bf16 v[96:99], a[228:231], v[40:43], v[96:99]
v_mfma_f32_16x16x32_bf16 v[100:103], v[144:147], v[32:35], v[100:103]
v_mfma_f32_16x16x32_bf16 v[104:107], v[144:147], v[40:43], v[104:107]
v_mfma_f32_16x16x32_bf16 v[108:111], v[200:203], v[32:35], v[108:111]
v_mfma_f32_16x16x32_bf16 v[112:115], v[200:203], v[40:43], v[112:115]
s_waitcnt lgkmcnt(0)
v_mfma_f32_16x16x32_bf16 v[60:63], a[8:11], v[44:47], v[60:63]
v_mfma_f32_16x16x32_bf16 v[64:67], a[8:11], v[52:55], v[64:67]
ds_read_b128 v[28:31], v8 offset:16384
v_mfma_f32_16x16x32_bf16 v[68:71], a[64:67], v[44:47], v[68:71]
v_mfma_f32_16x16x32_bf16 v[72:75], a[64:67], v[52:55], v[72:75]
v_mfma_f32_16x16x32_bf16 v[76:79], a[120:123], v[44:47], v[76:79]
v_mfma_f32_16x16x32_bf16 v[80:83], a[120:123], v[52:55], v[80:83]
ds_read_b128 v[32:35], v8 offset:17408
v_mfma_f32_16x16x32_bf16 v[84:87], a[176:179], v[44:47], v[84:87]
v_mfma_f32_16x16x32_bf16 v[88:91], a[176:179], v[52:55], v[88:91]
v_mfma_f32_16x16x32_bf16 v[92:95], a[232:235], v[44:47], v[92:95]
v_mfma_f32_16x16x32_bf16 v[96:99], a[232:235], v[52:55], v[96:99]
ds_read_b128 v[36:39], v8 offset:18432
v_mfma_f32_16x16x32_bf16 v[100:103], v[148:151], v[44:47], v[100:103]
v_mfma_f32_16x16x32_bf16 v[104:107], v[148:151], v[52:55], v[104:107]
v_mfma_f32_16x16x32_bf16 v[108:111], v[204:207], v[44:47], v[108:111]
v_mfma_f32_16x16x32_bf16 v[112:115], v[204:207], v[52:55], v[112:115]
ds_read_b128 v[40:43], v8 offset:19456
v_mfma_f32_16x16x32_bf16 v[60:63], a[12:15], v[48:51], v[60:63]
v_mfma_f32_16x16x32_bf16 v[64:67], a[12:15], v[56:59], v[64:67]
v_mfma_f32_16x16x32_bf16 v[68:71], a[68:71], v[48:51], v[68:71]
v_mfma_f32_16x16x32_bf16 v[72:75], a[68:71], v[56:59], v[72:75]
v_mfma_f32_16x16x32_bf16 v[76:79], a[124:127], v[48:51], v[76:79]
v_mfma_f32_16x16x32_bf16 v[80:83], a[124:127], v[56:59], v[80:83]
v_mfma_f32_16x16x32_bf16 v[84:87], a[180:183], v[48:51], v[84:87]
v_mfma_f32_16x16x32_bf16 v[88:91], a[180:183], v[56:59], v[88:91]
v_mfma_f32_16x16x32_bf16 v[92:95], a[236:239], v[48:51], v[92:95]
v_mfma_f32_16x16x32_bf16 v[96:99], a[236:239], v[56:59], v[96:99]
v_mfma_f32_16x16x32_bf16 v[100:103], v[152:155], v[48:51], v[100:103]
v_mfma_f32_16x16x32_bf16 v[104:107], v[152:155], v[56:59], v[104:107]
v_mfma_f32_16x16x32_bf16 v[108:111], v[208:211], v[48:51], v[108:111]
v_mfma_f32_16x16x32_bf16 v[112:115], v[208:211], v[56:59], v[112:115]
s_waitcnt lgkmcnt(0)
v_mfma_f32_16x16x32_bf16 v[60:63], a[16:19], v[28:31], v[60:63]
v_mfma_f32_16x16x32_bf16 v[64:67], a[16:19], v[36:39], v[64:67]
ds_read_b128 v[44:47], v8 offset:24576
v_mfma_f32_16x16x32_bf16 v[68:71], a[72:75], v[28:31], v[68:71]
v_mfma_f32_16x16x32_bf16 v[72:75], a[72:75], v[36:39], v[72:75]
v_mfma_f32_16x16x32_bf16 v[76:79], a[128:131], v[28:31], v[76:79]
v_mfma_f32_16x16x32_bf16 v[80:83], a[128:131], v[36:39], v[80:83]
ds_read_b128 v[48:51], v8 offset:25600
v_mfma_f32_16x16x32_bf16 v[84:87], a[184:187], v[28:31], v[84:87]
v_mfma_f32_16x16x32_bf16 v[88:91], a[184:187], v[36:39], v[88:91]
v_mfma_f32_16x16x32_bf16 v[92:95], a[240:243], v[28:31], v[92:95]
v_mfma_f32_16x16x32_bf16 v[96:99], a[240:243], v[36:39], v[96:99]
ds_read_b128 v[52:55], v8 offset:26624
v_mfma_f32_16x16x32_bf16 v[100:103], v[156:159], v[28:31], v[100:103]
v_mfma_f32_16x16x32_bf16 v[104:107], v[156:159], v[36:39], v[104:107]
v_mfma_f32_16x16x32_bf16 v[108:111], v[212:215], v[28:31], v[108:111]
v_mfma_f32_16x16x32_bf16 v[112:115], v[212:215], v[36:39], v[112:115]
ds_read_b128 v[56:59], v8 offset:27648
v_mfma_f32_16x16x32_bf16 v[60:63], a[20:23], v[32:35], v[60:63]
v_mfma_f32_16x16x32_bf16 v[64:67], a[20:23], v[40:43], v[64:67]
v_mfma_f32_16x16x32_bf16 v[68:71], a[76:79], v[32:35], v[68:71]
v_mfma_f32_16x16x32_bf16 v[72:75], a[76:79], v[40:43], v[72:75]
v_mfma_f32_16x16x32_bf16 v[76:79], a[132:135], v[32:35], v[76:79]
v_mfma_f32_16x16x32_bf16 v[80:83], a[132:135], v[40:43], v[80:83]
v_mfma_f32_16x16x32_bf16 v[84:87], a[188:191], v[32:35], v[84:87]
v_mfma_f32_16x16x32_bf16 v[88:91], a[188:191], v[40:43], v[88:91]
v_mfma_f32_16x16x32_bf16 v[92:95], a[244:247], v[32:35], v[92:95]
v_mfma_f32_16x16x32_bf16 v[96:99], a[244:247], v[40:43], v[96:99]
v_mfma_f32_16x16x32_bf16 v[100:103], v[160:163], v[32:35], v[100:103]
v_mfma_f32_16x16x32_bf16 v[104:107], v[160:163], v[40:43], v[104:107]
v_mfma_f32_16x16x32_bf16 v[108:111], v[216:219], v[32:35], v[108:111]
v_mfma_f32_16x16x32_bf16 v[112:115], v[216:219], v[40:43], v[112:115]
s_waitcnt lgkmcnt(0)
v_mfma_f32_16x16x32_bf16 v[60:63], a[24:27], v[44:47], v[60:63]
v_mfma_f32_16x16x32_bf16 v[64:67], a[24:27], v[52:55], v[64:67]
ds_read_b128 v[28:31], v8 offset:4096
v_mfma_f32_16x16x32_bf16 v[68:71], a[80:83], v[44:47], v[68:71]
v_mfma_f32_16x16x32_bf16 v[72:75], a[80:83], v[52:55], v[72:75]
v_mfma_f32_16x16x32_bf16 v[76:79], a[136:139], v[44:47], v[76:79]
v_mfma_f32_16x16x32_bf16 v[80:83], a[136:139], v[52:55], v[80:83]
ds_read_b128 v[32:35], v8 offset:5120
v_mfma_f32_16x16x32_bf16 v[84:87], a[192:195], v[44:47], v[84:87]
v_mfma_f32_16x16x32_bf16 v[88:91], a[192:195], v[52:55], v[88:91]
v_mfma_f32_16x16x32_bf16 v[92:95], a[248:251], v[44:47], v[92:95]
v_mfma_f32_16x16x32_bf16 v[96:99], a[248:251], v[52:55], v[96:99]
ds_read_b128 v[36:39], v8 offset:6144
v_mfma_f32_16x16x32_bf16 v[100:103], v[164:167], v[44:47], v[100:103]
v_mfma_f32_16x16x32_bf16 v[104:107], v[164:167], v[52:55], v[104:107]
v_mfma_f32_16x16x32_bf16 v[108:111], v[220:223], v[44:47], v[108:111]
v_mfma_f32_16x16x32_bf16 v[112:115], v[220:223], v[52:55], v[112:115]
ds_read_b128 v[40:43], v8 offset:7168
v_mfma_f32_16x16x32_bf16 v[60:63], a[28:31], v[48:51], v[60:63]
v_mfma_f32_16x16x32_bf16 v[64:67], a[28:31], v[56:59], v[64:67]
v_mfma_f32_16x16x32_bf16 v[68:71], a[84:87], v[48:51], v[68:71]
v_mfma_f32_16x16x32_bf16 v[72:75], a[84:87], v[56:59], v[72:75]
v_mfma_f32_16x16x32_bf16 v[76:79], a[140:143], v[48:51], v[76:79]
v_mfma_f32_16x16x32_bf16 v[80:83], a[140:143], v[56:59], v[80:83]
v_mfma_f32_16x16x32_bf16 v[84:87], a[196:199], v[48:51], v[84:87]
v_mfma_f32_16x16x32_bf16 v[88:91], a[196:199], v[56:59], v[88:91]
v_mfma_f32_16x16x32_bf16 v[92:95], a[252:255], v[48:51], v[92:95]
v_mfma_f32_16x16x32_bf16 v[96:99], a[252:255], v[56:59], v[96:99]
v_mfma_f32_16x16x32_bf16 v[100:103], v[168:171], v[48:51], v[100:103]
v_mfma_f32_16x16x32_bf16 v[104:107], v[168:171], v[56:59], v[104:107]
v_mfma_f32_16x16x32_bf16 v[108:111], v[224:227], v[48:51], v[108:111]
v_mfma_f32_16x16x32_bf16 v[112:115], v[224:227], v[56:59], v[112:115]
s_waitcnt lgkmcnt(0)
v_mfma_f32_16x16x32_bf16 v[60:63], a[32:35], v[28:31], v[60:63]
v_mfma_f32_16x16x32_bf16 v[64:67], a[32:35], v[36:39], v[64:67]
ds_read_b128 v[44:47], v8 offset:12288
v_mfma_f32_16x16x32_bf16 v[68:71], a[88:91], v[28:31], v[68:71]
v_mfma_f32_16x16x32_bf16 v[72:75], a[88:91], v[36:39], v[72:75]
v_mfma_f32_16x16x32_bf16 v[76:79], a[144:147], v[28:31], v[76:79]
v_mfma_f32_16x16x32_bf16 v[80:83], a[144:147], v[36:39], v[80:83]
ds_read_b128 v[48:51], v8 offset:13312
v_mfma_f32_16x16x32_bf16 v[84:87], a[200:203], v[28:31], v[84:87]
v_mfma_f32_16x16x32_bf16 v[88:91], a[200:203], v[36:39], v[88:91]
v_mfma_f32_16x16x32_bf16 v[92:95], v[116:119], v[28:31], v[92:95]
v_mfma_f32_16x16x32_bf16 v[96:99], v[116:119], v[36:39], v[96:99]
ds_read_b128 v[52:55], v8 offset:14336
v_mfma_f32_16x16x32_bf16 v[100:103], v[172:175], v[28:31], v[100:103]
v_mfma_f32_16x16x32_bf16 v[104:107], v[172:175], v[36:39], v[104:107]
v_mfma_f32_16x16x32_bf16 v[108:111], v[228:231], v[28:31], v[108:111]
v_mfma_f32_16x16x32_bf16 v[112:115], v[228:231], v[36:39], v[112:115]
ds_read_b128 v[56:59], v8 offset:15360
v_mfma_f32_16x16x32_bf16 v[60:63], a[36:39], v[32:35], v[60:63]
v_mfma_f32_16x16x32_bf16 v[64:67], a[36:39], v[40:43], v[64:67]
v_mfma_f32_16x16x32_bf16 v[68:71], a[92:95], v[32:35], v[68:71]
v_mfma_f32_16x16x32_bf16 v[72:75], a[92:95], v[40:43], v[72:75]
v_mfma_f32_16x16x32_bf16 v[76:79], a[148:151], v[32:35], v[76:79]
v_mfma_f32_16x16x32_bf16 v[80:83], a[148:151], v[40:43], v[80:83]
v_mfma_f32_16x16x32_bf16 v[84:87], a[204:207], v[32:35], v[84:87]
v_mfma_f32_16x16x32_bf16 v[88:91], a[204:207], v[40:43], v[88:91]
v_mfma_f32_16x16x32_bf16 v[92:95], v[120:123], v[32:35], v[92:95]
v_mfma_f32_16x16x32_bf16 v[96:99], v[120:123], v[40:43], v[96:99]
v_mfma_f32_16x16x32_bf16 v[100:103], v[176:179], v[32:35], v[100:103]
v_mfma_f32_16x16x32_bf16 v[104:107], v[176:179], v[40:43], v[104:107]
v_mfma_f32_16x16x32_bf16 v[108:111], v[232:235], v[32:35], v[108:111]
v_mfma_f32_16x16x32_bf16 v[112:115], v[232:235], v[40:43], v[112:115]
s_waitcnt lgkmcnt(0)
v_mfma_f32_16x16x32_bf16 v[60:63], a[40:43], v[44:47], v[60:63]
v_mfma_f32_16x16x32_bf16 v[64:67], a[40:43], v[52:55], v[64:67]
ds_read_b128 v[28:31], v8 offset:20480
v_mfma_f32_16x16x32_bf16 v[68:71], a[96:99], v[44:47], v[68:71]
v_mfma_f32_16x16x32_bf16 v[72:75], a[96:99], v[52:55], v[72:75]
v_mfma_f32_16x16x32_bf16 v[76:79], a[152:155], v[44:47], v[76:79]
v_mfma_f32_16x16x32_bf16 v[80:83], a[152:155], v[52:55], v[80:83]
ds_read_b128 v[32:35], v8 offset:21504
v_mfma_f32_16x16x32_bf16 v[84:87], a[208:211], v[44:47], v[84:87]
v_mfma_f32_16x16x32_bf16 v[88:91], a[208:211], v[52:55], v[88:91]
v_mfma_f32_16x16x32_bf16 v[92:95], v[124:127], v[44:47], v[92:95]
v_mfma_f32_16x16x32_bf16 v[96:99], v[124:127], v[52:55], v[96:99]
ds_read_b128 v[36:39], v8 offset:22528
v_mfma_f32_16x16x32_bf16 v[100:103], v[180:183], v[44:47], v[100:103]
v_mfma_f32_16x16x32_bf16 v[104:107], v[180:183], v[52:55], v[104:107]
v_mfma_f32_16x16x32_bf16 v[108:111], v[236:239], v[44:47], v[108:111]
v_mfma_f32_16x16x32_bf16 v[112:115], v[236:239], v[52:55], v[112:115]
ds_read_b128 v[40:43], v8 offset:23552
v_mfma_f32_16x16x32_bf16 v[60:63], a[44:47], v[48:51], v[60:63]
v_mfma_f32_16x16x32_bf16 v[64:67], a[44:47], v[56:59], v[64:67]
v_mfma_f32_16x16x32_bf16 v[68:71], a[100:103], v[48:51], v[68:71]
v_mfma_f32_16x16x32_bf16 v[72:75], a[100:103], v[56:59], v[72:75]
v_mfma_f32_16x16x32_bf16 v[76:79], a[156:159], v[48:51], v[76:79]
v_mfma_f32_16x16x32_bf16 v[80:83], a[156:159], v[56:59], v[80:83]
v_mfma_f32_16x16x32_bf16 v[84:87], a[212:215], v[48:51], v[84:87]
v_mfma_f32_16x16x32_bf16 v[88:91], a[212:215], v[56:59], v[88:91]
v_mfma_f32_16x16x32_bf16 v[92:95], v[128:131], v[48:51], v[92:95]
v_mfma_f32_16x16x32_bf16 v[96:99], v[128:131], v[56:59], v[96:99]
v_mfma_f32_16x16x32_bf16 v[100:103], v[184:187], v[48:51], v[100:103]
v_mfma_f32_16x16x32_bf16 v[104:107], v[184:187], v[56:59], v[104:107]
v_mfma_f32_16x16x32_bf16 v[108:111], v[240:243], v[48:51], v[108:111]
v_mfma_f32_16x16x32_bf16 v[112:115], v[240:243], v[56:59], v[112:115]
s_waitcnt lgkmcnt(0)
v_mfma_f32_16x16x32_bf16 v[60:63], a[48:51], v[28:31], v[60:63]
v_mfma_f32_16x16x32_bf16 v[64:67], a[48:51], v[36:39], v[64:67]
v_mfma_f32_16x16x32_bf16 v[68:71], a[104:107], v[28:31], v[68:71]
v_mfma_f32_16x16x32_bf16 v[72:75], a[104:107], v[36:39], v[72:75]
v_mfma_f32_16x16x32_bf16 v[76:79], a[160:163], v[28:31], v[76:79]
v_mfma_f32_16x16x32_bf16 v[80:83], a[160:163], v[36:39], v[80:83]
v_mfma_f32_16x16x32_bf16 v[84:87], a[216:219], v[28:31], v[84:87]
v_mfma_f32_16x16x32_bf16 v[88:91], a[216:219], v[36:39], v[88:91]
v_mfma_f32_16x16x32_bf16 v[92:95], v[132:135], v[28:31], v[92:95]
v_mfma_f32_16x16x32_bf16 v[96:99], v[132:135], v[36:39], v[96:99]
v_mfma_f32_16x16x32_bf16 v[100:103], v[188:191], v[28:31], v[100:103]
v_mfma_f32_16x16x32_bf16 v[104:107], v[188:191], v[36:39], v[104:107]
v_mfma_f32_16x16x32_bf16 v[108:111], v[244:247], v[28:31], v[108:111]
v_mfma_f32_16x16x32_bf16 v[112:115], v[244:247], v[36:39], v[112:115]
v_mfma_f32_16x16x32_bf16 v[60:63], a[52:55], v[32:35], v[60:63]
v_mfma_f32_16x16x32_bf16 v[64:67], a[52:55], v[40:43], v[64:67]
v_mfma_f32_16x16x32_bf16 v[68:71], a[108:111], v[32:35], v[68:71]
v_mfma_f32_16x16x32_bf16 v[72:75], a[108:111], v[40:43], v[72:75]
v_mfma_f32_16x16x32_bf16 v[76:79], a[164:167], v[32:35], v[76:79]
v_mfma_f32_16x16x32_bf16 v[80:83], a[164:167], v[40:43], v[80:83]
v_mfma_f32_16x16x32_bf16 v[84:87], a[220:223], v[32:35], v[84:87]
v_mfma_f32_16x16x32_bf16 v[88:91], a[220:223], v[40:43], v[88:91]
v_mfma_f32_16x16x32_bf16 v[92:95], v[136:139], v[32:35], v[92:95]
v_mfma_f32_16x16x32_bf16 v[96:99], v[136:139], v[40:43], v[96:99]
v_mfma_f32_16x16x32_bf16 v[100:103], v[192:195], v[32:35], v[100:103]
v_mfma_f32_16x16x32_bf16 v[104:107], v[192:195], v[40:43], v[104:107]
v_mfma_f32_16x16x32_bf16 v[108:111], v[248:251], v[32:35], v[108:111]
v_mfma_f32_16x16x32_bf16 v[112:115], v[248:251], v[40:43], v[112:115]
v_xor_b32 v8, 32768, v8
v_cvt_pk_bf16_f32 v60, v60, v61
v_cvt_pk_bf16_f32 v61, v62, v63
ds_write_b64 v10, v[60:61] offset:0
v_cvt_pk_bf16_f32 v64, v64, v65
v_cvt_pk_bf16_f32 v65, v66, v67
ds_write_b64 v10, v[64:65] offset:14336
v_cvt_pk_bf16_f32 v68, v68, v69
v_cvt_pk_bf16_f32 v69, v70, v71
ds_write_b64 v11, v[68:69] offset:0
v_cvt_pk_bf16_f32 v72, v72, v73
v_cvt_pk_bf16_f32 v73, v74, v75
ds_write_b64 v11, v[72:73] offset:14336
v_cvt_pk_bf16_f32 v76, v76, v77
v_cvt_pk_bf16_f32 v77, v78, v79
ds_write_b64 v10, v[76:77] offset:1024
v_cvt_pk_bf16_f32 v80, v80, v81
v_cvt_pk_bf16_f32 v81, v82, v83
ds_write_b64 v10, v[80:81] offset:15360
v_cvt_pk_bf16_f32 v84, v84, v85
v_cvt_pk_bf16_f32 v85, v86, v87
ds_write_b64 v11, v[84:85] offset:1024
v_cvt_pk_bf16_f32 v88, v88, v89
v_cvt_pk_bf16_f32 v89, v90, v91
ds_write_b64 v11, v[88:89] offset:15360
v_cvt_pk_bf16_f32 v92, v92, v93
v_cvt_pk_bf16_f32 v93, v94, v95
ds_write_b64 v10, v[92:93] offset:2048
v_cvt_pk_bf16_f32 v96, v96, v97
v_cvt_pk_bf16_f32 v97, v98, v99
ds_write_b64 v10, v[96:97] offset:16384
v_cvt_pk_bf16_f32 v100, v100, v101
v_cvt_pk_bf16_f32 v101, v102, v103
ds_write_b64 v11, v[100:101] offset:2048
v_cvt_pk_bf16_f32 v104, v104, v105
v_cvt_pk_bf16_f32 v105, v106, v107
ds_write_b64 v11, v[104:105] offset:16384
v_cvt_pk_bf16_f32 v108, v108, v109
v_cvt_pk_bf16_f32 v109, v110, v111
ds_write_b64 v10, v[108:109] offset:3072
v_cvt_pk_bf16_f32 v112, v112, v113
v_cvt_pk_bf16_f32 v113, v114, v115
ds_write_b64 v10, v[112:113] offset:17408
s_waitcnt vmcnt(0) lgkmcnt(0)
s_barrier
s_and_b32 s17, s9, 1
s_mul_i32 s16, s17, 14336
s_add_u32 s16, s16, 65536
v_add_u32 v4, s16, v7
v_add_u32 v6, 98304, v7
s_lshl_b32 s17, s17, 11
v_add_u32 v9, s17, v7
ds_read_b128 v[60:63], v4 offset:0
ds_read_b128 v[64:67], v4 offset:1024
ds_read_b128 v[68:71], v4 offset:2048
ds_read_b128 v[72:75], v4 offset:3072
ds_read_b128 v[76:79], v4 offset:4096
ds_read_b128 v[80:83], v4 offset:5120
ds_read_b128 v[84:87], v4 offset:6144
ds_read_b128 v[88:91], v4 offset:7168
ds_read_b128 v[92:95], v4 offset:8192
ds_read_b128 v[96:99], v4 offset:9216
ds_read_b128 v[100:103], v4 offset:10240
ds_read_b128 v[104:107], v4 offset:11264
ds_read_b128 v[108:111], v4 offset:12288
ds_read_b128 v[112:115], v4 offset:13312
s_cmp_lt_u32 s9, 2
s_cbranch_scc1 TSM_38
s_waitcnt lgkmcnt(6)
ds_read_b128 v[28:31], v6 offset:0
ds_read_b128 v[32:35], v6 offset:1024
ds_read_b128 v[36:39], v6 offset:2048
ds_read_b128 v[40:43], v6 offset:3072
ds_read_b128 v[44:47], v6 offset:4096
ds_read_b128 v[48:51], v6 offset:5120
ds_read_b128 v[52:55], v6 offset:6144
ds_read_b128 v[56:59], v6 offset:7168
s_waitcnt lgkmcnt(7)
v_mfma_f32_16x16x32_bf16 v[12:15], v[28:31], v[60:63], 0
ds_read_b128 v[28:31], v6 offset:8192
s_waitcnt lgkmcnt(7)
v_mfma_f32_16x16x32_bf16 v[12:15], v[32:35], v[64:67], v[12:15]
ds_read_b128 v[32:35], v6 offset:9216
s_waitcnt lgkmcnt(7)
v_mfma_f32_16x16x32_bf16 v[12:15], v[36:39], v[68:71], v[12:15]
ds_read_b128 v[36:39], v6 offset:10240
s_waitcnt lgkmcnt(7)
v_mfma_f32_16x16x32_bf16 v[12:15], v[40:43], v[72:75], v[12:15]
ds_read_b128 v[40:43], v6 offset:11264
s_waitcnt lgkmcnt(7)
v_mfma_f32_16x16x32_bf16 v[12:15], v[44:47], v[76:79], v[12:15]
ds_read_b128 v[44:47], v6 offset:12288
s_waitcnt lgkmcnt(7)
v_mfma_f32_16x16x32_bf16 v[12:15], v[48:51], v[80:83], v[12:15]
ds_read_b128 v[48:51], v6 offset:13312
s_waitcnt lgkmcnt(7)
v_mfma_f32_16x16x32_bf16 v[12:15], v[52:55], v[84:87], v[12:15]
ds_read_b128 v[52:55], v6 offset:14336
s_waitcnt lgkmcnt(7)
v_mfma_f32_16x16x32_bf16 v[12:15], v[56:59], v[88:91], v[12:15]
ds_read_b128 v[56:59], v6 offset:15360
s_waitcnt lgkmcnt(7)
v_mfma_f32_16x16x32_bf16 v[12:15], v[28:31], v[92:95], v[12:15]
ds_read_b128 v[28:31], v6 offset:16384
s_waitcnt lgkmcnt(7)
v_mfma_f32_16x16x32_bf16 v[12:15], v[32:35], v[96:99], v[12:15]
ds_read_b128 v[32:35], v6 offset:17408
s_waitcnt lgkmcnt(7)
v_mfma_f32_16x16x32_bf16 v[12:15], v[36:39], v[100:103], v[12:15]
ds_read_b128 v[36:39], v6 offset:18432
s_waitcnt lgkmcnt(7)
v_mfma_f32_16x16x32_bf16 v[12:15], v[40:43], v[104:107], v[12:15]
ds_read_b128 v[40:43], v6 offset:19456
s_waitcnt lgkmcnt(7)
v_mfma_f32_16x16x32_bf16 v[12:15], v[44:47], v[108:111], v[12:15]
ds_read_b128 v[44:47], v6 offset:20480
s_waitcnt lgkmcnt(7)
v_mfma_f32_16x16x32_bf16 v[12:15], v[48:51], v[112:115], v[12:15]
ds_read_b128 v[48:51], v6 offset:21504
s_waitcnt lgkmcnt(7)
v_mfma_f32_16x16x32_bf16 v[16:19], v[52:55], v[60:63], 0
ds_read_b128 v[52:55], v6 offset:22528
s_waitcnt lgkmcnt(7)
v_mfma_f32_16x16x32_bf16 v[16:19], v[56:59], v[64:67], v[16:19]
ds_read_b128 v[56:59], v6 offset:23552
s_waitcnt lgkmcnt(7)
v_mfma_f32_16x16x32_bf16 v[16:19], v[28:31], v[68:71], v[16:19]
ds_read_b128 v[28:31], v6 offset:24576
s_waitcnt lgkmcnt(7)
v_mfma_f32_16x16x32_bf16 v[16:19], v[32:35], v[72:75], v[16:19]
ds_read_b128 v[32:35], v6 offset:25600
s_waitcnt lgkmcnt(7)
v_mfma_f32_16x16x32_bf16 v[16:19], v[36:39], v[76:79], v[16:19]
ds_read_b128 v[36:39], v6 offset:26624
s_waitcnt lgkmcnt(7)
v_mfma_f32_16x16x32_bf16 v[16:19], v[40:43], v[80:83], v[16:19]
ds_read_b128 v[40:43], v6 offset:27648
s_waitcnt lgkmcnt(7)
v_mfma_f32_16x16x32_bf16 v[16:19], v[44:47], v[84:87], v[16:19]
s_waitcnt lgkmcnt(6)
v_mfma_f32_16x16x32_bf16 v[16:19], v[48:51], v[88:91], v[16:19]
s_waitcnt lgkmcnt(5)
v_mfma_f32_16x16x32_bf16 v[16:19], v[52:55], v[92:95], v[16:19]
s_waitcnt lgkmcnt(4)
v_mfma_f32_16x16x32_bf16 v[16:19], v[56:59], v[96:99], v[16:19]
s_waitcnt lgkmcnt(3)
v_mfma_f32_16x16x32_bf16 v[16:19], v[28:31], v[100:103], v[16:19]
s_waitcnt lgkmcnt(2)
v_mfma_f32_16x16x32_bf16 v[16:19], v[32:35], v[104:107], v[16:19]
s_waitcnt lgkmcnt(1)
v_mfma_f32_16x16x32_bf16 v[16:19], v[36:39], v[108:111], v[16:19]
s_waitcnt lgkmcnt(0)
v_mfma_f32_16x16x32_bf16 v[16:19], v[40:43], v[112:115], v[16:19]
v_mov_b32 v5, 0xff800000
v_cndmask_b32 v12, v5, v12, s[40:41]
v_cndmask_b32 v13, v5, v13, s[42:43]
v_cndmask_b32 v14, v5, v14, s[44:45]
v_cndmask_b32 v15, v5, v15, s[46:47]
s_nop 2
v_cndmask_b32 v16, v5, v16, s[48:49]
v_cndmask_b32 v17, v5, v17, s[50:51]
v_cndmask_b32 v18, v5, v18, s[52:53]
v_cndmask_b32 v19, v5, v19, s[54:55]
ds_write_b128 v9, v[12:15] offset:28672
ds_write_b128 v9, v[16:19] offset:29696
s_waitcnt lgkmcnt(0)
s_barrier
s_branch TSK_37
TSM_38:
s_lshl_b32 s16, s12, 13
s_add_u32 s16, s16, 56623104
s_add_u32 s17, s16, 4096
LV_39:
buffer_load_dwordx4 v[28:31], v7, s[4:7], s16 offen offset:0 sc1
buffer_load_dwordx4 v[32:35], v7, s[4:7], s16 offen offset:1024 sc1
buffer_load_dwordx4 v[36:39], v7, s[4:7], s16 offen offset:2048 sc1
buffer_load_dwordx4 v[40:43], v7, s[4:7], s16 offen offset:3072 sc1
buffer_load_dwordx4 v[44:47], v7, s[4:7], s17 offen offset:0 sc1
buffer_load_dwordx4 v[48:51], v7, s[4:7], s17 offen offset:1024 sc1
buffer_load_dwordx4 v[52:55], v7, s[4:7], s17 offen offset:2048 sc1
s_sub_u32 s38, s38, 1
s_cmp_gt_i32 s38, 0
s_cbranch_scc0 LD_40
s_waitcnt vmcnt(6)
v_max_u32 v4, v28, v29
v_max3_u32 v4, v4, v30, v31
s_waitcnt vmcnt(5)
v_max3_u32 v4, v4, v32, v33
v_max3_u32 v4, v4, v34, v35
s_waitcnt vmcnt(4)
v_max3_u32 v4, v4, v36, v37
v_max3_u32 v4, v4, v38, v39
s_waitcnt vmcnt(3)
v_max3_u32 v4, v4, v40, v41
v_max3_u32 v4, v4, v42, v43
s_waitcnt vmcnt(2)
v_max3_u32 v4, v4, v44, v45
v_max3_u32 v4, v4, v46, v47
s_waitcnt vmcnt(1)
v_max3_u32 v4, v4, v48, v49
v_max3_u32 v4, v4, v50, v51
s_waitcnt vmcnt(0)
v_max3_u32 v4, v4, v52, v53
v_max3_u32 v4, v4, v54, v55
v_cmp_eq_u32 vcc, -1, v4
s_cbranch_vccz LD_40
s_sleep 3
s_branch LV_39
LD_40:
s_waitcnt vmcnt(0) lgkmcnt(0)
s_barrier
ds_read_b128 v[12:15], v9 offset:28672
ds_read_b128 v[16:19], v9 offset:29696
v_mfma_f32_16x16x32_bf16 v[20:23], v[28:31], v[60:63], 0
v_mfma_f32_16x16x32_bf16 v[24:27], v[28:31], v[64:67], 0
v_mfma_f32_16x16x32_bf16 v[20:23], v[32:35], v[68:71], v[20:23]
v_mfma_f32_16x16x32_bf16 v[24:27], v[32:35], v[72:75], v[24:27]
v_mfma_f32_16x16x32_bf16 v[20:23], v[36:39], v[76:79], v[20:23]
v_mfma_f32_16x16x32_bf16 v[24:27], v[36:39], v[80:83], v[24:27]
v_mfma_f32_16x16x32_bf16 v[20:23], v[40:43], v[84:87], v[20:23]
v_mfma_f32_16x16x32_bf16 v[24:27], v[40:43], v[88:91], v[24:27]
v_mfma_f32_16x16x32_bf16 v[20:23], v[44:47], v[92:95], v[20:23]
v_mfma_f32_16x16x32_bf16 v[24:27], v[44:47], v[96:99], v[24:27]
v_mfma_f32_16x16x32_bf16 v[20:23], v[48:51], v[100:103], v[20:23]
v_mfma_f32_16x16x32_bf16 v[24:27], v[48:51], v[104:107], v[24:27]
v_mfma_f32_16x16x32_bf16 v[20:23], v[52:55], v[108:111], v[20:23]
v_mfma_f32_16x16x32_bf16 v[24:27], v[52:55], v[112:115], v[24:27]
s_waitcnt lgkmcnt(0)
v_max3_f32 v6, v12, v13, v14
v_max3_f32 v6, v6, v15, v16
v_max3_f32 v6, v6, v17, v18
v_max_f32 v6, v6, v19
s_lshl_b32 s16, s12, 1
s_add_u32 s16, s16, s9
s_lshl_b32 s16, s16, 4
s_add_u32 s16, s16, s10
s_lshl_b32 s17, s16, 10
s_add_u32 s17, s17, 67108864
s_lshl_b32 s16, s16, 8
s_add_u32 s16, s16, 69206016
v_add_f32 v20, v20, v26
v_add_f32 v21, v21, v27
v_max3_f32 v4, v6, v20, v21
v_mov_b32 v5, v4
s_nop 1
v_permlane16_swap_b32 v4, v5
v_max_f32 v4, v4, v5
v_mov_b32 v5, v4
s_nop 1
v_permlane32_swap_b32 v4, v5
v_max_f32 v4, v4, v5
v_sub_f32 v12, v12, v4
v_sub_f32 v13, v13, v4
v_sub_f32 v14, v14, v4
v_sub_f32 v15, v15, v4
v_sub_f32 v16, v16, v4
v_sub_f32 v17, v17, v4
v_sub_f32 v18, v18, v4
v_sub_f32 v19, v19, v4
v_sub_f32 v20, v20, v4
v_sub_f32 v21, v21, v4
v_exp_f32 v12, v12
v_exp_f32 v13, v13
v_exp_f32 v14, v14
v_exp_f32 v15, v15
v_exp_f32 v16, v16
v_exp_f32 v17, v17
v_exp_f32 v18, v18
v_exp_f32 v19, v19
v_exp_f32 v20, v20
v_exp_f32 v21, v21
v_add_f32 v4, v12, v13
v_add_f32 v4, v4, v14
v_add_f32 v4, v4, v15
v_add_f32 v4, v4, v16
v_add_f32 v4, v4, v17
v_add_f32 v4, v4, v18
v_add_f32 v4, v4, v19
v_add_f32 v4, v4, v20
v_add_f32 v4, v4, v21
v_mov_b32 v5, v4
s_nop 1
v_permlane16_swap_b32 v4, v5
v_add_f32 v4, v4, v5
v_mov_b32 v5, v4
s_nop 1
v_permlane32_swap_b32 v4, v5
v_add_f32 v4, v4, v5
v_rcp_f32 v4, v4
s_nop 0
v_mul_f32 v12, v12, v4
v_mul_f32 v13, v13, v4
v_mul_f32 v14, v14, v4
v_mul_f32 v15, v15, v4
v_mul_f32 v16, v16, v4
v_mul_f32 v17, v17, v4
v_mul_f32 v18, v18, v4
v_mul_f32 v19, v19, v4
v_mul_f32 v20, v20, v4
v_mul_f32 v21, v21, v4
v_cvt_pk_bf16_f32 v12, v12, v13
v_cvt_pk_bf16_f32 v13, v14, v15
v_cvt_pk_bf16_f32 v14, v16, v17
v_cvt_pk_bf16_f32 v15, v18, v19
v_cvt_pk_bf16_f32 v20, v20, v21
buffer_store_dwordx4 v[12:15], v7, s[4:7], s17 offen sc1
v_lshlrev_b32 v4, 4, v3
v_lshl_add_u32 v4, v2, 2, v4
buffer_store_dword v20, v4, s[4:7], s16 offen sc1
TSK_37:
s_add_u32 s12, s12, 4
s_cmp_lt_u32 s12, 64
s_cbranch_scc1 JOB_36
s_endpgm
ROLE_F:
s_cmp_ge_u32 s8, 192
s_cbranch_scc1 EXIT
s_cmp_ge_u32 s8, 128
s_cbranch_scc1 F_CONT
s_sub_u32 s10, s8, 96
s_lshl_b32 s89, s10, 2
s_add_u32 s89, s89, 21504
s_mov_b32 s90, 8
s_lshl_b32 s10, s10, 2
s_add_u32 s10, s10, s9
s_branch LN_LOOP
F_CONT:
s_cmp_lg_u32 s9, 0
s_cbranch_scc1 RB_42
s_mov_b32 s23, 71319552
s_and_b32 s22, s8, 7
s_lshl_b32 s22, s22, 7
s_add_u32 s22, s22, 21504
v_and_b32 v1, 31, v0
v_lshlrev_b32 v1, 2, v1
v_add_u32 v1, s22, v1
v_and_b32 v3, 15, v0
v_min_u32 v3, 13, v3
v_lshlrev_b32 v3, 2, v3
s_mov_b32 s22, 200000
RW_41:
buffer_load_dword v3, v1, s[4:7], s23 offen sc1
s_sub_u32 s22, s22, 1
s_cmp_gt_i32 s22, 0
s_cbranch_scc0 RB_42
s_waitcnt vmcnt(0)
v_cmp_ne_u32 vcc, 1, v3
s_cbranch_vccz RB_42
s_sleep 4
s_branch RW_41
RB_42:
s_barrier
s_sub_u32 s10, s8, 112
s_load_dwordx2 s[16:17], s[0:1], 64
s_mov_b32 s18, 1605632
s_mov_b32 s19, 0x20000
s_load_dwordx2 s[20:21], s[0:1], 80
s_mov_b32 s22, 1605632
s_mov_b32 s23, 0x20000
s_load_dwordx2 s[24:25], s[0:1], 72
s_mov_b32 s26, 3584
s_mov_b32 s27, 0x20000
s_load_dwordx2 s[28:29], s[0:1], 88
s_mov_b32 s30, 896
s_mov_b32 s31, 0x20000
s_load_dwordx2 s[40:41], s[0:1], 0
s_mov_b32 s42, 1835008
s_mov_b32 s43, 0x20000
s_load_dwordx2 s[44:45], s[0:1], 96
s_mov_b32 s46, 1835008
s_mov_b32 s47, 0x20000
v_and_b32 v1, 63, v0
v_lshrrev_b32 v2, 4, v1
v_and_b32 v3, 15, v1
v_lshlrev_b32 v7, 4, v1
v_lshlrev_b32 v9, 3, v2
s_mov_b32 s38, 400000
s_mov_b32 s39, 71319552
s_lshr_b32 s12, s10, 1
s_and_b32 s13, s10, 1
v_add_u32 v10, 0, v7
v_add_u32 v11, 4096, v7
v_add_u32 v12, 8192, v7
v_add_u32 v13, 12288, v7
v_add_u32 v14, 16384, v7
v_add_u32 v15, 20480, v7
v_add_u32 v16, 24576, v7
s_cmp_lg_u32 s9, 0
s_cbranch_scc1 GW_43
s_and_b32 s14, s8, 7
s_lshl_b32 s14, s14, 7
s_add_u32 s14, s14, 22528
v_mov_b32 v8, s14
WT_44:
buffer_load_dword v4, v8, s[4:7], s39 offen sc1
s_sub_u32 s38, s38, 1
s_cmp_gt_i32 s38, 0
s_cbranch_scc0 WD_45
s_waitcnt vmcnt(0)
v_cmp_gt_u32 vcc, 7, v4
s_cbranch_vccz WD_45
s_sleep 16
s_branch WT_44
WD_45:
GW_43:
s_barrier
v_mul_u32_u24 v4, 14336, v2
v_lshl_add_u32 v4, v3, 1, v4
v_mul_u32_u24 v5, 3584, v2
v_and_b32 v6, 7, v3
v_lshl_add_u32 v5, v6, 1, v5
v_lshrrev_b32 v6, 3, v3
v_lshl_add_u32 v5, v6, 6, v5
s_lshl_b32 s33, s10, 2
s_add_u32 s33, s33, s9
s_waitcnt lgkmcnt(0)
CV_46:
s_mul_i32 s14, s33, 4682
s_lshr_b32 s14, s14, 16
s_mul_i32 s15, s14, 14
s_sub_u32 s15, s33, s15
s_lshl_b32 s14, s14, 5
s_lshr_b32 s32, s15, 1
s_mul_i32 s32, s32, 229376
s_add_u32 s14, s14, s32
s_and_b32 s15, s15, 1
s_mul_i32 s15, s15, 57344
s_add_u32 s14, s14, s15
s_add_u32 s15, s14, 0
buffer_load_ushort v56, v4, s[16:19], s15 offen
s_add_u32 s15, s14, 3584
buffer_load_ushort v57, v4, s[16:19], s15 offen
s_add_u32 s15, s14, 114688
buffer_load_ushort v58, v4, s[16:19], s15 offen
s_add_u32 s15, s14, 118272
buffer_load_ushort v59, v4, s[16:19], s15 offen
s_add_u32 s15, s14, 7168
buffer_load_ushort v60, v4, s[16:19], s15 offen
s_add_u32 s15, s14, 10752
buffer_load_ushort v61, v4, s[16:19], s15 offen
s_add_u32 s15, s14, 121856
buffer_load_ushort v62, v4, s[16:19], s15 offen
s_add_u32 s15, s14, 125440
buffer_load_ushort v63, v4, s[16:19], s15 offen
s_mul_i32 s14, s33, 2341
s_lshr_b32 s14, s14, 16
s_mul_i32 s15, s14, 28
s_sub_u32 s15, s33, s15
s_mul_i32 s14, s14, 28672
s_lshr_b32 s32, s15, 2
s_lshl_b32 s32, s32, 7
s_add_u32 s14, s14, s32
s_and_b32 s15, s15, 3
s_lshl_b32 s15, s15, 4
s_add_u32 s14, s14, s15
s_add_u32 s15, s14, 14336
buffer_load_ushort v64, v5, s[20:23], s14 offen offset:0
buffer_load_ushort v65, v5, s[20:23], s14 offen offset:896
buffer_load_ushort v66, v5, s[20:23], s14 offen offset:1792
buffer_load_ushort v67, v5, s[20:23], s14 offen offset:2688
buffer_load_ushort v68, v5, s[20:23], s15 offen offset:0
buffer_load_ushort v69, v5, s[20:23], s15 offen offset:896
buffer_load_ushort v70, v5, s[20:23], s15 offen offset:1792
buffer_load_ushort v71, v5, s[20:23], s15 offen offset:2688
s_lshl_b32 s14, s33, 10
s_add_u32 s15, s14, 75497472
s_add_u32 s14, s14, 73400320
s_waitcnt vmcnt(0)
v_lshl_or_b32 v72, v57, 16, v56
v_lshl_or_b32 v73, v59, 16, v58
v_lshl_or_b32 v74, v61, 16, v60
v_lshl_or_b32 v75, v63, 16, v62
v_lshl_or_b32 v76, v65, 16, v64
v_lshl_or_b32 v77, v67, 16, v66
v_lshl_or_b32 v78, v69, 16, v68
v_lshl_or_b32 v79, v71, 16, v70
buffer_store_dwordx4 v[72:75], v7, s[4:7], s14 offen sc1
buffer_store_dwordx4 v[76:79], v7, s[4:7], s15 offen sc1
s_add_u32 s33, s33, 320
s_cmp_lt_u32 s33, 1568
s_cbranch_scc1 CV_46
v_mov_b32 v8, 16512
s_waitcnt vmcnt(0) lgkmcnt(0)
s_barrier
s_cmp_lg_u32 s9, 0
s_cbranch_scc1 SG_47
v_mov_b32 v4, 1
s_mov_b64 exec, 1
buffer_atomic_add v4, v8, s[4:7], s39 offen
s_mov_b64 exec, -1
SG_47:
s_cmp_ge_u32 s10, 64
s_cbranch_scc1 F_P2
s_lshl_b32 s14, s10, 15
s_add_u32 s14, s14, 50331648
buffer_load_dwordx4 v[56:59], v10, s[4:7], s14 offen offset:0 sc1
buffer_load_dwordx4 v[60:63], v10, s[4:7], s14 offen offset:1024 sc1
buffer_load_dwordx4 v[112:115], v10, s[4:7], s14 offen offset:2048 sc1
buffer_load_dwordx4 v[116:119], v10, s[4:7], s14 offen offset:3072 sc1
buffer_load_dwordx4 v[64:67], v12, s[4:7], s14 offen offset:0 sc1
buffer_load_dwordx4 v[68:71], v12, s[4:7], s14 offen offset:1024 sc1
buffer_load_dwordx4 v[120:123], v12, s[4:7], s14 offen offset:2048 sc1
buffer_load_dwordx4 v[124:127], v12, s[4:7], s14 offen offset:3072 sc1
buffer_load_dwordx4 v[72:75], v14, s[4:7], s14 offen offset:0 sc1
buffer_load_dwordx4 v[76:79], v14, s[4:7], s14 offen offset:1024 sc1
buffer_load_dwordx4 v[128:131], v14, s[4:7], s14 offen offset:2048 sc1
buffer_load_dwordx4 v[132:135], v14, s[4:7], s14 offen offset:3072 sc1
buffer_load_dwordx4 v[80:83], v16, s[4:7], s14 offen offset:0 sc1
buffer_load_dwordx4 v[84:87], v16, s[4:7], s14 offen offset:1024 sc1
buffer_load_dwordx4 v[136:139], v16, s[4:7], s14 offen offset:2048 sc1
buffer_load_dwordx4 v[140:143], v16, s[4:7], s14 offen offset:3072 sc1
buffer_load_dwordx4 v[88:91], v11, s[4:7], s14 offen offset:0 sc1
buffer_load_dwordx4 v[92:95], v11, s[4:7], s14 offen offset:1024 sc1
buffer_load_dwordx4 v[144:147], v11, s[4:7], s14 offen offset:2048 sc1
buffer_load_dwordx4 v[148:151], v11, s[4:7], s14 offen offset:3072 sc1
buffer_load_dwordx4 v[96:99], v13, s[4:7], s14 offen offset:0 sc1
buffer_load_dwordx4 v[100:103], v13, s[4:7], s14 offen offset:1024 sc1
buffer_load_dwordx4 v[152:155], v13, s[4:7], s14 offen offset:2048 sc1
buffer_load_dwordx4 v[156:159], v13, s[4:7], s14 offen offset:3072 sc1
buffer_load_dwordx4 v[104:107], v15, s[4:7], s14 offen offset:0 sc1
buffer_load_dwordx4 v[108:111], v15, s[4:7], s14 offen offset:1024 sc1
buffer_load_dwordx4 v[160:163], v15, s[4:7], s14 offen offset:2048 sc1
buffer_load_dwordx4 v[164:167], v15, s[4:7], s14 offen offset:3072 sc1
v_accvgpr_write_b32 a0, 0
v_accvgpr_write_b32 a1, 0
v_accvgpr_write_b32 a2, 0
v_accvgpr_write_b32 a3, 0
v_accvgpr_write_b32 a4, 0
v_accvgpr_write_b32 a5, 0
v_accvgpr_write_b32 a6, 0
v_accvgpr_write_b32 a7, 0
v_accvgpr_write_b32 a8, 0
v_accvgpr_write_b32 a9, 0
v_accvgpr_write_b32 a10, 0
v_accvgpr_write_b32 a11, 0
v_accvgpr_write_b32 a12, 0
v_accvgpr_write_b32 a13, 0
v_accvgpr_write_b32 a14, 0
v_accvgpr_write_b32 a15, 0
v_accvgpr_write_b32 a16, 0
v_accvgpr_write_b32 a17, 0
v_accvgpr_write_b32 a18, 0
v_accvgpr_write_b32 a19, 0
v_accvgpr_write_b32 a20, 0
v_accvgpr_write_b32 a21, 0
v_accvgpr_write_b32 a22, 0
v_accvgpr_write_b32 a23, 0
v_accvgpr_write_b32 a24, 0
v_accvgpr_write_b32 a25, 0
v_accvgpr_write_b32 a26, 0
v_accvgpr_write_b32 a27, 0
v_accvgpr_write_b32 a28, 0
v_accvgpr_write_b32 a29, 0
v_accvgpr_write_b32 a30, 0
v_accvgpr_write_b32 a31, 0
v_accvgpr_write_b32 a32, 0
v_accvgpr_write_b32 a33, 0
v_accvgpr_write_b32 a34, 0
v_accvgpr_write_b32 a35, 0
v_accvgpr_write_b32 a36, 0
v_accvgpr_write_b32 a37, 0
v_accvgpr_write_b32 a38, 0
v_accvgpr_write_b32 a39, 0
v_accvgpr_write_b32 a40, 0
v_accvgpr_write_b32 a41, 0
v_accvgpr_write_b32 a42, 0
v_accvgpr_write_b32 a43, 0
v_accvgpr_write_b32 a44, 0
v_accvgpr_write_b32 a45, 0
v_accvgpr_write_b32 a46, 0
v_accvgpr_write_b32 a47, 0
v_accvgpr_write_b32 a48, 0
v_accvgpr_write_b32 a49, 0
v_accvgpr_write_b32 a50, 0
v_accvgpr_write_b32 a51, 0
v_accvgpr_write_b32 a52, 0
v_accvgpr_write_b32 a53, 0
v_accvgpr_write_b32 a54, 0
v_accvgpr_write_b32 a55, 0
v_accvgpr_write_b32 a56, 0
v_accvgpr_write_b32 a57, 0
v_accvgpr_write_b32 a58, 0
v_accvgpr_write_b32 a59, 0
v_accvgpr_write_b32 a60, 0
v_accvgpr_write_b32 a61, 0
v_accvgpr_write_b32 a62, 0
v_accvgpr_write_b32 a63, 0
v_accvgpr_write_b32 a64, 0
v_accvgpr_write_b32 a65, 0
v_accvgpr_write_b32 a66, 0
v_accvgpr_write_b32 a67, 0
v_accvgpr_write_b32 a68, 0
v_accvgpr_write_b32 a69, 0
v_accvgpr_write_b32 a70, 0
v_accvgpr_write_b32 a71, 0
v_accvgpr_write_b32 a72, 0
v_accvgpr_write_b32 a73, 0
v_accvgpr_write_b32 a74, 0
v_accvgpr_write_b32 a75, 0
v_accvgpr_write_b32 a76, 0
v_accvgpr_write_b32 a77, 0
v_accvgpr_write_b32 a78, 0
v_accvgpr_write_b32 a79, 0
v_accvgpr_write_b32 a80, 0
v_accvgpr_write_b32 a81, 0
v_accvgpr_write_b32 a82, 0
v_accvgpr_write_b32 a83, 0
v_accvgpr_write_b32 a84, 0
v_accvgpr_write_b32 a85, 0
v_accvgpr_write_b32 a86, 0
v_accvgpr_write_b32 a87, 0
v_accvgpr_write_b32 a88, 0
v_accvgpr_write_b32 a89, 0
v_accvgpr_write_b32 a90, 0
v_accvgpr_write_b32 a91, 0
v_accvgpr_write_b32 a92, 0
v_accvgpr_write_b32 a93, 0
v_accvgpr_write_b32 a94, 0
v_accvgpr_write_b32 a95, 0
v_accvgpr_write_b32 a96, 0
v_accvgpr_write_b32 a97, 0
v_accvgpr_write_b32 a98, 0
v_accvgpr_write_b32 a99, 0
v_accvgpr_write_b32 a100, 0
v_accvgpr_write_b32 a101, 0
v_accvgpr_write_b32 a102, 0
v_accvgpr_write_b32 a103, 0
v_accvgpr_write_b32 a104, 0
v_accvgpr_write_b32 a105, 0
v_accvgpr_write_b32 a106, 0
v_accvgpr_write_b32 a107, 0
v_accvgpr_write_b32 a108, 0
v_accvgpr_write_b32 a109, 0
v_accvgpr_write_b32 a110, 0
v_accvgpr_write_b32 a111, 0
v_accvgpr_write_b32 a112, 0
v_accvgpr_write_b32 a113, 0
v_accvgpr_write_b32 a114, 0
v_accvgpr_write_b32 a115, 0
v_accvgpr_write_b32 a116, 0
v_accvgpr_write_b32 a117, 0
v_accvgpr_write_b32 a118, 0
v_accvgpr_write_b32 a119, 0
v_accvgpr_write_b32 a120, 0
v_accvgpr_write_b32 a121, 0
v_accvgpr_write_b32 a122, 0
v_accvgpr_write_b32 a123, 0
v_accvgpr_write_b32 a124, 0
v_accvgpr_write_b32 a125, 0
v_accvgpr_write_b32 a126, 0
v_accvgpr_write_b32 a127, 0
v_accvgpr_write_b32 a128, 0
v_accvgpr_write_b32 a129, 0
v_accvgpr_write_b32 a130, 0
v_accvgpr_write_b32 a131, 0
v_accvgpr_write_b32 a132, 0
v_accvgpr_write_b32 a133, 0
v_accvgpr_write_b32 a134, 0
v_accvgpr_write_b32 a135, 0
v_accvgpr_write_b32 a136, 0
v_accvgpr_write_b32 a137, 0
v_accvgpr_write_b32 a138, 0
v_accvgpr_write_b32 a139, 0
v_accvgpr_write_b32 a140, 0
v_accvgpr_write_b32 a141, 0
v_accvgpr_write_b32 a142, 0
v_accvgpr_write_b32 a143, 0
v_accvgpr_write_b32 a144, 0
v_accvgpr_write_b32 a145, 0
v_accvgpr_write_b32 a146, 0
v_accvgpr_write_b32 a147, 0
v_accvgpr_write_b32 a148, 0
v_accvgpr_write_b32 a149, 0
v_accvgpr_write_b32 a150, 0
v_accvgpr_write_b32 a151, 0
v_accvgpr_write_b32 a152, 0
v_accvgpr_write_b32 a153, 0
v_accvgpr_write_b32 a154, 0
v_accvgpr_write_b32 a155, 0
v_accvgpr_write_b32 a156, 0
v_accvgpr_write_b32 a157, 0
v_accvgpr_write_b32 a158, 0
v_accvgpr_write_b32 a159, 0
v_accvgpr_write_b32 a160, 0
v_accvgpr_write_b32 a161, 0
v_accvgpr_write_b32 a162, 0
v_accvgpr_write_b32 a163, 0
v_accvgpr_write_b32 a164, 0
v_accvgpr_write_b32 a165, 0
v_accvgpr_write_b32 a166, 0
v_accvgpr_write_b32 a167, 0
v_accvgpr_write_b32 a168, 0
v_accvgpr_write_b32 a169, 0
v_accvgpr_write_b32 a170, 0
v_accvgpr_write_b32 a171, 0
v_accvgpr_write_b32 a172, 0
v_accvgpr_write_b32 a173, 0
v_accvgpr_write_b32 a174, 0
v_accvgpr_write_b32 a175, 0
v_accvgpr_write_b32 a176, 0
v_accvgpr_write_b32 a177, 0
v_accvgpr_write_b32 a178, 0
v_accvgpr_write_b32 a179, 0
v_accvgpr_write_b32 a180, 0
v_accvgpr_write_b32 a181, 0
v_accvgpr_write_b32 a182, 0
v_accvgpr_write_b32 a183, 0
v_accvgpr_write_b32 a184, 0
v_accvgpr_write_b32 a185, 0
v_accvgpr_write_b32 a186, 0
v_accvgpr_write_b32 a187, 0
v_accvgpr_write_b32 a188, 0
v_accvgpr_write_b32 a189, 0
v_accvgpr_write_b32 a190, 0
v_accvgpr_write_b32 a191, 0
v_accvgpr_write_b32 a192, 0
v_accvgpr_write_b32 a193, 0
v_accvgpr_write_b32 a194, 0
v_accvgpr_write_b32 a195, 0
v_accvgpr_write_b32 a196, 0
v_accvgpr_write_b32 a197, 0
v_accvgpr_write_b32 a198, 0
v_accvgpr_write_b32 a199, 0
v_accvgpr_write_b32 a200, 0
v_accvgpr_write_b32 a201, 0
v_accvgpr_write_b32 a202, 0
v_accvgpr_write_b32 a203, 0
v_accvgpr_write_b32 a204, 0
v_accvgpr_write_b32 a205, 0
v_accvgpr_write_b32 a206, 0
v_accvgpr_write_b32 a207, 0
v_accvgpr_write_b32 a208, 0
v_accvgpr_write_b32 a209, 0
v_accvgpr_write_b32 a210, 0
v_accvgpr_write_b32 a211, 0
v_accvgpr_write_b32 a212, 0
v_accvgpr_write_b32 a213, 0
v_accvgpr_write_b32 a214, 0
v_accvgpr_write_b32 a215, 0
v_accvgpr_write_b32 a216, 0
v_accvgpr_write_b32 a217, 0
v_accvgpr_write_b32 a218, 0
v_accvgpr_write_b32 a219, 0
v_accvgpr_write_b32 a220, 0
v_accvgpr_write_b32 a221, 0
v_accvgpr_write_b32 a222, 0
v_accvgpr_write_b32 a223, 0
s_mov_b32 s14, 80
WT_48:
buffer_load_dword v4, v8, s[4:7], s39 offen sc1
s_sub_u32 s38, s38, 1
s_cmp_gt_i32 s38, 0
s_cbranch_scc0 WD_49
s_waitcnt vmcnt(0)
v_cmp_gt_u32 vcc, s14, v4
s_cbranch_vccz WD_49
s_sleep 8
s_branch WT_48
WD_49:
s_mul_i32 s34, s9, 28672
s_add_u32 s35, s34, 75497472
s_add_u32 s34, s34, 73400320
s_lshl_b32 s32, s9, 6
s_mov_b32 s33, 0
buffer_load_dwordx4 v[168:171], v10, s[4:7], s34 offen offset:0 sc1
buffer_load_dwordx4 v[172:175], v10, s[4:7], s34 offen offset:1024 sc1
buffer_load_dwordx4 v[176:179], v10, s[4:7], s34 offen offset:2048 sc1
buffer_load_dwordx4 v[180:183], v10, s[4:7], s34 offen offset:3072 sc1
buffer_load_dwordx4 v[184:187], v11, s[4:7], s34 offen offset:0 sc1
buffer_load_dwordx4 v[188:191], v11, s[4:7], s34 offen offset:1024 sc1
buffer_load_dwordx4 v[192:195], v11, s[4:7], s34 offen offset:2048 sc1
buffer_load_dwordx4 v[196:199], v11, s[4:7], s34 offen offset:3072 sc1
buffer_load_dwordx4 v[200:203], v12, s[4:7], s34 offen offset:0 sc1
buffer_load_dwordx4 v[204:207], v12, s[4:7], s34 offen offset:1024 sc1
buffer_load_dwordx4 v[208:211], v12, s[4:7], s34 offen offset:2048 sc1
buffer_load_dwordx4 v[212:215], v12, s[4:7], s34 offen offset:3072 sc1
buffer_load_dwordx4 v[216:219], v13, s[4:7], s34 offen offset:0 sc1
buffer_load_dwordx4 v[220:223], v13, s[4:7], s34 offen offset:1024 sc1
buffer_load_dwordx4 v[224:227], v13, s[4:7], s34 offen offset:2048 sc1
buffer_load_dwordx4 v[228:231], v13, s[4:7], s34 offen offset:3072 sc1
buffer_load_dwordx4 v[232:235], v14, s[4:7], s34 offen offset:0 sc1
buffer_load_dwordx4 v[236:239], v14, s[4:7], s34 offen offset:1024 sc1
buffer_load_dwordx4 v[240:243], v14, s[4:7], s34 offen offset:2048 sc1
buffer_load_dwordx4 v[244:247], v14, s[4:7], s34 offen offset:3072 sc1
buffer_load_dwordx4 a[224:227], v15, s[4:7], s34 offen offset:0 sc1
buffer_load_dwordx4 a[228:231], v15, s[4:7], s34 offen offset:1024 sc1
buffer_load_dwordx4 a[232:235], v15, s[4:7], s34 offen offset:2048 sc1
buffer_load_dwordx4 a[236:239], v15, s[4:7], s34 offen offset:3072 sc1
buffer_load_dwordx4 a[240:243], v16, s[4:7], s34 offen offset:0 sc1
buffer_load_dwordx4 a[244:247], v16, s[4:7], s34 offen offset:1024 sc1
buffer_load_dwordx4 a[248:251], v16, s[4:7], s34 offen offset:2048 sc1
buffer_load_dwordx4 a[252:255], v16, s[4:7], s34 offen offset:3072 sc1
FL_50:
buffer_load_dwordx2 v[44:45], v9, s[24:27], s32 offen
buffer_load_dwordx2 v[46:47], v9, s[24:27], s32 offen offset:32
s_add_u32 s34, s34, 114688
s_waitcnt vmcnt(29)
v_mfma_f32_16x16x32_bf16 v[28:31], v[168:171], v[56:59], 0
v_mfma_f32_16x16x32_bf16 v[36:39], v[168:171], v[112:115], 0
buffer_load_dwordx4 v[168:171], v10, s[4:7], s35 offen offset:0 sc1
s_waitcnt vmcnt(29)
v_mfma_f32_16x16x32_bf16 v[28:31], v[172:175], v[60:63], v[28:31]
v_mfma_f32_16x16x32_bf16 v[36:39], v[172:175], v[116:119], v[36:39]
buffer_load_dwordx4 v[172:175], v10, s[4:7], s35 offen offset:1024 sc1
s_waitcnt vmcnt(29)
v_mfma_f32_16x16x32_bf16 v[28:31], v[176:179], v[64:67], v[28:31]
v_mfma_f32_16x16x32_bf16 v[36:39], v[176:179], v[120:123], v[36:39]
buffer_load_dwordx4 v[176:179], v10, s[4:7], s35 offen offset:2048 sc1
s_waitcnt vmcnt(29)
v_mfma_f32_16x16x32_bf16 v[28:31], v[180:183], v[68:71], v[28:31]
v_mfma_f32_16x16x32_bf16 v[36:39], v[180:183], v[124:127], v[36:39]
buffer_load_dwordx4 v[180:183], v10, s[4:7], s35 offen offset:3072 sc1
s_waitcnt vmcnt(29)
v_mfma_f32_16x16x32_bf16 v[28:31], v[184:187], v[72:75], v[28:31]
v_mfma_f32_16x16x32_bf16 v[36:39], v[184:187], v[128:131], v[36:39]
buffer_load_dwordx4 v[184:187], v11, s[4:7], s35 offen offset:0 sc1
s_waitcnt vmcnt(29)
v_mfma_f32_16x16x32_bf16 v[28:31], v[188:191], v[76:79], v[28:31]
v_mfma_f32_16x16x32_bf16 v[36:39], v[188:191], v[132:135], v[36:39]
buffer_load_dwordx4 v[188:191], v11, s[4:7], s35 offen offset:1024 sc1
s_waitcnt vmcnt(29)
v_mfma_f32_16x16x32_bf16 v[28:31], v[192:195], v[80:83], v[28:31]
v_mfma_f32_16x16x32_bf16 v[36:39], v[192:195], v[136:139], v[36:39]
buffer_load_dwordx4 v[192:195], v11, s[4:7], s35 offen offset:2048 sc1
s_waitcnt vmcnt(29)
v_mfma_f32_16x16x32_bf16 v[28:31], v[196:199], v[84:87], v[28:31]
v_mfma_f32_16x16x32_bf16 v[36:39], v[196:199], v[140:143], v[36:39]
buffer_load_dwordx4 v[196:199], v11, s[4:7], s35 offen offset:3072 sc1
s_waitcnt vmcnt(29)
v_mfma_f32_16x16x32_bf16 v[28:31], v[200:203], v[88:91], v[28:31]
v_mfma_f32_16x16x32_bf16 v[36:39], v[200:203], v[144:147], v[36:39]
buffer_load_dwordx4 v[200:203], v12, s[4:7], s35 offen offset:0 sc1
s_waitcnt vmcnt(29)
v_mfma_f32_16x16x32_bf16 v[28:31], v[204:207], v[92:95], v[28:31]
v_mfma_f32_16x16x32_bf16 v[36:39], v[204:207], v[148:151], v[36:39]
buffer_load_dwordx4 v[204:207], v12, s[4:7], s35 offen offset:1024 sc1
s_waitcnt vmcnt(29)
v_mfma_f32_16x16x32_bf16 v[28:31], v[208:211], v[96:99], v[28:31]
v_mfma_f32_16x16x32_bf16 v[36:39], v[208:211], v[152:155], v[36:39]
buffer_load_dwordx4 v[208:211], v12, s[4:7], s35 offen offset:2048 sc1
s_waitcnt vmcnt(29)
v_mfma_f32_16x16x32_bf16 v[28:31], v[212:215], v[100:103], v[28:31]
v_mfma_f32_16x16x32_bf16 v[36:39], v[212:215], v[156:159], v[36:39]
buffer_load_dwordx4 v[212:215], v12, s[4:7], s35 offen offset:3072 sc1
s_waitcnt vmcnt(29)
v_mfma_f32_16x16x32_bf16 v[28:31], v[216:219], v[104:107], v[28:31]
v_mfma_f32_16x16x32_bf16 v[36:39], v[216:219], v[160:163], v[36:39]
buffer_load_dwordx4 v[216:219], v13, s[4:7], s35 offen offset:0 sc1
s_waitcnt vmcnt(29)
v_mfma_f32_16x16x32_bf16 v[28:31], v[220:223], v[108:111], v[28:31]
v_mfma_f32_16x16x32_bf16 v[36:39], v[220:223], v[164:167], v[36:39]
buffer_load_dwordx4 v[220:223], v13, s[4:7], s35 offen offset:1024 sc1
s_waitcnt vmcnt(29)
v_mfma_f32_16x16x32_bf16 v[32:35], v[224:227], v[56:59], 0
v_mfma_f32_16x16x32_bf16 v[40:43], v[224:227], v[112:115], 0
buffer_load_dwordx4 v[224:227], v13, s[4:7], s35 offen offset:2048 sc1
s_waitcnt vmcnt(29)
v_mfma_f32_16x16x32_bf16 v[32:35], v[228:231], v[60:63], v[32:35]
v_mfma_f32_16x16x32_bf16 v[40:43], v[228:231], v[116:119], v[40:43]
buffer_load_dwordx4 v[228:231], v13, s[4:7], s35 offen offset:3072 sc1
s_waitcnt vmcnt(29)
v_mfma_f32_16x16x32_bf16 v[32:35], v[232:235], v[64:67], v[32:35]
v_mfma_f32_16x16x32_bf16 v[40:43], v[232:235], v[120:123], v[40:43]
buffer_load_dwordx4 v[232:235], v14, s[4:7], s35 offen offset:0 sc1
s_waitcnt vmcnt(29)
v_mfma_f32_16x16x32_bf16 v[32:35], v[236:239], v[68:71], v[32:35]
v_mfma_f32_16x16x32_bf16 v[40:43], v[236:239], v[124:127], v[40:43]
buffer_load_dwordx4 v[236:239], v14, s[4:7], s35 offen offset:1024 sc1
s_waitcnt vmcnt(29)
v_mfma_f32_16x16x32_bf16 v[32:35], v[240:243], v[72:75], v[32:35]
v_mfma_f32_16x16x32_bf16 v[40:43], v[240:243], v[128:131], v[40:43]
buffer_load_dwordx4 v[240:243], v14, s[4:7], s35 offen offset:2048 sc1
s_waitcnt vmcnt(29)
v_mfma_f32_16x16x32_bf16 v[32:35], v[244:247], v[76:79], v[32:35]
v_mfma_f32_16x16x32_bf16 v[40:43], v[244:247], v[132:135], v[40:43]
buffer_load_dwordx4 v[244:247], v14, s[4:7], s35 offen offset:3072 sc1
s_waitcnt vmcnt(29)
v_mfma_f32_16x16x32_bf16 v[32:35], a[224:227], v[80:83], v[32:35]
v_mfma_f32_16x16x32_bf16 v[40:43], a[224:227], v[136:139], v[40:43]
buffer_load_dwordx4 a[224:227], v15, s[4:7], s35 offen offset:0 sc1
s_waitcnt vmcnt(29)
v_mfma_f32_16x16x32_bf16 v[32:35], a[228:231], v[84:87], v[32:35]
v_mfma_f32_16x16x32_bf16 v[40:43], a[228:231], v[140:143], v[40:43]
buffer_load_dwordx4 a[228:231], v15, s[4:7], s35 offen offset:1024 sc1
s_waitcnt vmcnt(29)
v_mfma_f32_16x16x32_bf16 v[32:35], a[232:235], v[88:91], v[32:35]
v_mfma_f32_16x16x32_bf16 v[40:43], a[232:235], v[144:147], v[40:43]
buffer_load_dwordx4 a[232:235], v15, s[4:7], s35 offen offset:2048 sc1
s_waitcnt vmcnt(29)
v_mfma_f32_16x16x32_bf16 v[32:35], a[236:239], v[92:95], v[32:35]
v_mfma_f32_16x16x32_bf16 v[40:43], a[236:239], v[148:151], v[40:43]
buffer_load_dwordx4 a[236:239], v15, s[4:7], s35 offen offset:3072 sc1
s_waitcnt vmcnt(29)
v_mfma_f32_16x16x32_bf16 v[32:35], a[240:243], v[96:99], v[32:35]
v_mfma_f32_16x16x32_bf16 v[40:43], a[240:243], v[152:155], v[40:43]
buffer_load_dwordx4 a[240:243], v16, s[4:7], s35 offen offset:0 sc1
s_waitcnt vmcnt(29)
v_mfma_f32_16x16x32_bf16 v[32:35], a[244:247], v[100:103], v[32:35]
v_mfma_f32_16x16x32_bf16 v[40:43], a[244:247], v[156:159], v[40:43]
buffer_load_dwordx4 a[244:247], v16, s[4:7], s35 offen offset:1024 sc1
s_waitcnt vmcnt(29)
v_mfma_f32_16x16x32_bf16 v[32:35], a[248:251], v[104:107], v[32:35]
v_mfma_f32_16x16x32_bf16 v[40:43], a[248:251], v[160:163], v[40:43]
buffer_load_dwordx4 a[248:251], v16, s[4:7], s35 offen offset:2048 sc1
s_waitcnt vmcnt(29)
v_mfma_f32_16x16x32_bf16 v[32:35], a[252:255], v[108:111], v[32:35]
v_mfma_f32_16x16x32_bf16 v[40:43], a[252:255], v[164:167], v[40:43]
buffer_load_dwordx4 a[252:255], v16, s[4:7], s35 offen offset:3072 sc1
s_waitcnt vmcnt(28)
v_cvt_pk_bf16_f32 v4, v28, v29
v_lshlrev_b32 v28, 16, v4
v_and_b32 v29, 0xffff0000, v4
v_lshlrev_b32 v5, 16, v44
v_and_b32 v6, 0xffff0000, v44
v_add_f32 v28, v28, v5
v_add_f32 v29, v29, v6
v_cvt_pk_bf16_f32 v4, v28, v29
v_lshlrev_b32 v28, 16, v4
v_and_b32 v29, 0xffff0000, v4
v_max_f32 v28, 0, v28
v_max_f32 v29, 0, v29
v_mul_f32 v28, v28, v28
v_mul_f32 v29, v29, v29
v_cvt_pk_bf16_f32 v48, v28, v29
v_cvt_pk_bf16_f32 v4, v30, v31
v_lshlrev_b32 v30, 16, v4
v_and_b32 v31, 0xffff0000, v4
v_lshlrev_b32 v5, 16, v45
v_and_b32 v6, 0xffff0000, v45
v_add_f32 v30, v30, v5
v_add_f32 v31, v31, v6
v_cvt_pk_bf16_f32 v4, v30, v31
v_lshlrev_b32 v30, 16, v4
v_and_b32 v31, 0xffff0000, v4
v_max_f32 v30, 0, v30
v_max_f32 v31, 0, v31
v_mul_f32 v30, v30, v30
v_mul_f32 v31, v31, v31
v_cvt_pk_bf16_f32 v49, v30, v31
v_cvt_pk_bf16_f32 v4, v32, v33
v_lshlrev_b32 v32, 16, v4
v_and_b32 v33, 0xffff0000, v4
v_lshlrev_b32 v5, 16, v46
v_and_b32 v6, 0xffff0000, v46
v_add_f32 v32, v32, v5
v_add_f32 v33, v33, v6
v_cvt_pk_bf16_f32 v4, v32, v33
v_lshlrev_b32 v32, 16, v4
v_and_b32 v33, 0xffff0000, v4
v_max_f32 v32, 0, v32
v_max_f32 v33, 0, v33
v_mul_f32 v32, v32, v32
v_mul_f32 v33, v33, v33
v_cvt_pk_bf16_f32 v50, v32, v33
v_cvt_pk_bf16_f32 v4, v34, v35
v_lshlrev_b32 v34, 16, v4
v_and_b32 v35, 0xffff0000, v4
v_lshlrev_b32 v5, 16, v47
v_and_b32 v6, 0xffff0000, v47
v_add_f32 v34, v34, v5
v_add_f32 v35, v35, v6
v_cvt_pk_bf16_f32 v4, v34, v35
v_lshlrev_b32 v34, 16, v4
v_and_b32 v35, 0xffff0000, v4
v_max_f32 v34, 0, v34
v_max_f32 v35, 0, v35
v_mul_f32 v34, v34, v34
v_mul_f32 v35, v35, v35
v_cvt_pk_bf16_f32 v51, v34, v35
v_cvt_pk_bf16_f32 v4, v36, v37
v_lshlrev_b32 v36, 16, v4
v_and_b32 v37, 0xffff0000, v4
v_lshlrev_b32 v5, 16, v44
v_and_b32 v6, 0xffff0000, v44
v_add_f32 v36, v36, v5
v_add_f32 v37, v37, v6
v_cvt_pk_bf16_f32 v4, v36, v37
v_lshlrev_b32 v36, 16, v4
v_and_b32 v37, 0xffff0000, v4
v_max_f32 v36, 0, v36
v_max_f32 v37, 0, v37
v_mul_f32 v36, v36, v36
v_mul_f32 v37, v37, v37
v_cvt_pk_bf16_f32 v52, v36, v37
v_cvt_pk_bf16_f32 v4, v38, v39
v_lshlrev_b32 v38, 16, v4
v_and_b32 v39, 0xffff0000, v4
v_lshlrev_b32 v5, 16, v45
v_and_b32 v6, 0xffff0000, v45
v_add_f32 v38, v38, v5
v_add_f32 v39, v39, v6
v_cvt_pk_bf16_f32 v4, v38, v39
v_lshlrev_b32 v38, 16, v4
v_and_b32 v39, 0xffff0000, v4
v_max_f32 v38, 0, v38
v_max_f32 v39, 0, v39
v_mul_f32 v38, v38, v38
v_mul_f32 v39, v39, v39
v_cvt_pk_bf16_f32 v53, v38, v39
v_cvt_pk_bf16_f32 v4, v40, v41
v_lshlrev_b32 v40, 16, v4
v_and_b32 v41, 0xffff0000, v4
v_lshlrev_b32 v5, 16, v46
v_and_b32 v6, 0xffff0000, v46
v_add_f32 v40, v40, v5
v_add_f32 v41, v41, v6
v_cvt_pk_bf16_f32 v4, v40, v41
v_lshlrev_b32 v40, 16, v4
v_and_b32 v41, 0xffff0000, v4
v_max_f32 v40, 0, v40
v_max_f32 v41, 0, v41
v_mul_f32 v40, v40, v40
v_mul_f32 v41, v41, v41
v_cvt_pk_bf16_f32 v54, v40, v41
v_cvt_pk_bf16_f32 v4, v42, v43
v_lshlrev_b32 v42, 16, v4
v_and_b32 v43, 0xffff0000, v4
v_lshlrev_b32 v5, 16, v47
v_and_b32 v6, 0xffff0000, v47
v_add_f32 v42, v42, v5
v_add_f32 v43, v43, v6
v_cvt_pk_bf16_f32 v4, v42, v43
v_lshlrev_b32 v42, 16, v4
v_and_b32 v43, 0xffff0000, v4
v_max_f32 v42, 0, v42
v_max_f32 v43, 0, v43
v_mul_f32 v42, v42, v42
v_mul_f32 v43, v43, v43
v_cvt_pk_bf16_f32 v55, v42, v43
s_waitcnt vmcnt(27)
v_mfma_f32_16x16x32_bf16 a[0:3], v[48:51], v[168:171], a[0:3]
v_mfma_f32_16x16x32_bf16 a[112:115], v[52:55], v[168:171], a[112:115]
buffer_load_dwordx4 v[168:171], v10, s[4:7], s34 offen offset:0 sc1
s_waitcnt vmcnt(27)
v_mfma_f32_16x16x32_bf16 a[4:7], v[48:51], v[172:175], a[4:7]
v_mfma_f32_16x16x32_bf16 a[116:119], v[52:55], v[172:175], a[116:119]
buffer_load_dwordx4 v[172:175], v10, s[4:7], s34 offen offset:1024 sc1
s_waitcnt vmcnt(27)
v_mfma_f32_16x16x32_bf16 a[8:11], v[48:51], v[176:179], a[8:11]
v_mfma_f32_16x16x32_bf16 a[120:123], v[52:55], v[176:179], a[120:123]
buffer_load_dwordx4 v[176:179], v10, s[4:7], s34 offen offset:2048 sc1
s_waitcnt vmcnt(27)
v_mfma_f32_16x16x32_bf16 a[12:15], v[48:51], v[180:183], a[12:15]
v_mfma_f32_16x16x32_bf16 a[124:127], v[52:55], v[180:183], a[124:127]
buffer_load_dwordx4 v[180:183], v10, s[4:7], s34 offen offset:3072 sc1
s_waitcnt vmcnt(27)
v_mfma_f32_16x16x32_bf16 a[16:19], v[48:51], v[184:187], a[16:19]
v_mfma_f32_16x16x32_bf16 a[128:131], v[52:55], v[184:187], a[128:131]
buffer_load_dwordx4 v[184:187], v11, s[4:7], s34 offen offset:0 sc1
s_waitcnt vmcnt(27)
v_mfma_f32_16x16x32_bf16 a[20:23], v[48:51], v[188:191], a[20:23]
v_mfma_f32_16x16x32_bf16 a[132:135], v[52:55], v[188:191], a[132:135]
buffer_load_dwordx4 v[188:191], v11, s[4:7], s34 offen offset:1024 sc1
s_waitcnt vmcnt(27)
v_mfma_f32_16x16x32_bf16 a[24:27], v[48:51], v[192:195], a[24:27]
v_mfma_f32_16x16x32_bf16 a[136:139], v[52:55], v[192:195], a[136:139]
buffer_load_dwordx4 v[192:195], v11, s[4:7], s34 offen offset:2048 sc1
s_waitcnt vmcnt(27)
v_mfma_f32_16x16x32_bf16 a[28:31], v[48:51], v[196:199], a[28:31]
v_mfma_f32_16x16x32_bf16 a[140:143], v[52:55], v[196:199], a[140:143]
buffer_load_dwordx4 v[196:199], v11, s[4:7], s34 offen offset:3072 sc1
s_waitcnt vmcnt(27)
v_mfma_f32_16x16x32_bf16 a[32:35], v[48:51], v[200:203], a[32:35]
v_mfma_f32_16x16x32_bf16 a[144:147], v[52:55], v[200:203], a[144:147]
buffer_load_dwordx4 v[200:203], v12, s[4:7], s34 offen offset:0 sc1
s_waitcnt vmcnt(27)
v_mfma_f32_16x16x32_bf16 a[36:39], v[48:51], v[204:207], a[36:39]
v_mfma_f32_16x16x32_bf16 a[148:151], v[52:55], v[204:207], a[148:151]
buffer_load_dwordx4 v[204:207], v12, s[4:7], s34 offen offset:1024 sc1
s_waitcnt vmcnt(27)
v_mfma_f32_16x16x32_bf16 a[40:43], v[48:51], v[208:211], a[40:43]
v_mfma_f32_16x16x32_bf16 a[152:155], v[52:55], v[208:211], a[152:155]
buffer_load_dwordx4 v[208:211], v12, s[4:7], s34 offen offset:2048 sc1
s_waitcnt vmcnt(27)
v_mfma_f32_16x16x32_bf16 a[44:47], v[48:51], v[212:215], a[44:47]
v_mfma_f32_16x16x32_bf16 a[156:159], v[52:55], v[212:215], a[156:159]
buffer_load_dwordx4 v[212:215], v12, s[4:7], s34 offen offset:3072 sc1
s_waitcnt vmcnt(27)
v_mfma_f32_16x16x32_bf16 a[48:51], v[48:51], v[216:219], a[48:51]
v_mfma_f32_16x16x32_bf16 a[160:163], v[52:55], v[216:219], a[160:163]
buffer_load_dwordx4 v[216:219], v13, s[4:7], s34 offen offset:0 sc1
s_waitcnt vmcnt(27)
v_mfma_f32_16x16x32_bf16 a[52:55], v[48:51], v[220:223], a[52:55]
v_mfma_f32_16x16x32_bf16 a[164:167], v[52:55], v[220:223], a[164:167]
buffer_load_dwordx4 v[220:223], v13, s[4:7], s34 offen offset:1024 sc1
s_waitcnt vmcnt(27)
v_mfma_f32_16x16x32_bf16 a[56:59], v[48:51], v[224:227], a[56:59]
v_mfma_f32_16x16x32_bf16 a[168:171], v[52:55], v[224:227], a[168:171]
buffer_load_dwordx4 v[224:227], v13, s[4:7], s34 offen offset:2048 sc1
s_waitcnt vmcnt(27)
v_mfma_f32_16x16x32_bf16 a[60:63], v[48:51], v[228:231], a[60:63]
v_mfma_f32_16x16x32_bf16 a[172:175], v[52:55], v[228:231], a[172:175]
buffer_load_dwordx4 v[228:231], v13, s[4:7], s34 offen offset:3072 sc1
s_waitcnt vmcnt(27)
v_mfma_f32_16x16x32_bf16 a[64:67], v[48:51], v[232:235], a[64:67]
v_mfma_f32_16x16x32_bf16 a[176:179], v[52:55], v[232:235], a[176:179]
buffer_load_dwordx4 v[232:235], v14, s[4:7], s34 offen offset:0 sc1
s_waitcnt vmcnt(27)
v_mfma_f32_16x16x32_bf16 a[68:71], v[48:51], v[236:239], a[68:71]
v_mfma_f32_16x16x32_bf16 a[180:183], v[52:55], v[236:239], a[180:183]
buffer_load_dwordx4 v[236:239], v14, s[4:7], s34 offen offset:1024 sc1
s_waitcnt vmcnt(27)
v_mfma_f32_16x16x32_bf16 a[72:75], v[48:51], v[240:243], a[72:75]
v_mfma_f32_16x16x32_bf16 a[184:187], v[52:55], v[240:243], a[184:187]
buffer_load_dwordx4 v[240:243], v14, s[4:7], s34 offen offset:2048 sc1
s_waitcnt vmcnt(27)
v_mfma_f32_16x16x32_bf16 a[76:79], v[48:51], v[244:247], a[76:79]
v_mfma_f32_16x16x32_bf16 a[188:191], v[52:55], v[244:247], a[188:191]
buffer_load_dwordx4 v[244:247], v14, s[4:7], s34 offen offset:3072 sc1
s_waitcnt vmcnt(27)
v_mfma_f32_16x16x32_bf16 a[80:83], v[48:51], a[224:227], a[80:83]
v_mfma_f32_16x16x32_bf16 a[192:195], v[52:55], a[224:227], a[192:195]
buffer_load_dwordx4 a[224:227], v15, s[4:7], s34 offen offset:0 sc1
s_waitcnt vmcnt(27)
v_mfma_f32_16x16x32_bf16 a[84:87], v[48:51], a[228:231], a[84:87]
v_mfma_f32_16x16x32_bf16 a[196:199], v[52:55], a[228:231], a[196:199]
buffer_load_dwordx4 a[228:231], v15, s[4:7], s34 offen offset:1024 sc1
s_waitcnt vmcnt(27)
v_mfma_f32_16x16x32_bf16 a[88:91], v[48:51], a[232:235], a[88:91]
v_mfma_f32_16x16x32_bf16 a[200:203], v[52:55], a[232:235], a[200:203]
buffer_load_dwordx4 a[232:235], v15, s[4:7], s34 offen offset:2048 sc1
s_waitcnt vmcnt(27)
v_mfma_f32_16x16x32_bf16 a[92:95], v[48:51], a[236:239], a[92:95]
v_mfma_f32_16x16x32_bf16 a[204:207], v[52:55], a[236:239], a[204:207]
buffer_load_dwordx4 a[236:239], v15, s[4:7], s34 offen offset:3072 sc1
s_waitcnt vmcnt(27)
v_mfma_f32_16x16x32_bf16 a[96:99], v[48:51], a[240:243], a[96:99]
v_mfma_f32_16x16x32_bf16 a[208:211], v[52:55], a[240:243], a[208:211]
buffer_load_dwordx4 a[240:243], v16, s[4:7], s34 offen offset:0 sc1
s_waitcnt vmcnt(27)
v_mfma_f32_16x16x32_bf16 a[100:103], v[48:51], a[244:247], a[100:103]
v_mfma_f32_16x16x32_bf16 a[212:215], v[52:55], a[244:247], a[212:215]
buffer_load_dwordx4 a[244:247], v16, s[4:7], s34 offen offset:1024 sc1
s_waitcnt vmcnt(27)
v_mfma_f32_16x16x32_bf16 a[104:107], v[48:51], a[248:251], a[104:107]
v_mfma_f32_16x16x32_bf16 a[216:219], v[52:55], a[248:251], a[216:219]
buffer_load_dwordx4 a[248:251], v16, s[4:7], s34 offen offset:2048 sc1
s_waitcnt vmcnt(27)
v_mfma_f32_16x16x32_bf16 a[108:111], v[48:51], a[252:255], a[108:111]
v_mfma_f32_16x16x32_bf16 a[220:223], v[52:55], a[252:255], a[220:223]
buffer_load_dwordx4 a[252:255], v16, s[4:7], s34 offen offset:3072 sc1
s_add_u32 s35, s35, 114688
s_add_u32 s32, s32, 256
s_add_u32 s33, s33, 1
s_cmp_lt_u32 s33, 14
s_cbranch_scc1 FL_50
s_waitcnt vmcnt(0)
s_mov_b32 s14, 0
s_mov_b32 s15, 0
v_add_u32 v4, 0, v0
v_mul_u32_u24 v5, 1171, v4
v_lshrrev_b32 v5, 16, v5
v_mul_u32_u24 v6, 56, v5
v_sub_u32 v6, v4, v6
v_mul_u32_u24 v17, 2048, v5
v_lshl_add_u32 v17, v6, 5, v17
v_add_u32 v5, s15, v5
v_mul_u32_u24 v21, 896, v5
v_and_b32 v5, 1, v6
v_lshl_add_u32 v21, v5, 6, v21
v_lshrrev_b32 v6, 1, v6
v_add_u32 v6, s14, v6
v_lshrrev_b32 v5, 2, v6
v_lshl_add_u32 v21, v5, 7, v21
v_and_b32 v5, 3, v6
v_lshl_add_u32 v21, v5, 4, v21
v_add_u32 v4, 256, v0
v_mul_u32_u24 v5, 1171, v4
v_lshrrev_b32 v5, 16, v5
v_mul_u32_u24 v6, 56, v5
v_sub_u32 v6, v4, v6
v_mul_u32_u24 v18, 2048, v5
v_lshl_add_u32 v18, v6, 5, v18
v_add_u32 v5, s15, v5
v_mul_u32_u24 v22, 896, v5
v_and_b32 v5, 1, v6
v_lshl_add_u32 v22, v5, 6, v22
v_lshrrev_b32 v6, 1, v6
v_add_u32 v6, s14, v6
v_lshrrev_b32 v5, 2, v6
v_lshl_add_u32 v22, v5, 7, v22
v_and_b32 v5, 3, v6
v_lshl_add_u32 v22, v5, 4, v22
v_add_u32 v4, 512, v0
v_mul_u32_u24 v5, 1171, v4
v_lshrrev_b32 v5, 16, v5
v_mul_u32_u24 v6, 56, v5
v_sub_u32 v6, v4, v6
v_mul_u32_u24 v19, 2048, v5
v_lshl_add_u32 v19, v6, 5, v19
v_add_u32 v5, s15, v5
v_mul_u32_u24 v23, 896, v5
v_and_b32 v5, 1, v6
v_lshl_add_u32 v23, v5, 6, v23
v_lshrrev_b32 v6, 1, v6
v_add_u32 v6, s14, v6
v_lshrrev_b32 v5, 2, v6
v_lshl_add_u32 v23, v5, 7, v23
v_and_b32 v5, 3, v6
v_lshl_add_u32 v23, v5, 4, v23
v_add_u32 v4, 768, v0
v_mul_u32_u24 v5, 1171, v4
v_lshrrev_b32 v5, 16, v5
v_mul_u32_u24 v6, 56, v5
v_sub_u32 v6, v4, v6
v_mul_u32_u24 v20, 2048, v5
v_lshl_add_u32 v20, v6, 5, v20
v_add_u32 v5, s15, v5
v_mul_u32_u24 v24, 896, v5
v_and_b32 v5, 1, v6
v_lshl_add_u32 v24, v5, 6, v24
v_lshrrev_b32 v6, 1, v6
v_add_u32 v6, s14, v6
v_lshrrev_b32 v5, 2, v6
v_lshl_add_u32 v24, v5, 7, v24
v_and_b32 v5, 3, v6
v_lshl_add_u32 v24, v5, 4, v24
v_cmp_gt_u32 vcc, 128, v0
v_mov_b32 v4, 1073741824
s_nop 0
v_cndmask_b32 v24, v4, v24, vcc
v_cndmask_b32 v20, 0, v20, vcc
v_lshrrev_b32 v5, 11, v17
v_mul_u32_u24 v5, 896, v5
v_sub_u32 v5, v21, v5
buffer_load_dwordx4 v[168:171], v5, s[28:31], 0 offen
v_lshrrev_b32 v5, 11, v18
v_mul_u32_u24 v5, 896, v5
v_sub_u32 v5, v22, v5
buffer_load_dwordx4 v[172:175], v5, s[28:31], 0 offen
v_lshrrev_b32 v5, 11, v19
v_mul_u32_u24 v5, 896, v5
v_sub_u32 v5, v23, v5
buffer_load_dwordx4 v[176:179], v5, s[28:31], 0 offen
v_lshrrev_b32 v5, 11, v20
v_mul_u32_u24 v5, 896, v5
v_sub_u32 v5, v24, v5
buffer_load_dwordx4 v[180:183], v5, s[28:31], 0 offen
v_mul_u32_u24 v4, 8192, v2
v_lshl_add_u32 v4, v3, 2, v4
s_lshl_b32 s14, s9, 15
v_add_u32 v4, s14, v4
ds_write2st64_b32 v4, a0, a1 offset0:0 offset1:8
ds_write2st64_b32 v4, a2, a3 offset0:16 offset1:24
v_add_u32 v4, 64, v4
ds_write2st64_b32 v4, a4, a5 offset0:0 offset1:8
ds_write2st64_b32 v4, a6, a7 offset0:16 offset1:24
v_add_u32 v4, 64, v4
ds_write2st64_b32 v4, a8, a9 offset0:0 offset1:8
ds_write2st64_b32 v4, a10, a11 offset0:16 offset1:24
v_add_u32 v4, 64, v4
ds_write2st64_b32 v4, a12, a13 offset0:0 offset1:8
ds_write2st64_b32 v4, a14, a15 offset0:16 offset1:24
v_add_u32 v4, 64, v4
ds_write2st64_b32 v4, a16, a17 offset0:0 offset1:8
ds_write2st64_b32 v4, a18, a19 offset0:16 offset1:24
v_add_u32 v4, 64, v4
ds_write2st64_b32 v4, a20, a21 offset0:0 offset1:8
ds_write2st64_b32 v4, a22, a23 offset0:16 offset1:24
v_add_u32 v4, 64, v4
ds_write2st64_b32 v4, a24, a25 offset0:0 offset1:8
ds_write2st64_b32 v4, a26, a27 offset0:16 offset1:24
v_add_u32 v4, 64, v4
ds_write2st64_b32 v4, a28, a29 offset0:0 offset1:8
ds_write2st64_b32 v4, a30, a31 offset0:16 offset1:24
v_add_u32 v4, 64, v4
ds_write2st64_b32 v4, a32, a33 offset0:0 offset1:8
ds_write2st64_b32 v4, a34, a35 offset0:16 offset1:24
v_add_u32 v4, 64, v4
ds_write2st64_b32 v4, a36, a37 offset0:0 offset1:8
ds_write2st64_b32 v4, a38, a39 offset0:16 offset1:24
v_add_u32 v4, 64, v4
ds_write2st64_b32 v4, a40, a41 offset0:0 offset1:8
ds_write2st64_b32 v4, a42, a43 offset0:16 offset1:24
v_add_u32 v4, 64, v4
ds_write2st64_b32 v4, a44, a45 offset0:0 offset1:8
ds_write2st64_b32 v4, a46, a47 offset0:16 offset1:24
v_add_u32 v4, 64, v4
ds_write2st64_b32 v4, a48, a49 offset0:0 offset1:8
ds_write2st64_b32 v4, a50, a51 offset0:16 offset1:24
v_add_u32 v4, 64, v4
ds_write2st64_b32 v4, a52, a53 offset0:0 offset1:8
ds_write2st64_b32 v4, a54, a55 offset0:16 offset1:24
v_add_u32 v4, 64, v4
ds_write2st64_b32 v4, a56, a57 offset0:0 offset1:8
ds_write2st64_b32 v4, a58, a59 offset0:16 offset1:24
v_add_u32 v4, 64, v4
ds_write2st64_b32 v4, a60, a61 offset0:0 offset1:8
ds_write2st64_b32 v4, a62, a63 offset0:16 offset1:24
v_add_u32 v4, 64, v4
ds_write2st64_b32 v4, a64, a65 offset0:0 offset1:8
ds_write2st64_b32 v4, a66, a67 offset0:16 offset1:24
v_add_u32 v4, 64, v4
ds_write2st64_b32 v4, a68, a69 offset0:0 offset1:8
ds_write2st64_b32 v4, a70, a71 offset0:16 offset1:24
v_add_u32 v4, 64, v4
ds_write2st64_b32 v4, a72, a73 offset0:0 offset1:8
ds_write2st64_b32 v4, a74, a75 offset0:16 offset1:24
v_add_u32 v4, 64, v4
ds_write2st64_b32 v4, a76, a77 offset0:0 offset1:8
ds_write2st64_b32 v4, a78, a79 offset0:16 offset1:24
v_add_u32 v4, 64, v4
ds_write2st64_b32 v4, a80, a81 offset0:0 offset1:8
ds_write2st64_b32 v4, a82, a83 offset0:16 offset1:24
v_add_u32 v4, 64, v4
ds_write2st64_b32 v4, a84, a85 offset0:0 offset1:8
ds_write2st64_b32 v4, a86, a87 offset0:16 offset1:24
v_add_u32 v4, 64, v4
ds_write2st64_b32 v4, a88, a89 offset0:0 offset1:8
ds_write2st64_b32 v4, a90, a91 offset0:16 offset1:24
v_add_u32 v4, 64, v4
ds_write2st64_b32 v4, a92, a93 offset0:0 offset1:8
ds_write2st64_b32 v4, a94, a95 offset0:16 offset1:24
v_add_u32 v4, 64, v4
ds_write2st64_b32 v4, a96, a97 offset0:0 offset1:8
ds_write2st64_b32 v4, a98, a99 offset0:16 offset1:24
v_add_u32 v4, 64, v4
ds_write2st64_b32 v4, a100, a101 offset0:0 offset1:8
ds_write2st64_b32 v4, a102, a103 offset0:16 offset1:24
v_add_u32 v4, 64, v4
ds_write2st64_b32 v4, a104, a105 offset0:0 offset1:8
ds_write2st64_b32 v4, a106, a107 offset0:16 offset1:24
v_add_u32 v4, 64, v4
ds_write2st64_b32 v4, a108, a109 offset0:0 offset1:8
ds_write2st64_b32 v4, a110, a111 offset0:16 offset1:24
v_add_u32 v4, 64, v4
s_waitcnt lgkmcnt(0)
s_barrier
s_mul_i32 s15, s10, 28672
s_add_u32 s15, s15, 77594624
s_waitcnt vmcnt(0)
v_add_u32 v4, 65536, v17
ds_read_b128 v[56:59], v17 offset:0
ds_read_b128 v[60:63], v17 offset:16
ds_read_b128 v[64:67], v17 offset:32768
ds_read_b128 v[68:71], v17 offset:32784
ds_read_b128 v[72:75], v4 offset:0
ds_read_b128 v[76:79], v4 offset:16
ds_read_b128 v[80:83], v4 offset:32768
ds_read_b128 v[84:87], v4 offset:32784
s_waitcnt lgkmcnt(0)
v_add_f32 v56, v56, v64
v_add_f32 v72, v72, v80
v_add_f32 v56, v56, v72
v_add_f32 v57, v57, v65
v_add_f32 v73, v73, v81
v_add_f32 v57, v57, v73
v_add_f32 v58, v58, v66
v_add_f32 v74, v74, v82
v_add_f32 v58, v58, v74
v_add_f32 v59, v59, v67
v_add_f32 v75, v75, v83
v_add_f32 v59, v59, v75
v_add_f32 v60, v60, v68
v_add_f32 v76, v76, v84
v_add_f32 v60, v60, v76
v_add_f32 v61, v61, v69
v_add_f32 v77, v77, v85
v_add_f32 v61, v61, v77
v_add_f32 v62, v62, v70
v_add_f32 v78, v78, v86
v_add_f32 v62, v62, v78
v_add_f32 v63, v63, v71
v_add_f32 v79, v79, v87
v_add_f32 v63, v63, v79
v_cvt_pk_bf16_f32 v4, v56, v57
v_lshlrev_b32 v56, 16, v4
v_and_b32 v57, 0xffff0000, v4
v_lshlrev_b32 v5, 16, v168
v_and_b32 v6, 0xffff0000, v168
v_add_f32 v56, v56, v5
v_add_f32 v57, v57, v6
v_cvt_pk_bf16_f32 v4, v58, v59
v_lshlrev_b32 v58, 16, v4
v_and_b32 v59, 0xffff0000, v4
v_lshlrev_b32 v5, 16, v169
v_and_b32 v6, 0xffff0000, v169
v_add_f32 v58, v58, v5
v_add_f32 v59, v59, v6
v_cvt_pk_bf16_f32 v4, v60, v61
v_lshlrev_b32 v60, 16, v4
v_and_b32 v61, 0xffff0000, v4
v_lshlrev_b32 v5, 16, v170
v_and_b32 v6, 0xffff0000, v170
v_add_f32 v60, v60, v5
v_add_f32 v61, v61, v6
v_cvt_pk_bf16_f32 v4, v62, v63
v_lshlrev_b32 v62, 16, v4
v_and_b32 v63, 0xffff0000, v4
v_lshlrev_b32 v5, 16, v171
v_and_b32 v6, 0xffff0000, v171
v_add_f32 v62, v62, v5
v_add_f32 v63, v63, v6
v_cvt_pk_bf16_f32 v88, v56, v57
v_cvt_pk_bf16_f32 v89, v58, v59
v_cvt_pk_bf16_f32 v90, v60, v61
v_cvt_pk_bf16_f32 v91, v62, v63
buffer_store_dwordx4 v[88:91], v21, s[4:7], s15 offen sc1
v_add_u32 v4, 65536, v18
ds_read_b128 v[56:59], v18 offset:0
ds_read_b128 v[60:63], v18 offset:16
ds_read_b128 v[64:67], v18 offset:32768
ds_read_b128 v[68:71], v18 offset:32784
ds_read_b128 v[72:75], v4 offset:0
ds_read_b128 v[76:79], v4 offset:16
ds_read_b128 v[80:83], v4 offset:32768
ds_read_b128 v[84:87], v4 offset:32784
s_waitcnt lgkmcnt(0)
v_add_f32 v56, v56, v64
v_add_f32 v72, v72, v80
v_add_f32 v56, v56, v72
v_add_f32 v57, v57, v65
v_add_f32 v73, v73, v81
v_add_f32 v57, v57, v73
v_add_f32 v58, v58, v66
v_add_f32 v74, v74, v82
v_add_f32 v58, v58, v74
v_add_f32 v59, v59, v67
v_add_f32 v75, v75, v83
v_add_f32 v59, v59, v75
v_add_f32 v60, v60, v68
v_add_f32 v76, v76, v84
v_add_f32 v60, v60, v76
v_add_f32 v61, v61, v69
v_add_f32 v77, v77, v85
v_add_f32 v61, v61, v77
v_add_f32 v62, v62, v70
v_add_f32 v78, v78, v86
v_add_f32 v62, v62, v78
v_add_f32 v63, v63, v71
v_add_f32 v79, v79, v87
v_add_f32 v63, v63, v79
v_cvt_pk_bf16_f32 v4, v56, v57
v_lshlrev_b32 v56, 16, v4
v_and_b32 v57, 0xffff0000, v4
v_lshlrev_b32 v5, 16, v172
v_and_b32 v6, 0xffff0000, v172
v_add_f32 v56, v56, v5
v_add_f32 v57, v57, v6
v_cvt_pk_bf16_f32 v4, v58, v59
v_lshlrev_b32 v58, 16, v4
v_and_b32 v59, 0xffff0000, v4
v_lshlrev_b32 v5, 16, v173
v_and_b32 v6, 0xffff0000, v173
v_add_f32 v58, v58, v5
v_add_f32 v59, v59, v6
v_cvt_pk_bf16_f32 v4, v60, v61
v_lshlrev_b32 v60, 16, v4
v_and_b32 v61, 0xffff0000, v4
v_lshlrev_b32 v5, 16, v174
v_and_b32 v6, 0xffff0000, v174
v_add_f32 v60, v60, v5
v_add_f32 v61, v61, v6
v_cvt_pk_bf16_f32 v4, v62, v63
v_lshlrev_b32 v62, 16, v4
v_and_b32 v63, 0xffff0000, v4
v_lshlrev_b32 v5, 16, v175
v_and_b32 v6, 0xffff0000, v175
v_add_f32 v62, v62, v5
v_add_f32 v63, v63, v6
v_cvt_pk_bf16_f32 v92, v56, v57
v_cvt_pk_bf16_f32 v93, v58, v59
v_cvt_pk_bf16_f32 v94, v60, v61
v_cvt_pk_bf16_f32 v95, v62, v63
buffer_store_dwordx4 v[92:95], v22, s[4:7], s15 offen sc1
v_add_u32 v4, 65536, v19
ds_read_b128 v[56:59], v19 offset:0
ds_read_b128 v[60:63], v19 offset:16
ds_read_b128 v[64:67], v19 offset:32768
ds_read_b128 v[68:71], v19 offset:32784
ds_read_b128 v[72:75], v4 offset:0
ds_read_b128 v[76:79], v4 offset:16
ds_read_b128 v[80:83], v4 offset:32768
ds_read_b128 v[84:87], v4 offset:32784
s_waitcnt lgkmcnt(0)
v_add_f32 v56, v56, v64
v_add_f32 v72, v72, v80
v_add_f32 v56, v56, v72
v_add_f32 v57, v57, v65
v_add_f32 v73, v73, v81
v_add_f32 v57, v57, v73
v_add_f32 v58, v58, v66
v_add_f32 v74, v74, v82
v_add_f32 v58, v58, v74
v_add_f32 v59, v59, v67
v_add_f32 v75, v75, v83
v_add_f32 v59, v59, v75
v_add_f32 v60, v60, v68
v_add_f32 v76, v76, v84
v_add_f32 v60, v60, v76
v_add_f32 v61, v61, v69
v_add_f32 v77, v77, v85
v_add_f32 v61, v61, v77
v_add_f32 v62, v62, v70
v_add_f32 v78, v78, v86
v_add_f32 v62, v62, v78
v_add_f32 v63, v63, v71
v_add_f32 v79, v79, v87
v_add_f32 v63, v63, v79
v_cvt_pk_bf16_f32 v4, v56, v57
v_lshlrev_b32 v56, 16, v4
v_and_b32 v57, 0xffff0000, v4
v_lshlrev_b32 v5, 16, v176
v_and_b32 v6, 0xffff0000, v176
v_add_f32 v56, v56, v5
v_add_f32 v57, v57, v6
v_cvt_pk_bf16_f32 v4, v58, v59
v_lshlrev_b32 v58, 16, v4
v_and_b32 v59, 0xffff0000, v4
v_lshlrev_b32 v5, 16, v177
v_and_b32 v6, 0xffff0000, v177
v_add_f32 v58, v58, v5
v_add_f32 v59, v59, v6
v_cvt_pk_bf16_f32 v4, v60, v61
v_lshlrev_b32 v60, 16, v4
v_and_b32 v61, 0xffff0000, v4
v_lshlrev_b32 v5, 16, v178
v_and_b32 v6, 0xffff0000, v178
v_add_f32 v60, v60, v5
v_add_f32 v61, v61, v6
v_cvt_pk_bf16_f32 v4, v62, v63
v_lshlrev_b32 v62, 16, v4
v_and_b32 v63, 0xffff0000, v4
v_lshlrev_b32 v5, 16, v179
v_and_b32 v6, 0xffff0000, v179
v_add_f32 v62, v62, v5
v_add_f32 v63, v63, v6
v_cvt_pk_bf16_f32 v96, v56, v57
v_cvt_pk_bf16_f32 v97, v58, v59
v_cvt_pk_bf16_f32 v98, v60, v61
v_cvt_pk_bf16_f32 v99, v62, v63
buffer_store_dwordx4 v[96:99], v23, s[4:7], s15 offen sc1
v_add_u32 v4, 65536, v20
ds_read_b128 v[56:59], v20 offset:0
ds_read_b128 v[60:63], v20 offset:16
ds_read_b128 v[64:67], v20 offset:32768
ds_read_b128 v[68:71], v20 offset:32784
ds_read_b128 v[72:75], v4 offset:0
ds_read_b128 v[76:79], v4 offset:16
ds_read_b128 v[80:83], v4 offset:32768
ds_read_b128 v[84:87], v4 offset:32784
s_waitcnt lgkmcnt(0)
v_add_f32 v56, v56, v64
v_add_f32 v72, v72, v80
v_add_f32 v56, v56, v72
v_add_f32 v57, v57, v65
v_add_f32 v73, v73, v81
v_add_f32 v57, v57, v73
v_add_f32 v58, v58, v66
v_add_f32 v74, v74, v82
v_add_f32 v58, v58, v74
v_add_f32 v59, v59, v67
v_add_f32 v75, v75, v83
v_add_f32 v59, v59, v75
v_add_f32 v60, v60, v68
v_add_f32 v76, v76, v84
v_add_f32 v60, v60, v76
v_add_f32 v61, v61, v69
v_add_f32 v77, v77, v85
v_add_f32 v61, v61, v77
v_add_f32 v62, v62, v70
v_add_f32 v78, v78, v86
v_add_f32 v62, v62, v78
v_add_f32 v63, v63, v71
v_add_f32 v79, v79, v87
v_add_f32 v63, v63, v79
v_cvt_pk_bf16_f32 v4, v56, v57
v_lshlrev_b32 v56, 16, v4
v_and_b32 v57, 0xffff0000, v4
v_lshlrev_b32 v5, 16, v180
v_and_b32 v6, 0xffff0000, v180
v_add_f32 v56, v56, v5
v_add_f32 v57, v57, v6
v_cvt_pk_bf16_f32 v4, v58, v59
v_lshlrev_b32 v58, 16, v4
v_and_b32 v59, 0xffff0000, v4
v_lshlrev_b32 v5, 16, v181
v_and_b32 v6, 0xffff0000, v181
v_add_f32 v58, v58, v5
v_add_f32 v59, v59, v6
v_cvt_pk_bf16_f32 v4, v60, v61
v_lshlrev_b32 v60, 16, v4
v_and_b32 v61, 0xffff0000, v4
v_lshlrev_b32 v5, 16, v182
v_and_b32 v6, 0xffff0000, v182
v_add_f32 v60, v60, v5
v_add_f32 v61, v61, v6
v_cvt_pk_bf16_f32 v4, v62, v63
v_lshlrev_b32 v62, 16, v4
v_and_b32 v63, 0xffff0000, v4
v_lshlrev_b32 v5, 16, v183
v_and_b32 v6, 0xffff0000, v183
v_add_f32 v62, v62, v5
v_add_f32 v63, v63, v6
v_cvt_pk_bf16_f32 v100, v56, v57
v_cvt_pk_bf16_f32 v101, v58, v59
v_cvt_pk_bf16_f32 v102, v60, v61
v_cvt_pk_bf16_f32 v103, v62, v63
buffer_store_dwordx4 v[100:103], v24, s[4:7], s15 offen sc1
s_barrier
v_mul_u32_u24 v4, 8192, v2
v_lshl_add_u32 v4, v3, 2, v4
s_lshl_b32 s14, s9, 15
v_add_u32 v4, s14, v4
ds_write2st64_b32 v4, a112, a113 offset0:0 offset1:8
ds_write2st64_b32 v4, a114, a115 offset0:16 offset1:24
v_add_u32 v4, 64, v4
ds_write2st64_b32 v4, a116, a117 offset0:0 offset1:8
ds_write2st64_b32 v4, a118, a119 offset0:16 offset1:24
v_add_u32 v4, 64, v4
ds_write2st64_b32 v4, a120, a121 offset0:0 offset1:8
ds_write2st64_b32 v4, a122, a123 offset0:16 offset1:24
v_add_u32 v4, 64, v4
ds_write2st64_b32 v4, a124, a125 offset0:0 offset1:8
ds_write2st64_b32 v4, a126, a127 offset0:16 offset1:24
v_add_u32 v4, 64, v4
ds_write2st64_b32 v4, a128, a129 offset0:0 offset1:8
ds_write2st64_b32 v4, a130, a131 offset0:16 offset1:24
v_add_u32 v4, 64, v4
ds_write2st64_b32 v4, a132, a133 offset0:0 offset1:8
ds_write2st64_b32 v4, a134, a135 offset0:16 offset1:24
v_add_u32 v4, 64, v4
ds_write2st64_b32 v4, a136, a137 offset0:0 offset1:8
ds_write2st64_b32 v4, a138, a139 offset0:16 offset1:24
v_add_u32 v4, 64, v4
ds_write2st64_b32 v4, a140, a141 offset0:0 offset1:8
ds_write2st64_b32 v4, a142, a143 offset0:16 offset1:24
v_add_u32 v4, 64, v4
ds_write2st64_b32 v4, a144, a145 offset0:0 offset1:8
ds_write2st64_b32 v4, a146, a147 offset0:16 offset1:24
v_add_u32 v4, 64, v4
ds_write2st64_b32 v4, a148, a149 offset0:0 offset1:8
ds_write2st64_b32 v4, a150, a151 offset0:16 offset1:24
v_add_u32 v4, 64, v4
ds_write2st64_b32 v4, a152, a153 offset0:0 offset1:8
ds_write2st64_b32 v4, a154, a155 offset0:16 offset1:24
v_add_u32 v4, 64, v4
ds_write2st64_b32 v4, a156, a157 offset0:0 offset1:8
ds_write2st64_b32 v4, a158, a159 offset0:16 offset1:24
v_add_u32 v4, 64, v4
ds_write2st64_b32 v4, a160, a161 offset0:0 offset1:8
ds_write2st64_b32 v4, a162, a163 offset0:16 offset1:24
v_add_u32 v4, 64, v4
ds_write2st64_b32 v4, a164, a165 offset0:0 offset1:8
ds_write2st64_b32 v4, a166, a167 offset0:16 offset1:24
v_add_u32 v4, 64, v4
ds_write2st64_b32 v4, a168, a169 offset0:0 offset1:8
ds_write2st64_b32 v4, a170, a171 offset0:16 offset1:24
v_add_u32 v4, 64, v4
ds_write2st64_b32 v4, a172, a173 offset0:0 offset1:8
ds_write2st64_b32 v4, a174, a175 offset0:16 offset1:24
v_add_u32 v4, 64, v4
ds_write2st64_b32 v4, a176, a177 offset0:0 offset1:8
ds_write2st64_b32 v4, a178, a179 offset0:16 offset1:24
v_add_u32 v4, 64, v4
ds_write2st64_b32 v4, a180, a181 offset0:0 offset1:8
ds_write2st64_b32 v4, a182, a183 offset0:16 offset1:24
v_add_u32 v4, 64, v4
ds_write2st64_b32 v4, a184, a185 offset0:0 offset1:8
ds_write2st64_b32 v4, a186, a187 offset0:16 offset1:24
v_add_u32 v4, 64, v4
ds_write2st64_b32 v4, a188, a189 offset0:0 offset1:8
ds_write2st64_b32 v4, a190, a191 offset0:16 offset1:24
v_add_u32 v4, 64, v4
ds_write2st64_b32 v4, a192, a193 offset0:0 offset1:8
ds_write2st64_b32 v4, a194, a195 offset0:16 offset1:24
v_add_u32 v4, 64, v4
ds_write2st64_b32 v4, a196, a197 offset0:0 offset1:8
ds_write2st64_b32 v4, a198, a199 offset0:16 offset1:24
v_add_u32 v4, 64, v4
ds_write2st64_b32 v4, a200, a201 offset0:0 offset1:8
ds_write2st64_b32 v4, a202, a203 offset0:16 offset1:24
v_add_u32 v4, 64, v4
ds_write2st64_b32 v4, a204, a205 offset0:0 offset1:8
ds_write2st64_b32 v4, a206, a207 offset0:16 offset1:24
v_add_u32 v4, 64, v4
ds_write2st64_b32 v4, a208, a209 offset0:0 offset1:8
ds_write2st64_b32 v4, a210, a211 offset0:16 offset1:24
v_add_u32 v4, 64, v4
ds_write2st64_b32 v4, a212, a213 offset0:0 offset1:8
ds_write2st64_b32 v4, a214, a215 offset0:16 offset1:24
v_add_u32 v4, 64, v4
ds_write2st64_b32 v4, a216, a217 offset0:0 offset1:8
ds_write2st64_b32 v4, a218, a219 offset0:16 offset1:24
v_add_u32 v4, 64, v4
ds_write2st64_b32 v4, a220, a221 offset0:0 offset1:8
ds_write2st64_b32 v4, a222, a223 offset0:16 offset1:24
v_add_u32 v4, 64, v4
s_waitcnt lgkmcnt(0)
s_barrier
s_mul_i32 s15, s10, 28672
s_add_u32 s15, s15, 77608960
v_add_u32 v4, 65536, v17
ds_read_b128 v[56:59], v17 offset:0
ds_read_b128 v[60:63], v17 offset:16
ds_read_b128 v[64:67], v17 offset:32768
ds_read_b128 v[68:71], v17 offset:32784
ds_read_b128 v[72:75], v4 offset:0
ds_read_b128 v[76:79], v4 offset:16
ds_read_b128 v[80:83], v4 offset:32768
ds_read_b128 v[84:87], v4 offset:32784
s_waitcnt lgkmcnt(0)
v_add_f32 v56, v56, v64
v_add_f32 v72, v72, v80
v_add_f32 v56, v56, v72
v_add_f32 v57, v57, v65
v_add_f32 v73, v73, v81
v_add_f32 v57, v57, v73
v_add_f32 v58, v58, v66
v_add_f32 v74, v74, v82
v_add_f32 v58, v58, v74
v_add_f32 v59, v59, v67
v_add_f32 v75, v75, v83
v_add_f32 v59, v59, v75
v_add_f32 v60, v60, v68
v_add_f32 v76, v76, v84
v_add_f32 v60, v60, v76
v_add_f32 v61, v61, v69
v_add_f32 v77, v77, v85
v_add_f32 v61, v61, v77
v_add_f32 v62, v62, v70
v_add_f32 v78, v78, v86
v_add_f32 v62, v62, v78
v_add_f32 v63, v63, v71
v_add_f32 v79, v79, v87
v_add_f32 v63, v63, v79
v_cvt_pk_bf16_f32 v4, v56, v57
v_lshlrev_b32 v56, 16, v4
v_and_b32 v57, 0xffff0000, v4
v_lshlrev_b32 v5, 16, v168
v_and_b32 v6, 0xffff0000, v168
v_add_f32 v56, v56, v5
v_add_f32 v57, v57, v6
v_cvt_pk_bf16_f32 v4, v58, v59
v_lshlrev_b32 v58, 16, v4
v_and_b32 v59, 0xffff0000, v4
v_lshlrev_b32 v5, 16, v169
v_and_b32 v6, 0xffff0000, v169
v_add_f32 v58, v58, v5
v_add_f32 v59, v59, v6
v_cvt_pk_bf16_f32 v4, v60, v61
v_lshlrev_b32 v60, 16, v4
v_and_b32 v61, 0xffff0000, v4
v_lshlrev_b32 v5, 16, v170
v_and_b32 v6, 0xffff0000, v170
v_add_f32 v60, v60, v5
v_add_f32 v61, v61, v6
v_cvt_pk_bf16_f32 v4, v62, v63
v_lshlrev_b32 v62, 16, v4
v_and_b32 v63, 0xffff0000, v4
v_lshlrev_b32 v5, 16, v171
v_and_b32 v6, 0xffff0000, v171
v_add_f32 v62, v62, v5
v_add_f32 v63, v63, v6
v_cvt_pk_bf16_f32 v104, v56, v57
v_cvt_pk_bf16_f32 v105, v58, v59
v_cvt_pk_bf16_f32 v106, v60, v61
v_cvt_pk_bf16_f32 v107, v62, v63
buffer_store_dwordx4 v[104:107], v21, s[4:7], s15 offen sc1
v_add_u32 v4, 65536, v18
ds_read_b128 v[56:59], v18 offset:0
ds_read_b128 v[60:63], v18 offset:16
ds_read_b128 v[64:67], v18 offset:32768
ds_read_b128 v[68:71], v18 offset:32784
ds_read_b128 v[72:75], v4 offset:0
ds_read_b128 v[76:79], v4 offset:16
ds_read_b128 v[80:83], v4 offset:32768
ds_read_b128 v[84:87], v4 offset:32784
s_waitcnt lgkmcnt(0)
v_add_f32 v56, v56, v64
v_add_f32 v72, v72, v80
v_add_f32 v56, v56, v72
v_add_f32 v57, v57, v65
v_add_f32 v73, v73, v81
v_add_f32 v57, v57, v73
v_add_f32 v58, v58, v66
v_add_f32 v74, v74, v82
v_add_f32 v58, v58, v74
v_add_f32 v59, v59, v67
v_add_f32 v75, v75, v83
v_add_f32 v59, v59, v75
v_add_f32 v60, v60, v68
v_add_f32 v76, v76, v84
v_add_f32 v60, v60, v76
v_add_f32 v61, v61, v69
v_add_f32 v77, v77, v85
v_add_f32 v61, v61, v77
v_add_f32 v62, v62, v70
v_add_f32 v78, v78, v86
v_add_f32 v62, v62, v78
v_add_f32 v63, v63, v71
v_add_f32 v79, v79, v87
v_add_f32 v63, v63, v79
v_cvt_pk_bf16_f32 v4, v56, v57
v_lshlrev_b32 v56, 16, v4
v_and_b32 v57, 0xffff0000, v4
v_lshlrev_b32 v5, 16, v172
v_and_b32 v6, 0xffff0000, v172
v_add_f32 v56, v56, v5
v_add_f32 v57, v57, v6
v_cvt_pk_bf16_f32 v4, v58, v59
v_lshlrev_b32 v58, 16, v4
v_and_b32 v59, 0xffff0000, v4
v_lshlrev_b32 v5, 16, v173
v_and_b32 v6, 0xffff0000, v173
v_add_f32 v58, v58, v5
v_add_f32 v59, v59, v6
v_cvt_pk_bf16_f32 v4, v60, v61
v_lshlrev_b32 v60, 16, v4
v_and_b32 v61, 0xffff0000, v4
v_lshlrev_b32 v5, 16, v174
v_and_b32 v6, 0xffff0000, v174
v_add_f32 v60, v60, v5
v_add_f32 v61, v61, v6
v_cvt_pk_bf16_f32 v4, v62, v63
v_lshlrev_b32 v62, 16, v4
v_and_b32 v63, 0xffff0000, v4
v_lshlrev_b32 v5, 16, v175
v_and_b32 v6, 0xffff0000, v175
v_add_f32 v62, v62, v5
v_add_f32 v63, v63, v6
v_cvt_pk_bf16_f32 v108, v56, v57
v_cvt_pk_bf16_f32 v109, v58, v59
v_cvt_pk_bf16_f32 v110, v60, v61
v_cvt_pk_bf16_f32 v111, v62, v63
buffer_store_dwordx4 v[108:111], v22, s[4:7], s15 offen sc1
v_add_u32 v4, 65536, v19
ds_read_b128 v[56:59], v19 offset:0
ds_read_b128 v[60:63], v19 offset:16
ds_read_b128 v[64:67], v19 offset:32768
ds_read_b128 v[68:71], v19 offset:32784
ds_read_b128 v[72:75], v4 offset:0
ds_read_b128 v[76:79], v4 offset:16
ds_read_b128 v[80:83], v4 offset:32768
ds_read_b128 v[84:87], v4 offset:32784
s_waitcnt lgkmcnt(0)
v_add_f32 v56, v56, v64
v_add_f32 v72, v72, v80
v_add_f32 v56, v56, v72
v_add_f32 v57, v57, v65
v_add_f32 v73, v73, v81
v_add_f32 v57, v57, v73
v_add_f32 v58, v58, v66
v_add_f32 v74, v74, v82
v_add_f32 v58, v58, v74
v_add_f32 v59, v59, v67
v_add_f32 v75, v75, v83
v_add_f32 v59, v59, v75
v_add_f32 v60, v60, v68
v_add_f32 v76, v76, v84
v_add_f32 v60, v60, v76
v_add_f32 v61, v61, v69
v_add_f32 v77, v77, v85
v_add_f32 v61, v61, v77
v_add_f32 v62, v62, v70
v_add_f32 v78, v78, v86
v_add_f32 v62, v62, v78
v_add_f32 v63, v63, v71
v_add_f32 v79, v79, v87
v_add_f32 v63, v63, v79
v_cvt_pk_bf16_f32 v4, v56, v57
v_lshlrev_b32 v56, 16, v4
v_and_b32 v57, 0xffff0000, v4
v_lshlrev_b32 v5, 16, v176
v_and_b32 v6, 0xffff0000, v176
v_add_f32 v56, v56, v5
v_add_f32 v57, v57, v6
v_cvt_pk_bf16_f32 v4, v58, v59
v_lshlrev_b32 v58, 16, v4
v_and_b32 v59, 0xffff0000, v4
v_lshlrev_b32 v5, 16, v177
v_and_b32 v6, 0xffff0000, v177
v_add_f32 v58, v58, v5
v_add_f32 v59, v59, v6
v_cvt_pk_bf16_f32 v4, v60, v61
v_lshlrev_b32 v60, 16, v4
v_and_b32 v61, 0xffff0000, v4
v_lshlrev_b32 v5, 16, v178
v_and_b32 v6, 0xffff0000, v178
v_add_f32 v60, v60, v5
v_add_f32 v61, v61, v6
v_cvt_pk_bf16_f32 v4, v62, v63
v_lshlrev_b32 v62, 16, v4
v_and_b32 v63, 0xffff0000, v4
v_lshlrev_b32 v5, 16, v179
v_and_b32 v6, 0xffff0000, v179
v_add_f32 v62, v62, v5
v_add_f32 v63, v63, v6
v_cvt_pk_bf16_f32 v112, v56, v57
v_cvt_pk_bf16_f32 v113, v58, v59
v_cvt_pk_bf16_f32 v114, v60, v61
v_cvt_pk_bf16_f32 v115, v62, v63
buffer_store_dwordx4 v[112:115], v23, s[4:7], s15 offen sc1
v_add_u32 v4, 65536, v20
ds_read_b128 v[56:59], v20 offset:0
ds_read_b128 v[60:63], v20 offset:16
ds_read_b128 v[64:67], v20 offset:32768
ds_read_b128 v[68:71], v20 offset:32784
ds_read_b128 v[72:75], v4 offset:0
ds_read_b128 v[76:79], v4 offset:16
ds_read_b128 v[80:83], v4 offset:32768
ds_read_b128 v[84:87], v4 offset:32784
s_waitcnt lgkmcnt(0)
v_add_f32 v56, v56, v64
v_add_f32 v72, v72, v80
v_add_f32 v56, v56, v72
v_add_f32 v57, v57, v65
v_add_f32 v73, v73, v81
v_add_f32 v57, v57, v73
v_add_f32 v58, v58, v66
v_add_f32 v74, v74, v82
v_add_f32 v58, v58, v74
v_add_f32 v59, v59, v67
v_add_f32 v75, v75, v83
v_add_f32 v59, v59, v75
v_add_f32 v60, v60, v68
v_add_f32 v76, v76, v84
v_add_f32 v60, v60, v76
v_add_f32 v61, v61, v69
v_add_f32 v77, v77, v85
v_add_f32 v61, v61, v77
v_add_f32 v62, v62, v70
v_add_f32 v78, v78, v86
v_add_f32 v62, v62, v78
v_add_f32 v63, v63, v71
v_add_f32 v79, v79, v87
v_add_f32 v63, v63, v79
v_cvt_pk_bf16_f32 v4, v56, v57
v_lshlrev_b32 v56, 16, v4
v_and_b32 v57, 0xffff0000, v4
v_lshlrev_b32 v5, 16, v180
v_and_b32 v6, 0xffff0000, v180
v_add_f32 v56, v56, v5
v_add_f32 v57, v57, v6
v_cvt_pk_bf16_f32 v4, v58, v59
v_lshlrev_b32 v58, 16, v4
v_and_b32 v59, 0xffff0000, v4
v_lshlrev_b32 v5, 16, v181
v_and_b32 v6, 0xffff0000, v181
v_add_f32 v58, v58, v5
v_add_f32 v59, v59, v6
v_cvt_pk_bf16_f32 v4, v60, v61
v_lshlrev_b32 v60, 16, v4
v_and_b32 v61, 0xffff0000, v4
v_lshlrev_b32 v5, 16, v182
v_and_b32 v6, 0xffff0000, v182
v_add_f32 v60, v60, v5
v_add_f32 v61, v61, v6
v_cvt_pk_bf16_f32 v4, v62, v63
v_lshlrev_b32 v62, 16, v4
v_and_b32 v63, 0xffff0000, v4
v_lshlrev_b32 v5, 16, v183
v_and_b32 v6, 0xffff0000, v183
v_add_f32 v62, v62, v5
v_add_f32 v63, v63, v6
v_cvt_pk_bf16_f32 v116, v56, v57
v_cvt_pk_bf16_f32 v117, v58, v59
v_cvt_pk_bf16_f32 v118, v60, v61
v_cvt_pk_bf16_f32 v119, v62, v63
buffer_store_dwordx4 v[116:119], v24, s[4:7], s15 offen sc1
s_lshl_b32 s14, s10, 7
s_add_u32 s14, s14, 8192
v_mov_b32 v8, s14
s_waitcnt vmcnt(0) lgkmcnt(0)
s_barrier
s_cmp_lg_u32 s9, 0
s_cbranch_scc1 SG_51
v_mov_b32 v4, 1
s_mov_b64 exec, 1
buffer_atomic_add v4, v8, s[4:7], s39 offen
s_mov_b64 exec, -1
SG_51:
F_P2:
s_cmp_ge_u32 s10, 77
s_cbranch_scc1 EXIT
s_mul_i32 s12, s10, 147
s_lshr_b32 s12, s12, 10
s_mul_i32 s36, s12, 7
s_sub_u32 s36, s10, s36
v_mov_b32 v8, 16384
s_mov_b32 s14, 112
WT_52:
buffer_load_dword v4, v8, s[4:7], s39 offen sc1
s_sub_u32 s38, s38, 1
s_cmp_gt_i32 s38, 0
s_cbranch_scc0 WD_53
s_waitcnt vmcnt(0)
v_cmp_gt_u32 vcc, s14, v4
s_cbranch_vccz WD_53
s_sleep 16
s_branch WT_52
WD_53:
v_lshlrev_b32 v17, 10, v2
v_and_b32 v4, 7, v3
v_lshl_add_u32 v17, v4, 2, v17
v_lshrrev_b32 v4, 3, v3
v_lshl_add_u32 v17, v4, 7, v17
s_lshl_b32 s14, s9, 13
v_add_u32 v17, s14, v17
v_lshlrev_b32 v18, 5, v0
v_lshrrev_b32 v4, 3, v0
v_mul_u32_u24 v21, 896, v4
v_and_b32 v4, 7, v0
v_lshl_add_u32 v21, v4, 4, v21
s_lshl_b32 s14, s36, 7
v_add_u32 v21, s14, v21
J2_54:
s_lshl_b32 s14, s12, 2
v_mov_b32 v8, s14
s_mov_b32 s14, 16
WT_55:
buffer_load_dword v4, v8, s[4:7], s39 offen sc1
s_sub_u32 s38, s38, 1
s_cmp_gt_i32 s38, 0
s_cbranch_scc0 WD_56
s_waitcnt vmcnt(0)
v_cmp_gt_u32 vcc, s14, v4
s_cbranch_vccz WD_56
s_sleep 8
s_branch WT_55
WD_56:
s_lshl_b32 s14, s12, 7
s_add_u32 s14, s14, 8192
v_mov_b32 v8, s14
s_mov_b32 s14, 1
WT_57:
buffer_load_dword v4, v8, s[4:7], s39 offen sc1
s_sub_u32 s38, s38, 1
s_cmp_gt_i32 s38, 0
s_cbranch_scc0 WD_58
s_waitcnt vmcnt(0)
v_cmp_gt_u32 vcc, s14, v4
s_cbranch_vccz WD_58
s_sleep 8
s_branch WT_57
WD_58:
s_mul_i32 s14, s12, 458752
s_lshl_b32 s15, s36, 16
s_add_u32 s14, s14, s15
s_lshl_b32 s15, s9, 12
s_add_u32 s14, s14, s15
s_add_u32 s14, s14, 16777216
buffer_load_dwordx4 a[0:3], v7, s[4:7], s14 offen offset:0 sc1
buffer_load_dwordx4 a[4:7], v7, s[4:7], s14 offen offset:1024 sc1
buffer_load_dwordx4 a[8:11], v7, s[4:7], s14 offen offset:2048 sc1
buffer_load_dwordx4 a[12:15], v7, s[4:7], s14 offen offset:3072 sc1
s_add_u32 s14, s14, 16384
buffer_load_dwordx4 a[16:19], v7, s[4:7], s14 offen offset:0 sc1
buffer_load_dwordx4 a[20:23], v7, s[4:7], s14 offen offset:1024 sc1
buffer_load_dwordx4 a[24:27], v7, s[4:7], s14 offen offset:2048 sc1
buffer_load_dwordx4 a[28:31], v7, s[4:7], s14 offen offset:3072 sc1
s_add_u32 s14, s14, 16384
buffer_load_dwordx4 a[32:35], v7, s[4:7], s14 offen offset:0 sc1
buffer_load_dwordx4 a[36:39], v7, s[4:7], s14 offen offset:1024 sc1
buffer_load_dwordx4 a[40:43], v7, s[4:7], s14 offen offset:2048 sc1
buffer_load_dwordx4 a[44:47], v7, s[4:7], s14 offen offset:3072 sc1
s_add_u32 s14, s14, 16384
buffer_load_dwordx4 a[48:51], v7, s[4:7], s14 offen offset:0 sc1
buffer_load_dwordx4 a[52:55], v7, s[4:7], s14 offen offset:1024 sc1
buffer_load_dwordx4 a[56:59], v7, s[4:7], s14 offen offset:2048 sc1
buffer_load_dwordx4 a[60:63], v7, s[4:7], s14 offen offset:3072 sc1
s_add_u32 s14, s14, 16384
s_mul_i32 s33, s12, 28672
s_add_u32 s15, s33, 77594624
buffer_load_dwordx4 v[224:227], v21, s[40:43], s33 offen
buffer_load_dwordx4 v[228:231], v21, s[4:7], s15 offen sc1
s_lshl_b32 s14, s12, 13
s_add_u32 s14, s14, 56623104
v_mov_b32 v5, 0
LV_59:
buffer_load_dword v6, v5, s[4:7], s14 offen sc1
s_sub_u32 s38, s38, 1
s_cmp_gt_i32 s38, 0
s_cbranch_scc0 LD_60
s_waitcnt vmcnt(0)
v_mov_b32 v4, v6
v_cmp_eq_u32 vcc, -1, v4
s_cbranch_vccz LD_60
s_sleep 8
s_branch LV_59
LD_60:
s_waitcnt vmcnt(0)
s_lshl_b32 s14, s12, 15
s_lshl_b32 s15, s9, 12
s_add_u32 s14, s14, s15
s_add_u32 s14, s14, 67108864
s_lshl_b32 s34, s12, 13
s_lshl_b32 s15, s9, 10
s_add_u32 s34, s34, s15
s_add_u32 s34, s34, 69206016
s_lshl_b32 s35, s12, 17
s_add_u32 s35, s35, s15
s_lshl_b32 s15, s36, 14
s_add_u32 s35, s35, s15
s_add_u32 s35, s35, 58720256
LV_61:
buffer_load_dwordx4 v[168:171], v10, s[4:7], s14 offen offset:0 sc1
buffer_load_dwordx4 v[172:175], v14, s[4:7], s14 offen offset:0 sc1
buffer_load_dwordx4 v[176:179], v10, s[4:7], s14 offen offset:1024 sc1
buffer_load_dwordx4 v[180:183], v14, s[4:7], s14 offen offset:1024 sc1
buffer_load_dwordx4 v[184:187], v10, s[4:7], s14 offen offset:2048 sc1
buffer_load_dwordx4 v[188:191], v14, s[4:7], s14 offen offset:2048 sc1
buffer_load_dwordx4 v[192:195], v10, s[4:7], s14 offen offset:3072 sc1
buffer_load_dwordx4 v[196:199], v14, s[4:7], s14 offen offset:3072 sc1
buffer_load_dwordx4 v[200:203], v10, s[4:7], s34 offen sc1
buffer_load_dwordx4 v[204:207], v11, s[4:7], s34 offen sc1
buffer_load_dwordx4 v[208:211], v10, s[4:7], s35 offen sc1
buffer_load_dwordx4 v[212:215], v11, s[4:7], s35 offen sc1
buffer_load_dwordx4 v[216:219], v12, s[4:7], s35 offen sc1
buffer_load_dwordx4 v[220:223], v13, s[4:7], s35 offen sc1
s_sub_u32 s38, s38, 1
s_cmp_gt_i32 s38, 0
s_cbranch_scc0 LD_62
s_waitcnt vmcnt(13)
v_max_u32 v4, v168, v169
v_max3_u32 v4, v4, v170, v171
s_waitcnt vmcnt(12)
v_max3_u32 v4, v4, v172, v173
v_max3_u32 v4, v4, v174, v175
s_waitcnt vmcnt(11)
v_max3_u32 v4, v4, v176, v177
v_max3_u32 v4, v4, v178, v179
s_waitcnt vmcnt(10)
v_max3_u32 v4, v4, v180, v181
v_max3_u32 v4, v4, v182, v183
s_waitcnt vmcnt(9)
v_max3_u32 v4, v4, v184, v185
v_max3_u32 v4, v4, v186, v187
s_waitcnt vmcnt(8)
v_max3_u32 v4, v4, v188, v189
v_max3_u32 v4, v4, v190, v191
s_waitcnt vmcnt(7)
v_max3_u32 v4, v4, v192, v193
v_max3_u32 v4, v4, v194, v195
s_waitcnt vmcnt(6)
v_max3_u32 v4, v4, v196, v197
v_max3_u32 v4, v4, v198, v199
s_waitcnt vmcnt(5)
v_max3_u32 v4, v4, v200, v201
v_max3_u32 v4, v4, v202, v203
s_waitcnt vmcnt(4)
v_max3_u32 v4, v4, v204, v205
v_max3_u32 v4, v4, v206, v207
s_waitcnt vmcnt(3)
v_max3_u32 v4, v4, v208, v209
v_max3_u32 v4, v4, v210, v211
s_waitcnt vmcnt(2)
v_max3_u32 v4, v4, v212, v213
v_max3_u32 v4, v4, v214, v215
s_waitcnt vmcnt(1)
v_max3_u32 v4, v4, v216, v217
v_max3_u32 v4, v4, v218, v219
s_waitcnt vmcnt(0)
v_max3_u32 v4, v4, v220, v221
v_max3_u32 v4, v4, v222, v223
v_cmp_eq_u32 vcc, -1, v4
s_cbranch_vccz LD_62
s_sleep 1
s_branch LV_61
LD_62:
s_waitcnt vmcnt(0)
v_mfma_f32_16x16x32_bf16 v[56:59], v[168:171], a[0:3], 0
v_mfma_f32_16x16x32_bf16 v[60:63], v[172:175], a[0:3], 0
v_mfma_f32_16x16x32_bf16 v[64:67], v[168:171], a[16:19], 0
v_mfma_f32_16x16x32_bf16 v[68:71], v[172:175], a[16:19], 0
v_mfma_f32_16x16x32_bf16 v[72:75], v[168:171], a[32:35], 0
v_mfma_f32_16x16x32_bf16 v[76:79], v[172:175], a[32:35], 0
v_mfma_f32_16x16x32_bf16 v[80:83], v[168:171], a[48:51], 0
v_mfma_f32_16x16x32_bf16 v[84:87], v[172:175], a[48:51], 0
v_mfma_f32_16x16x32_bf16 v[56:59], v[176:179], a[4:7], v[56:59]
v_mfma_f32_16x16x32_bf16 v[60:63], v[180:183], a[4:7], v[60:63]
v_mfma_f32_16x16x32_bf16 v[64:67], v[176:179], a[20:23], v[64:67]
v_mfma_f32_16x16x32_bf16 v[68:71], v[180:183], a[20:23], v[68:71]
v_mfma_f32_16x16x32_bf16 v[72:75], v[176:179], a[36:39], v[72:75]
v_mfma_f32_16x16x32_bf16 v[76:79], v[180:183], a[36:39], v[76:79]
v_mfma_f32_16x16x32_bf16 v[80:83], v[176:179], a[52:55], v[80:83]
v_mfma_f32_16x16x32_bf16 v[84:87], v[180:183], a[52:55], v[84:87]
v_mfma_f32_16x16x32_bf16 v[56:59], v[184:187], a[8:11], v[56:59]
v_mfma_f32_16x16x32_bf16 v[60:63], v[188:191], a[8:11], v[60:63]
v_mfma_f32_16x16x32_bf16 v[64:67], v[184:187], a[24:27], v[64:67]
v_mfma_f32_16x16x32_bf16 v[68:71], v[188:191], a[24:27], v[68:71]
v_mfma_f32_16x16x32_bf16 v[72:75], v[184:187], a[40:43], v[72:75]
v_mfma_f32_16x16x32_bf16 v[76:79], v[188:191], a[40:43], v[76:79]
v_mfma_f32_16x16x32_bf16 v[80:83], v[184:187], a[56:59], v[80:83]
v_mfma_f32_16x16x32_bf16 v[84:87], v[188:191], a[56:59], v[84:87]
v_mfma_f32_16x16x32_bf16 v[56:59], v[192:195], a[12:15], v[56:59]
v_mfma_f32_16x16x32_bf16 v[60:63], v[196:199], a[12:15], v[60:63]
v_mfma_f32_16x16x32_bf16 v[64:67], v[192:195], a[28:31], v[64:67]
v_mfma_f32_16x16x32_bf16 v[68:71], v[196:199], a[28:31], v[68:71]
v_mfma_f32_16x16x32_bf16 v[72:75], v[192:195], a[44:47], v[72:75]
v_mfma_f32_16x16x32_bf16 v[76:79], v[196:199], a[44:47], v[76:79]
v_mfma_f32_16x16x32_bf16 v[80:83], v[192:195], a[60:63], v[80:83]
v_mfma_f32_16x16x32_bf16 v[84:87], v[196:199], a[60:63], v[84:87]
v_mfma_f32_16x16x32_bf16 v[56:59], v[200:203], v[208:211], v[56:59]
v_mfma_f32_16x16x32_bf16 v[60:63], v[204:207], v[208:211], v[60:63]
v_mfma_f32_16x16x32_bf16 v[64:67], v[200:203], v[212:215], v[64:67]
v_mfma_f32_16x16x32_bf16 v[68:71], v[204:207], v[212:215], v[68:71]
v_mfma_f32_16x16x32_bf16 v[72:75], v[200:203], v[216:219], v[72:75]
v_mfma_f32_16x16x32_bf16 v[76:79], v[204:207], v[216:219], v[76:79]
v_mfma_f32_16x16x32_bf16 v[80:83], v[200:203], v[220:223], v[80:83]
v_mfma_f32_16x16x32_bf16 v[84:87], v[204:207], v[220:223], v[84:87]
ds_write2st64_b32 v17, v56, v57 offset0:0 offset1:1
ds_write2st64_b32 v17, v58, v59 offset0:2 offset1:3
ds_write2st64_b32 v17, v60, v61 offset0:16 offset1:17
ds_write2st64_b32 v17, v62, v63 offset0:18 offset1:19
v_add_u32 v4, 32, v17
ds_write2st64_b32 v4, v64, v65 offset0:0 offset1:1
ds_write2st64_b32 v4, v66, v67 offset0:2 offset1:3
ds_write2st64_b32 v4, v68, v69 offset0:16 offset1:17
ds_write2st64_b32 v4, v70, v71 offset0:18 offset1:19
v_add_u32 v4, 64, v17
ds_write2st64_b32 v4, v72, v73 offset0:0 offset1:1
ds_write2st64_b32 v4, v74, v75 offset0:2 offset1:3
ds_write2st64_b32 v4, v76, v77 offset0:16 offset1:17
ds_write2st64_b32 v4, v78, v79 offset0:18 offset1:19
v_add_u32 v4, 96, v17
ds_write2st64_b32 v4, v80, v81 offset0:0 offset1:1
ds_write2st64_b32 v4, v82, v83 offset0:2 offset1:3
ds_write2st64_b32 v4, v84, v85 offset0:16 offset1:17
ds_write2st64_b32 v4, v86, v87 offset0:18 offset1:19
s_waitcnt lgkmcnt(0)
s_barrier
ds_read_b128 v[88:91], v18 offset:0
ds_read_b128 v[92:95], v18 offset:16
ds_read_b128 v[96:99], v18 offset:8192
ds_read_b128 v[100:103], v18 offset:8208
ds_read_b128 v[104:107], v18 offset:16384
ds_read_b128 v[108:111], v18 offset:16400
ds_read_b128 v[112:115], v18 offset:24576
ds_read_b128 v[116:119], v18 offset:24592
s_waitcnt lgkmcnt(0)
s_barrier
v_add_f32 v88, v88, v96
v_add_f32 v104, v104, v112
v_add_f32 v88, v88, v104
v_add_f32 v89, v89, v97
v_add_f32 v105, v105, v113
v_add_f32 v89, v89, v105
v_add_f32 v90, v90, v98
v_add_f32 v106, v106, v114
v_add_f32 v90, v90, v106
v_add_f32 v91, v91, v99
v_add_f32 v107, v107, v115
v_add_f32 v91, v91, v107
v_add_f32 v92, v92, v100
v_add_f32 v108, v108, v116
v_add_f32 v92, v92, v108
v_add_f32 v93, v93, v101
v_add_f32 v109, v109, v117
v_add_f32 v93, v93, v109
v_add_f32 v94, v94, v102
v_add_f32 v110, v110, v118
v_add_f32 v94, v94, v110
v_add_f32 v95, v95, v103
v_add_f32 v111, v111, v119
v_add_f32 v95, v95, v111
v_cvt_pk_bf16_f32 v4, v88, v89
v_lshlrev_b32 v88, 16, v4
v_and_b32 v89, 0xffff0000, v4
v_lshlrev_b32 v5, 16, v224
v_and_b32 v6, 0xffff0000, v224
v_add_f32 v88, v88, v5
v_add_f32 v89, v89, v6
v_cvt_pk_bf16_f32 v4, v90, v91
v_lshlrev_b32 v90, 16, v4
v_and_b32 v91, 0xffff0000, v4
v_lshlrev_b32 v5, 16, v225
v_and_b32 v6, 0xffff0000, v225
v_add_f32 v90, v90, v5
v_add_f32 v91, v91, v6
v_cvt_pk_bf16_f32 v4, v92, v93
v_lshlrev_b32 v92, 16, v4
v_and_b32 v93, 0xffff0000, v4
v_lshlrev_b32 v5, 16, v226
v_and_b32 v6, 0xffff0000, v226
v_add_f32 v92, v92, v5
v_add_f32 v93, v93, v6
v_cvt_pk_bf16_f32 v4, v94, v95
v_lshlrev_b32 v94, 16, v4
v_and_b32 v95, 0xffff0000, v4
v_lshlrev_b32 v5, 16, v227
v_and_b32 v6, 0xffff0000, v227
v_add_f32 v94, v94, v5
v_add_f32 v95, v95, v6
v_cvt_pk_bf16_f32 v4, v88, v89
v_lshlrev_b32 v88, 16, v4
v_and_b32 v89, 0xffff0000, v4
v_lshlrev_b32 v5, 16, v228
v_and_b32 v6, 0xffff0000, v228
v_add_f32 v88, v88, v5
v_add_f32 v89, v89, v6
v_cvt_pk_bf16_f32 v4, v90, v91
v_lshlrev_b32 v90, 16, v4
v_and_b32 v91, 0xffff0000, v4
v_lshlrev_b32 v5, 16, v229
v_and_b32 v6, 0xffff0000, v229
v_add_f32 v90, v90, v5
v_add_f32 v91, v91, v6
v_cvt_pk_bf16_f32 v4, v92, v93
v_lshlrev_b32 v92, 16, v4
v_and_b32 v93, 0xffff0000, v4
v_lshlrev_b32 v5, 16, v230
v_and_b32 v6, 0xffff0000, v230
v_add_f32 v92, v92, v5
v_add_f32 v93, v93, v6
v_cvt_pk_bf16_f32 v4, v94, v95
v_lshlrev_b32 v94, 16, v4
v_and_b32 v95, 0xffff0000, v4
v_lshlrev_b32 v5, 16, v231
v_and_b32 v6, 0xffff0000, v231
v_add_f32 v94, v94, v5
v_add_f32 v95, v95, v6
v_cvt_pk_bf16_f32 v120, v88, v89
v_cvt_pk_bf16_f32 v121, v90, v91
v_cvt_pk_bf16_f32 v122, v92, v93
v_cvt_pk_bf16_f32 v123, v94, v95
buffer_store_dwordx4 v[120:123], v21, s[44:47], s33 offen
s_add_u32 s12, s12, 11
s_cmp_lt_u32 s12, 64
s_cbranch_scc1 J2_54
s_endpgm
QK0:
v_and_b32 v0, 63, v0
v_lshrrev_b32 v1, 4, v0
v_and_b32 v2, 15, v0
v_lshlrev_b32 v9, 4, v0
v_add_u32 v14, 0, v9
v_bfe_u32 v3, v2, 1, 1
v_lshrrev_b32 v4, 2, v2
v_lshlrev_b32 v4, 1, v4
v_and_b32 v5, 1, v2
v_add_u32 v4, v4, v5
v_mul_u32_u24 v8, 0xaaaa, v3
v_add_u32 v8, 0x4444, v8
v_mov_b32 v13, -1
s_mov_b32 s43, 71303168
v_lshlrev_b32 v160, 7, v0
v_lshrrev_b32 v5, 2, v2
v_and_b32 v6, 1, v2
v_lshlrev_b32 v6, 4, v6
v_mov_b32 v7, 0x3f80
v_lshlrev_b32 v6, v6, v7
v_cmp_eq_u32 vcc, v5, v1
s_nop 1
v_cndmask_b32 v6, 0, v6, vcc
v_cmp_eq_u32 vcc, 0, v3
s_nop 1
v_cndmask_b32 v152, 0, v6, vcc
v_cndmask_b32 v153, 0, v6, vcc
v_cndmask_b32 v154, v6, 0, vcc
v_cndmask_b32 v155, v6, 0, vcc
s_mov_b64 s[48:49], vcc
v_mul_u32_u24 v5, 320, v1
v_add_u32 v5, 57344, v5
v_and_b32 v6, 12, v2
v_add_u32 v6, v6, v2
v_lshl_add_u32 v156, v6, 2, v5
v_lshl_add_u32 v5, v4, 2, v5
v_add_u32 v5, 128, v5
v_lshlrev_b32 v6, 2, v2
v_add_u32 v6, 62528, v6
v_cndmask_b32 v157, v6, v5, vcc
v_lshrrev_b32 v3, 5, v0
v_and_b32 v4, 31, v0
v_mul_u32_u24 v5, 160, v3
v_lshl_add_u32 v5, v4, 3, v5
v_add_u32 v5, 57344, v5
v_mov_b32 v6, 58624
v_cmp_gt_u32 vcc, 20, v4
s_nop 1
v_cndmask_b32 v158, v6, v5, vcc
v_mov_b32 v6, 58632
v_cndmask_b32 v161, v6, v5, vcc
v_and_b32 v5, 1, v4
v_lshl_add_u32 v5, v5, 1, v3
v_lshlrev_b32 v5, 4, v5
v_bfe_u32 v6, v4, 3, 1
v_lshl_add_u32 v6, v6, 8, v5
v_bfe_u32 v7, v4, 1, 2
v_lshl_add_u32 v6, v7, 2, v6
s_lshl_b32 s35, s11, 9
s_add_u32 s35, s35, 2048
v_add_u32 v6, s35, v6
v_bfe_u32 v5, v4, 1, 1
v_lshlrev_b32 v5, 8, v5
v_lshl_add_u32 v5, v3, 4, v5
v_and_b32 v7, 1, v4
v_lshl_add_u32 v5, v7, 3, v5
s_lshr_b32 s35, s11, 2
s_lshl_b32 s35, s35, 9
s_and_b32 s36, s11, 1
s_lshl_b32 s36, s36, 5
s_add_u32 s35, s35, s36
s_and_b32 s36, s11, 2
s_lshl_b32 s36, s36, 1
s_add_u32 s35, s35, s36
s_add_u32 s35, s35, 0
v_add_u32 v5, s35, v5
v_mov_b32 v7, 1073741824
v_cndmask_b32 v5, v7, v5, vcc
v_cmp_gt_u32 vcc, 16, v4
s_nop 1
v_cndmask_b32 v159, v5, v6, vcc
s_mov_b32 s35, 55312384
buffer_store_dword v13, v159, s[4:7], s35 offen sc1
s_mov_b32 s35, 55328768
buffer_store_dword v13, v159, s[4:7], s35 offen sc1
s_mov_b32 s35, 55345152
buffer_store_dword v13, v159, s[4:7], s35 offen sc1
s_mov_b32 s35, 55361536
buffer_store_dword v13, v159, s[4:7], s35 offen sc1
v_mov_b32 v5, 58624
v_mov_b32 v6, 0xf149f2ca
ds_write2_b32 v5, v6, v6 offset0:0 offset1:1
v_mul_u32_u24 v12, 640, v0
s_lshl_b32 s35, s11, 2
s_add_u32 s35, s35, 0
v_add_u32 v12, s35, v12
v_mov_b32 v7, 1073741824
v_cmp_gt_u32 vcc, 4, v0
s_nop 1
v_cndmask_b32 v12, v7, v12, vcc
v_mov_b32 v136, 0
v_mov_b32 v137, 0
v_mov_b32 v138, 0
v_mov_b32 v139, 0
s_and_b32 s35, s8, 3
s_mul_i32 s35, s35, 640
s_add_u32 s35, s35, 4224
v_min_u32 v11, 14, v0
v_lshlrev_b32 v11, 2, v11
v_add_u32 v11, s35, v11
s_mul_i32 s40, s11, 0
s_add_u32 s40, s40, 16801792
s_mov_b32 s10, 0
s_mov_b32 s38, 200000
s_mov_b32 s68, 0
s_mov_b32 s69, 0
s_mov_b32 s70, 0
s_mov_b32 s71, 0
v_mov_b32 v3, -1
v_mov_b32 v4, -1
ds_write2_b32 v161, v13, v13 offset0:0 offset1:1
v_add_u32 v5, 1296, v161
ds_write2_b32 v5, v13, v13 offset0:0 offset1:1
v_add_u32 v5, 2592, v161
ds_write2_b32 v5, v13, v13 offset0:0 offset1:1
v_add_u32 v5, 3888, v161
ds_write2_b32 v5, v13, v13 offset0:0 offset1:1
s_waitcnt vmcnt(0) lgkmcnt(0)
s_barrier
s_mov_b32 s34, 71343104
v_lshlrev_b32 v3, 7, v0
s_lshl_b32 s35, s8, 2
v_add_u32 v3, s35, v3
v_mov_b32 v4, 1073741824
v_cmp_gt_u32 vcc, 4, v0
s_nop 1
v_cndmask_b32 v3, v4, v3, vcc
s_add_u32 s35, s66, 1
v_mov_b32 v4, s35
buffer_store_dword v4, v3, s[4:7], s34 offen sc1
v_min_u32 v3, 24, v0
v_lshlrev_b32 v3, 14, v3
s_mul_i32 s34, s11, 401408
s_add_u32 s34, s34, 0
buffer_load_dword v4, v3, s[4:7], s34 offen sc1
s_waitcnt vmcnt(0)
v_min_u32 v3, 13, v2
v_lshlrev_b32 v3, 2, v3
s_lshl_b32 s35, s11, 8
s_add_u32 s35, s35, 17408
v_add_u32 v3, s35, v3
s_mov_b32 s41, 71319552
s_mov_b64 vcc, -1
s_mul_i32 s34, s11, 401408
s_and_b32 s36, vcc_lo, 65535
s_cbranch_scc0 RD_66
RL_65:
buffer_load_dword v4, v3, s[4:7], s41 offen sc1
s_sub_u32 s38, s38, 1
s_cmp_gt_i32 s38, 0
s_cbranch_scc0 RD_66
s_waitcnt vmcnt(0)
v_cmp_ne_u32 vcc, 1, v4
s_nop 0
s_and_b32 s36, vcc_lo, 65535
s_cbranch_scc0 RD_66
s_sleep 2
s_branch RL_65
RD_66:
s_add_u32 s35, s34, 0
buffer_load_dwordx4 a[0:3], v9, s[4:7], s35 offen sc1
buffer_load_dwordx4 a[4:7], v9, s[4:7], s35 offen offset:1024 sc1
s_add_u32 s35, s34, 2048
buffer_load_dwordx4 a[8:11], v9, s[4:7], s35 offen sc1
buffer_load_dwordx4 a[12:15], v9, s[4:7], s35 offen offset:1024 sc1
s_add_u32 s35, s34, 4096
buffer_load_dwordx4 a[16:19], v9, s[4:7], s35 offen sc1
buffer_load_dwordx4 a[20:23], v9, s[4:7], s35 offen offset:1024 sc1
s_add_u32 s35, s34, 6144
buffer_load_dwordx4 a[24:27], v9, s[4:7], s35 offen sc1
buffer_load_dwordx4 a[28:31], v9, s[4:7], s35 offen offset:1024 sc1
s_add_u32 s35, s34, 8192
buffer_load_dwordx4 a[32:35], v9, s[4:7], s35 offen sc1
buffer_load_dwordx4 a[36:39], v9, s[4:7], s35 offen offset:1024 sc1
s_add_u32 s35, s34, 10240
buffer_load_dwordx4 a[40:43], v9, s[4:7], s35 offen sc1
buffer_load_dwordx4 a[44:47], v9, s[4:7], s35 offen offset:1024 sc1
s_add_u32 s35, s34, 12288
buffer_load_dwordx4 a[48:51], v9, s[4:7], s35 offen sc1
buffer_load_dwordx4 a[52:55], v9, s[4:7], s35 offen offset:1024 sc1
s_add_u32 s35, s34, 28672
buffer_load_dwordx4 a[56:59], v9, s[4:7], s35 offen sc1
buffer_load_dwordx4 a[60:63], v9, s[4:7], s35 offen offset:1024 sc1
s_add_u32 s35, s34, 30720
buffer_load_dwordx4 a[64:67], v9, s[4:7], s35 offen sc1
buffer_load_dwordx4 a[68:71], v9, s[4:7], s35 offen offset:1024 sc1
s_add_u32 s35, s34, 32768
buffer_load_dwordx4 a[72:75], v9, s[4:7], s35 offen sc1
buffer_load_dwordx4 a[76:79], v9, s[4:7], s35 offen offset:1024 sc1
s_add_u32 s35, s34, 34816
buffer_load_dwordx4 a[80:83], v9, s[4:7], s35 offen sc1
buffer_load_dwordx4 a[84:87], v9, s[4:7], s35 offen offset:1024 sc1
s_add_u32 s35, s34, 36864
buffer_load_dwordx4 a[88:91], v9, s[4:7], s35 offen sc1
buffer_load_dwordx4 a[92:95], v9, s[4:7], s35 offen offset:1024 sc1
s_add_u32 s35, s34, 38912
buffer_load_dwordx4 a[96:99], v9, s[4:7], s35 offen sc1
buffer_load_dwordx4 a[100:103], v9, s[4:7], s35 offen offset:1024 sc1
s_add_u32 s35, s34, 40960
buffer_load_dwordx4 a[104:107], v9, s[4:7], s35 offen sc1
buffer_load_dwordx4 a[108:111], v9, s[4:7], s35 offen offset:1024 sc1
s_add_u32 s35, s34, 14336
buffer_load_dwordx4 a[112:115], v9, s[4:7], s35 offen sc1
buffer_load_dwordx4 a[116:119], v9, s[4:7], s35 offen offset:1024 sc1
s_add_u32 s35, s34, 16384
buffer_load_dwordx4 a[120:123], v9, s[4:7], s35 offen sc1
buffer_load_dwordx4 a[124:127], v9, s[4:7], s35 offen offset:1024 sc1
s_add_u32 s35, s34, 18432
buffer_load_dwordx4 a[128:131], v9, s[4:7], s35 offen sc1
buffer_load_dwordx4 a[132:135], v9, s[4:7], s35 offen offset:1024 sc1
s_add_u32 s35, s34, 20480
buffer_load_dwordx4 a[136:139], v9, s[4:7], s35 offen sc1
buffer_load_dwordx4 a[140:143], v9, s[4:7], s35 offen offset:1024 sc1
s_add_u32 s35, s34, 22528
buffer_load_dwordx4 a[144:147], v9, s[4:7], s35 offen sc1
buffer_load_dwordx4 a[148:151], v9, s[4:7], s35 offen offset:1024 sc1
s_add_u32 s35, s34, 24576
buffer_load_dwordx4 a[152:155], v9, s[4:7], s35 offen sc1
buffer_load_dwordx4 a[156:159], v9, s[4:7], s35 offen offset:1024 sc1
s_add_u32 s35, s34, 26624
buffer_load_dwordx4 a[160:163], v9, s[4:7], s35 offen sc1
buffer_load_dwordx4 a[164:167], v9, s[4:7], s35 offen offset:1024 sc1
s_add_u32 s35, s34, 43008
buffer_load_dwordx4 a[168:171], v9, s[4:7], s35 offen sc1
buffer_load_dwordx4 a[172:175], v9, s[4:7], s35 offen offset:1024 sc1
s_add_u32 s35, s34, 45056
buffer_load_dwordx4 a[176:179], v9, s[4:7], s35 offen sc1
buffer_load_dwordx4 a[180:183], v9, s[4:7], s35 offen offset:1024 sc1
s_add_u32 s35, s34, 47104
buffer_load_dwordx4 a[184:187], v9, s[4:7], s35 offen sc1
buffer_load_dwordx4 a[188:191], v9, s[4:7], s35 offen offset:1024 sc1
s_add_u32 s35, s34, 49152
buffer_load_dwordx4 a[192:195], v9, s[4:7], s35 offen sc1
buffer_load_dwordx4 a[196:199], v9, s[4:7], s35 offen offset:1024 sc1
s_add_u32 s35, s34, 51200
buffer_load_dwordx4 a[200:203], v9, s[4:7], s35 offen sc1
buffer_load_dwordx4 a[204:207], v9, s[4:7], s35 offen offset:1024 sc1
s_add_u32 s35, s34, 53248
buffer_load_dwordx4 a[208:211], v9, s[4:7], s35 offen sc1
buffer_load_dwordx4 a[212:215], v9, s[4:7], s35 offen offset:1024 sc1
s_add_u32 s35, s34, 55296
buffer_load_dwordx4 a[216:219], v9, s[4:7], s35 offen sc1
buffer_load_dwordx4 a[220:223], v9, s[4:7], s35 offen offset:1024 sc1
s_add_u32 s35, s34, 243712
s_mov_b32 m0, 0
s_nop 0
buffer_load_dwordx4 v9, s[4:7], s35 offen sc1 lds
buffer_load_dwordx4 v9, s[4:7], s35 offen offset:1024 sc1 lds
s_add_u32 s35, s34, 245760
s_mov_b32 m0, 2048
s_nop 0
buffer_load_dwordx4 v9, s[4:7], s35 offen sc1 lds
buffer_load_dwordx4 v9, s[4:7], s35 offen offset:1024 sc1 lds
s_waitcnt vmcnt(40)
s_add_u32 s35, s34, 247808
s_mov_b32 m0, 4096
s_nop 0
buffer_load_dwordx4 v9, s[4:7], s35 offen sc1 lds
buffer_load_dwordx4 v9, s[4:7], s35 offen offset:1024 sc1 lds
s_add_u32 s35, s34, 249856
s_mov_b32 m0, 6144
s_nop 0
buffer_load_dwordx4 v9, s[4:7], s35 offen sc1 lds
buffer_load_dwordx4 v9, s[4:7], s35 offen offset:1024 sc1 lds
s_add_u32 s35, s34, 251904
s_mov_b32 m0, 8192
s_nop 0
buffer_load_dwordx4 v9, s[4:7], s35 offen sc1 lds
buffer_load_dwordx4 v9, s[4:7], s35 offen offset:1024 sc1 lds
s_add_u32 s35, s34, 253952
s_mov_b32 m0, 10240
s_nop 0
buffer_load_dwordx4 v9, s[4:7], s35 offen sc1 lds
buffer_load_dwordx4 v9, s[4:7], s35 offen offset:1024 sc1 lds
s_add_u32 s35, s34, 256000
s_mov_b32 m0, 12288
s_nop 0
buffer_load_dwordx4 v9, s[4:7], s35 offen sc1 lds
buffer_load_dwordx4 v9, s[4:7], s35 offen offset:1024 sc1 lds
s_add_u32 s35, s34, 272384
buffer_load_dwordx4 a[224:227], v9, s[4:7], s35 offen sc1
buffer_load_dwordx4 a[228:231], v9, s[4:7], s35 offen offset:1024 sc1
s_add_u32 s35, s34, 274432
buffer_load_dwordx4 a[232:235], v9, s[4:7], s35 offen sc1
buffer_load_dwordx4 a[236:239], v9, s[4:7], s35 offen offset:1024 sc1
s_add_u32 s35, s34, 276480
buffer_load_dwordx4 a[240:243], v9, s[4:7], s35 offen sc1
buffer_load_dwordx4 a[244:247], v9, s[4:7], s35 offen offset:1024 sc1
s_add_u32 s35, s34, 278528
buffer_load_dwordx4 a[248:251], v9, s[4:7], s35 offen sc1
buffer_load_dwordx4 a[252:255], v9, s[4:7], s35 offen offset:1024 sc1
s_add_u32 s35, s34, 280576
buffer_load_dwordx4 v[164:167], v9, s[4:7], s35 offen sc1
buffer_load_dwordx4 v[168:171], v9, s[4:7], s35 offen offset:1024 sc1
s_waitcnt vmcnt(40)
s_add_u32 s35, s34, 282624
buffer_load_dwordx4 v[172:175], v9, s[4:7], s35 offen sc1
buffer_load_dwordx4 v[176:179], v9, s[4:7], s35 offen offset:1024 sc1
s_add_u32 s35, s34, 284672
buffer_load_dwordx4 v[180:183], v9, s[4:7], s35 offen sc1
buffer_load_dwordx4 v[184:187], v9, s[4:7], s35 offen offset:1024 sc1
s_add_u32 s35, s34, 258048
buffer_load_dwordx4 v[188:191], v9, s[4:7], s35 offen sc1
buffer_load_dwordx4 v[192:195], v9, s[4:7], s35 offen offset:1024 sc1
s_add_u32 s35, s34, 260096
buffer_load_dwordx4 v[196:199], v9, s[4:7], s35 offen sc1
buffer_load_dwordx4 v[200:203], v9, s[4:7], s35 offen offset:1024 sc1
s_add_u32 s35, s34, 262144
buffer_load_dwordx4 v[204:207], v9, s[4:7], s35 offen sc1
buffer_load_dwordx4 v[208:211], v9, s[4:7], s35 offen offset:1024 sc1
s_add_u32 s35, s34, 264192
buffer_load_dwordx4 v[212:215], v9, s[4:7], s35 offen sc1
buffer_load_dwordx4 v[216:219], v9, s[4:7], s35 offen offset:1024 sc1
s_add_u32 s35, s34, 266240
buffer_load_dwordx4 v[220:223], v9, s[4:7], s35 offen sc1
buffer_load_dwordx4 v[224:227], v9, s[4:7], s35 offen offset:1024 sc1
s_add_u32 s35, s34, 268288
buffer_load_dwordx4 v[228:231], v9, s[4:7], s35 offen sc1
buffer_load_dwordx4 v[232:235], v9, s[4:7], s35 offen offset:1024 sc1
s_add_u32 s35, s34, 270336
buffer_load_dwordx4 v[236:239], v9, s[4:7], s35 offen sc1
buffer_load_dwordx4 v[240:243], v9, s[4:7], s35 offen offset:1024 sc1
s_mov_b32 s34, 71343104
v_and_b32 v3, 31, v0
v_lshlrev_b32 v3, 2, v3
s_and_b32 s35, s8, 3
s_lshl_b32 s35, s35, 7
s_add_u32 s34, s34, s35
TB_67:
buffer_load_dword v5, v3, s[4:7], s34 offen sc1
s_sub_u32 s38, s38, 1
s_cmp_gt_i32 s38, 0
s_cbranch_scc0 TBD_68
s_waitcnt vmcnt(0)
v_cmp_eq_u32 vcc, 0, v5
s_cbranch_vccz TBD_68
s_sleep 4
s_branch TB_67
TBD_68:
v_cmp_lt_u32 vcc, 1, v5
s_nop 0
s_or_b32 s66, vcc_lo, vcc_hi
v_mov_b32 v4, s66
v_mov_b32 v3, 151552
ds_write_b32 v3, v4
s_waitcnt lgkmcnt(0)
s_barrier
v_mov_b32 v3, 151552
ds_read_b32 v4, v3
s_waitcnt lgkmcnt(0)
v_readfirstlane_b32 s66, v4
s_lshl_b32 s52, s10, 15
s_add_u32 s52, s52, 50331648
buffer_load_dwordx4 v[104:107], v9, s[4:7], s52 offen offset:0 sc1
buffer_load_dwordx4 v[108:111], v9, s[4:7], s52 offen offset:1024 sc1
buffer_load_dwordx4 v[112:115], v9, s[4:7], s52 offen offset:2048 sc1
buffer_load_dwordx4 v[116:119], v9, s[4:7], s52 offen offset:3072 sc1
s_waitcnt vmcnt(4)
v_mov_b32 v60, 0
v_mov_b32 v61, 0
v_mov_b32 v62, 0
v_mov_b32 v63, 0
v_mov_b32 v64, 0
v_mov_b32 v65, 0
v_mov_b32 v66, 0
v_mov_b32 v67, 0
v_mov_b32 v68, 0
v_mov_b32 v69, 0
v_mov_b32 v70, 0
v_mov_b32 v71, 0
v_mov_b32 v72, 0
v_mov_b32 v73, 0
v_mov_b32 v74, 0
v_mov_b32 v75, 0
v_mov_b32 v76, 0
v_mov_b32 v77, 0
v_mov_b32 v78, 0
v_mov_b32 v79, 0
v_mov_b32 v80, 0
v_mov_b32 v81, 0
v_mov_b32 v82, 0
v_mov_b32 v83, 0
v_mov_b32 v84, 0
v_mov_b32 v85, 0
v_mov_b32 v86, 0
v_mov_b32 v87, 0
v_mov_b32 v140, 0
v_mov_b32 v141, 0
v_mov_b32 v142, 0
v_mov_b32 v143, 0
v_mov_b32 v144, 0
v_mov_b32 v145, 0
v_mov_b32 v146, 0
v_mov_b32 v147, 0
s_lshl_b32 s26, s10, 13
s_add_u32 s26, s26, 54525952
s_add_u32 s27, s26, 4096
LOOP_69:
buffer_load_dwordx4 v[16:19], v9, s[4:7], s26 offen offset:0 sc1
s_barrier
ds_read_b128 v[44:47], v14 offset:0
ds_read_b128 v[48:51], v14 offset:1024
ds_read_b128 v[52:55], v14 offset:2048
ds_read_b128 v[56:59], v14 offset:3072
s_add_u32 s39, s10, 1
s_barrier
buffer_load_dwordx4 v[20:23], v9, s[4:7], s26 offen offset:1024
s_mov_b64 s[50:51], -1
v_mov_b32 v10, s39
s_and_b32 s34, s10, 3
s_lshl_b32 s28, s34, 14
s_add_u32 s28, s28, 55312384
s_barrier
buffer_load_dwordx4 v[24:27], v9, s[4:7], s26 offen offset:2048
s_xor_b32 s29, s28, 32768
s_min_u32 s37, s39, 63
s_add_u32 s53, s52, 4096
s_lshl_b32 s52, s37, 15
s_add_u32 s52, s52, 50331648
s_barrier
buffer_load_dwordx4 v[28:31], v9, s[4:7], s26 offen offset:3072
s_waitcnt vmcnt(3)
v_smfmac_f32_16x16x64_bf16 v[60:63], v[16:19], a[0:7], v8
buffer_load_dwordx4 v[32:35], v9, s[4:7], s27 offen offset:0
v_cmp_eq_u32 vcc, -1, v16
v_smfmac_f32_16x16x64_bf16 v[64:67], v[16:19], a[56:63], v8
v_smfmac_f32_16x16x64_bf16 v[68:71], v[16:19], a[112:119], v8
s_cbranch_vccnz RT_73
BK_74:
v_smfmac_f32_16x16x64_bf16 v[72:75], v[16:19], a[168:175], v8
s_waitcnt lgkmcnt(2)
v_smfmac_f32_16x16x64_bf16 v[76:79], v[16:19], v[44:51], v8
s_waitcnt vmcnt(3)
v_smfmac_f32_16x16x64_bf16 v[60:63], v[20:23], a[8:15], v8
buffer_load_dwordx4 v[36:39], v9, s[4:7], s27 offen offset:1024
v_smfmac_f32_16x16x64_bf16 v[64:67], v[20:23], a[64:71], v8
ds_read_b128 v[44:47], v14 offset:4096
v_smfmac_f32_16x16x64_bf16 v[68:71], v[20:23], a[120:127], v8
ds_read_b128 v[48:51], v14 offset:5120
v_smfmac_f32_16x16x64_bf16 v[72:75], v[20:23], a[176:183], v8
s_waitcnt lgkmcnt(2)
v_smfmac_f32_16x16x64_bf16 v[76:79], v[20:23], v[52:59], v8
s_waitcnt vmcnt(3)
v_smfmac_f32_16x16x64_bf16 v[60:63], v[24:27], a[16:23], v8
buffer_load_dwordx4 v[40:43], v9, s[4:7], s27 offen offset:2048
v_smfmac_f32_16x16x64_bf16 v[64:67], v[24:27], a[72:79], v8
ds_read_b128 v[52:55], v14 offset:6144
v_smfmac_f32_16x16x64_bf16 v[68:71], v[24:27], a[128:135], v8
ds_read_b128 v[56:59], v14 offset:7168
v_smfmac_f32_16x16x64_bf16 v[72:75], v[24:27], a[184:191], v8
s_waitcnt lgkmcnt(2)
v_smfmac_f32_16x16x64_bf16 v[76:79], v[24:27], v[44:51], v8
s_waitcnt vmcnt(3)
v_smfmac_f32_16x16x64_bf16 v[60:63], v[28:31], a[24:31], v8
buffer_load_dwordx4 v[120:123], v9, s[4:7], s53 offen offset:0 sc1
v_smfmac_f32_16x16x64_bf16 v[64:67], v[28:31], a[80:87], v8
ds_read_b128 v[44:47], v14 offset:8192
v_smfmac_f32_16x16x64_bf16 v[68:71], v[28:31], a[136:143], v8
ds_read_b128 v[48:51], v14 offset:9216
v_smfmac_f32_16x16x64_bf16 v[72:75], v[28:31], a[192:199], v8
s_waitcnt lgkmcnt(2)
v_smfmac_f32_16x16x64_bf16 v[76:79], v[28:31], v[52:59], v8
buffer_load_dwordx4 v[124:127], v9, s[4:7], s53 offen offset:1024 sc1
s_waitcnt vmcnt(4)
v_smfmac_f32_16x16x64_bf16 v[60:63], v[32:35], a[32:39], v8
ds_read_b128 v[52:55], v14 offset:10240
v_smfmac_f32_16x16x64_bf16 v[64:67], v[32:35], a[88:95], v8
ds_read_b128 v[56:59], v14 offset:11264
v_smfmac_f32_16x16x64_bf16 v[68:71], v[32:35], a[144:151], v8
v_smfmac_f32_16x16x64_bf16 v[72:75], v[32:35], a[200:207], v8
buffer_load_dwordx4 v[128:131], v9, s[4:7], s53 offen offset:2048 sc1
s_waitcnt lgkmcnt(2)
v_smfmac_f32_16x16x64_bf16 v[76:79], v[32:35], v[44:51], v8
s_waitcnt vmcnt(4)
v_smfmac_f32_16x16x64_bf16 v[60:63], v[36:39], a[40:47], v8
ds_read_b128 v[44:47], v14 offset:12288
v_smfmac_f32_16x16x64_bf16 v[64:67], v[36:39], a[96:103], v8
ds_read_b128 v[48:51], v14 offset:13312
v_smfmac_f32_16x16x64_bf16 v[68:71], v[36:39], a[152:159], v8
buffer_load_dwordx4 v[132:135], v9, s[4:7], s53 offen offset:3072 sc1
v_smfmac_f32_16x16x64_bf16 v[72:75], v[36:39], a[208:215], v8
s_waitcnt lgkmcnt(2)
v_smfmac_f32_16x16x64_bf16 v[76:79], v[36:39], v[52:59], v8
s_waitcnt vmcnt(4)
v_smfmac_f32_16x16x64_bf16 v[60:63], v[40:43], a[48:55], v8
v_smfmac_f32_16x16x64_bf16 v[64:67], v[40:43], a[104:111], v8
v_smfmac_f32_16x16x64_bf16 v[68:71], v[40:43], a[160:167], v8
v_cvt_pk_bf16_f32 v60, v60, v61
v_smfmac_f32_16x16x64_bf16 v[72:75], v[40:43], a[216:223], v8
s_waitcnt lgkmcnt(0)
v_cvt_pk_bf16_f32 v61, v62, v63
v_smfmac_f32_16x16x64_bf16 v[76:79], v[40:43], v[44:51], v8
v_cvt_pk_bf16_f32 v62, v64, v65
JOIN_72:
v_smfmac_f32_16x16x64_bf16 v[80:83], v[16:19], a[224:231], v8
v_cvt_pk_bf16_f32 v63, v66, v67
v_smfmac_f32_16x16x64_bf16 v[80:83], v[20:23], a[232:239], v8
v_cvt_pk_bf16_f32 v68, v68, v69
v_mfma_f32_16x16x32_bf16 v[88:91], v[60:63], v[152:155], 0
v_cvt_pk_bf16_f32 v69, v70, v71
v_cvt_pk_bf16_f32 v70, v72, v73
v_smfmac_f32_16x16x64_bf16 v[80:83], v[24:27], a[240:247], v8
v_cvt_pk_bf16_f32 v71, v74, v75
v_smfmac_f32_16x16x64_bf16 v[80:83], v[28:31], a[248:255], v8
v_cvt_pk_bf16_f32 v76, v76, v77
v_mfma_f32_16x16x32_bf16 v[92:95], v[68:71], v[152:155], 0
v_cvt_pk_bf16_f32 v96, v88, v89
v_cvt_pk_bf16_f32 v97, v90, v91
v_smfmac_f32_16x16x64_bf16 v[80:83], v[32:35], v[164:171], v8
v_cmp_u_f32 vcc, v88, v89
v_smfmac_f32_16x16x64_bf16 v[80:83], v[36:39], v[172:179], v8
v_cvt_pk_bf16_f32 v77, v78, v79
v_smfmac_f32_16x16x64_bf16 v[80:83], v[40:43], v[180:187], v8
v_cvt_pk_bf16_f32 v98, v92, v93
v_smfmac_f32_16x16x64_bf16 v[84:87], v[16:19], v[188:195], v8
v_cvt_pk_bf16_f32 v99, v94, v95
v_smfmac_f32_16x16x64_bf16 v[84:87], v[20:23], v[196:203], v8
s_and_b64 vcc, vcc, s[50:51]
s_cbranch_scc1 FAIL_71
v_smfmac_f32_16x16x64_bf16 v[84:87], v[24:27], v[204:211], v8
v_cvt_pk_bf16_f32 v78, v80, v81
v_smfmac_f32_16x16x64_bf16 v[84:87], v[28:31], v[212:219], v8
v_cvt_pk_bf16_f32 v79, v82, v83
v_smfmac_f32_16x16x64_bf16 v[84:87], v[32:35], v[220:227], v8
v_mov_b32 v60, 0
v_smfmac_f32_16x16x64_bf16 v[84:87], v[36:39], v[228:235], v8
v_mov_b32 v61, 0
v_smfmac_f32_16x16x64_bf16 v[84:87], v[40:43], v[236:243], v8
v_mov_b32 v62, 0
v_mfma_f32_16x16x32_bf16 v[92:95], v[76:79], v[152:155], 0
v_mov_b32 v63, 0
v_mov_b32 v64, 0
v_mfma_f32_16x16x32_bf16 v[148:151], v[96:99], v[16:19], 0
v_cvt_pk_bf16_f32 v138, v84, v85
v_cvt_pk_bf16_f32 v139, v86, v87
v_mov_b32 v65, 0
s_nop 0
v_cvt_pk_bf16_f32 v102, v92, v93
v_mfma_f32_16x16x32_bf16 v[88:91], v[136:139], v[152:155], 0
v_cvt_pk_bf16_f32 v103, v94, v95
v_mov_b32 v66, 0
v_smfmac_f32_16x16x64_bf16 v[140:143], v[96:99], v[104:111], v8
v_mov_b32 v67, 0
v_smfmac_f32_16x16x64_bf16 v[144:147], v[96:99], v[112:119], v8
v_cvt_pk_bf16_f32 v100, v88, v89
v_cvt_pk_bf16_f32 v101, v90, v91
v_mov_b32 v68, 0
s_waitcnt vmcnt(2)
v_smfmac_f32_16x16x64_bf16 v[140:143], v[100:103], v[120:127], v8
s_waitcnt vmcnt(0)
v_smfmac_f32_16x16x64_bf16 v[144:147], v[100:103], v[128:135], v8
v_mfma_f32_16x16x32_bf16 v[148:151], v[100:103], v[32:35], v[148:151]
v_add_f32 v140, v140, v142
v_add_f32 v141, v141, v143
ds_write2_b32 v156, v140, v141 offset0:0 offset1:40
s_nop 0
v_add_f32 v144, v144, v146
v_add_f32 v145, v145, v147
ds_write2_b32 v156, v144, v145 offset0:4 offset1:44
s_nop 0
v_add_f32_dpp v148, v150, v148 quad_perm:[2,3,0,1] row_mask:0xf bank_mask:0xf
v_add_f32_dpp v149, v151, v149 quad_perm:[2,3,0,1] row_mask:0xf bank_mask:0xf
ds_write2_b32 v157, v148, v149 offset0:0 offset1:40
v_mov_b32 v69, 0
v_mov_b32 v70, 0
v_mov_b32 v71, 0
v_mov_b32 v72, 0
s_barrier
ds_read_b64 v[16:17], v158 offset:0
v_mov_b32 v73, 0
ds_read_b64 v[18:19], v158 offset:1296
ds_read_b64 v[20:21], v158 offset:2592
v_mov_b32 v74, 0
ds_read_b64 v[22:23], v158 offset:3888
v_mov_b32 v75, 0
v_mov_b32 v76, 0
v_mov_b32 v77, 0
v_mov_b32 v78, 0
v_mov_b32 v79, 0
s_waitcnt lgkmcnt(2)
v_add_f32 v16, v16, v18
v_add_f32 v17, v17, v19
s_waitcnt lgkmcnt(0)
v_add_f32 v20, v20, v22
v_add_f32 v21, v21, v23
v_add_f32 v16, v16, v20
v_add_f32 v17, v17, v21
v_exp_f32 v24, v16
v_exp_f32 v25, v17
s_nop 0
v_add_f32 v3, v24, v25
v_mov_b32 v80, 0
v_mov_b32 v81, 0
v_add_f32_dpp v3, v3, v3 quad_perm:[1,0,3,2] row_mask:0xf bank_mask:0xf
v_mov_b32 v82, 0
v_mov_b32 v83, 0
v_add_f32_dpp v3, v3, v3 quad_perm:[2,3,0,1] row_mask:0xf bank_mask:0xf
v_mov_b32 v84, 0
v_mov_b32 v85, 0
v_add_f32_dpp v3, v3, v3 row_half_mirror row_mask:0xf bank_mask:0xf
v_mov_b32 v86, 0
v_mov_b32 v87, 0
v_add_f32_dpp v3, v3, v3 row_mirror row_mask:0xf bank_mask:0xf
v_mov_b32 v4, v3
s_nop 1
v_permlane16_swap_b32 v3, v4
v_add_f32 v3, v3, v4
v_rcp_f32 v26, v3
v_subrev_u32 v3, 0x21800000, v3
v_mul_f32 v24, v24, v26
v_mul_f32 v25, v25, v26
v_cvt_pk_bf16_f32 v4, v24, v25
v_cmpx_gt_u32 vcc, 0x50000000, v3
buffer_store_dword v4, v159, s[4:7], s28 offen
s_mov_b64 exec, -1
s_cmp_lg_u64 vcc, -1
s_cbranch_scc1 FB_75
FD_76:
s_cmp_lg_u32 s66, 0
s_cbranch_scc1 SL_77
SB_78:
s_barrier
buffer_store_dword v13, v159, s[4:7], s29 offen
s_cmp_lg_u32 s66, 0
s_cbranch_scc1 SL_79
SB_80:
buffer_load_dwordx4 v[104:107], v9, s[4:7], s52 offen offset:0 sc1
buffer_load_dwordx4 v[108:111], v9, s[4:7], s52 offen offset:1024 sc1
buffer_load_dwordx4 v[112:115], v9, s[4:7], s52 offen offset:2048 sc1
buffer_load_dwordx4 v[116:119], v9, s[4:7], s52 offen offset:3072 sc1
v_mov_b32 v16, -1
v_mov_b32 v17, -1
ds_write_b64 v161, v[16:17] offset:0
ds_write_b64 v161, v[16:17] offset:1296
ds_write_b64 v161, v[16:17] offset:2592
ds_write_b64 v161, v[16:17] offset:3888
s_waitcnt lgkmcnt(0)
v_mov_b32 v140, 0
v_mov_b32 v141, 0
v_mov_b32 v142, 0
v_mov_b32 v143, 0
v_mov_b32 v144, 0
v_mov_b32 v145, 0
v_mov_b32 v146, 0
v_mov_b32 v147, 0
s_add_u32 s10, s10, 1
s_lshl_b32 s26, s10, 13
s_add_u32 s26, s26, 54525952
s_add_u32 s27, s26, 4096
s_cmp_ge_u32 s10, 63
s_cbranch_scc1 END_70
s_waitcnt vmcnt(0)
buffer_load_dword v88, v11, s[4:7], s43 offen sc1
buffer_load_dword v89, v11, s[4:7], s43 offen sc1
buffer_load_dword v90, v11, s[4:7], s43 offen sc1
buffer_load_dword v91, v11, s[4:7], s43 offen sc1
PL_81:
s_waitcnt vmcnt(3)
v_cmp_gt_u32 vcc, s39, v88
buffer_load_dword v88, v11, s[4:7], s43 offen sc1
s_cbranch_vccz LOOP_69
s_waitcnt vmcnt(3)
v_cmp_gt_u32 vcc, s39, v89
buffer_load_dword v89, v11, s[4:7], s43 offen sc1
s_cbranch_vccz LOOP_69
s_waitcnt vmcnt(3)
v_cmp_gt_u32 vcc, s39, v90
buffer_load_dword v90, v11, s[4:7], s43 offen sc1
s_cbranch_vccz LOOP_69
s_waitcnt vmcnt(3)
v_cmp_gt_u32 vcc, s39, v91
buffer_load_dword v91, v11, s[4:7], s43 offen sc1
s_cbranch_vccz LOOP_69
s_sub_u32 s38, s38, 1
s_cmp_gt_i32 s38, 0
s_cbranch_scc1 PL_81
GO_82:
s_branch LOOP_69
END_70:
s_endpgm
RT_73:
buffer_load_dwordx4 v[16:19], v9, s[4:7], s26 offen offset:0 sc1
buffer_load_dwordx4 v[20:23], v9, s[4:7], s26 offen offset:1024 sc1
buffer_load_dwordx4 v[24:27], v9, s[4:7], s26 offen offset:2048 sc1
buffer_load_dwordx4 v[28:31], v9, s[4:7], s26 offen offset:3072 sc1
buffer_load_dwordx4 v[32:35], v9, s[4:7], s27 offen offset:0 sc1
s_sub_u32 s38, s38, 1
s_cmp_gt_i32 s38, 0
s_cbranch_scc0 END_70
v_mov_b32 v60, 0
v_mov_b32 v61, 0
v_mov_b32 v62, 0
v_mov_b32 v63, 0
v_mov_b32 v64, 0
v_mov_b32 v65, 0
v_mov_b32 v66, 0
v_mov_b32 v67, 0
v_mov_b32 v68, 0
v_mov_b32 v69, 0
v_mov_b32 v70, 0
v_mov_b32 v71, 0
s_waitcnt vmcnt(0)
v_cmp_eq_u32 vcc, -1, v16
s_cbranch_vccnz RT_73
v_smfmac_f32_16x16x64_bf16 v[60:63], v[16:19], a[0:7], v8
v_smfmac_f32_16x16x64_bf16 v[64:67], v[16:19], a[56:63], v8
v_smfmac_f32_16x16x64_bf16 v[68:71], v[16:19], a[112:119], v8
s_branch BK_74
FAIL_71:
s_mov_b64 s[50:51], 0
FAIL_71b:
buffer_load_dwordx4 v[16:19], v9, s[4:7], s26 offen offset:0 sc1
buffer_load_dwordx4 v[20:23], v9, s[4:7], s26 offen offset:1024 sc1
buffer_load_dwordx4 v[24:27], v9, s[4:7], s26 offen offset:2048 sc1
buffer_load_dwordx4 v[28:31], v9, s[4:7], s26 offen offset:3072 sc1
buffer_load_dwordx4 v[32:35], v9, s[4:7], s27 offen offset:0 sc1
buffer_load_dwordx4 v[36:39], v9, s[4:7], s27 offen offset:1024 sc1
buffer_load_dwordx4 v[40:43], v9, s[4:7], s27 offen offset:2048 sc1
s_sub_u32 s38, s38, 1
s_cmp_gt_i32 s38, 0
s_cbranch_scc0 END_70
v_mov_b32 v60, 0
v_mov_b32 v61, 0
v_mov_b32 v62, 0
v_mov_b32 v63, 0
v_mov_b32 v64, 0
v_mov_b32 v65, 0
v_mov_b32 v66, 0
v_mov_b32 v67, 0
v_mov_b32 v68, 0
v_mov_b32 v69, 0
v_mov_b32 v70, 0
v_mov_b32 v71, 0
v_mov_b32 v72, 0
v_mov_b32 v73, 0
v_mov_b32 v74, 0
v_mov_b32 v75, 0
v_mov_b32 v76, 0
v_mov_b32 v77, 0
v_mov_b32 v78, 0
v_mov_b32 v79, 0
v_mov_b32 v80, 0
v_mov_b32 v81, 0
v_mov_b32 v82, 0
v_mov_b32 v83, 0
v_mov_b32 v84, 0
v_mov_b32 v85, 0
v_mov_b32 v86, 0
v_mov_b32 v87, 0
ds_read_b128 v[44:47], v14 offset:0
ds_read_b128 v[48:51], v14 offset:1024
ds_read_b128 v[52:55], v14 offset:2048
ds_read_b128 v[56:59], v14 offset:3072
s_waitcnt vmcnt(0)
v_max3_u32 v3, v16, v17, v18
v_max3_u32 v3, v3, v19, v20
v_max3_u32 v3, v3, v21, v22
v_max3_u32 v3, v3, v23, v24
v_max3_u32 v3, v3, v25, v26
v_max3_u32 v3, v3, v27, v28
v_max3_u32 v3, v3, v29, v30
v_max3_u32 v3, v3, v31, v32
v_max3_u32 v3, v3, v33, v34
v_max3_u32 v3, v3, v35, v36
v_max3_u32 v3, v3, v37, v38
v_max3_u32 v3, v3, v39, v40
v_max3_u32 v3, v3, v41, v42
v_max_u32 v3, v3, v43
v_cmp_eq_u32 vcc, -1, v3
s_cbranch_vccnz FAIL_71b
s_waitcnt lgkmcnt(2)
v_smfmac_f32_16x16x64_bf16 v[60:63], v[16:19], a[0:7], v8
v_smfmac_f32_16x16x64_bf16 v[64:67], v[16:19], a[56:63], v8
v_smfmac_f32_16x16x64_bf16 v[68:71], v[16:19], a[112:119], v8
v_smfmac_f32_16x16x64_bf16 v[72:75], v[16:19], a[168:175], v8
v_smfmac_f32_16x16x64_bf16 v[76:79], v[16:19], v[44:51], v8
ds_read_b128 v[44:47], v14 offset:4096
ds_read_b128 v[48:51], v14 offset:5120
s_waitcnt lgkmcnt(2)
v_smfmac_f32_16x16x64_bf16 v[60:63], v[20:23], a[8:15], v8
v_smfmac_f32_16x16x64_bf16 v[64:67], v[20:23], a[64:71], v8
v_smfmac_f32_16x16x64_bf16 v[68:71], v[20:23], a[120:127], v8
v_smfmac_f32_16x16x64_bf16 v[72:75], v[20:23], a[176:183], v8
v_smfmac_f32_16x16x64_bf16 v[76:79], v[20:23], v[52:59], v8
ds_read_b128 v[52:55], v14 offset:6144
ds_read_b128 v[56:59], v14 offset:7168
s_waitcnt lgkmcnt(2)
v_smfmac_f32_16x16x64_bf16 v[60:63], v[24:27], a[16:23], v8
v_smfmac_f32_16x16x64_bf16 v[64:67], v[24:27], a[72:79], v8
v_smfmac_f32_16x16x64_bf16 v[68:71], v[24:27], a[128:135], v8
v_smfmac_f32_16x16x64_bf16 v[72:75], v[24:27], a[184:191], v8
v_smfmac_f32_16x16x64_bf16 v[76:79], v[24:27], v[44:51], v8
ds_read_b128 v[44:47], v14 offset:8192
ds_read_b128 v[48:51], v14 offset:9216
s_waitcnt lgkmcnt(2)
v_smfmac_f32_16x16x64_bf16 v[60:63], v[28:31], a[24:31], v8
v_smfmac_f32_16x16x64_bf16 v[64:67], v[28:31], a[80:87], v8
v_smfmac_f32_16x16x64_bf16 v[68:71], v[28:31], a[136:143], v8
v_smfmac_f32_16x16x64_bf16 v[72:75], v[28:31], a[192:199], v8
v_smfmac_f32_16x16x64_bf16 v[76:79], v[28:31], v[52:59], v8
ds_read_b128 v[52:55], v14 offset:10240
ds_read_b128 v[56:59], v14 offset:11264
s_waitcnt lgkmcnt(2)
v_smfmac_f32_16x16x64_bf16 v[60:63], v[32:35], a[32:39], v8
v_smfmac_f32_16x16x64_bf16 v[64:67], v[32:35], a[88:95], v8
v_smfmac_f32_16x16x64_bf16 v[68:71], v[32:35], a[144:151], v8
v_smfmac_f32_16x16x64_bf16 v[72:75], v[32:35], a[200:207], v8
v_smfmac_f32_16x16x64_bf16 v[76:79], v[32:35], v[44:51], v8
ds_read_b128 v[44:47], v14 offset:12288
ds_read_b128 v[48:51], v14 offset:13312
s_waitcnt lgkmcnt(2)
v_smfmac_f32_16x16x64_bf16 v[60:63], v[36:39], a[40:47], v8
v_smfmac_f32_16x16x64_bf16 v[64:67], v[36:39], a[96:103], v8
v_smfmac_f32_16x16x64_bf16 v[68:71], v[36:39], a[152:159], v8
v_smfmac_f32_16x16x64_bf16 v[72:75], v[36:39], a[208:215], v8
v_smfmac_f32_16x16x64_bf16 v[76:79], v[36:39], v[52:59], v8
s_waitcnt lgkmcnt(0)
v_smfmac_f32_16x16x64_bf16 v[60:63], v[40:43], a[48:55], v8
v_smfmac_f32_16x16x64_bf16 v[64:67], v[40:43], a[104:111], v8
v_smfmac_f32_16x16x64_bf16 v[68:71], v[40:43], a[160:167], v8
v_smfmac_f32_16x16x64_bf16 v[72:75], v[40:43], a[216:223], v8
v_smfmac_f32_16x16x64_bf16 v[76:79], v[40:43], v[44:51], v8
v_cvt_pk_bf16_f32 v60, v60, v61
v_cvt_pk_bf16_f32 v61, v62, v63
v_cvt_pk_bf16_f32 v62, v64, v65
s_nop 7
s_branch JOIN_72
FB_75:
ds_read_b64 v[16:17], v158 offset:0
ds_read_b64 v[18:19], v158 offset:1296
ds_read_b64 v[20:21], v158 offset:2592
ds_read_b64 v[22:23], v158 offset:3888
s_sub_u32 s38, s38, 1
s_cmp_gt_i32 s38, 0
s_cbranch_scc0 FD_76
s_waitcnt lgkmcnt(0)
v_max3_u32 v3, v16, v17, v18
v_max3_u32 v3, v3, v19, v20
v_max3_u32 v3, v3, v21, v22
v_max_u32 v3, v3, v23
v_cmp_eq_u32 vcc, -1, v3
s_cbranch_vccnz FB_75
s_waitcnt lgkmcnt(2)
v_add_f32 v16, v16, v18
v_add_f32 v17, v17, v19
s_waitcnt lgkmcnt(0)
v_add_f32 v20, v20, v22
v_add_f32 v21, v21, v23
v_add_f32 v16, v16, v20
v_add_f32 v17, v17, v21
v_max_f32 v3, v16, v17
s_nop 1
v_max_f32_dpp v3, v3, v3 quad_perm:[1,0,3,2] row_mask:0xf bank_mask:0xf
s_nop 1
v_max_f32_dpp v3, v3, v3 quad_perm:[2,3,0,1] row_mask:0xf bank_mask:0xf
s_nop 1
v_max_f32_dpp v3, v3, v3 row_half_mirror row_mask:0xf bank_mask:0xf
s_nop 1
v_max_f32_dpp v3, v3, v3 row_mirror row_mask:0xf bank_mask:0xf
v_mov_b32 v4, v3
s_nop 1
v_permlane16_swap_b32 v3, v4
v_max_f32 v3, v3, v4
v_sub_f32 v24, v16, v3
v_sub_f32 v25, v17, v3
v_exp_f32 v24, v24
v_exp_f32 v25, v25
s_nop 0
v_add_f32 v3, v24, v25
s_nop 1
v_add_f32_dpp v3, v3, v3 quad_perm:[1,0,3,2] row_mask:0xf bank_mask:0xf
s_nop 1
v_add_f32_dpp v3, v3, v3 quad_perm:[2,3,0,1] row_mask:0xf bank_mask:0xf
s_nop 1
v_add_f32_dpp v3, v3, v3 row_half_mirror row_mask:0xf bank_mask:0xf
s_nop 1
v_add_f32_dpp v3, v3, v3 row_mirror row_mask:0xf bank_mask:0xf
v_mov_b32 v4, v3
s_nop 1
v_permlane16_swap_b32 v3, v4
v_add_f32 v3, v3, v4
v_rcp_f32 v26, v3
v_subrev_u32 v3, 0x21800000, v3
v_mul_f32 v24, v24, v26
v_mul_f32 v25, v25, v26
v_cvt_pk_bf16_f32 v4, v24, v25
buffer_store_dword v4, v159, s[4:7], s28 offen
s_branch FD_76
SL_77:
buffer_store_dword v4, v159, s[4:7], s28 offen sc1
s_branch SB_78
SL_79:
buffer_store_dword v13, v159, s[4:7], s29 offen sc1
s_branch SB_80
QK1:
v_and_b32 v0, 63, v0
v_lshrrev_b32 v1, 4, v0
v_and_b32 v2, 15, v0
v_lshlrev_b32 v9, 4, v0
v_add_u32 v14, 14336, v9
v_bfe_u32 v3, v2, 1, 1
v_lshrrev_b32 v4, 2, v2
v_lshlrev_b32 v4, 1, v4
v_and_b32 v5, 1, v2
v_add_u32 v4, v4, v5
v_mul_u32_u24 v8, 0xaaaa, v3
v_add_u32 v8, 0x4444, v8
v_mov_b32 v13, -1
s_mov_b32 s43, 71303168
v_lshlrev_b32 v160, 7, v0
v_lshrrev_b32 v5, 2, v2
v_and_b32 v6, 1, v2
v_lshlrev_b32 v6, 4, v6
v_mov_b32 v7, 0x3f80
v_lshlrev_b32 v6, v6, v7
v_cmp_eq_u32 vcc, v5, v1
s_nop 1
v_cndmask_b32 v6, 0, v6, vcc
v_cmp_eq_u32 vcc, 0, v3
s_nop 1
v_cndmask_b32 v152, 0, v6, vcc
v_cndmask_b32 v153, 0, v6, vcc
v_cndmask_b32 v154, v6, 0, vcc
v_cndmask_b32 v155, v6, 0, vcc
s_mov_b64 s[48:49], vcc
v_mul_u32_u24 v5, 320, v1
v_add_u32 v5, 58640, v5
v_and_b32 v6, 12, v2
v_add_u32 v6, v6, v2
v_lshl_add_u32 v156, v6, 2, v5
v_lshl_add_u32 v5, v4, 2, v5
v_add_u32 v5, 128, v5
v_lshlrev_b32 v6, 2, v2
v_add_u32 v6, 62528, v6
v_cndmask_b32 v157, v6, v5, vcc
v_lshrrev_b32 v3, 5, v0
v_and_b32 v4, 31, v0
v_mul_u32_u24 v5, 160, v3
v_lshl_add_u32 v5, v4, 3, v5
v_add_u32 v5, 57664, v5
v_mov_b32 v6, 58624
v_cmp_gt_u32 vcc, 20, v4
s_nop 1
v_cndmask_b32 v158, v6, v5, vcc
v_mov_b32 v6, 58632
v_cndmask_b32 v161, v6, v5, vcc
v_and_b32 v5, 1, v4
v_lshl_add_u32 v5, v5, 1, v3
v_lshlrev_b32 v5, 4, v5
v_bfe_u32 v6, v4, 3, 1
v_lshl_add_u32 v6, v6, 8, v5
v_bfe_u32 v7, v4, 1, 2
v_lshl_add_u32 v6, v7, 2, v6
s_lshl_b32 s35, s11, 9
s_add_u32 s35, s35, 2112
v_add_u32 v6, s35, v6
v_bfe_u32 v5, v4, 1, 1
v_lshlrev_b32 v5, 8, v5
v_lshl_add_u32 v5, v3, 4, v5
v_and_b32 v7, 1, v4
v_lshl_add_u32 v5, v7, 3, v5
s_lshr_b32 s35, s11, 2
s_lshl_b32 s35, s35, 9
s_and_b32 s36, s11, 1
s_lshl_b32 s36, s36, 5
s_add_u32 s35, s35, s36
s_and_b32 s36, s11, 2
s_lshl_b32 s36, s36, 1
s_add_u32 s35, s35, s36
s_add_u32 s35, s35, 64
v_add_u32 v5, s35, v5
v_mov_b32 v7, 1073741824
v_cndmask_b32 v5, v7, v5, vcc
v_cmp_gt_u32 vcc, 16, v4
s_nop 1
v_cndmask_b32 v159, v5, v6, vcc
s_mov_b32 s35, 55312384
buffer_store_dword v13, v159, s[4:7], s35 offen sc1
s_mov_b32 s35, 55328768
buffer_store_dword v13, v159, s[4:7], s35 offen sc1
s_mov_b32 s35, 55345152
buffer_store_dword v13, v159, s[4:7], s35 offen sc1
s_mov_b32 s35, 55361536
buffer_store_dword v13, v159, s[4:7], s35 offen sc1
v_mov_b32 v5, 59920
v_mov_b32 v6, 0xf149f2ca
ds_write2_b32 v5, v6, v6 offset0:0 offset1:1
v_mul_u32_u24 v12, 640, v0
s_lshl_b32 s35, s11, 2
s_add_u32 s35, s35, 0
v_add_u32 v12, s35, v12
v_mov_b32 v7, 1073741824
v_cmp_gt_u32 vcc, 4, v0
s_nop 1
v_cndmask_b32 v12, v7, v12, vcc
v_mov_b32 v7, 0
buffer_store_dword v7, v12, s[4:7], s43 offen sc1
v_mov_b32 v136, 0
v_mov_b32 v137, 0
v_mov_b32 v138, 0
v_mov_b32 v139, 0
s_mul_i32 s40, s11, 0
s_add_u32 s40, s40, 16793600
s_mov_b32 s10, 0
s_mov_b32 s38, 200000
s_mov_b32 s68, 0
s_mov_b32 s69, 0
s_mov_b32 s70, 0
s_mov_b32 s71, 0
v_mov_b32 v3, -1
v_mov_b32 v4, -1
ds_write2_b32 v161, v13, v13 offset0:0 offset1:1
v_add_u32 v5, 1296, v161
ds_write2_b32 v5, v13, v13 offset0:0 offset1:1
v_add_u32 v5, 2592, v161
ds_write2_b32 v5, v13, v13 offset0:0 offset1:1
v_add_u32 v5, 3888, v161
ds_write2_b32 v5, v13, v13 offset0:0 offset1:1
s_waitcnt vmcnt(0) lgkmcnt(0)
s_barrier
s_mov_b32 s34, 71343104
v_min_u32 v3, 24, v0
v_lshlrev_b32 v3, 14, v3
s_mul_i32 s34, s11, 401408
s_add_u32 s34, s34, 0
buffer_load_dword v4, v3, s[4:7], s34 offen sc1
s_waitcnt vmcnt(0)
v_min_u32 v3, 13, v2
v_lshlrev_b32 v3, 2, v3
s_lshl_b32 s35, s11, 8
s_add_u32 s35, s35, 17408
v_add_u32 v3, s35, v3
s_mov_b32 s41, 71319552
s_mov_b64 vcc, -1
s_mul_i32 s34, s11, 401408
s_and_b32 s36, vcc_lo, 65535
s_cbranch_scc0 RD_86
RL_85:
buffer_load_dword v4, v3, s[4:7], s41 offen sc1
s_sub_u32 s38, s38, 1
s_cmp_gt_i32 s38, 0
s_cbranch_scc0 RD_86
s_waitcnt vmcnt(0)
v_cmp_ne_u32 vcc, 1, v4
s_nop 0
s_and_b32 s36, vcc_lo, 65535
s_cbranch_scc0 RD_86
s_sleep 2
s_branch RL_85
RD_86:
s_add_u32 s35, s34, 59392
buffer_load_dwordx4 a[0:3], v9, s[4:7], s35 offen sc1
buffer_load_dwordx4 a[4:7], v9, s[4:7], s35 offen offset:1024 sc1
s_add_u32 s35, s34, 61440
buffer_load_dwordx4 a[8:11], v9, s[4:7], s35 offen sc1
buffer_load_dwordx4 a[12:15], v9, s[4:7], s35 offen offset:1024 sc1
s_add_u32 s35, s34, 57344
buffer_load_dwordx4 a[16:19], v9, s[4:7], s35 offen sc1
buffer_load_dwordx4 a[20:23], v9, s[4:7], s35 offen offset:1024 sc1
s_add_u32 s35, s34, 63488
buffer_load_dwordx4 a[24:27], v9, s[4:7], s35 offen sc1
buffer_load_dwordx4 a[28:31], v9, s[4:7], s35 offen offset:1024 sc1
s_add_u32 s35, s34, 67584
buffer_load_dwordx4 a[32:35], v9, s[4:7], s35 offen sc1
buffer_load_dwordx4 a[36:39], v9, s[4:7], s35 offen offset:1024 sc1
s_add_u32 s35, s34, 69632
buffer_load_dwordx4 a[40:43], v9, s[4:7], s35 offen sc1
buffer_load_dwordx4 a[44:47], v9, s[4:7], s35 offen offset:1024 sc1
s_add_u32 s35, s34, 65536
buffer_load_dwordx4 a[48:51], v9, s[4:7], s35 offen sc1
buffer_load_dwordx4 a[52:55], v9, s[4:7], s35 offen offset:1024 sc1
s_add_u32 s35, s34, 88064
buffer_load_dwordx4 a[56:59], v9, s[4:7], s35 offen sc1
buffer_load_dwordx4 a[60:63], v9, s[4:7], s35 offen offset:1024 sc1
s_add_u32 s35, s34, 90112
buffer_load_dwordx4 a[64:67], v9, s[4:7], s35 offen sc1
buffer_load_dwordx4 a[68:71], v9, s[4:7], s35 offen offset:1024 sc1
s_add_u32 s35, s34, 86016
buffer_load_dwordx4 a[72:75], v9, s[4:7], s35 offen sc1
buffer_load_dwordx4 a[76:79], v9, s[4:7], s35 offen offset:1024 sc1
s_add_u32 s35, s34, 92160
buffer_load_dwordx4 a[80:83], v9, s[4:7], s35 offen sc1
buffer_load_dwordx4 a[84:87], v9, s[4:7], s35 offen offset:1024 sc1
s_add_u32 s35, s34, 96256
buffer_load_dwordx4 a[88:91], v9, s[4:7], s35 offen sc1
buffer_load_dwordx4 a[92:95], v9, s[4:7], s35 offen offset:1024 sc1
s_add_u32 s35, s34, 98304
buffer_load_dwordx4 a[96:99], v9, s[4:7], s35 offen sc1
buffer_load_dwordx4 a[100:103], v9, s[4:7], s35 offen offset:1024 sc1
s_add_u32 s35, s34, 94208
buffer_load_dwordx4 a[104:107], v9, s[4:7], s35 offen sc1
buffer_load_dwordx4 a[108:111], v9, s[4:7], s35 offen offset:1024 sc1
s_add_u32 s35, s34, 73728
buffer_load_dwordx4 a[112:115], v9, s[4:7], s35 offen sc1
buffer_load_dwordx4 a[116:119], v9, s[4:7], s35 offen offset:1024 sc1
s_add_u32 s35, s34, 75776
buffer_load_dwordx4 a[120:123], v9, s[4:7], s35 offen sc1
buffer_load_dwordx4 a[124:127], v9, s[4:7], s35 offen offset:1024 sc1
s_add_u32 s35, s34, 71680
buffer_load_dwordx4 a[128:131], v9, s[4:7], s35 offen sc1
buffer_load_dwordx4 a[132:135], v9, s[4:7], s35 offen offset:1024 sc1
s_add_u32 s35, s34, 77824
buffer_load_dwordx4 a[136:139], v9, s[4:7], s35 offen sc1
buffer_load_dwordx4 a[140:143], v9, s[4:7], s35 offen offset:1024 sc1
s_add_u32 s35, s34, 81920
buffer_load_dwordx4 a[144:147], v9, s[4:7], s35 offen sc1
buffer_load_dwordx4 a[148:151], v9, s[4:7], s35 offen offset:1024 sc1
s_add_u32 s35, s34, 83968
buffer_load_dwordx4 a[152:155], v9, s[4:7], s35 offen sc1
buffer_load_dwordx4 a[156:159], v9, s[4:7], s35 offen offset:1024 sc1
s_add_u32 s35, s34, 79872
buffer_load_dwordx4 a[160:163], v9, s[4:7], s35 offen sc1
buffer_load_dwordx4 a[164:167], v9, s[4:7], s35 offen offset:1024 sc1
s_add_u32 s35, s34, 102400
buffer_load_dwordx4 a[168:171], v9, s[4:7], s35 offen sc1
buffer_load_dwordx4 a[172:175], v9, s[4:7], s35 offen offset:1024 sc1
s_add_u32 s35, s34, 104448
buffer_load_dwordx4 a[176:179], v9, s[4:7], s35 offen sc1
buffer_load_dwordx4 a[180:183], v9, s[4:7], s35 offen offset:1024 sc1
s_add_u32 s35, s34, 100352
buffer_load_dwordx4 a[184:187], v9, s[4:7], s35 offen sc1
buffer_load_dwordx4 a[188:191], v9, s[4:7], s35 offen offset:1024 sc1
s_add_u32 s35, s34, 106496
buffer_load_dwordx4 a[192:195], v9, s[4:7], s35 offen sc1
buffer_load_dwordx4 a[196:199], v9, s[4:7], s35 offen offset:1024 sc1
s_add_u32 s35, s34, 110592
buffer_load_dwordx4 a[200:203], v9, s[4:7], s35 offen sc1
buffer_load_dwordx4 a[204:207], v9, s[4:7], s35 offen offset:1024 sc1
s_add_u32 s35, s34, 112640
buffer_load_dwordx4 a[208:211], v9, s[4:7], s35 offen sc1
buffer_load_dwordx4 a[212:215], v9, s[4:7], s35 offen offset:1024 sc1
s_add_u32 s35, s34, 108544
buffer_load_dwordx4 a[216:219], v9, s[4:7], s35 offen sc1
buffer_load_dwordx4 a[220:223], v9, s[4:7], s35 offen offset:1024 sc1
s_add_u32 s35, s34, 303104
s_mov_b32 m0, 14336
s_nop 0
buffer_load_dwordx4 v9, s[4:7], s35 offen sc1 lds
buffer_load_dwordx4 v9, s[4:7], s35 offen offset:1024 sc1 lds
s_add_u32 s35, s34, 305152
s_mov_b32 m0, 16384
s_nop 0
buffer_load_dwordx4 v9, s[4:7], s35 offen sc1 lds
buffer_load_dwordx4 v9, s[4:7], s35 offen offset:1024 sc1 lds
s_waitcnt vmcnt(40)
s_add_u32 s35, s34, 301056
s_mov_b32 m0, 18432
s_nop 0
buffer_load_dwordx4 v9, s[4:7], s35 offen sc1 lds
buffer_load_dwordx4 v9, s[4:7], s35 offen offset:1024 sc1 lds
s_add_u32 s35, s34, 307200
s_mov_b32 m0, 20480
s_nop 0
buffer_load_dwordx4 v9, s[4:7], s35 offen sc1 lds
buffer_load_dwordx4 v9, s[4:7], s35 offen offset:1024 sc1 lds
s_add_u32 s35, s34, 311296
s_mov_b32 m0, 22528
s_nop 0
buffer_load_dwordx4 v9, s[4:7], s35 offen sc1 lds
buffer_load_dwordx4 v9, s[4:7], s35 offen offset:1024 sc1 lds
s_add_u32 s35, s34, 313344
s_mov_b32 m0, 24576
s_nop 0
buffer_load_dwordx4 v9, s[4:7], s35 offen sc1 lds
buffer_load_dwordx4 v9, s[4:7], s35 offen offset:1024 sc1 lds
s_add_u32 s35, s34, 309248
s_mov_b32 m0, 26624
s_nop 0
buffer_load_dwordx4 v9, s[4:7], s35 offen sc1 lds
buffer_load_dwordx4 v9, s[4:7], s35 offen offset:1024 sc1 lds
s_add_u32 s35, s34, 331776
buffer_load_dwordx4 a[224:227], v9, s[4:7], s35 offen sc1
buffer_load_dwordx4 a[228:231], v9, s[4:7], s35 offen offset:1024 sc1
s_add_u32 s35, s34, 333824
buffer_load_dwordx4 a[232:235], v9, s[4:7], s35 offen sc1
buffer_load_dwordx4 a[236:239], v9, s[4:7], s35 offen offset:1024 sc1
s_add_u32 s35, s34, 329728
buffer_load_dwordx4 a[240:243], v9, s[4:7], s35 offen sc1
buffer_load_dwordx4 a[244:247], v9, s[4:7], s35 offen offset:1024 sc1
s_add_u32 s35, s34, 335872
buffer_load_dwordx4 a[248:251], v9, s[4:7], s35 offen sc1
buffer_load_dwordx4 a[252:255], v9, s[4:7], s35 offen offset:1024 sc1
s_add_u32 s35, s34, 339968
buffer_load_dwordx4 v[164:167], v9, s[4:7], s35 offen sc1
buffer_load_dwordx4 v[168:171], v9, s[4:7], s35 offen offset:1024 sc1
s_waitcnt vmcnt(40)
s_add_u32 s35, s34, 342016
buffer_load_dwordx4 v[172:175], v9, s[4:7], s35 offen sc1
buffer_load_dwordx4 v[176:179], v9, s[4:7], s35 offen offset:1024 sc1
s_add_u32 s35, s34, 337920
buffer_load_dwordx4 v[180:183], v9, s[4:7], s35 offen sc1
buffer_load_dwordx4 v[184:187], v9, s[4:7], s35 offen offset:1024 sc1
s_add_u32 s35, s34, 288768
buffer_load_dwordx4 v[188:191], v9, s[4:7], s35 offen sc1
buffer_load_dwordx4 v[192:195], v9, s[4:7], s35 offen offset:1024 sc1
s_add_u32 s35, s34, 290816
buffer_load_dwordx4 v[196:199], v9, s[4:7], s35 offen sc1
buffer_load_dwordx4 v[200:203], v9, s[4:7], s35 offen offset:1024 sc1
s_add_u32 s35, s34, 286720
buffer_load_dwordx4 v[204:207], v9, s[4:7], s35 offen sc1
buffer_load_dwordx4 v[208:211], v9, s[4:7], s35 offen offset:1024 sc1
s_add_u32 s35, s34, 292864
buffer_load_dwordx4 v[212:215], v9, s[4:7], s35 offen sc1
buffer_load_dwordx4 v[216:219], v9, s[4:7], s35 offen offset:1024 sc1
s_add_u32 s35, s34, 296960
buffer_load_dwordx4 v[220:223], v9, s[4:7], s35 offen sc1
buffer_load_dwordx4 v[224:227], v9, s[4:7], s35 offen offset:1024 sc1
s_add_u32 s35, s34, 299008
buffer_load_dwordx4 v[228:231], v9, s[4:7], s35 offen sc1
buffer_load_dwordx4 v[232:235], v9, s[4:7], s35 offen offset:1024 sc1
s_add_u32 s35, s34, 294912
buffer_load_dwordx4 v[236:239], v9, s[4:7], s35 offen sc1
buffer_load_dwordx4 v[240:243], v9, s[4:7], s35 offen offset:1024 sc1
s_mov_b32 s34, 71343104
s_barrier
v_mov_b32 v3, 151552
ds_read_b32 v4, v3
s_waitcnt lgkmcnt(0)
v_readfirstlane_b32 s66, v4
s_lshl_b32 s52, s10, 15
s_add_u32 s52, s52, 50339840
buffer_load_dwordx4 v[104:107], v9, s[4:7], s52 offen offset:0 sc1
buffer_load_dwordx4 v[108:111], v9, s[4:7], s52 offen offset:1024 sc1
buffer_load_dwordx4 v[112:115], v9, s[4:7], s52 offen offset:2048 sc1
buffer_load_dwordx4 v[116:119], v9, s[4:7], s52 offen offset:3072 sc1
s_waitcnt vmcnt(4)
v_mov_b32 v60, 0
v_mov_b32 v61, 0
v_mov_b32 v62, 0
v_mov_b32 v63, 0
v_mov_b32 v64, 0
v_mov_b32 v65, 0
v_mov_b32 v66, 0
v_mov_b32 v67, 0
v_mov_b32 v68, 0
v_mov_b32 v69, 0
v_mov_b32 v70, 0
v_mov_b32 v71, 0
v_mov_b32 v72, 0
v_mov_b32 v73, 0
v_mov_b32 v74, 0
v_mov_b32 v75, 0
v_mov_b32 v76, 0
v_mov_b32 v77, 0
v_mov_b32 v78, 0
v_mov_b32 v79, 0
v_mov_b32 v80, 0
v_mov_b32 v81, 0
v_mov_b32 v82, 0
v_mov_b32 v83, 0
v_mov_b32 v84, 0
v_mov_b32 v85, 0
v_mov_b32 v86, 0
v_mov_b32 v87, 0
v_mov_b32 v140, 0
v_mov_b32 v141, 0
v_mov_b32 v142, 0
v_mov_b32 v143, 0
v_mov_b32 v144, 0
v_mov_b32 v145, 0
v_mov_b32 v146, 0
v_mov_b32 v147, 0
s_lshl_b32 s26, s10, 13
s_add_u32 s26, s26, 54525952
s_add_u32 s27, s26, 4096
LOOP_89:
s_barrier
buffer_load_dwordx4 v[16:19], v9, s[4:7], s26 offen offset:1024 sc1
ds_read_b128 v[44:47], v14 offset:0
ds_read_b128 v[48:51], v14 offset:1024
ds_read_b128 v[52:55], v14 offset:2048
ds_read_b128 v[56:59], v14 offset:3072
s_add_u32 s39, s10, 1
s_barrier
buffer_load_dwordx4 v[20:23], v9, s[4:7], s26 offen offset:2048
s_mov_b64 s[50:51], -1
v_mov_b32 v10, s39
s_and_b32 s34, s10, 3
s_lshl_b32 s28, s34, 14
s_add_u32 s28, s28, 55312384
s_barrier
buffer_load_dwordx4 v[24:27], v9, s[4:7], s26 offen offset:0
s_xor_b32 s29, s28, 32768
s_min_u32 s37, s39, 63
s_add_u32 s53, s52, 4096
s_lshl_b32 s52, s37, 15
s_add_u32 s52, s52, 50339840
s_barrier
buffer_load_dwordx4 v[28:31], v9, s[4:7], s26 offen offset:3072
s_waitcnt vmcnt(3)
v_smfmac_f32_16x16x64_bf16 v[60:63], v[16:19], a[0:7], v8
buffer_load_dwordx4 v[32:35], v9, s[4:7], s27 offen offset:1024
v_cmp_eq_u32 vcc, -1, v16
v_smfmac_f32_16x16x64_bf16 v[64:67], v[16:19], a[56:63], v8
v_smfmac_f32_16x16x64_bf16 v[68:71], v[16:19], a[112:119], v8
s_cbranch_vccnz RT_93
BK_94:
v_smfmac_f32_16x16x64_bf16 v[72:75], v[16:19], a[168:175], v8
s_waitcnt lgkmcnt(2)
v_smfmac_f32_16x16x64_bf16 v[76:79], v[16:19], v[44:51], v8
s_waitcnt vmcnt(3)
v_smfmac_f32_16x16x64_bf16 v[60:63], v[20:23], a[8:15], v8
buffer_load_dwordx4 v[36:39], v9, s[4:7], s27 offen offset:2048
v_smfmac_f32_16x16x64_bf16 v[64:67], v[20:23], a[64:71], v8
ds_read_b128 v[44:47], v14 offset:4096
v_smfmac_f32_16x16x64_bf16 v[68:71], v[20:23], a[120:127], v8
ds_read_b128 v[48:51], v14 offset:5120
v_smfmac_f32_16x16x64_bf16 v[72:75], v[20:23], a[176:183], v8
s_waitcnt lgkmcnt(2)
v_smfmac_f32_16x16x64_bf16 v[76:79], v[20:23], v[52:59], v8
s_waitcnt vmcnt(3)
v_smfmac_f32_16x16x64_bf16 v[60:63], v[24:27], a[16:23], v8
buffer_load_dwordx4 v[40:43], v9, s[4:7], s27 offen offset:0
v_smfmac_f32_16x16x64_bf16 v[64:67], v[24:27], a[72:79], v8
ds_read_b128 v[52:55], v14 offset:6144
v_smfmac_f32_16x16x64_bf16 v[68:71], v[24:27], a[128:135], v8
ds_read_b128 v[56:59], v14 offset:7168
v_smfmac_f32_16x16x64_bf16 v[72:75], v[24:27], a[184:191], v8
s_waitcnt lgkmcnt(2)
v_smfmac_f32_16x16x64_bf16 v[76:79], v[24:27], v[44:51], v8
s_waitcnt vmcnt(3)
v_smfmac_f32_16x16x64_bf16 v[60:63], v[28:31], a[24:31], v8
buffer_load_dwordx4 v[120:123], v9, s[4:7], s53 offen offset:0 sc1
v_smfmac_f32_16x16x64_bf16 v[64:67], v[28:31], a[80:87], v8
ds_read_b128 v[44:47], v14 offset:8192
v_smfmac_f32_16x16x64_bf16 v[68:71], v[28:31], a[136:143], v8
ds_read_b128 v[48:51], v14 offset:9216
v_smfmac_f32_16x16x64_bf16 v[72:75], v[28:31], a[192:199], v8
s_waitcnt lgkmcnt(2)
v_smfmac_f32_16x16x64_bf16 v[76:79], v[28:31], v[52:59], v8
buffer_load_dwordx4 v[124:127], v9, s[4:7], s53 offen offset:1024 sc1
s_waitcnt vmcnt(4)
v_smfmac_f32_16x16x64_bf16 v[60:63], v[32:35], a[32:39], v8
ds_read_b128 v[52:55], v14 offset:10240
v_smfmac_f32_16x16x64_bf16 v[64:67], v[32:35], a[88:95], v8
ds_read_b128 v[56:59], v14 offset:11264
v_smfmac_f32_16x16x64_bf16 v[68:71], v[32:35], a[144:151], v8
v_smfmac_f32_16x16x64_bf16 v[72:75], v[32:35], a[200:207], v8
buffer_load_dwordx4 v[128:131], v9, s[4:7], s53 offen offset:2048 sc1
s_waitcnt lgkmcnt(2)
v_smfmac_f32_16x16x64_bf16 v[76:79], v[32:35], v[44:51], v8
s_waitcnt vmcnt(4)
v_smfmac_f32_16x16x64_bf16 v[60:63], v[36:39], a[40:47], v8
ds_read_b128 v[44:47], v14 offset:12288
v_smfmac_f32_16x16x64_bf16 v[64:67], v[36:39], a[96:103], v8
ds_read_b128 v[48:51], v14 offset:13312
v_smfmac_f32_16x16x64_bf16 v[68:71], v[36:39], a[152:159], v8
buffer_load_dwordx4 v[132:135], v9, s[4:7], s53 offen offset:3072 sc1
v_smfmac_f32_16x16x64_bf16 v[72:75], v[36:39], a[208:215], v8
s_waitcnt lgkmcnt(2)
v_smfmac_f32_16x16x64_bf16 v[76:79], v[36:39], v[52:59], v8
s_waitcnt vmcnt(4)
v_smfmac_f32_16x16x64_bf16 v[60:63], v[40:43], a[48:55], v8
v_smfmac_f32_16x16x64_bf16 v[64:67], v[40:43], a[104:111], v8
v_smfmac_f32_16x16x64_bf16 v[68:71], v[40:43], a[160:167], v8
v_cvt_pk_bf16_f32 v60, v60, v61
v_smfmac_f32_16x16x64_bf16 v[72:75], v[40:43], a[216:223], v8
s_waitcnt lgkmcnt(0)
v_cvt_pk_bf16_f32 v61, v62, v63
v_smfmac_f32_16x16x64_bf16 v[76:79], v[40:43], v[44:51], v8
v_cvt_pk_bf16_f32 v62, v64, v65
JOIN_92:
v_smfmac_f32_16x16x64_bf16 v[80:83], v[16:19], a[224:231], v8
v_cvt_pk_bf16_f32 v63, v66, v67
v_smfmac_f32_16x16x64_bf16 v[80:83], v[20:23], a[232:239], v8
v_cvt_pk_bf16_f32 v68, v68, v69
v_mfma_f32_16x16x32_bf16 v[88:91], v[60:63], v[152:155], 0
v_cvt_pk_bf16_f32 v69, v70, v71
v_cvt_pk_bf16_f32 v70, v72, v73
v_smfmac_f32_16x16x64_bf16 v[80:83], v[24:27], a[240:247], v8
v_cvt_pk_bf16_f32 v71, v74, v75
v_smfmac_f32_16x16x64_bf16 v[80:83], v[28:31], a[248:255], v8
v_cvt_pk_bf16_f32 v76, v76, v77
v_mfma_f32_16x16x32_bf16 v[92:95], v[68:71], v[152:155], 0
v_cvt_pk_bf16_f32 v96, v88, v89
v_cvt_pk_bf16_f32 v97, v90, v91
v_smfmac_f32_16x16x64_bf16 v[80:83], v[32:35], v[164:171], v8
v_cmp_u_f32 vcc, v88, v89
v_smfmac_f32_16x16x64_bf16 v[80:83], v[36:39], v[172:179], v8
v_cvt_pk_bf16_f32 v77, v78, v79
v_smfmac_f32_16x16x64_bf16 v[80:83], v[40:43], v[180:187], v8
v_cvt_pk_bf16_f32 v98, v92, v93
v_smfmac_f32_16x16x64_bf16 v[84:87], v[16:19], v[188:195], v8
v_cvt_pk_bf16_f32 v99, v94, v95
v_smfmac_f32_16x16x64_bf16 v[84:87], v[20:23], v[196:203], v8
s_and_b64 vcc, vcc, s[50:51]
s_cbranch_scc1 FAIL_91
v_smfmac_f32_16x16x64_bf16 v[84:87], v[24:27], v[204:211], v8
v_cvt_pk_bf16_f32 v78, v80, v81
v_smfmac_f32_16x16x64_bf16 v[84:87], v[28:31], v[212:219], v8
v_cvt_pk_bf16_f32 v79, v82, v83
v_smfmac_f32_16x16x64_bf16 v[84:87], v[32:35], v[220:227], v8
v_mov_b32 v60, 0
v_smfmac_f32_16x16x64_bf16 v[84:87], v[36:39], v[228:235], v8
v_mov_b32 v61, 0
v_smfmac_f32_16x16x64_bf16 v[84:87], v[40:43], v[236:243], v8
v_mov_b32 v62, 0
v_mfma_f32_16x16x32_bf16 v[92:95], v[76:79], v[152:155], 0
v_mov_b32 v63, 0
v_mov_b32 v64, 0
v_mfma_f32_16x16x32_bf16 v[148:151], v[96:99], v[16:19], 0
v_cvt_pk_bf16_f32 v136, v84, v85
v_cvt_pk_bf16_f32 v137, v86, v87
v_mov_b32 v65, 0
s_nop 0
v_cvt_pk_bf16_f32 v102, v92, v93
v_mfma_f32_16x16x32_bf16 v[88:91], v[136:139], v[152:155], 0
v_cvt_pk_bf16_f32 v103, v94, v95
v_mov_b32 v66, 0
v_smfmac_f32_16x16x64_bf16 v[140:143], v[96:99], v[104:111], v8
v_mov_b32 v67, 0
v_smfmac_f32_16x16x64_bf16 v[144:147], v[96:99], v[112:119], v8
v_cvt_pk_bf16_f32 v100, v88, v89
v_cvt_pk_bf16_f32 v101, v90, v91
v_mov_b32 v68, 0
s_waitcnt vmcnt(2)
v_smfmac_f32_16x16x64_bf16 v[140:143], v[100:103], v[120:127], v8
s_waitcnt vmcnt(0)
v_smfmac_f32_16x16x64_bf16 v[144:147], v[100:103], v[128:135], v8
v_mfma_f32_16x16x32_bf16 v[148:151], v[100:103], v[32:35], v[148:151]
v_add_f32 v140, v140, v142
v_add_f32 v141, v141, v143
ds_write2_b32 v156, v140, v141 offset0:0 offset1:40
s_nop 0
v_add_f32 v144, v144, v146
v_add_f32 v145, v145, v147
ds_write2_b32 v156, v144, v145 offset0:4 offset1:44
s_nop 0
v_add_f32_dpp v148, v150, v148 quad_perm:[2,3,0,1] row_mask:0xf bank_mask:0xf
v_add_f32_dpp v149, v151, v149 quad_perm:[2,3,0,1] row_mask:0xf bank_mask:0xf
ds_write2_b32 v157, v148, v149 offset0:0 offset1:40
v_mov_b32 v69, 0
v_mov_b32 v70, 0
v_mov_b32 v71, 0
v_mov_b32 v72, 0
s_barrier
ds_read_b64 v[16:17], v158 offset:0
v_mov_b32 v73, 0
ds_read_b64 v[18:19], v158 offset:1296
ds_read_b64 v[20:21], v158 offset:2592
v_mov_b32 v74, 0
ds_read_b64 v[22:23], v158 offset:3888
v_mov_b32 v75, 0
v_mov_b32 v76, 0
v_mov_b32 v77, 0
v_mov_b32 v78, 0
buffer_store_dword v10, v12, s[4:7], s43 offen
v_mov_b32 v79, 0
s_waitcnt lgkmcnt(2)
v_add_f32 v16, v16, v18
v_add_f32 v17, v17, v19
s_waitcnt lgkmcnt(0)
v_add_f32 v20, v20, v22
v_add_f32 v21, v21, v23
v_add_f32 v16, v16, v20
v_add_f32 v17, v17, v21
v_exp_f32 v24, v16
v_exp_f32 v25, v17
s_nop 0
v_add_f32 v3, v24, v25
v_mov_b32 v80, 0
v_mov_b32 v81, 0
v_add_f32_dpp v3, v3, v3 quad_perm:[1,0,3,2] row_mask:0xf bank_mask:0xf
v_mov_b32 v82, 0
v_mov_b32 v83, 0
v_add_f32_dpp v3, v3, v3 quad_perm:[2,3,0,1] row_mask:0xf bank_mask:0xf
v_mov_b32 v84, 0
v_mov_b32 v85, 0
v_add_f32_dpp v3, v3, v3 row_half_mirror row_mask:0xf bank_mask:0xf
v_mov_b32 v86, 0
v_mov_b32 v87, 0
v_add_f32_dpp v3, v3, v3 row_mirror row_mask:0xf bank_mask:0xf
v_mov_b32 v4, v3
s_nop 1
v_permlane16_swap_b32 v3, v4
v_add_f32 v3, v3, v4
v_rcp_f32 v26, v3
v_subrev_u32 v3, 0x21800000, v3
v_mul_f32 v24, v24, v26
v_mul_f32 v25, v25, v26
v_cvt_pk_bf16_f32 v4, v24, v25
v_cmpx_gt_u32 vcc, 0x50000000, v3
buffer_store_dword v4, v159, s[4:7], s28 offen
s_mov_b64 exec, -1
s_cmp_lg_u64 vcc, -1
s_cbranch_scc1 FB_95
FD_96:
s_cmp_lg_u32 s66, 0
s_cbranch_scc1 SL_97
SB_98:
s_barrier
buffer_store_dword v13, v159, s[4:7], s29 offen
s_cmp_lg_u32 s66, 0
s_cbranch_scc1 SL_99
SB_100:
buffer_load_dwordx4 v[104:107], v9, s[4:7], s52 offen offset:0 sc1
buffer_load_dwordx4 v[108:111], v9, s[4:7], s52 offen offset:1024 sc1
buffer_load_dwordx4 v[112:115], v9, s[4:7], s52 offen offset:2048 sc1
buffer_load_dwordx4 v[116:119], v9, s[4:7], s52 offen offset:3072 sc1
v_mov_b32 v16, -1
v_mov_b32 v17, -1
ds_write_b64 v161, v[16:17] offset:0
ds_write_b64 v161, v[16:17] offset:1296
ds_write_b64 v161, v[16:17] offset:2592
ds_write_b64 v161, v[16:17] offset:3888
s_waitcnt lgkmcnt(0)
v_mov_b32 v140, 0
v_mov_b32 v141, 0
v_mov_b32 v142, 0
v_mov_b32 v143, 0
v_mov_b32 v144, 0
v_mov_b32 v145, 0
v_mov_b32 v146, 0
v_mov_b32 v147, 0
s_add_u32 s10, s10, 1
s_lshl_b32 s26, s10, 13
s_add_u32 s26, s26, 54525952
s_add_u32 s27, s26, 4096
s_cmp_ge_u32 s10, 63
s_cbranch_scc1 END_90
s_branch LOOP_89
END_90:
s_endpgm
RT_93:
buffer_load_dwordx4 v[16:19], v9, s[4:7], s26 offen offset:1024 sc1
buffer_load_dwordx4 v[20:23], v9, s[4:7], s26 offen offset:2048 sc1
buffer_load_dwordx4 v[24:27], v9, s[4:7], s26 offen offset:0 sc1
buffer_load_dwordx4 v[28:31], v9, s[4:7], s26 offen offset:3072 sc1
buffer_load_dwordx4 v[32:35], v9, s[4:7], s27 offen offset:1024 sc1
s_sub_u32 s38, s38, 1
s_cmp_gt_i32 s38, 0
s_cbranch_scc0 END_90
v_mov_b32 v60, 0
v_mov_b32 v61, 0
v_mov_b32 v62, 0
v_mov_b32 v63, 0
v_mov_b32 v64, 0
v_mov_b32 v65, 0
v_mov_b32 v66, 0
v_mov_b32 v67, 0
v_mov_b32 v68, 0
v_mov_b32 v69, 0
v_mov_b32 v70, 0
v_mov_b32 v71, 0
s_waitcnt vmcnt(0)
v_cmp_eq_u32 vcc, -1, v16
s_cbranch_vccnz RT_93
v_smfmac_f32_16x16x64_bf16 v[60:63], v[16:19], a[0:7], v8
v_smfmac_f32_16x16x64_bf16 v[64:67], v[16:19], a[56:63], v8
v_smfmac_f32_16x16x64_bf16 v[68:71], v[16:19], a[112:119], v8
s_branch BK_94
FAIL_91:
s_mov_b64 s[50:51], 0
FAIL_91b:
buffer_load_dwordx4 v[16:19], v9, s[4:7], s26 offen offset:1024 sc1
buffer_load_dwordx4 v[20:23], v9, s[4:7], s26 offen offset:2048 sc1
buffer_load_dwordx4 v[24:27], v9, s[4:7], s26 offen offset:0 sc1
buffer_load_dwordx4 v[28:31], v9, s[4:7], s26 offen offset:3072 sc1
buffer_load_dwordx4 v[32:35], v9, s[4:7], s27 offen offset:1024 sc1
buffer_load_dwordx4 v[36:39], v9, s[4:7], s27 offen offset:2048 sc1
buffer_load_dwordx4 v[40:43], v9, s[4:7], s27 offen offset:0 sc1
s_sub_u32 s38, s38, 1
s_cmp_gt_i32 s38, 0
s_cbranch_scc0 END_90
v_mov_b32 v60, 0
v_mov_b32 v61, 0
v_mov_b32 v62, 0
v_mov_b32 v63, 0
v_mov_b32 v64, 0
v_mov_b32 v65, 0
v_mov_b32 v66, 0
v_mov_b32 v67, 0
v_mov_b32 v68, 0
v_mov_b32 v69, 0
v_mov_b32 v70, 0
v_mov_b32 v71, 0
v_mov_b32 v72, 0
v_mov_b32 v73, 0
v_mov_b32 v74, 0
v_mov_b32 v75, 0
v_mov_b32 v76, 0
v_mov_b32 v77, 0
v_mov_b32 v78, 0
v_mov_b32 v79, 0
v_mov_b32 v80, 0
v_mov_b32 v81, 0
v_mov_b32 v82, 0
v_mov_b32 v83, 0
v_mov_b32 v84, 0
v_mov_b32 v85, 0
v_mov_b32 v86, 0
v_mov_b32 v87, 0
ds_read_b128 v[44:47], v14 offset:0
ds_read_b128 v[48:51], v14 offset:1024
ds_read_b128 v[52:55], v14 offset:2048
ds_read_b128 v[56:59], v14 offset:3072
s_waitcnt vmcnt(0)
v_max3_u32 v3, v16, v17, v18
v_max3_u32 v3, v3, v19, v20
v_max3_u32 v3, v3, v21, v22
v_max3_u32 v3, v3, v23, v24
v_max3_u32 v3, v3, v25, v26
v_max3_u32 v3, v3, v27, v28
v_max3_u32 v3, v3, v29, v30
v_max3_u32 v3, v3, v31, v32
v_max3_u32 v3, v3, v33, v34
v_max3_u32 v3, v3, v35, v36
v_max3_u32 v3, v3, v37, v38
v_max3_u32 v3, v3, v39, v40
v_max3_u32 v3, v3, v41, v42
v_max_u32 v3, v3, v43
v_cmp_eq_u32 vcc, -1, v3
s_cbranch_vccnz FAIL_91b
s_waitcnt lgkmcnt(2)
v_smfmac_f32_16x16x64_bf16 v[60:63], v[16:19], a[0:7], v8
v_smfmac_f32_16x16x64_bf16 v[64:67], v[16:19], a[56:63], v8
v_smfmac_f32_16x16x64_bf16 v[68:71], v[16:19], a[112:119], v8
v_smfmac_f32_16x16x64_bf16 v[72:75], v[16:19], a[168:175], v8
v_smfmac_f32_16x16x64_bf16 v[76:79], v[16:19], v[44:51], v8
ds_read_b128 v[44:47], v14 offset:4096
ds_read_b128 v[48:51], v14 offset:5120
s_waitcnt lgkmcnt(2)
v_smfmac_f32_16x16x64_bf16 v[60:63], v[20:23], a[8:15], v8
v_smfmac_f32_16x16x64_bf16 v[64:67], v[20:23], a[64:71], v8
v_smfmac_f32_16x16x64_bf16 v[68:71], v[20:23], a[120:127], v8
v_smfmac_f32_16x16x64_bf16 v[72:75], v[20:23], a[176:183], v8
v_smfmac_f32_16x16x64_bf16 v[76:79], v[20:23], v[52:59], v8
ds_read_b128 v[52:55], v14 offset:6144
ds_read_b128 v[56:59], v14 offset:7168
s_waitcnt lgkmcnt(2)
v_smfmac_f32_16x16x64_bf16 v[60:63], v[24:27], a[16:23], v8
v_smfmac_f32_16x16x64_bf16 v[64:67], v[24:27], a[72:79], v8
v_smfmac_f32_16x16x64_bf16 v[68:71], v[24:27], a[128:135], v8
v_smfmac_f32_16x16x64_bf16 v[72:75], v[24:27], a[184:191], v8
v_smfmac_f32_16x16x64_bf16 v[76:79], v[24:27], v[44:51], v8
ds_read_b128 v[44:47], v14 offset:8192
ds_read_b128 v[48:51], v14 offset:9216
s_waitcnt lgkmcnt(2)
v_smfmac_f32_16x16x64_bf16 v[60:63], v[28:31], a[24:31], v8
v_smfmac_f32_16x16x64_bf16 v[64:67], v[28:31], a[80:87], v8
v_smfmac_f32_16x16x64_bf16 v[68:71], v[28:31], a[136:143], v8
v_smfmac_f32_16x16x64_bf16 v[72:75], v[28:31], a[192:199], v8
v_smfmac_f32_16x16x64_bf16 v[76:79], v[28:31], v[52:59], v8
ds_read_b128 v[52:55], v14 offset:10240
ds_read_b128 v[56:59], v14 offset:11264
s_waitcnt lgkmcnt(2)
v_smfmac_f32_16x16x64_bf16 v[60:63], v[32:35], a[32:39], v8
v_smfmac_f32_16x16x64_bf16 v[64:67], v[32:35], a[88:95], v8
v_smfmac_f32_16x16x64_bf16 v[68:71], v[32:35], a[144:151], v8
v_smfmac_f32_16x16x64_bf16 v[72:75], v[32:35], a[200:207], v8
v_smfmac_f32_16x16x64_bf16 v[76:79], v[32:35], v[44:51], v8
ds_read_b128 v[44:47], v14 offset:12288
ds_read_b128 v[48:51], v14 offset:13312
s_waitcnt lgkmcnt(2)
v_smfmac_f32_16x16x64_bf16 v[60:63], v[36:39], a[40:47], v8
v_smfmac_f32_16x16x64_bf16 v[64:67], v[36:39], a[96:103], v8
v_smfmac_f32_16x16x64_bf16 v[68:71], v[36:39], a[152:159], v8
v_smfmac_f32_16x16x64_bf16 v[72:75], v[36:39], a[208:215], v8
v_smfmac_f32_16x16x64_bf16 v[76:79], v[36:39], v[52:59], v8
s_waitcnt lgkmcnt(0)
v_smfmac_f32_16x16x64_bf16 v[60:63], v[40:43], a[48:55], v8
v_smfmac_f32_16x16x64_bf16 v[64:67], v[40:43], a[104:111], v8
v_smfmac_f32_16x16x64_bf16 v[68:71], v[40:43], a[160:167], v8
v_smfmac_f32_16x16x64_bf16 v[72:75], v[40:43], a[216:223], v8
v_smfmac_f32_16x16x64_bf16 v[76:79], v[40:43], v[44:51], v8
v_cvt_pk_bf16_f32 v60, v60, v61
v_cvt_pk_bf16_f32 v61, v62, v63
v_cvt_pk_bf16_f32 v62, v64, v65
s_nop 7
s_branch JOIN_92
FB_95:
ds_read_b64 v[16:17], v158 offset:0
ds_read_b64 v[18:19], v158 offset:1296
ds_read_b64 v[20:21], v158 offset:2592
ds_read_b64 v[22:23], v158 offset:3888
s_sub_u32 s38, s38, 1
s_cmp_gt_i32 s38, 0
s_cbranch_scc0 FD_96
s_waitcnt lgkmcnt(0)
v_max3_u32 v3, v16, v17, v18
v_max3_u32 v3, v3, v19, v20
v_max3_u32 v3, v3, v21, v22
v_max_u32 v3, v3, v23
v_cmp_eq_u32 vcc, -1, v3
s_cbranch_vccnz FB_95
s_waitcnt lgkmcnt(2)
v_add_f32 v16, v16, v18
v_add_f32 v17, v17, v19
s_waitcnt lgkmcnt(0)
v_add_f32 v20, v20, v22
v_add_f32 v21, v21, v23
v_add_f32 v16, v16, v20
v_add_f32 v17, v17, v21
v_max_f32 v3, v16, v17
s_nop 1
v_max_f32_dpp v3, v3, v3 quad_perm:[1,0,3,2] row_mask:0xf bank_mask:0xf
s_nop 1
v_max_f32_dpp v3, v3, v3 quad_perm:[2,3,0,1] row_mask:0xf bank_mask:0xf
s_nop 1
v_max_f32_dpp v3, v3, v3 row_half_mirror row_mask:0xf bank_mask:0xf
s_nop 1
v_max_f32_dpp v3, v3, v3 row_mirror row_mask:0xf bank_mask:0xf
v_mov_b32 v4, v3
s_nop 1
v_permlane16_swap_b32 v3, v4
v_max_f32 v3, v3, v4
v_sub_f32 v24, v16, v3
v_sub_f32 v25, v17, v3
v_exp_f32 v24, v24
v_exp_f32 v25, v25
s_nop 0
v_add_f32 v3, v24, v25
s_nop 1
v_add_f32_dpp v3, v3, v3 quad_perm:[1,0,3,2] row_mask:0xf bank_mask:0xf
s_nop 1
v_add_f32_dpp v3, v3, v3 quad_perm:[2,3,0,1] row_mask:0xf bank_mask:0xf
s_nop 1
v_add_f32_dpp v3, v3, v3 row_half_mirror row_mask:0xf bank_mask:0xf
s_nop 1
v_add_f32_dpp v3, v3, v3 row_mirror row_mask:0xf bank_mask:0xf
v_mov_b32 v4, v3
s_nop 1
v_permlane16_swap_b32 v3, v4
v_add_f32 v3, v3, v4
v_rcp_f32 v26, v3
v_subrev_u32 v3, 0x21800000, v3
v_mul_f32 v24, v24, v26
v_mul_f32 v25, v25, v26
v_cvt_pk_bf16_f32 v4, v24, v25
buffer_store_dword v4, v159, s[4:7], s28 offen
s_branch FD_96
SL_97:
buffer_store_dword v4, v159, s[4:7], s28 offen sc1
buffer_store_dword v10, v12, s[4:7], s43 offen sc1
s_branch SB_98
SL_99:
buffer_store_dword v13, v159, s[4:7], s29 offen sc1
s_branch SB_100
QK2:
v_and_b32 v0, 63, v0
v_lshrrev_b32 v1, 4, v0
v_and_b32 v2, 15, v0
v_lshlrev_b32 v9, 4, v0
v_add_u32 v14, 28672, v9
v_bfe_u32 v3, v2, 1, 1
v_lshrrev_b32 v4, 2, v2
v_lshlrev_b32 v4, 1, v4
v_and_b32 v5, 1, v2
v_add_u32 v4, v4, v5
v_mul_u32_u24 v8, 0xaaaa, v3
v_add_u32 v8, 0x4444, v8
v_mov_b32 v13, -1
s_mov_b32 s43, 71303168
v_lshlrev_b32 v160, 7, v0
v_lshrrev_b32 v5, 2, v2
v_and_b32 v6, 1, v2
v_lshlrev_b32 v6, 4, v6
v_mov_b32 v7, 0x3f80
v_lshlrev_b32 v6, v6, v7
v_cmp_eq_u32 vcc, v5, v1
s_nop 1
v_cndmask_b32 v6, 0, v6, vcc
v_cmp_eq_u32 vcc, 0, v3
s_nop 1
v_cndmask_b32 v152, 0, v6, vcc
v_cndmask_b32 v153, 0, v6, vcc
v_cndmask_b32 v154, v6, 0, vcc
v_cndmask_b32 v155, v6, 0, vcc
s_mov_b64 s[48:49], vcc
v_mul_u32_u24 v5, 320, v1
v_add_u32 v5, 59936, v5
v_and_b32 v6, 12, v2
v_add_u32 v6, v6, v2
v_lshl_add_u32 v156, v6, 2, v5
v_lshl_add_u32 v5, v4, 2, v5
v_add_u32 v5, 128, v5
v_lshlrev_b32 v6, 2, v2
v_add_u32 v6, 62528, v6
v_cndmask_b32 v157, v6, v5, vcc
v_lshrrev_b32 v3, 5, v0
v_and_b32 v4, 31, v0
v_mul_u32_u24 v5, 160, v3
v_lshl_add_u32 v5, v4, 3, v5
v_add_u32 v5, 57984, v5
v_mov_b32 v6, 58624
v_cmp_gt_u32 vcc, 20, v4
s_nop 1
v_cndmask_b32 v158, v6, v5, vcc
v_mov_b32 v6, 58632
v_cndmask_b32 v161, v6, v5, vcc
v_and_b32 v5, 1, v4
v_lshl_add_u32 v5, v5, 1, v3
v_lshlrev_b32 v5, 4, v5
v_bfe_u32 v6, v4, 3, 1
v_lshl_add_u32 v6, v6, 8, v5
v_bfe_u32 v7, v4, 1, 2
v_lshl_add_u32 v6, v7, 2, v6
s_lshl_b32 s35, s11, 9
s_add_u32 s35, s35, 2176
v_add_u32 v6, s35, v6
v_bfe_u32 v5, v4, 1, 1
v_lshlrev_b32 v5, 8, v5
v_lshl_add_u32 v5, v3, 4, v5
v_and_b32 v7, 1, v4
v_lshl_add_u32 v5, v7, 3, v5
s_lshr_b32 s35, s11, 2
s_lshl_b32 s35, s35, 9
s_and_b32 s36, s11, 1
s_lshl_b32 s36, s36, 5
s_add_u32 s35, s35, s36
s_and_b32 s36, s11, 2
s_lshl_b32 s36, s36, 1
s_add_u32 s35, s35, s36
s_add_u32 s35, s35, 128
v_add_u32 v5, s35, v5
v_mov_b32 v7, 1073741824
v_cndmask_b32 v5, v7, v5, vcc
v_cmp_gt_u32 vcc, 16, v4
s_nop 1
v_cndmask_b32 v159, v5, v6, vcc
s_mov_b32 s35, 55312384
buffer_store_dword v13, v159, s[4:7], s35 offen sc1
s_mov_b32 s35, 55328768
buffer_store_dword v13, v159, s[4:7], s35 offen sc1
s_mov_b32 s35, 55345152
buffer_store_dword v13, v159, s[4:7], s35 offen sc1
s_mov_b32 s35, 55361536
buffer_store_dword v13, v159, s[4:7], s35 offen sc1
v_mov_b32 v5, 61216
v_mov_b32 v6, 0xf149f2ca
ds_write2_b32 v5, v6, v6 offset0:0 offset1:1
v_mul_u32_u24 v12, 640, v0
s_lshl_b32 s35, s11, 2
s_add_u32 s35, s35, 0
v_add_u32 v12, s35, v12
v_mov_b32 v7, 1073741824
v_cmp_gt_u32 vcc, 4, v0
s_nop 1
v_cndmask_b32 v12, v7, v12, vcc
v_mov_b32 v136, 0
v_mov_b32 v137, 0
v_mov_b32 v138, 0
v_mov_b32 v139, 0
s_mul_i32 s40, s11, 0
s_add_u32 s40, s40, 16785408
s_mov_b32 s10, 0
s_mov_b32 s38, 200000
s_mov_b32 s68, 0
s_mov_b32 s69, 0
s_mov_b32 s70, 0
s_mov_b32 s71, 0
v_mov_b32 v3, -1
v_mov_b32 v4, -1
ds_write2_b32 v161, v13, v13 offset0:0 offset1:1
v_add_u32 v5, 1296, v161
ds_write2_b32 v5, v13, v13 offset0:0 offset1:1
v_add_u32 v5, 2592, v161
ds_write2_b32 v5, v13, v13 offset0:0 offset1:1
v_add_u32 v5, 3888, v161
ds_write2_b32 v5, v13, v13 offset0:0 offset1:1
s_waitcnt vmcnt(0) lgkmcnt(0)
s_barrier
s_mov_b32 s34, 71343104
v_min_u32 v3, 24, v0
v_lshlrev_b32 v3, 14, v3
s_mul_i32 s34, s11, 401408
s_add_u32 s34, s34, 0
buffer_load_dword v4, v3, s[4:7], s34 offen sc1
s_waitcnt vmcnt(0)
v_min_u32 v3, 13, v2
v_lshlrev_b32 v3, 2, v3
s_lshl_b32 s35, s11, 8
s_add_u32 s35, s35, 17408
v_add_u32 v3, s35, v3
s_mov_b32 s41, 71319552
s_mov_b64 vcc, -1
s_mul_i32 s34, s11, 401408
s_and_b32 s36, vcc_lo, 65535
s_cbranch_scc0 RD_104
RL_103:
buffer_load_dword v4, v3, s[4:7], s41 offen sc1
s_sub_u32 s38, s38, 1
s_cmp_gt_i32 s38, 0
s_cbranch_scc0 RD_104
s_waitcnt vmcnt(0)
v_cmp_ne_u32 vcc, 1, v4
s_nop 0
s_and_b32 s36, vcc_lo, 65535
s_cbranch_scc0 RD_104
s_sleep 2
s_branch RL_103
RD_104:
s_add_u32 s35, s34, 118784
buffer_load_dwordx4 a[0:3], v9, s[4:7], s35 offen sc1
buffer_load_dwordx4 a[4:7], v9, s[4:7], s35 offen offset:1024 sc1
s_add_u32 s35, s34, 114688
buffer_load_dwordx4 a[8:11], v9, s[4:7], s35 offen sc1
buffer_load_dwordx4 a[12:15], v9, s[4:7], s35 offen offset:1024 sc1
s_add_u32 s35, s34, 116736
buffer_load_dwordx4 a[16:19], v9, s[4:7], s35 offen sc1
buffer_load_dwordx4 a[20:23], v9, s[4:7], s35 offen offset:1024 sc1
s_add_u32 s35, s34, 120832
buffer_load_dwordx4 a[24:27], v9, s[4:7], s35 offen sc1
buffer_load_dwordx4 a[28:31], v9, s[4:7], s35 offen offset:1024 sc1
s_add_u32 s35, s34, 126976
buffer_load_dwordx4 a[32:35], v9, s[4:7], s35 offen sc1
buffer_load_dwordx4 a[36:39], v9, s[4:7], s35 offen offset:1024 sc1
s_add_u32 s35, s34, 122880
buffer_load_dwordx4 a[40:43], v9, s[4:7], s35 offen sc1
buffer_load_dwordx4 a[44:47], v9, s[4:7], s35 offen offset:1024 sc1
s_add_u32 s35, s34, 124928
buffer_load_dwordx4 a[48:51], v9, s[4:7], s35 offen sc1
buffer_load_dwordx4 a[52:55], v9, s[4:7], s35 offen offset:1024 sc1
s_add_u32 s35, s34, 147456
buffer_load_dwordx4 a[56:59], v9, s[4:7], s35 offen sc1
buffer_load_dwordx4 a[60:63], v9, s[4:7], s35 offen offset:1024 sc1
s_add_u32 s35, s34, 143360
buffer_load_dwordx4 a[64:67], v9, s[4:7], s35 offen sc1
buffer_load_dwordx4 a[68:71], v9, s[4:7], s35 offen offset:1024 sc1
s_add_u32 s35, s34, 145408
buffer_load_dwordx4 a[72:75], v9, s[4:7], s35 offen sc1
buffer_load_dwordx4 a[76:79], v9, s[4:7], s35 offen offset:1024 sc1
s_add_u32 s35, s34, 149504
buffer_load_dwordx4 a[80:83], v9, s[4:7], s35 offen sc1
buffer_load_dwordx4 a[84:87], v9, s[4:7], s35 offen offset:1024 sc1
s_add_u32 s35, s34, 155648
buffer_load_dwordx4 a[88:91], v9, s[4:7], s35 offen sc1
buffer_load_dwordx4 a[92:95], v9, s[4:7], s35 offen offset:1024 sc1
s_add_u32 s35, s34, 151552
buffer_load_dwordx4 a[96:99], v9, s[4:7], s35 offen sc1
buffer_load_dwordx4 a[100:103], v9, s[4:7], s35 offen offset:1024 sc1
s_add_u32 s35, s34, 153600
buffer_load_dwordx4 a[104:107], v9, s[4:7], s35 offen sc1
buffer_load_dwordx4 a[108:111], v9, s[4:7], s35 offen offset:1024 sc1
s_add_u32 s35, s34, 133120
buffer_load_dwordx4 a[112:115], v9, s[4:7], s35 offen sc1
buffer_load_dwordx4 a[116:119], v9, s[4:7], s35 offen offset:1024 sc1
s_add_u32 s35, s34, 129024
buffer_load_dwordx4 a[120:123], v9, s[4:7], s35 offen sc1
buffer_load_dwordx4 a[124:127], v9, s[4:7], s35 offen offset:1024 sc1
s_add_u32 s35, s34, 131072
buffer_load_dwordx4 a[128:131], v9, s[4:7], s35 offen sc1
buffer_load_dwordx4 a[132:135], v9, s[4:7], s35 offen offset:1024 sc1
s_add_u32 s35, s34, 135168
buffer_load_dwordx4 a[136:139], v9, s[4:7], s35 offen sc1
buffer_load_dwordx4 a[140:143], v9, s[4:7], s35 offen offset:1024 sc1
s_add_u32 s35, s34, 141312
buffer_load_dwordx4 a[144:147], v9, s[4:7], s35 offen sc1
buffer_load_dwordx4 a[148:151], v9, s[4:7], s35 offen offset:1024 sc1
s_add_u32 s35, s34, 137216
buffer_load_dwordx4 a[152:155], v9, s[4:7], s35 offen sc1
buffer_load_dwordx4 a[156:159], v9, s[4:7], s35 offen offset:1024 sc1
s_add_u32 s35, s34, 139264
buffer_load_dwordx4 a[160:163], v9, s[4:7], s35 offen sc1
buffer_load_dwordx4 a[164:167], v9, s[4:7], s35 offen offset:1024 sc1
s_add_u32 s35, s34, 161792
buffer_load_dwordx4 a[168:171], v9, s[4:7], s35 offen sc1
buffer_load_dwordx4 a[172:175], v9, s[4:7], s35 offen offset:1024 sc1
s_add_u32 s35, s34, 157696
buffer_load_dwordx4 a[176:179], v9, s[4:7], s35 offen sc1
buffer_load_dwordx4 a[180:183], v9, s[4:7], s35 offen offset:1024 sc1
s_add_u32 s35, s34, 159744
buffer_load_dwordx4 a[184:187], v9, s[4:7], s35 offen sc1
buffer_load_dwordx4 a[188:191], v9, s[4:7], s35 offen offset:1024 sc1
s_add_u32 s35, s34, 163840
buffer_load_dwordx4 a[192:195], v9, s[4:7], s35 offen sc1
buffer_load_dwordx4 a[196:199], v9, s[4:7], s35 offen offset:1024 sc1
s_add_u32 s35, s34, 169984
buffer_load_dwordx4 a[200:203], v9, s[4:7], s35 offen sc1
buffer_load_dwordx4 a[204:207], v9, s[4:7], s35 offen offset:1024 sc1
s_add_u32 s35, s34, 165888
buffer_load_dwordx4 a[208:211], v9, s[4:7], s35 offen sc1
buffer_load_dwordx4 a[212:215], v9, s[4:7], s35 offen offset:1024 sc1
s_add_u32 s35, s34, 167936
buffer_load_dwordx4 a[216:219], v9, s[4:7], s35 offen sc1
buffer_load_dwordx4 a[220:223], v9, s[4:7], s35 offen offset:1024 sc1
s_add_u32 s35, s34, 348160
s_mov_b32 m0, 28672
s_nop 0
buffer_load_dwordx4 v9, s[4:7], s35 offen sc1 lds
buffer_load_dwordx4 v9, s[4:7], s35 offen offset:1024 sc1 lds
s_add_u32 s35, s34, 344064
s_mov_b32 m0, 30720
s_nop 0
buffer_load_dwordx4 v9, s[4:7], s35 offen sc1 lds
buffer_load_dwordx4 v9, s[4:7], s35 offen offset:1024 sc1 lds
s_waitcnt vmcnt(40)
s_add_u32 s35, s34, 346112
s_mov_b32 m0, 32768
s_nop 0
buffer_load_dwordx4 v9, s[4:7], s35 offen sc1 lds
buffer_load_dwordx4 v9, s[4:7], s35 offen offset:1024 sc1 lds
s_add_u32 s35, s34, 350208
s_mov_b32 m0, 34816
s_nop 0
buffer_load_dwordx4 v9, s[4:7], s35 offen sc1 lds
buffer_load_dwordx4 v9, s[4:7], s35 offen offset:1024 sc1 lds
s_add_u32 s35, s34, 356352
s_mov_b32 m0, 36864
s_nop 0
buffer_load_dwordx4 v9, s[4:7], s35 offen sc1 lds
buffer_load_dwordx4 v9, s[4:7], s35 offen offset:1024 sc1 lds
s_add_u32 s35, s34, 352256
s_mov_b32 m0, 38912
s_nop 0
buffer_load_dwordx4 v9, s[4:7], s35 offen sc1 lds
buffer_load_dwordx4 v9, s[4:7], s35 offen offset:1024 sc1 lds
s_add_u32 s35, s34, 354304
s_mov_b32 m0, 40960
s_nop 0
buffer_load_dwordx4 v9, s[4:7], s35 offen sc1 lds
buffer_load_dwordx4 v9, s[4:7], s35 offen offset:1024 sc1 lds
s_add_u32 s35, s34, 376832
buffer_load_dwordx4 a[224:227], v9, s[4:7], s35 offen sc1
buffer_load_dwordx4 a[228:231], v9, s[4:7], s35 offen offset:1024 sc1
s_add_u32 s35, s34, 372736
buffer_load_dwordx4 a[232:235], v9, s[4:7], s35 offen sc1
buffer_load_dwordx4 a[236:239], v9, s[4:7], s35 offen offset:1024 sc1
s_add_u32 s35, s34, 374784
buffer_load_dwordx4 a[240:243], v9, s[4:7], s35 offen sc1
buffer_load_dwordx4 a[244:247], v9, s[4:7], s35 offen offset:1024 sc1
s_add_u32 s35, s34, 378880
buffer_load_dwordx4 a[248:251], v9, s[4:7], s35 offen sc1
buffer_load_dwordx4 a[252:255], v9, s[4:7], s35 offen offset:1024 sc1
s_add_u32 s35, s34, 385024
buffer_load_dwordx4 v[164:167], v9, s[4:7], s35 offen sc1
buffer_load_dwordx4 v[168:171], v9, s[4:7], s35 offen offset:1024 sc1
s_waitcnt vmcnt(40)
s_add_u32 s35, s34, 380928
buffer_load_dwordx4 v[172:175], v9, s[4:7], s35 offen sc1
buffer_load_dwordx4 v[176:179], v9, s[4:7], s35 offen offset:1024 sc1
s_add_u32 s35, s34, 382976
buffer_load_dwordx4 v[180:183], v9, s[4:7], s35 offen sc1
buffer_load_dwordx4 v[184:187], v9, s[4:7], s35 offen offset:1024 sc1
s_add_u32 s35, s34, 391168
buffer_load_dwordx4 v[188:191], v9, s[4:7], s35 offen sc1
buffer_load_dwordx4 v[192:195], v9, s[4:7], s35 offen offset:1024 sc1
s_add_u32 s35, s34, 387072
buffer_load_dwordx4 v[196:199], v9, s[4:7], s35 offen sc1
buffer_load_dwordx4 v[200:203], v9, s[4:7], s35 offen offset:1024 sc1
s_add_u32 s35, s34, 389120
buffer_load_dwordx4 v[204:207], v9, s[4:7], s35 offen sc1
buffer_load_dwordx4 v[208:211], v9, s[4:7], s35 offen offset:1024 sc1
s_add_u32 s35, s34, 393216
buffer_load_dwordx4 v[212:215], v9, s[4:7], s35 offen sc1
buffer_load_dwordx4 v[216:219], v9, s[4:7], s35 offen offset:1024 sc1
s_add_u32 s35, s34, 399360
buffer_load_dwordx4 v[220:223], v9, s[4:7], s35 offen sc1
buffer_load_dwordx4 v[224:227], v9, s[4:7], s35 offen offset:1024 sc1
s_add_u32 s35, s34, 395264
buffer_load_dwordx4 v[228:231], v9, s[4:7], s35 offen sc1
buffer_load_dwordx4 v[232:235], v9, s[4:7], s35 offen offset:1024 sc1
s_add_u32 s35, s34, 397312
buffer_load_dwordx4 v[236:239], v9, s[4:7], s35 offen sc1
buffer_load_dwordx4 v[240:243], v9, s[4:7], s35 offen offset:1024 sc1
s_mov_b32 s34, 71343104
s_barrier
v_mov_b32 v3, 151552
ds_read_b32 v4, v3
s_waitcnt lgkmcnt(0)
v_readfirstlane_b32 s66, v4
s_lshl_b32 s52, s10, 15
s_add_u32 s52, s52, 50348032
buffer_load_dwordx4 v[104:107], v9, s[4:7], s52 offen offset:0 sc1
buffer_load_dwordx4 v[108:111], v9, s[4:7], s52 offen offset:1024 sc1
buffer_load_dwordx4 v[112:115], v9, s[4:7], s52 offen offset:2048 sc1
buffer_load_dwordx4 v[116:119], v9, s[4:7], s52 offen offset:3072 sc1
s_waitcnt vmcnt(4)
v_mov_b32 v60, 0
v_mov_b32 v61, 0
v_mov_b32 v62, 0
v_mov_b32 v63, 0
v_mov_b32 v64, 0
v_mov_b32 v65, 0
v_mov_b32 v66, 0
v_mov_b32 v67, 0
v_mov_b32 v68, 0
v_mov_b32 v69, 0
v_mov_b32 v70, 0
v_mov_b32 v71, 0
v_mov_b32 v72, 0
v_mov_b32 v73, 0
v_mov_b32 v74, 0
v_mov_b32 v75, 0
v_mov_b32 v76, 0
v_mov_b32 v77, 0
v_mov_b32 v78, 0
v_mov_b32 v79, 0
v_mov_b32 v80, 0
v_mov_b32 v81, 0
v_mov_b32 v82, 0
v_mov_b32 v83, 0
v_mov_b32 v84, 0
v_mov_b32 v85, 0
v_mov_b32 v86, 0
v_mov_b32 v87, 0
v_mov_b32 v140, 0
v_mov_b32 v141, 0
v_mov_b32 v142, 0
v_mov_b32 v143, 0
v_mov_b32 v144, 0
v_mov_b32 v145, 0
v_mov_b32 v146, 0
v_mov_b32 v147, 0
s_lshl_b32 s26, s10, 13
s_add_u32 s26, s26, 54525952
s_add_u32 s27, s26, 4096
LOOP_107:
s_barrier
buffer_load_dwordx4 v[16:19], v9, s[4:7], s26 offen offset:2048 sc1
ds_read_b128 v[44:47], v14 offset:0
ds_read_b128 v[48:51], v14 offset:1024
ds_read_b128 v[52:55], v14 offset:2048
ds_read_b128 v[56:59], v14 offset:3072
s_add_u32 s39, s10, 1
s_barrier
buffer_load_dwordx4 v[20:23], v9, s[4:7], s26 offen offset:0
s_mov_b64 s[50:51], -1
v_mov_b32 v10, s39
s_and_b32 s34, s10, 3
s_lshl_b32 s28, s34, 14
s_add_u32 s28, s28, 55312384
s_barrier
buffer_load_dwordx4 v[24:27], v9, s[4:7], s26 offen offset:1024
s_xor_b32 s29, s28, 32768
s_min_u32 s37, s39, 63
s_add_u32 s53, s52, 4096
s_lshl_b32 s52, s37, 15
s_add_u32 s52, s52, 50348032
s_barrier
buffer_load_dwordx4 v[28:31], v9, s[4:7], s26 offen offset:3072
s_waitcnt vmcnt(3)
v_smfmac_f32_16x16x64_bf16 v[60:63], v[16:19], a[0:7], v8
buffer_load_dwordx4 v[32:35], v9, s[4:7], s27 offen offset:2048
v_cmp_eq_u32 vcc, -1, v16
v_smfmac_f32_16x16x64_bf16 v[64:67], v[16:19], a[56:63], v8
v_smfmac_f32_16x16x64_bf16 v[68:71], v[16:19], a[112:119], v8
s_cbranch_vccnz RT_111
BK_112:
v_smfmac_f32_16x16x64_bf16 v[72:75], v[16:19], a[168:175], v8
s_waitcnt lgkmcnt(2)
v_smfmac_f32_16x16x64_bf16 v[76:79], v[16:19], v[44:51], v8
s_waitcnt vmcnt(3)
v_smfmac_f32_16x16x64_bf16 v[60:63], v[20:23], a[8:15], v8
buffer_load_dwordx4 v[36:39], v9, s[4:7], s27 offen offset:0
v_smfmac_f32_16x16x64_bf16 v[64:67], v[20:23], a[64:71], v8
ds_read_b128 v[44:47], v14 offset:4096
v_smfmac_f32_16x16x64_bf16 v[68:71], v[20:23], a[120:127], v8
ds_read_b128 v[48:51], v14 offset:5120
v_smfmac_f32_16x16x64_bf16 v[72:75], v[20:23], a[176:183], v8
s_waitcnt lgkmcnt(2)
v_smfmac_f32_16x16x64_bf16 v[76:79], v[20:23], v[52:59], v8
s_waitcnt vmcnt(3)
v_smfmac_f32_16x16x64_bf16 v[60:63], v[24:27], a[16:23], v8
buffer_load_dwordx4 v[40:43], v9, s[4:7], s27 offen offset:1024
v_smfmac_f32_16x16x64_bf16 v[64:67], v[24:27], a[72:79], v8
ds_read_b128 v[52:55], v14 offset:6144
v_smfmac_f32_16x16x64_bf16 v[68:71], v[24:27], a[128:135], v8
ds_read_b128 v[56:59], v14 offset:7168
v_smfmac_f32_16x16x64_bf16 v[72:75], v[24:27], a[184:191], v8
s_waitcnt lgkmcnt(2)
v_smfmac_f32_16x16x64_bf16 v[76:79], v[24:27], v[44:51], v8
s_waitcnt vmcnt(3)
v_smfmac_f32_16x16x64_bf16 v[60:63], v[28:31], a[24:31], v8
buffer_load_dwordx4 v[120:123], v9, s[4:7], s53 offen offset:0 sc1
v_smfmac_f32_16x16x64_bf16 v[64:67], v[28:31], a[80:87], v8
ds_read_b128 v[44:47], v14 offset:8192
v_smfmac_f32_16x16x64_bf16 v[68:71], v[28:31], a[136:143], v8
ds_read_b128 v[48:51], v14 offset:9216
v_smfmac_f32_16x16x64_bf16 v[72:75], v[28:31], a[192:199], v8
s_waitcnt lgkmcnt(2)
v_smfmac_f32_16x16x64_bf16 v[76:79], v[28:31], v[52:59], v8
buffer_load_dwordx4 v[124:127], v9, s[4:7], s53 offen offset:1024 sc1
s_waitcnt vmcnt(4)
v_smfmac_f32_16x16x64_bf16 v[60:63], v[32:35], a[32:39], v8
ds_read_b128 v[52:55], v14 offset:10240
v_smfmac_f32_16x16x64_bf16 v[64:67], v[32:35], a[88:95], v8
ds_read_b128 v[56:59], v14 offset:11264
v_smfmac_f32_16x16x64_bf16 v[68:71], v[32:35], a[144:151], v8
v_smfmac_f32_16x16x64_bf16 v[72:75], v[32:35], a[200:207], v8
buffer_load_dwordx4 v[128:131], v9, s[4:7], s53 offen offset:2048 sc1
s_waitcnt lgkmcnt(2)
v_smfmac_f32_16x16x64_bf16 v[76:79], v[32:35], v[44:51], v8
s_waitcnt vmcnt(4)
v_smfmac_f32_16x16x64_bf16 v[60:63], v[36:39], a[40:47], v8
ds_read_b128 v[44:47], v14 offset:12288
v_smfmac_f32_16x16x64_bf16 v[64:67], v[36:39], a[96:103], v8
ds_read_b128 v[48:51], v14 offset:13312
v_smfmac_f32_16x16x64_bf16 v[68:71], v[36:39], a[152:159], v8
buffer_load_dwordx4 v[132:135], v9, s[4:7], s53 offen offset:3072 sc1
v_smfmac_f32_16x16x64_bf16 v[72:75], v[36:39], a[208:215], v8
s_waitcnt lgkmcnt(2)
v_smfmac_f32_16x16x64_bf16 v[76:79], v[36:39], v[52:59], v8
s_waitcnt vmcnt(4)
v_smfmac_f32_16x16x64_bf16 v[60:63], v[40:43], a[48:55], v8
v_smfmac_f32_16x16x64_bf16 v[64:67], v[40:43], a[104:111], v8
v_smfmac_f32_16x16x64_bf16 v[68:71], v[40:43], a[160:167], v8
v_cvt_pk_bf16_f32 v60, v60, v61
v_smfmac_f32_16x16x64_bf16 v[72:75], v[40:43], a[216:223], v8
s_waitcnt lgkmcnt(0)
v_cvt_pk_bf16_f32 v61, v62, v63
v_smfmac_f32_16x16x64_bf16 v[76:79], v[40:43], v[44:51], v8
v_cvt_pk_bf16_f32 v62, v64, v65
JOIN_110:
v_smfmac_f32_16x16x64_bf16 v[80:83], v[16:19], a[224:231], v8
v_cvt_pk_bf16_f32 v63, v66, v67
v_smfmac_f32_16x16x64_bf16 v[80:83], v[20:23], a[232:239], v8
v_cvt_pk_bf16_f32 v68, v68, v69
v_mfma_f32_16x16x32_bf16 v[88:91], v[60:63], v[152:155], 0
v_cvt_pk_bf16_f32 v69, v70, v71
v_cvt_pk_bf16_f32 v70, v72, v73
v_smfmac_f32_16x16x64_bf16 v[80:83], v[24:27], a[240:247], v8
v_cvt_pk_bf16_f32 v71, v74, v75
v_smfmac_f32_16x16x64_bf16 v[80:83], v[28:31], a[248:255], v8
v_cvt_pk_bf16_f32 v76, v76, v77
v_mfma_f32_16x16x32_bf16 v[92:95], v[68:71], v[152:155], 0
v_cvt_pk_bf16_f32 v96, v88, v89
v_cvt_pk_bf16_f32 v97, v90, v91
v_smfmac_f32_16x16x64_bf16 v[80:83], v[32:35], v[164:171], v8
v_cmp_u_f32 vcc, v88, v89
v_smfmac_f32_16x16x64_bf16 v[80:83], v[36:39], v[172:179], v8
v_cvt_pk_bf16_f32 v77, v78, v79
v_smfmac_f32_16x16x64_bf16 v[80:83], v[40:43], v[180:187], v8
v_cvt_pk_bf16_f32 v98, v92, v93
v_smfmac_f32_16x16x64_bf16 v[84:87], v[16:19], v[188:195], v8
v_cvt_pk_bf16_f32 v99, v94, v95
v_smfmac_f32_16x16x64_bf16 v[84:87], v[20:23], v[196:203], v8
s_and_b64 vcc, vcc, s[50:51]
s_cbranch_scc1 FAIL_109
v_smfmac_f32_16x16x64_bf16 v[84:87], v[24:27], v[204:211], v8
v_cvt_pk_bf16_f32 v78, v80, v81
v_smfmac_f32_16x16x64_bf16 v[84:87], v[28:31], v[212:219], v8
v_cvt_pk_bf16_f32 v79, v82, v83
v_smfmac_f32_16x16x64_bf16 v[84:87], v[32:35], v[220:227], v8
v_mov_b32 v60, 0
v_smfmac_f32_16x16x64_bf16 v[84:87], v[36:39], v[228:235], v8
v_mov_b32 v61, 0
v_smfmac_f32_16x16x64_bf16 v[84:87], v[40:43], v[236:243], v8
v_mov_b32 v62, 0
v_mfma_f32_16x16x32_bf16 v[88:91], v[76:79], v[152:155], 0
v_mov_b32 v63, 0
v_mov_b32 v64, 0
v_mfma_f32_16x16x32_bf16 v[148:151], v[96:99], v[16:19], 0
v_cvt_pk_bf16_f32 v138, v84, v85
v_cvt_pk_bf16_f32 v139, v86, v87
v_mov_b32 v65, 0
s_nop 0
v_cvt_pk_bf16_f32 v100, v88, v89
v_mfma_f32_16x16x32_bf16 v[92:95], v[136:139], v[152:155], 0
v_cvt_pk_bf16_f32 v101, v90, v91
v_mov_b32 v66, 0
v_smfmac_f32_16x16x64_bf16 v[140:143], v[96:99], v[104:111], v8
v_mov_b32 v67, 0
v_smfmac_f32_16x16x64_bf16 v[144:147], v[96:99], v[112:119], v8
v_cvt_pk_bf16_f32 v102, v92, v93
v_cvt_pk_bf16_f32 v103, v94, v95
v_mov_b32 v68, 0
s_waitcnt vmcnt(2)
v_smfmac_f32_16x16x64_bf16 v[140:143], v[100:103], v[120:127], v8
s_waitcnt vmcnt(0)
v_smfmac_f32_16x16x64_bf16 v[144:147], v[100:103], v[128:135], v8
v_mfma_f32_16x16x32_bf16 v[148:151], v[100:103], v[32:35], v[148:151]
v_add_f32 v140, v140, v142
v_add_f32 v141, v141, v143
ds_write2_b32 v156, v140, v141 offset0:0 offset1:40
s_nop 0
v_add_f32 v144, v144, v146
v_add_f32 v145, v145, v147
ds_write2_b32 v156, v144, v145 offset0:4 offset1:44
s_nop 0
v_add_f32_dpp v148, v150, v148 quad_perm:[2,3,0,1] row_mask:0xf bank_mask:0xf
v_add_f32_dpp v149, v151, v149 quad_perm:[2,3,0,1] row_mask:0xf bank_mask:0xf
ds_write2_b32 v157, v148, v149 offset0:0 offset1:40
v_mov_b32 v69, 0
v_mov_b32 v70, 0
v_mov_b32 v71, 0
v_mov_b32 v72, 0
s_barrier
ds_read_b64 v[16:17], v158 offset:0
v_mov_b32 v73, 0
ds_read_b64 v[18:19], v158 offset:1296
ds_read_b64 v[20:21], v158 offset:2592
v_mov_b32 v74, 0
ds_read_b64 v[22:23], v158 offset:3888
v_mov_b32 v75, 0
v_mov_b32 v76, 0
v_mov_b32 v77, 0
v_mov_b32 v78, 0
v_mov_b32 v79, 0
s_waitcnt lgkmcnt(2)
v_add_f32 v16, v16, v18
v_add_f32 v17, v17, v19
s_waitcnt lgkmcnt(0)
v_add_f32 v20, v20, v22
v_add_f32 v21, v21, v23
v_add_f32 v16, v16, v20
v_add_f32 v17, v17, v21
v_exp_f32 v24, v16
v_exp_f32 v25, v17
s_nop 0
v_add_f32 v3, v24, v25
v_mov_b32 v80, 0
v_mov_b32 v81, 0
v_add_f32_dpp v3, v3, v3 quad_perm:[1,0,3,2] row_mask:0xf bank_mask:0xf
v_mov_b32 v82, 0
v_mov_b32 v83, 0
v_add_f32_dpp v3, v3, v3 quad_perm:[2,3,0,1] row_mask:0xf bank_mask:0xf
v_mov_b32 v84, 0
v_mov_b32 v85, 0
v_add_f32_dpp v3, v3, v3 row_half_mirror row_mask:0xf bank_mask:0xf
v_mov_b32 v86, 0
v_mov_b32 v87, 0
v_add_f32_dpp v3, v3, v3 row_mirror row_mask:0xf bank_mask:0xf
v_mov_b32 v4, v3
s_nop 1
v_permlane16_swap_b32 v3, v4
v_add_f32 v3, v3, v4
v_rcp_f32 v26, v3
v_subrev_u32 v3, 0x21800000, v3
v_mul_f32 v24, v24, v26
v_mul_f32 v25, v25, v26
v_cvt_pk_bf16_f32 v4, v24, v25
v_cmpx_gt_u32 vcc, 0x50000000, v3
buffer_store_dword v4, v159, s[4:7], s28 offen
s_mov_b64 exec, -1
s_cmp_lg_u64 vcc, -1
s_cbranch_scc1 FB_113
FD_114:
s_cmp_lg_u32 s66, 0
s_cbranch_scc1 SL_115
SB_116:
s_barrier
buffer_store_dword v13, v159, s[4:7], s29 offen
s_cmp_lg_u32 s66, 0
s_cbranch_scc1 SL_117
SB_118:
buffer_load_dwordx4 v[104:107], v9, s[4:7], s52 offen offset:0 sc1
buffer_load_dwordx4 v[108:111], v9, s[4:7], s52 offen offset:1024 sc1
buffer_load_dwordx4 v[112:115], v9, s[4:7], s52 offen offset:2048 sc1
buffer_load_dwordx4 v[116:119], v9, s[4:7], s52 offen offset:3072 sc1
v_mov_b32 v16, -1
v_mov_b32 v17, -1
ds_write_b64 v161, v[16:17] offset:0
ds_write_b64 v161, v[16:17] offset:1296
ds_write_b64 v161, v[16:17] offset:2592
ds_write_b64 v161, v[16:17] offset:3888
s_waitcnt lgkmcnt(0)
v_mov_b32 v140, 0
v_mov_b32 v141, 0
v_mov_b32 v142, 0
v_mov_b32 v143, 0
v_mov_b32 v144, 0
v_mov_b32 v145, 0
v_mov_b32 v146, 0
v_mov_b32 v147, 0
s_add_u32 s10, s10, 1
s_lshl_b32 s26, s10, 13
s_add_u32 s26, s26, 54525952
s_add_u32 s27, s26, 4096
s_cmp_ge_u32 s10, 63
s_cbranch_scc1 END_108
s_branch LOOP_107
END_108:
s_endpgm
RT_111:
buffer_load_dwordx4 v[16:19], v9, s[4:7], s26 offen offset:2048 sc1
buffer_load_dwordx4 v[20:23], v9, s[4:7], s26 offen offset:0 sc1
buffer_load_dwordx4 v[24:27], v9, s[4:7], s26 offen offset:1024 sc1
buffer_load_dwordx4 v[28:31], v9, s[4:7], s26 offen offset:3072 sc1
buffer_load_dwordx4 v[32:35], v9, s[4:7], s27 offen offset:2048 sc1
s_sub_u32 s38, s38, 1
s_cmp_gt_i32 s38, 0
s_cbranch_scc0 END_108
v_mov_b32 v60, 0
v_mov_b32 v61, 0
v_mov_b32 v62, 0
v_mov_b32 v63, 0
v_mov_b32 v64, 0
v_mov_b32 v65, 0
v_mov_b32 v66, 0
v_mov_b32 v67, 0
v_mov_b32 v68, 0
v_mov_b32 v69, 0
v_mov_b32 v70, 0
v_mov_b32 v71, 0
s_waitcnt vmcnt(0)
v_cmp_eq_u32 vcc, -1, v16
s_cbranch_vccnz RT_111
v_smfmac_f32_16x16x64_bf16 v[60:63], v[16:19], a[0:7], v8
v_smfmac_f32_16x16x64_bf16 v[64:67], v[16:19], a[56:63], v8
v_smfmac_f32_16x16x64_bf16 v[68:71], v[16:19], a[112:119], v8
s_branch BK_112
FAIL_109:
s_mov_b64 s[50:51], 0
FAIL_109b:
buffer_load_dwordx4 v[16:19], v9, s[4:7], s26 offen offset:2048 sc1
buffer_load_dwordx4 v[20:23], v9, s[4:7], s26 offen offset:0 sc1
buffer_load_dwordx4 v[24:27], v9, s[4:7], s26 offen offset:1024 sc1
buffer_load_dwordx4 v[28:31], v9, s[4:7], s26 offen offset:3072 sc1
buffer_load_dwordx4 v[32:35], v9, s[4:7], s27 offen offset:2048 sc1
buffer_load_dwordx4 v[36:39], v9, s[4:7], s27 offen offset:0 sc1
buffer_load_dwordx4 v[40:43], v9, s[4:7], s27 offen offset:1024 sc1
s_sub_u32 s38, s38, 1
s_cmp_gt_i32 s38, 0
s_cbranch_scc0 END_108
v_mov_b32 v60, 0
v_mov_b32 v61, 0
v_mov_b32 v62, 0
v_mov_b32 v63, 0
v_mov_b32 v64, 0
v_mov_b32 v65, 0
v_mov_b32 v66, 0
v_mov_b32 v67, 0
v_mov_b32 v68, 0
v_mov_b32 v69, 0
v_mov_b32 v70, 0
v_mov_b32 v71, 0
v_mov_b32 v72, 0
v_mov_b32 v73, 0
v_mov_b32 v74, 0
v_mov_b32 v75, 0
v_mov_b32 v76, 0
v_mov_b32 v77, 0
v_mov_b32 v78, 0
v_mov_b32 v79, 0
v_mov_b32 v80, 0
v_mov_b32 v81, 0
v_mov_b32 v82, 0
v_mov_b32 v83, 0
v_mov_b32 v84, 0
v_mov_b32 v85, 0
v_mov_b32 v86, 0
v_mov_b32 v87, 0
ds_read_b128 v[44:47], v14 offset:0
ds_read_b128 v[48:51], v14 offset:1024
ds_read_b128 v[52:55], v14 offset:2048
ds_read_b128 v[56:59], v14 offset:3072
s_waitcnt vmcnt(0)
v_max3_u32 v3, v16, v17, v18
v_max3_u32 v3, v3, v19, v20
v_max3_u32 v3, v3, v21, v22
v_max3_u32 v3, v3, v23, v24
v_max3_u32 v3, v3, v25, v26
v_max3_u32 v3, v3, v27, v28
v_max3_u32 v3, v3, v29, v30
v_max3_u32 v3, v3, v31, v32
v_max3_u32 v3, v3, v33, v34
v_max3_u32 v3, v3, v35, v36
v_max3_u32 v3, v3, v37, v38
v_max3_u32 v3, v3, v39, v40
v_max3_u32 v3, v3, v41, v42
v_max_u32 v3, v3, v43
v_cmp_eq_u32 vcc, -1, v3
s_cbranch_vccnz FAIL_109b
s_waitcnt lgkmcnt(2)
v_smfmac_f32_16x16x64_bf16 v[60:63], v[16:19], a[0:7], v8
v_smfmac_f32_16x16x64_bf16 v[64:67], v[16:19], a[56:63], v8
v_smfmac_f32_16x16x64_bf16 v[68:71], v[16:19], a[112:119], v8
v_smfmac_f32_16x16x64_bf16 v[72:75], v[16:19], a[168:175], v8
v_smfmac_f32_16x16x64_bf16 v[76:79], v[16:19], v[44:51], v8
ds_read_b128 v[44:47], v14 offset:4096
ds_read_b128 v[48:51], v14 offset:5120
s_waitcnt lgkmcnt(2)
v_smfmac_f32_16x16x64_bf16 v[60:63], v[20:23], a[8:15], v8
v_smfmac_f32_16x16x64_bf16 v[64:67], v[20:23], a[64:71], v8
v_smfmac_f32_16x16x64_bf16 v[68:71], v[20:23], a[120:127], v8
v_smfmac_f32_16x16x64_bf16 v[72:75], v[20:23], a[176:183], v8
v_smfmac_f32_16x16x64_bf16 v[76:79], v[20:23], v[52:59], v8
ds_read_b128 v[52:55], v14 offset:6144
ds_read_b128 v[56:59], v14 offset:7168
s_waitcnt lgkmcnt(2)
v_smfmac_f32_16x16x64_bf16 v[60:63], v[24:27], a[16:23], v8
v_smfmac_f32_16x16x64_bf16 v[64:67], v[24:27], a[72:79], v8
v_smfmac_f32_16x16x64_bf16 v[68:71], v[24:27], a[128:135], v8
v_smfmac_f32_16x16x64_bf16 v[72:75], v[24:27], a[184:191], v8
v_smfmac_f32_16x16x64_bf16 v[76:79], v[24:27], v[44:51], v8
ds_read_b128 v[44:47], v14 offset:8192
ds_read_b128 v[48:51], v14 offset:9216
s_waitcnt lgkmcnt(2)
v_smfmac_f32_16x16x64_bf16 v[60:63], v[28:31], a[24:31], v8
v_smfmac_f32_16x16x64_bf16 v[64:67], v[28:31], a[80:87], v8
v_smfmac_f32_16x16x64_bf16 v[68:71], v[28:31], a[136:143], v8
v_smfmac_f32_16x16x64_bf16 v[72:75], v[28:31], a[192:199], v8
v_smfmac_f32_16x16x64_bf16 v[76:79], v[28:31], v[52:59], v8
ds_read_b128 v[52:55], v14 offset:10240
ds_read_b128 v[56:59], v14 offset:11264
s_waitcnt lgkmcnt(2)
v_smfmac_f32_16x16x64_bf16 v[60:63], v[32:35], a[32:39], v8
v_smfmac_f32_16x16x64_bf16 v[64:67], v[32:35], a[88:95], v8
v_smfmac_f32_16x16x64_bf16 v[68:71], v[32:35], a[144:151], v8
v_smfmac_f32_16x16x64_bf16 v[72:75], v[32:35], a[200:207], v8
v_smfmac_f32_16x16x64_bf16 v[76:79], v[32:35], v[44:51], v8
ds_read_b128 v[44:47], v14 offset:12288
ds_read_b128 v[48:51], v14 offset:13312
s_waitcnt lgkmcnt(2)
v_smfmac_f32_16x16x64_bf16 v[60:63], v[36:39], a[40:47], v8
v_smfmac_f32_16x16x64_bf16 v[64:67], v[36:39], a[96:103], v8
v_smfmac_f32_16x16x64_bf16 v[68:71], v[36:39], a[152:159], v8
v_smfmac_f32_16x16x64_bf16 v[72:75], v[36:39], a[208:215], v8
v_smfmac_f32_16x16x64_bf16 v[76:79], v[36:39], v[52:59], v8
s_waitcnt lgkmcnt(0)
v_smfmac_f32_16x16x64_bf16 v[60:63], v[40:43], a[48:55], v8
v_smfmac_f32_16x16x64_bf16 v[64:67], v[40:43], a[104:111], v8
v_smfmac_f32_16x16x64_bf16 v[68:71], v[40:43], a[160:167], v8
v_smfmac_f32_16x16x64_bf16 v[72:75], v[40:43], a[216:223], v8
v_smfmac_f32_16x16x64_bf16 v[76:79], v[40:43], v[44:51], v8
v_cvt_pk_bf16_f32 v60, v60, v61
v_cvt_pk_bf16_f32 v61, v62, v63
v_cvt_pk_bf16_f32 v62, v64, v65
s_nop 7
s_branch JOIN_110
FB_113:
ds_read_b64 v[16:17], v158 offset:0
ds_read_b64 v[18:19], v158 offset:1296
ds_read_b64 v[20:21], v158 offset:2592
ds_read_b64 v[22:23], v158 offset:3888
s_sub_u32 s38, s38, 1
s_cmp_gt_i32 s38, 0
s_cbranch_scc0 FD_114
s_waitcnt lgkmcnt(0)
v_max3_u32 v3, v16, v17, v18
v_max3_u32 v3, v3, v19, v20
v_max3_u32 v3, v3, v21, v22
v_max_u32 v3, v3, v23
v_cmp_eq_u32 vcc, -1, v3
s_cbranch_vccnz FB_113
s_waitcnt lgkmcnt(2)
v_add_f32 v16, v16, v18
v_add_f32 v17, v17, v19
s_waitcnt lgkmcnt(0)
v_add_f32 v20, v20, v22
v_add_f32 v21, v21, v23
v_add_f32 v16, v16, v20
v_add_f32 v17, v17, v21
v_max_f32 v3, v16, v17
s_nop 1
v_max_f32_dpp v3, v3, v3 quad_perm:[1,0,3,2] row_mask:0xf bank_mask:0xf
s_nop 1
v_max_f32_dpp v3, v3, v3 quad_perm:[2,3,0,1] row_mask:0xf bank_mask:0xf
s_nop 1
v_max_f32_dpp v3, v3, v3 row_half_mirror row_mask:0xf bank_mask:0xf
s_nop 1
v_max_f32_dpp v3, v3, v3 row_mirror row_mask:0xf bank_mask:0xf
v_mov_b32 v4, v3
s_nop 1
v_permlane16_swap_b32 v3, v4
v_max_f32 v3, v3, v4
v_sub_f32 v24, v16, v3
v_sub_f32 v25, v17, v3
v_exp_f32 v24, v24
v_exp_f32 v25, v25
s_nop 0
v_add_f32 v3, v24, v25
s_nop 1
v_add_f32_dpp v3, v3, v3 quad_perm:[1,0,3,2] row_mask:0xf bank_mask:0xf
s_nop 1
v_add_f32_dpp v3, v3, v3 quad_perm:[2,3,0,1] row_mask:0xf bank_mask:0xf
s_nop 1
v_add_f32_dpp v3, v3, v3 row_half_mirror row_mask:0xf bank_mask:0xf
s_nop 1
v_add_f32_dpp v3, v3, v3 row_mirror row_mask:0xf bank_mask:0xf
v_mov_b32 v4, v3
s_nop 1
v_permlane16_swap_b32 v3, v4
v_add_f32 v3, v3, v4
v_rcp_f32 v26, v3
v_subrev_u32 v3, 0x21800000, v3
v_mul_f32 v24, v24, v26
v_mul_f32 v25, v25, v26
v_cvt_pk_bf16_f32 v4, v24, v25
buffer_store_dword v4, v159, s[4:7], s28 offen
s_branch FD_114
SL_115:
buffer_store_dword v4, v159, s[4:7], s28 offen sc1
s_branch SB_116
SL_117:
buffer_store_dword v13, v159, s[4:7], s29 offen sc1
s_branch SB_118
QK3:
v_and_b32 v0, 63, v0
v_lshrrev_b32 v1, 4, v0
v_and_b32 v2, 15, v0
v_lshlrev_b32 v9, 4, v0
v_add_u32 v14, 43008, v9
v_bfe_u32 v3, v2, 1, 1
v_lshrrev_b32 v4, 2, v2
v_lshlrev_b32 v4, 1, v4
v_and_b32 v5, 1, v2
v_add_u32 v4, v4, v5
v_mul_u32_u24 v8, 0xaaaa, v3
v_add_u32 v8, 0x4444, v8
v_mov_b32 v13, -1
s_mov_b32 s43, 71303168
v_lshlrev_b32 v160, 7, v0
v_lshrrev_b32 v5, 2, v2
v_and_b32 v6, 1, v2
v_lshlrev_b32 v6, 4, v6
v_mov_b32 v7, 0x3f80
v_lshlrev_b32 v6, v6, v7
v_cmp_eq_u32 vcc, v5, v1
s_nop 1
v_cndmask_b32 v6, 0, v6, vcc
v_cmp_eq_u32 vcc, 0, v3
s_nop 1
v_cndmask_b32 v152, 0, v6, vcc
v_cndmask_b32 v153, 0, v6, vcc
v_cndmask_b32 v154, v6, 0, vcc
v_cndmask_b32 v155, v6, 0, vcc
s_mov_b64 s[48:49], vcc
v_mul_u32_u24 v5, 320, v1
v_add_u32 v5, 61232, v5
v_and_b32 v6, 12, v2
v_add_u32 v6, v6, v2
v_lshl_add_u32 v156, v6, 2, v5
v_lshl_add_u32 v5, v4, 2, v5
v_add_u32 v5, 128, v5
v_lshlrev_b32 v6, 2, v2
v_add_u32 v6, 62528, v6
v_cndmask_b32 v157, v6, v5, vcc
v_lshrrev_b32 v3, 5, v0
v_and_b32 v4, 31, v0
v_mul_u32_u24 v5, 160, v3
v_lshl_add_u32 v5, v4, 3, v5
v_add_u32 v5, 58304, v5
v_mov_b32 v6, 58624
v_cmp_gt_u32 vcc, 20, v4
s_nop 1
v_cndmask_b32 v158, v6, v5, vcc
v_mov_b32 v6, 58632
v_cndmask_b32 v161, v6, v5, vcc
v_and_b32 v5, 1, v4
v_lshl_add_u32 v5, v5, 1, v3
v_lshlrev_b32 v5, 4, v5
v_bfe_u32 v6, v4, 3, 1
v_lshl_add_u32 v6, v6, 8, v5
v_bfe_u32 v7, v4, 1, 2
v_lshl_add_u32 v6, v7, 2, v6
s_lshl_b32 s35, s11, 9
s_add_u32 s35, s35, 2240
v_add_u32 v6, s35, v6
v_bfe_u32 v5, v4, 1, 1
v_lshlrev_b32 v5, 8, v5
v_lshl_add_u32 v5, v3, 4, v5
v_and_b32 v7, 1, v4
v_lshl_add_u32 v5, v7, 3, v5
s_lshr_b32 s35, s11, 2
s_lshl_b32 s35, s35, 9
s_and_b32 s36, s11, 1
s_lshl_b32 s36, s36, 5
s_add_u32 s35, s35, s36
s_and_b32 s36, s11, 2
s_lshl_b32 s36, s36, 1
s_add_u32 s35, s35, s36
s_add_u32 s35, s35, 192
v_add_u32 v5, s35, v5
v_mov_b32 v7, 1073741824
v_cndmask_b32 v5, v7, v5, vcc
v_cmp_gt_u32 vcc, 16, v4
s_nop 1
v_cndmask_b32 v159, v5, v6, vcc
s_mov_b32 s35, 55312384
buffer_store_dword v13, v159, s[4:7], s35 offen sc1
s_mov_b32 s35, 55328768
buffer_store_dword v13, v159, s[4:7], s35 offen sc1
s_mov_b32 s35, 55345152
buffer_store_dword v13, v159, s[4:7], s35 offen sc1
s_mov_b32 s35, 55361536
buffer_store_dword v13, v159, s[4:7], s35 offen sc1
v_mov_b32 v5, 62512
v_mov_b32 v6, 0xf149f2ca
ds_write2_b32 v5, v6, v6 offset0:0 offset1:1
v_mul_u32_u24 v12, 640, v0
s_lshl_b32 s35, s11, 2
s_add_u32 s35, s35, 0
v_add_u32 v12, s35, v12
v_mov_b32 v7, 1073741824
v_cmp_gt_u32 vcc, 4, v0
s_nop 1
v_cndmask_b32 v12, v7, v12, vcc
v_mov_b32 v136, 0
v_mov_b32 v137, 0
v_mov_b32 v138, 0
v_mov_b32 v139, 0
s_mul_i32 s40, s11, 0
s_add_u32 s40, s40, 16777216
s_mov_b32 s10, 0
s_mov_b32 s38, 200000
s_mov_b32 s68, 0
s_mov_b32 s69, 0
s_mov_b32 s70, 0
s_mov_b32 s71, 0
v_mov_b32 v3, -1
v_mov_b32 v4, -1
ds_write2_b32 v161, v13, v13 offset0:0 offset1:1
v_add_u32 v5, 1296, v161
ds_write2_b32 v5, v13, v13 offset0:0 offset1:1
v_add_u32 v5, 2592, v161
ds_write2_b32 v5, v13, v13 offset0:0 offset1:1
v_add_u32 v5, 3888, v161
ds_write2_b32 v5, v13, v13 offset0:0 offset1:1
s_waitcnt vmcnt(0) lgkmcnt(0)
s_barrier
s_mov_b32 s34, 71343104
v_min_u32 v3, 24, v0
v_lshlrev_b32 v3, 14, v3
s_mul_i32 s34, s11, 401408
s_add_u32 s34, s34, 0
buffer_load_dword v4, v3, s[4:7], s34 offen sc1
s_waitcnt vmcnt(0)
v_min_u32 v3, 13, v2
v_lshlrev_b32 v3, 2, v3
s_lshl_b32 s35, s11, 8
s_add_u32 s35, s35, 17408
v_add_u32 v3, s35, v3
s_mov_b32 s41, 71319552
s_mov_b64 vcc, -1
s_mul_i32 s34, s11, 401408
s_and_b32 s36, vcc_lo, 65535
s_cbranch_scc0 RD_122
RL_121:
buffer_load_dword v4, v3, s[4:7], s41 offen sc1
s_sub_u32 s38, s38, 1
s_cmp_gt_i32 s38, 0
s_cbranch_scc0 RD_122
s_waitcnt vmcnt(0)
v_cmp_ne_u32 vcc, 1, v4
s_nop 0
s_and_b32 s36, vcc_lo, 65535
s_cbranch_scc0 RD_122
s_sleep 2
s_branch RL_121
RD_122:
s_add_u32 s35, s34, 174080
buffer_load_dwordx4 a[0:3], v9, s[4:7], s35 offen sc1
buffer_load_dwordx4 a[4:7], v9, s[4:7], s35 offen offset:1024 sc1
s_add_u32 s35, s34, 172032
buffer_load_dwordx4 a[8:11], v9, s[4:7], s35 offen sc1
buffer_load_dwordx4 a[12:15], v9, s[4:7], s35 offen offset:1024 sc1
s_add_u32 s35, s34, 176128
buffer_load_dwordx4 a[16:19], v9, s[4:7], s35 offen sc1
buffer_load_dwordx4 a[20:23], v9, s[4:7], s35 offen offset:1024 sc1
s_add_u32 s35, s34, 178176
buffer_load_dwordx4 a[24:27], v9, s[4:7], s35 offen sc1
buffer_load_dwordx4 a[28:31], v9, s[4:7], s35 offen offset:1024 sc1
s_add_u32 s35, s34, 180224
buffer_load_dwordx4 a[32:35], v9, s[4:7], s35 offen sc1
buffer_load_dwordx4 a[36:39], v9, s[4:7], s35 offen offset:1024 sc1
s_add_u32 s35, s34, 184320
buffer_load_dwordx4 a[40:43], v9, s[4:7], s35 offen sc1
buffer_load_dwordx4 a[44:47], v9, s[4:7], s35 offen offset:1024 sc1
s_add_u32 s35, s34, 182272
buffer_load_dwordx4 a[48:51], v9, s[4:7], s35 offen sc1
buffer_load_dwordx4 a[52:55], v9, s[4:7], s35 offen offset:1024 sc1
s_add_u32 s35, s34, 202752
buffer_load_dwordx4 a[56:59], v9, s[4:7], s35 offen sc1
buffer_load_dwordx4 a[60:63], v9, s[4:7], s35 offen offset:1024 sc1
s_add_u32 s35, s34, 200704
buffer_load_dwordx4 a[64:67], v9, s[4:7], s35 offen sc1
buffer_load_dwordx4 a[68:71], v9, s[4:7], s35 offen offset:1024 sc1
s_add_u32 s35, s34, 204800
buffer_load_dwordx4 a[72:75], v9, s[4:7], s35 offen sc1
buffer_load_dwordx4 a[76:79], v9, s[4:7], s35 offen offset:1024 sc1
s_add_u32 s35, s34, 206848
buffer_load_dwordx4 a[80:83], v9, s[4:7], s35 offen sc1
buffer_load_dwordx4 a[84:87], v9, s[4:7], s35 offen offset:1024 sc1
s_add_u32 s35, s34, 208896
buffer_load_dwordx4 a[88:91], v9, s[4:7], s35 offen sc1
buffer_load_dwordx4 a[92:95], v9, s[4:7], s35 offen offset:1024 sc1
s_add_u32 s35, s34, 212992
buffer_load_dwordx4 a[96:99], v9, s[4:7], s35 offen sc1
buffer_load_dwordx4 a[100:103], v9, s[4:7], s35 offen offset:1024 sc1
s_add_u32 s35, s34, 210944
buffer_load_dwordx4 a[104:107], v9, s[4:7], s35 offen sc1
buffer_load_dwordx4 a[108:111], v9, s[4:7], s35 offen offset:1024 sc1
s_add_u32 s35, s34, 188416
buffer_load_dwordx4 a[112:115], v9, s[4:7], s35 offen sc1
buffer_load_dwordx4 a[116:119], v9, s[4:7], s35 offen offset:1024 sc1
s_add_u32 s35, s34, 186368
buffer_load_dwordx4 a[120:123], v9, s[4:7], s35 offen sc1
buffer_load_dwordx4 a[124:127], v9, s[4:7], s35 offen offset:1024 sc1
s_add_u32 s35, s34, 190464
buffer_load_dwordx4 a[128:131], v9, s[4:7], s35 offen sc1
buffer_load_dwordx4 a[132:135], v9, s[4:7], s35 offen offset:1024 sc1
s_add_u32 s35, s34, 192512
buffer_load_dwordx4 a[136:139], v9, s[4:7], s35 offen sc1
buffer_load_dwordx4 a[140:143], v9, s[4:7], s35 offen offset:1024 sc1
s_add_u32 s35, s34, 194560
buffer_load_dwordx4 a[144:147], v9, s[4:7], s35 offen sc1
buffer_load_dwordx4 a[148:151], v9, s[4:7], s35 offen offset:1024 sc1
s_add_u32 s35, s34, 198656
buffer_load_dwordx4 a[152:155], v9, s[4:7], s35 offen sc1
buffer_load_dwordx4 a[156:159], v9, s[4:7], s35 offen offset:1024 sc1
s_add_u32 s35, s34, 196608
buffer_load_dwordx4 a[160:163], v9, s[4:7], s35 offen sc1
buffer_load_dwordx4 a[164:167], v9, s[4:7], s35 offen offset:1024 sc1
s_add_u32 s35, s34, 217088
buffer_load_dwordx4 a[168:171], v9, s[4:7], s35 offen sc1
buffer_load_dwordx4 a[172:175], v9, s[4:7], s35 offen offset:1024 sc1
s_add_u32 s35, s34, 215040
buffer_load_dwordx4 a[176:179], v9, s[4:7], s35 offen sc1
buffer_load_dwordx4 a[180:183], v9, s[4:7], s35 offen offset:1024 sc1
s_add_u32 s35, s34, 219136
buffer_load_dwordx4 a[184:187], v9, s[4:7], s35 offen sc1
buffer_load_dwordx4 a[188:191], v9, s[4:7], s35 offen offset:1024 sc1
s_add_u32 s35, s34, 221184
buffer_load_dwordx4 a[192:195], v9, s[4:7], s35 offen sc1
buffer_load_dwordx4 a[196:199], v9, s[4:7], s35 offen offset:1024 sc1
s_add_u32 s35, s34, 223232
buffer_load_dwordx4 a[200:203], v9, s[4:7], s35 offen sc1
buffer_load_dwordx4 a[204:207], v9, s[4:7], s35 offen offset:1024 sc1
s_add_u32 s35, s34, 227328
buffer_load_dwordx4 a[208:211], v9, s[4:7], s35 offen sc1
buffer_load_dwordx4 a[212:215], v9, s[4:7], s35 offen offset:1024 sc1
s_add_u32 s35, s34, 225280
buffer_load_dwordx4 a[216:219], v9, s[4:7], s35 offen sc1
buffer_load_dwordx4 a[220:223], v9, s[4:7], s35 offen offset:1024 sc1
s_add_u32 s35, s34, 231424
s_mov_b32 m0, 43008
s_nop 0
buffer_load_dwordx4 v9, s[4:7], s35 offen sc1 lds
buffer_load_dwordx4 v9, s[4:7], s35 offen offset:1024 sc1 lds
s_add_u32 s35, s34, 229376
s_mov_b32 m0, 45056
s_nop 0
buffer_load_dwordx4 v9, s[4:7], s35 offen sc1 lds
buffer_load_dwordx4 v9, s[4:7], s35 offen offset:1024 sc1 lds
s_waitcnt vmcnt(40)
s_add_u32 s35, s34, 233472
s_mov_b32 m0, 47104
s_nop 0
buffer_load_dwordx4 v9, s[4:7], s35 offen sc1 lds
buffer_load_dwordx4 v9, s[4:7], s35 offen offset:1024 sc1 lds
s_add_u32 s35, s34, 235520
s_mov_b32 m0, 49152
s_nop 0
buffer_load_dwordx4 v9, s[4:7], s35 offen sc1 lds
buffer_load_dwordx4 v9, s[4:7], s35 offen offset:1024 sc1 lds
s_add_u32 s35, s34, 237568
s_mov_b32 m0, 51200
s_nop 0
buffer_load_dwordx4 v9, s[4:7], s35 offen sc1 lds
buffer_load_dwordx4 v9, s[4:7], s35 offen offset:1024 sc1 lds
s_add_u32 s35, s34, 241664
s_mov_b32 m0, 53248
s_nop 0
buffer_load_dwordx4 v9, s[4:7], s35 offen sc1 lds
buffer_load_dwordx4 v9, s[4:7], s35 offen offset:1024 sc1 lds
s_add_u32 s35, s34, 239616
s_mov_b32 m0, 55296
s_nop 0
buffer_load_dwordx4 v9, s[4:7], s35 offen sc1 lds
buffer_load_dwordx4 v9, s[4:7], s35 offen offset:1024 sc1 lds
s_add_u32 s35, s34, 317440
buffer_load_dwordx4 a[224:227], v9, s[4:7], s35 offen sc1
buffer_load_dwordx4 a[228:231], v9, s[4:7], s35 offen offset:1024 sc1
s_add_u32 s35, s34, 315392
buffer_load_dwordx4 a[232:235], v9, s[4:7], s35 offen sc1
buffer_load_dwordx4 a[236:239], v9, s[4:7], s35 offen offset:1024 sc1
s_add_u32 s35, s34, 319488
buffer_load_dwordx4 a[240:243], v9, s[4:7], s35 offen sc1
buffer_load_dwordx4 a[244:247], v9, s[4:7], s35 offen offset:1024 sc1
s_add_u32 s35, s34, 321536
buffer_load_dwordx4 a[248:251], v9, s[4:7], s35 offen sc1
buffer_load_dwordx4 a[252:255], v9, s[4:7], s35 offen offset:1024 sc1
s_add_u32 s35, s34, 323584
buffer_load_dwordx4 v[168:171], v9, s[4:7], s35 offen sc1
buffer_load_dwordx4 v[172:175], v9, s[4:7], s35 offen offset:1024 sc1
s_waitcnt vmcnt(40)
s_add_u32 s35, s34, 327680
buffer_load_dwordx4 v[176:179], v9, s[4:7], s35 offen sc1
buffer_load_dwordx4 v[180:183], v9, s[4:7], s35 offen offset:1024 sc1
s_add_u32 s35, s34, 325632
buffer_load_dwordx4 v[184:187], v9, s[4:7], s35 offen sc1
buffer_load_dwordx4 v[188:191], v9, s[4:7], s35 offen offset:1024 sc1
s_add_u32 s35, s34, 360448
buffer_load_dwordx4 v[192:195], v9, s[4:7], s35 offen sc1
buffer_load_dwordx4 v[196:199], v9, s[4:7], s35 offen offset:1024 sc1
s_add_u32 s35, s34, 358400
buffer_load_dwordx4 v[200:203], v9, s[4:7], s35 offen sc1
buffer_load_dwordx4 v[204:207], v9, s[4:7], s35 offen offset:1024 sc1
s_add_u32 s35, s34, 362496
buffer_load_dwordx4 v[208:211], v9, s[4:7], s35 offen sc1
buffer_load_dwordx4 v[212:215], v9, s[4:7], s35 offen offset:1024 sc1
s_add_u32 s35, s34, 364544
buffer_load_dwordx4 v[216:219], v9, s[4:7], s35 offen sc1
buffer_load_dwordx4 v[220:223], v9, s[4:7], s35 offen offset:1024 sc1
s_add_u32 s35, s34, 366592
buffer_load_dwordx4 v[224:227], v9, s[4:7], s35 offen sc1
buffer_load_dwordx4 v[228:231], v9, s[4:7], s35 offen offset:1024 sc1
s_add_u32 s35, s34, 370688
buffer_load_dwordx4 v[232:235], v9, s[4:7], s35 offen sc1
buffer_load_dwordx4 v[236:239], v9, s[4:7], s35 offen offset:1024 sc1
s_add_u32 s35, s34, 368640
buffer_load_dwordx4 v[240:243], v9, s[4:7], s35 offen sc1
buffer_load_dwordx4 v[244:247], v9, s[4:7], s35 offen offset:1024 sc1
s_mov_b32 s34, 71343104
s_barrier
v_mov_b32 v3, 151552
ds_read_b32 v4, v3
s_waitcnt lgkmcnt(0)
v_readfirstlane_b32 s66, v4
s_lshl_b32 s52, s10, 15
s_add_u32 s52, s52, 50356224
buffer_load_dwordx4 v[104:107], v9, s[4:7], s52 offen offset:0 sc1
buffer_load_dwordx4 v[108:111], v9, s[4:7], s52 offen offset:1024 sc1
buffer_load_dwordx4 v[112:115], v9, s[4:7], s52 offen offset:2048 sc1
buffer_load_dwordx4 v[116:119], v9, s[4:7], s52 offen offset:3072 sc1
s_waitcnt vmcnt(4)
v_mov_b32 v60, 0
v_mov_b32 v61, 0
v_mov_b32 v62, 0
v_mov_b32 v63, 0
v_mov_b32 v64, 0
v_mov_b32 v65, 0
v_mov_b32 v66, 0
v_mov_b32 v67, 0
v_mov_b32 v68, 0
v_mov_b32 v69, 0
v_mov_b32 v70, 0
v_mov_b32 v71, 0
v_mov_b32 v72, 0
v_mov_b32 v73, 0
v_mov_b32 v74, 0
v_mov_b32 v75, 0
v_mov_b32 v76, 0
v_mov_b32 v77, 0
v_mov_b32 v78, 0
v_mov_b32 v79, 0
v_mov_b32 v80, 0
v_mov_b32 v81, 0
v_mov_b32 v82, 0
v_mov_b32 v83, 0
v_mov_b32 v84, 0
v_mov_b32 v85, 0
v_mov_b32 v86, 0
v_mov_b32 v87, 0
v_mov_b32 v140, 0
v_mov_b32 v141, 0
v_mov_b32 v142, 0
v_mov_b32 v143, 0
v_mov_b32 v144, 0
v_mov_b32 v145, 0
v_mov_b32 v146, 0
v_mov_b32 v147, 0
s_lshl_b32 s26, s10, 13
s_add_u32 s26, s26, 54525952
s_add_u32 s27, s26, 4096
LOOP_125:
s_barrier
buffer_load_dwordx4 v[16:19], v9, s[4:7], s26 offen offset:1024 sc1
ds_read_b128 v[44:47], v14 offset:0
ds_read_b128 v[48:51], v14 offset:1024
ds_read_b128 v[52:55], v14 offset:2048
ds_read_b128 v[56:59], v14 offset:3072
s_add_u32 s39, s10, 1
s_barrier
buffer_load_dwordx4 v[20:23], v9, s[4:7], s26 offen offset:0
s_mov_b64 s[50:51], -1
v_mov_b32 v10, s39
s_and_b32 s34, s10, 3
s_lshl_b32 s28, s34, 14
s_add_u32 s28, s28, 55312384
s_barrier
buffer_load_dwordx4 v[24:27], v9, s[4:7], s26 offen offset:2048
s_xor_b32 s29, s28, 32768
s_min_u32 s37, s39, 63
s_add_u32 s53, s52, 4096
s_lshl_b32 s52, s37, 15
s_add_u32 s52, s52, 50356224
s_barrier
buffer_load_dwordx4 v[28:31], v9, s[4:7], s26 offen offset:3072
s_waitcnt vmcnt(3)
v_smfmac_f32_16x16x64_bf16 v[60:63], v[16:19], a[0:7], v8
buffer_load_dwordx4 v[32:35], v9, s[4:7], s27 offen offset:0
v_cmp_eq_u32 vcc, -1, v16
v_smfmac_f32_16x16x64_bf16 v[64:67], v[16:19], a[56:63], v8
v_smfmac_f32_16x16x64_bf16 v[68:71], v[16:19], a[112:119], v8
s_cbranch_vccnz RT_129
BK_130:
v_smfmac_f32_16x16x64_bf16 v[72:75], v[16:19], a[168:175], v8
s_waitcnt lgkmcnt(2)
v_smfmac_f32_16x16x64_bf16 v[76:79], v[16:19], v[44:51], v8
s_waitcnt vmcnt(3)
v_smfmac_f32_16x16x64_bf16 v[60:63], v[20:23], a[8:15], v8
buffer_load_dwordx4 v[36:39], v9, s[4:7], s27 offen offset:2048
v_smfmac_f32_16x16x64_bf16 v[64:67], v[20:23], a[64:71], v8
ds_read_b128 v[44:47], v14 offset:4096
v_smfmac_f32_16x16x64_bf16 v[68:71], v[20:23], a[120:127], v8
ds_read_b128 v[48:51], v14 offset:5120
v_smfmac_f32_16x16x64_bf16 v[72:75], v[20:23], a[176:183], v8
s_waitcnt lgkmcnt(2)
v_smfmac_f32_16x16x64_bf16 v[76:79], v[20:23], v[52:59], v8
s_waitcnt vmcnt(3)
v_smfmac_f32_16x16x64_bf16 v[60:63], v[24:27], a[16:23], v8
buffer_load_dwordx4 v[40:43], v9, s[4:7], s27 offen offset:1024
v_smfmac_f32_16x16x64_bf16 v[64:67], v[24:27], a[72:79], v8
ds_read_b128 v[52:55], v14 offset:6144
v_smfmac_f32_16x16x64_bf16 v[68:71], v[24:27], a[128:135], v8
ds_read_b128 v[56:59], v14 offset:7168
v_smfmac_f32_16x16x64_bf16 v[72:75], v[24:27], a[184:191], v8
s_waitcnt lgkmcnt(2)
v_smfmac_f32_16x16x64_bf16 v[76:79], v[24:27], v[44:51], v8
s_waitcnt vmcnt(3)
v_smfmac_f32_16x16x64_bf16 v[60:63], v[28:31], a[24:31], v8
buffer_load_dwordx4 v[120:123], v9, s[4:7], s53 offen offset:0 sc1
v_smfmac_f32_16x16x64_bf16 v[64:67], v[28:31], a[80:87], v8
ds_read_b128 v[44:47], v14 offset:8192
v_smfmac_f32_16x16x64_bf16 v[68:71], v[28:31], a[136:143], v8
ds_read_b128 v[48:51], v14 offset:9216
v_smfmac_f32_16x16x64_bf16 v[72:75], v[28:31], a[192:199], v8
s_waitcnt lgkmcnt(2)
v_smfmac_f32_16x16x64_bf16 v[76:79], v[28:31], v[52:59], v8
buffer_load_dwordx4 v[124:127], v9, s[4:7], s53 offen offset:1024 sc1
s_waitcnt vmcnt(4)
v_smfmac_f32_16x16x64_bf16 v[60:63], v[32:35], a[32:39], v8
ds_read_b128 v[52:55], v14 offset:10240
v_smfmac_f32_16x16x64_bf16 v[64:67], v[32:35], a[88:95], v8
ds_read_b128 v[56:59], v14 offset:11264
v_smfmac_f32_16x16x64_bf16 v[68:71], v[32:35], a[144:151], v8
v_smfmac_f32_16x16x64_bf16 v[72:75], v[32:35], a[200:207], v8
buffer_load_dwordx4 v[128:131], v9, s[4:7], s53 offen offset:2048 sc1
s_waitcnt lgkmcnt(2)
v_smfmac_f32_16x16x64_bf16 v[76:79], v[32:35], v[44:51], v8
s_waitcnt vmcnt(4)
v_smfmac_f32_16x16x64_bf16 v[60:63], v[36:39], a[40:47], v8
ds_read_b128 v[44:47], v14 offset:12288
v_smfmac_f32_16x16x64_bf16 v[64:67], v[36:39], a[96:103], v8
ds_read_b128 v[48:51], v14 offset:13312
v_smfmac_f32_16x16x64_bf16 v[68:71], v[36:39], a[152:159], v8
buffer_load_dwordx4 v[132:135], v9, s[4:7], s53 offen offset:3072 sc1
v_smfmac_f32_16x16x64_bf16 v[72:75], v[36:39], a[208:215], v8
s_waitcnt lgkmcnt(2)
v_smfmac_f32_16x16x64_bf16 v[76:79], v[36:39], v[52:59], v8
s_waitcnt vmcnt(4)
v_smfmac_f32_16x16x64_bf16 v[60:63], v[40:43], a[48:55], v8
v_smfmac_f32_16x16x64_bf16 v[64:67], v[40:43], a[104:111], v8
v_smfmac_f32_16x16x64_bf16 v[68:71], v[40:43], a[160:167], v8
v_cvt_pk_bf16_f32 v60, v60, v61
v_smfmac_f32_16x16x64_bf16 v[72:75], v[40:43], a[216:223], v8
s_waitcnt lgkmcnt(0)
v_cvt_pk_bf16_f32 v61, v62, v63
v_smfmac_f32_16x16x64_bf16 v[76:79], v[40:43], v[44:51], v8
v_cvt_pk_bf16_f32 v62, v64, v65
JOIN_128:
v_smfmac_f32_16x16x64_bf16 v[80:83], v[16:19], a[224:231], v8
v_cvt_pk_bf16_f32 v63, v66, v67
v_smfmac_f32_16x16x64_bf16 v[80:83], v[20:23], a[232:239], v8
v_cvt_pk_bf16_f32 v68, v68, v69
v_mfma_f32_16x16x32_bf16 v[88:91], v[60:63], v[152:155], 0
v_cvt_pk_bf16_f32 v69, v70, v71
v_cvt_pk_bf16_f32 v70, v72, v73
v_smfmac_f32_16x16x64_bf16 v[80:83], v[24:27], a[240:247], v8
v_cvt_pk_bf16_f32 v71, v74, v75
v_smfmac_f32_16x16x64_bf16 v[80:83], v[28:31], a[248:255], v8
v_cvt_pk_bf16_f32 v76, v76, v77
v_mfma_f32_16x16x32_bf16 v[92:95], v[68:71], v[152:155], 0
v_cvt_pk_bf16_f32 v96, v88, v89
v_cvt_pk_bf16_f32 v97, v90, v91
v_smfmac_f32_16x16x64_bf16 v[80:83], v[32:35], v[168:175], v8
v_cmp_u_f32 vcc, v88, v89
v_smfmac_f32_16x16x64_bf16 v[80:83], v[36:39], v[176:183], v8
v_cvt_pk_bf16_f32 v77, v78, v79
v_smfmac_f32_16x16x64_bf16 v[80:83], v[40:43], v[184:191], v8
v_cvt_pk_bf16_f32 v98, v92, v93
v_smfmac_f32_16x16x64_bf16 v[84:87], v[16:19], v[192:199], v8
v_cvt_pk_bf16_f32 v99, v94, v95
v_smfmac_f32_16x16x64_bf16 v[84:87], v[20:23], v[200:207], v8
s_and_b64 vcc, vcc, s[50:51]
s_cbranch_scc1 FAIL_127
v_smfmac_f32_16x16x64_bf16 v[84:87], v[24:27], v[208:215], v8
v_cvt_pk_bf16_f32 v78, v80, v81
v_smfmac_f32_16x16x64_bf16 v[84:87], v[28:31], v[216:223], v8
v_cvt_pk_bf16_f32 v79, v82, v83
v_smfmac_f32_16x16x64_bf16 v[84:87], v[32:35], v[224:231], v8
v_cndmask_b32 v164, v40, v32, s[48:49]
v_smfmac_f32_16x16x64_bf16 v[84:87], v[36:39], v[232:239], v8
v_cndmask_b32 v165, v41, v33, s[48:49]
v_smfmac_f32_16x16x64_bf16 v[84:87], v[40:43], v[240:247], v8
v_mov_b32 v166, v38
v_mfma_f32_16x16x32_bf16 v[88:91], v[76:79], v[152:155], 0
v_mov_b32 v167, v39
v_mov_b32 v60, 0
v_mfma_f32_16x16x32_bf16 v[148:151], v[96:99], v[28:31], 0
v_cvt_pk_bf16_f32 v136, v84, v85
v_cvt_pk_bf16_f32 v137, v86, v87
v_mov_b32 v61, 0
s_nop 0
v_cvt_pk_bf16_f32 v100, v88, v89
v_mfma_f32_16x16x32_bf16 v[92:95], v[136:139], v[152:155], 0
v_cvt_pk_bf16_f32 v101, v90, v91
v_mov_b32 v62, 0
v_smfmac_f32_16x16x64_bf16 v[140:143], v[96:99], v[104:111], v8
v_mov_b32 v63, 0
v_smfmac_f32_16x16x64_bf16 v[144:147], v[96:99], v[112:119], v8
v_cvt_pk_bf16_f32 v102, v92, v93
v_cvt_pk_bf16_f32 v103, v94, v95
v_mov_b32 v64, 0
s_waitcnt vmcnt(2)
v_smfmac_f32_16x16x64_bf16 v[140:143], v[100:103], v[120:127], v8
s_waitcnt vmcnt(0)
v_smfmac_f32_16x16x64_bf16 v[144:147], v[100:103], v[128:135], v8
v_mfma_f32_16x16x32_bf16 v[148:151], v[100:103], v[164:167], v[148:151]
v_add_f32 v140, v140, v142
v_add_f32 v141, v141, v143
ds_write2_b32 v156, v140, v141 offset0:0 offset1:40
s_nop 0
v_add_f32 v144, v144, v146
v_add_f32 v145, v145, v147
ds_write2_b32 v156, v144, v145 offset0:4 offset1:44
s_nop 0
v_add_f32_dpp v148, v150, v148 quad_perm:[2,3,0,1] row_mask:0xf bank_mask:0xf
v_add_f32_dpp v149, v151, v149 quad_perm:[2,3,0,1] row_mask:0xf bank_mask:0xf
ds_write2_b32 v157, v148, v149 offset0:0 offset1:40
v_mov_b32 v65, 0
v_mov_b32 v66, 0
v_mov_b32 v67, 0
v_mov_b32 v68, 0
s_barrier
ds_read_b64 v[16:17], v158 offset:0
v_mov_b32 v69, 0
ds_read_b64 v[18:19], v158 offset:1296
ds_read_b64 v[20:21], v158 offset:2592
v_mov_b32 v70, 0
ds_read_b64 v[22:23], v158 offset:3888
v_mov_b32 v71, 0
v_mov_b32 v72, 0
v_mov_b32 v73, 0
v_mov_b32 v74, 0
v_mov_b32 v75, 0
s_waitcnt lgkmcnt(2)
v_add_f32 v16, v16, v18
v_add_f32 v17, v17, v19
s_waitcnt lgkmcnt(0)
v_add_f32 v20, v20, v22
v_add_f32 v21, v21, v23
v_add_f32 v16, v16, v20
v_add_f32 v17, v17, v21
v_exp_f32 v24, v16
v_exp_f32 v25, v17
s_nop 0
v_add_f32 v3, v24, v25
v_mov_b32 v76, 0
v_mov_b32 v77, 0
v_add_f32_dpp v3, v3, v3 quad_perm:[1,0,3,2] row_mask:0xf bank_mask:0xf
v_mov_b32 v78, 0
v_mov_b32 v79, 0
v_add_f32_dpp v3, v3, v3 quad_perm:[2,3,0,1] row_mask:0xf bank_mask:0xf
v_mov_b32 v80, 0
v_mov_b32 v81, 0
v_add_f32_dpp v3, v3, v3 row_half_mirror row_mask:0xf bank_mask:0xf
v_mov_b32 v82, 0
v_mov_b32 v83, 0
v_add_f32_dpp v3, v3, v3 row_mirror row_mask:0xf bank_mask:0xf
v_mov_b32 v4, v3
s_nop 1
v_permlane16_swap_b32 v3, v4
v_add_f32 v3, v3, v4
v_rcp_f32 v26, v3
v_subrev_u32 v3, 0x21800000, v3
v_mul_f32 v24, v24, v26
v_mul_f32 v25, v25, v26
v_cvt_pk_bf16_f32 v4, v24, v25
v_cmpx_gt_u32 vcc, 0x50000000, v3
buffer_store_dword v4, v159, s[4:7], s28 offen
s_mov_b64 exec, -1
s_cmp_lg_u64 vcc, -1
s_cbranch_scc1 FB_131
FD_132:
s_cmp_lg_u32 s66, 0
s_cbranch_scc1 SL_133
SB_134:
s_barrier
buffer_store_dword v13, v159, s[4:7], s29 offen
s_cmp_lg_u32 s66, 0
s_cbranch_scc1 SL_135
SB_136:
v_mov_b32 v5, 24064
buffer_load_dword v6, v5, s[4:7], s26 offen sc1
v_mov_b32 v5, 65536
buffer_load_dword v6, v5, s[4:7], s53 offen sc1
buffer_load_dwordx4 v[104:107], v9, s[4:7], s52 offen offset:0 sc1
buffer_load_dwordx4 v[108:111], v9, s[4:7], s52 offen offset:1024 sc1
buffer_load_dwordx4 v[112:115], v9, s[4:7], s52 offen offset:2048 sc1
buffer_load_dwordx4 v[116:119], v9, s[4:7], s52 offen offset:3072 sc1
v_mov_b32 v16, -1
v_mov_b32 v17, -1
ds_write_b64 v161, v[16:17] offset:0
ds_write_b64 v161, v[16:17] offset:1296
ds_write_b64 v161, v[16:17] offset:2592
ds_write_b64 v161, v[16:17] offset:3888
s_waitcnt lgkmcnt(0)
v_mov_b32 v84, 0
v_mov_b32 v85, 0
v_mov_b32 v86, 0
v_mov_b32 v87, 0
v_mov_b32 v140, 0
v_mov_b32 v141, 0
v_mov_b32 v142, 0
v_mov_b32 v143, 0
v_mov_b32 v144, 0
v_mov_b32 v145, 0
v_mov_b32 v146, 0
v_mov_b32 v147, 0
s_add_u32 s10, s10, 1
s_lshl_b32 s26, s10, 13
s_add_u32 s26, s26, 54525952
s_add_u32 s27, s26, 4096
s_cmp_ge_u32 s10, 63
s_cbranch_scc1 END_126
s_branch LOOP_125
END_126:
s_endpgm
RT_129:
buffer_load_dwordx4 v[16:19], v9, s[4:7], s26 offen offset:1024 sc1
buffer_load_dwordx4 v[20:23], v9, s[4:7], s26 offen offset:0 sc1
buffer_load_dwordx4 v[24:27], v9, s[4:7], s26 offen offset:2048 sc1
buffer_load_dwordx4 v[28:31], v9, s[4:7], s26 offen offset:3072 sc1
buffer_load_dwordx4 v[32:35], v9, s[4:7], s27 offen offset:0 sc1
s_sub_u32 s38, s38, 1
s_cmp_gt_i32 s38, 0
s_cbranch_scc0 END_126
v_mov_b32 v60, 0
v_mov_b32 v61, 0
v_mov_b32 v62, 0
v_mov_b32 v63, 0
v_mov_b32 v64, 0
v_mov_b32 v65, 0
v_mov_b32 v66, 0
v_mov_b32 v67, 0
v_mov_b32 v68, 0
v_mov_b32 v69, 0
v_mov_b32 v70, 0
v_mov_b32 v71, 0
s_waitcnt vmcnt(0)
v_cmp_eq_u32 vcc, -1, v16
s_cbranch_vccnz RT_129
v_smfmac_f32_16x16x64_bf16 v[60:63], v[16:19], a[0:7], v8
v_smfmac_f32_16x16x64_bf16 v[64:67], v[16:19], a[56:63], v8
v_smfmac_f32_16x16x64_bf16 v[68:71], v[16:19], a[112:119], v8
s_branch BK_130
FAIL_127:
s_mov_b64 s[50:51], 0
FAIL_127b:
buffer_load_dwordx4 v[16:19], v9, s[4:7], s26 offen offset:1024 sc1
buffer_load_dwordx4 v[20:23], v9, s[4:7], s26 offen offset:0 sc1
buffer_load_dwordx4 v[24:27], v9, s[4:7], s26 offen offset:2048 sc1
buffer_load_dwordx4 v[28:31], v9, s[4:7], s26 offen offset:3072 sc1
buffer_load_dwordx4 v[32:35], v9, s[4:7], s27 offen offset:0 sc1
buffer_load_dwordx4 v[36:39], v9, s[4:7], s27 offen offset:2048 sc1
buffer_load_dwordx4 v[40:43], v9, s[4:7], s27 offen offset:1024 sc1
s_sub_u32 s38, s38, 1
s_cmp_gt_i32 s38, 0
s_cbranch_scc0 END_126
v_mov_b32 v60, 0
v_mov_b32 v61, 0
v_mov_b32 v62, 0
v_mov_b32 v63, 0
v_mov_b32 v64, 0
v_mov_b32 v65, 0
v_mov_b32 v66, 0
v_mov_b32 v67, 0
v_mov_b32 v68, 0
v_mov_b32 v69, 0
v_mov_b32 v70, 0
v_mov_b32 v71, 0
v_mov_b32 v72, 0
v_mov_b32 v73, 0
v_mov_b32 v74, 0
v_mov_b32 v75, 0
v_mov_b32 v76, 0
v_mov_b32 v77, 0
v_mov_b32 v78, 0
v_mov_b32 v79, 0
v_mov_b32 v80, 0
v_mov_b32 v81, 0
v_mov_b32 v82, 0
v_mov_b32 v83, 0
v_mov_b32 v84, 0
v_mov_b32 v85, 0
v_mov_b32 v86, 0
v_mov_b32 v87, 0
ds_read_b128 v[44:47], v14 offset:0
ds_read_b128 v[48:51], v14 offset:1024
ds_read_b128 v[52:55], v14 offset:2048
ds_read_b128 v[56:59], v14 offset:3072
s_waitcnt vmcnt(0)
v_max3_u32 v3, v16, v17, v18
v_max3_u32 v3, v3, v19, v20
v_max3_u32 v3, v3, v21, v22
v_max3_u32 v3, v3, v23, v24
v_max3_u32 v3, v3, v25, v26
v_max3_u32 v3, v3, v27, v28
v_max3_u32 v3, v3, v29, v30
v_max3_u32 v3, v3, v31, v32
v_max3_u32 v3, v3, v33, v34
v_max3_u32 v3, v3, v35, v36
v_max3_u32 v3, v3, v37, v38
v_max3_u32 v3, v3, v39, v40
v_max3_u32 v3, v3, v41, v42
v_max_u32 v3, v3, v43
v_cmp_eq_u32 vcc, -1, v3
s_cbranch_vccnz FAIL_127b
s_waitcnt lgkmcnt(2)
v_smfmac_f32_16x16x64_bf16 v[60:63], v[16:19], a[0:7], v8
v_smfmac_f32_16x16x64_bf16 v[64:67], v[16:19], a[56:63], v8
v_smfmac_f32_16x16x64_bf16 v[68:71], v[16:19], a[112:119], v8
v_smfmac_f32_16x16x64_bf16 v[72:75], v[16:19], a[168:175], v8
v_smfmac_f32_16x16x64_bf16 v[76:79], v[16:19], v[44:51], v8
ds_read_b128 v[44:47], v14 offset:4096
ds_read_b128 v[48:51], v14 offset:5120
s_waitcnt lgkmcnt(2)
v_smfmac_f32_16x16x64_bf16 v[60:63], v[20:23], a[8:15], v8
v_smfmac_f32_16x16x64_bf16 v[64:67], v[20:23], a[64:71], v8
v_smfmac_f32_16x16x64_bf16 v[68:71], v[20:23], a[120:127], v8
v_smfmac_f32_16x16x64_bf16 v[72:75], v[20:23], a[176:183], v8
v_smfmac_f32_16x16x64_bf16 v[76:79], v[20:23], v[52:59], v8
ds_read_b128 v[52:55], v14 offset:6144
ds_read_b128 v[56:59], v14 offset:7168
s_waitcnt lgkmcnt(2)
v_smfmac_f32_16x16x64_bf16 v[60:63], v[24:27], a[16:23], v8
v_smfmac_f32_16x16x64_bf16 v[64:67], v[24:27], a[72:79], v8
v_smfmac_f32_16x16x64_bf16 v[68:71], v[24:27], a[128:135], v8
v_smfmac_f32_16x16x64_bf16 v[72:75], v[24:27], a[184:191], v8
v_smfmac_f32_16x16x64_bf16 v[76:79], v[24:27], v[44:51], v8
ds_read_b128 v[44:47], v14 offset:8192
ds_read_b128 v[48:51], v14 offset:9216
s_waitcnt lgkmcnt(2)
v_smfmac_f32_16x16x64_bf16 v[60:63], v[28:31], a[24:31], v8
v_smfmac_f32_16x16x64_bf16 v[64:67], v[28:31], a[80:87], v8
v_smfmac_f32_16x16x64_bf16 v[68:71], v[28:31], a[136:143], v8
v_smfmac_f32_16x16x64_bf16 v[72:75], v[28:31], a[192:199], v8
v_smfmac_f32_16x16x64_bf16 v[76:79], v[28:31], v[52:59], v8
ds_read_b128 v[52:55], v14 offset:10240
ds_read_b128 v[56:59], v14 offset:11264
s_waitcnt lgkmcnt(2)
v_smfmac_f32_16x16x64_bf16 v[60:63], v[32:35], a[32:39], v8
v_smfmac_f32_16x16x64_bf16 v[64:67], v[32:35], a[88:95], v8
v_smfmac_f32_16x16x64_bf16 v[68:71], v[32:35], a[144:151], v8
v_smfmac_f32_16x16x64_bf16 v[72:75], v[32:35], a[200:207], v8
v_smfmac_f32_16x16x64_bf16 v[76:79], v[32:35], v[44:51], v8
ds_read_b128 v[44:47], v14 offset:12288
ds_read_b128 v[48:51], v14 offset:13312
s_waitcnt lgkmcnt(2)
v_smfmac_f32_16x16x64_bf16 v[60:63], v[36:39], a[40:47], v8
v_smfmac_f32_16x16x64_bf16 v[64:67], v[36:39], a[96:103], v8
v_smfmac_f32_16x16x64_bf16 v[68:71], v[36:39], a[152:159], v8
v_smfmac_f32_16x16x64_bf16 v[72:75], v[36:39], a[208:215], v8
v_smfmac_f32_16x16x64_bf16 v[76:79], v[36:39], v[52:59], v8
s_waitcnt lgkmcnt(0)
v_smfmac_f32_16x16x64_bf16 v[60:63], v[40:43], a[48:55], v8
v_smfmac_f32_16x16x64_bf16 v[64:67], v[40:43], a[104:111], v8
v_smfmac_f32_16x16x64_bf16 v[68:71], v[40:43], a[160:167], v8
v_smfmac_f32_16x16x64_bf16 v[72:75], v[40:43], a[216:223], v8
v_smfmac_f32_16x16x64_bf16 v[76:79], v[40:43], v[44:51], v8
v_cvt_pk_bf16_f32 v60, v60, v61
v_cvt_pk_bf16_f32 v61, v62, v63
v_cvt_pk_bf16_f32 v62, v64, v65
s_nop 7
s_branch JOIN_128
FB_131:
ds_read_b64 v[16:17], v158 offset:0
ds_read_b64 v[18:19], v158 offset:1296
ds_read_b64 v[20:21], v158 offset:2592
ds_read_b64 v[22:23], v158 offset:3888
s_sub_u32 s38, s38, 1
s_cmp_gt_i32 s38, 0
s_cbranch_scc0 FD_132
s_waitcnt lgkmcnt(0)
v_max3_u32 v3, v16, v17, v18
v_max3_u32 v3, v3, v19, v20
v_max3_u32 v3, v3, v21, v22
v_max_u32 v3, v3, v23
v_cmp_eq_u32 vcc, -1, v3
s_cbranch_vccnz FB_131
s_waitcnt lgkmcnt(2)
v_add_f32 v16, v16, v18
v_add_f32 v17, v17, v19
s_waitcnt lgkmcnt(0)
v_add_f32 v20, v20, v22
v_add_f32 v21, v21, v23
v_add_f32 v16, v16, v20
v_add_f32 v17, v17, v21
v_max_f32 v3, v16, v17
s_nop 1
v_max_f32_dpp v3, v3, v3 quad_perm:[1,0,3,2] row_mask:0xf bank_mask:0xf
s_nop 1
v_max_f32_dpp v3, v3, v3 quad_perm:[2,3,0,1] row_mask:0xf bank_mask:0xf
s_nop 1
v_max_f32_dpp v3, v3, v3 row_half_mirror row_mask:0xf bank_mask:0xf
s_nop 1
v_max_f32_dpp v3, v3, v3 row_mirror row_mask:0xf bank_mask:0xf
v_mov_b32 v4, v3
s_nop 1
v_permlane16_swap_b32 v3, v4
v_max_f32 v3, v3, v4
v_sub_f32 v24, v16, v3
v_sub_f32 v25, v17, v3
v_exp_f32 v24, v24
v_exp_f32 v25, v25
s_nop 0
v_add_f32 v3, v24, v25
s_nop 1
v_add_f32_dpp v3, v3, v3 quad_perm:[1,0,3,2] row_mask:0xf bank_mask:0xf
s_nop 1
v_add_f32_dpp v3, v3, v3 quad_perm:[2,3,0,1] row_mask:0xf bank_mask:0xf
s_nop 1
v_add_f32_dpp v3, v3, v3 row_half_mirror row_mask:0xf bank_mask:0xf
s_nop 1
v_add_f32_dpp v3, v3, v3 row_mirror row_mask:0xf bank_mask:0xf
v_mov_b32 v4, v3
s_nop 1
v_permlane16_swap_b32 v3, v4
v_add_f32 v3, v3, v4
v_rcp_f32 v26, v3
v_subrev_u32 v3, 0x21800000, v3
v_mul_f32 v24, v24, v26
v_mul_f32 v25, v25, v26
v_cvt_pk_bf16_f32 v4, v24, v25
buffer_store_dword v4, v159, s[4:7], s28 offen
s_branch FD_132
SL_133:
buffer_store_dword v4, v159, s[4:7], s28 offen sc1
s_branch SB_134
SL_135:
buffer_store_dword v13, v159, s[4:7], s29 offen sc1
s_branch SB_136
VO0:
v_and_b32 v0, 63, v0
v_lshrrev_b32 v1, 4, v0
v_and_b32 v2, 15, v0
v_lshlrev_b32 v9, 4, v0
v_add_u32 v14, 0, v9
v_bfe_u32 v3, v2, 1, 1
v_lshrrev_b32 v4, 2, v2
v_lshlrev_b32 v4, 1, v4
v_and_b32 v5, 1, v2
v_add_u32 v4, v4, v5
v_mul_u32_u24 v8, 0xaaaa, v3
v_add_u32 v8, 0x4444, v8
v_mov_b32 v13, -1
s_mov_b32 s43, 71303168
v_add_u32 v132, 143360, v9
s_add_u32 s24, s11, 0
v_lshrrev_b32 v5, 3, v2
v_lshlrev_b32 v5, 5, v5
v_lshl_add_u32 v5, v1, 6, v5
v_and_b32 v6, 7, v2
v_lshl_add_u32 v5, v6, 1, v5
s_lshl_b32 s35, s24, 8
v_add_u32 v200, s35, v5
v_lshlrev_b32 v5, 2, v0
v_add_u32 v201, s35, v5
s_lshl_b32 s40, s24, 14
s_add_u32 s40, s40, 16777216
s_add_u32 s56, s24, 0
s_and_b32 s56, s56, 3
s_lshl_b32 s56, s56, 11
s_add_u32 s57, s24, 1
s_and_b32 s57, s57, 3
s_lshl_b32 s57, s57, 11
s_add_u32 s58, s24, 2
s_and_b32 s58, s58, 3
s_lshl_b32 s58, s58, 11
s_add_u32 s59, s24, 3
s_and_b32 s59, s59, 3
s_lshl_b32 s59, s59, 11
v_bfe_u32 v5, v0, 2, 1
v_lshl_add_u32 v5, v1, 1, v5
v_mul_u32_u24 v5, 896, v5
v_bfe_u32 v6, v0, 3, 1
v_lshl_add_u32 v5, v6, 6, v5
v_and_b32 v6, 3, v0
v_lshl_add_u32 v5, v6, 2, v5
s_lshr_b32 s35, s24, 2
s_lshl_b32 s35, s35, 7
s_and_b32 s36, s24, 3
s_lshl_b32 s36, s36, 4
s_add_u32 s35, s35, s36
buffer_load_dword v6, v5, s[16:19], s35 offen
s_waitcnt vmcnt(0)
s_mov_b32 s35, 54525952
buffer_store_dword v6, v201, s[4:7], s35 offen sc1
s_mov_b32 s35, 54534144
buffer_store_dword v13, v201, s[4:7], s35 offen sc1
s_mov_b32 s35, 54542336
buffer_store_dword v13, v201, s[4:7], s35 offen sc1
v_mul_u32_u24 v12, 640, v0
s_lshl_b32 s35, s11, 2
s_add_u32 s35, s35, 4224
v_add_u32 v12, s35, v12
v_mov_b32 v7, 1073741824
v_cmp_gt_u32 vcc, 4, v0
s_nop 1
v_cndmask_b32 v12, v7, v12, vcc
v_mov_b32 v7, 0
buffer_store_dword v7, v12, s[4:7], s43 offen sc1
s_and_b32 s35, s8, 3
s_mul_i32 s35, s35, 640
s_add_u32 s35, s35, 0
v_min_u32 v11, 15, v0
v_lshlrev_b32 v11, 2, v11
v_add_u32 v11, s35, v11
s_and_b32 s35, s8, 3
s_mul_i32 s35, s35, 640
s_add_u32 s35, s35, 4224
v_min_u32 v133, 14, v0
v_lshlrev_b32 v133, 2, v133
v_add_u32 v133, s35, v133
s_mov_b32 s10, 0
s_mov_b32 s38, 200000
s_mov_b32 s68, 0
s_mov_b32 s69, 0
s_mov_b32 s70, 0
s_mov_b32 s71, 0
s_waitcnt vmcnt(0) lgkmcnt(0)
s_barrier
s_mov_b32 s34, 71343104
v_lshlrev_b32 v3, 7, v0
s_lshl_b32 s35, s8, 2
v_add_u32 v3, s35, v3
v_mov_b32 v4, 1073741824
v_cmp_gt_u32 vcc, 4, v0
s_nop 1
v_cndmask_b32 v3, v4, v3, vcc
s_add_u32 s35, s66, 1
v_mov_b32 v4, s35
buffer_store_dword v4, v3, s[4:7], s34 offen sc1
v_min_u32 v3, 27, v0
v_lshlrev_b32 v3, 14, v3
s_mul_i32 s34, s11, 458752
s_add_u32 s34, s34, 7340032
buffer_load_dword v4, v3, s[4:7], s34 offen sc1
s_waitcnt vmcnt(0)
v_min_u32 v3, 13, v2
v_lshlrev_b32 v3, 2, v3
v_lshl_add_u32 v3, v1, 8, v3
v_add_u32 v3, 17536, v3
s_mov_b32 s41, 71319552
s_mov_b64 vcc, -1
s_mul_i32 s34, s11, 458752
s_and_b32 s36, vcc_lo, 4294967295
s_cbranch_scc0 RD_140
RL_139:
buffer_load_dword v4, v3, s[4:7], s41 offen sc1
s_sub_u32 s38, s38, 1
s_cmp_gt_i32 s38, 0
s_cbranch_scc0 RD_140
s_waitcnt vmcnt(0)
v_cmp_ne_u32 vcc, 1, v4
s_nop 0
s_and_b32 s36, vcc_lo, 4294967295
s_cbranch_scc0 RD_140
s_sleep 2
s_branch RL_139
RD_140:
s_and_b32 s36, vcc_hi, 4294967295
s_cbranch_scc0 RD_142
RL_141:
buffer_load_dword v4, v3, s[4:7], s41 offen sc1
s_sub_u32 s38, s38, 1
s_cmp_gt_i32 s38, 0
s_cbranch_scc0 RD_142
s_waitcnt vmcnt(0)
v_cmp_ne_u32 vcc, 1, v4
s_nop 0
s_and_b32 s36, vcc_hi, 4294967295
s_cbranch_scc0 RD_142
s_sleep 2
s_branch RL_141
RD_142:
s_add_u32 s35, s34, 7340032
buffer_load_dwordx4 a[0:3], v9, s[4:7], s35 offen sc1
buffer_load_dwordx4 a[4:7], v9, s[4:7], s35 offen offset:1024 sc1
s_add_u32 s35, s34, 7342080
buffer_load_dwordx4 a[8:11], v9, s[4:7], s35 offen sc1
buffer_load_dwordx4 a[12:15], v9, s[4:7], s35 offen offset:1024 sc1
s_add_u32 s35, s34, 7344128
buffer_load_dwordx4 a[16:19], v9, s[4:7], s35 offen sc1
buffer_load_dwordx4 a[20:23], v9, s[4:7], s35 offen offset:1024 sc1
s_add_u32 s35, s34, 7346176
buffer_load_dwordx4 a[24:27], v9, s[4:7], s35 offen sc1
buffer_load_dwordx4 a[28:31], v9, s[4:7], s35 offen offset:1024 sc1
s_add_u32 s35, s34, 7348224
buffer_load_dwordx4 a[32:35], v9, s[4:7], s35 offen sc1
buffer_load_dwordx4 a[36:39], v9, s[4:7], s35 offen offset:1024 sc1
s_add_u32 s35, s34, 7350272
buffer_load_dwordx4 a[40:43], v9, s[4:7], s35 offen sc1
buffer_load_dwordx4 a[44:47], v9, s[4:7], s35 offen offset:1024 sc1
s_add_u32 s35, s34, 7352320
buffer_load_dwordx4 a[48:51], v9, s[4:7], s35 offen sc1
buffer_load_dwordx4 a[52:55], v9, s[4:7], s35 offen offset:1024 sc1
s_add_u32 s35, s34, 7354368
s_mov_b32 m0, 14336
s_nop 0
buffer_load_dwordx4 v9, s[4:7], s35 offen sc1 lds
buffer_load_dwordx4 v9, s[4:7], s35 offen offset:1024 sc1 lds
s_add_u32 s35, s34, 7356416
s_mov_b32 m0, 16384
s_nop 0
buffer_load_dwordx4 v9, s[4:7], s35 offen sc1 lds
buffer_load_dwordx4 v9, s[4:7], s35 offen offset:1024 sc1 lds
s_add_u32 s35, s34, 7358464
s_mov_b32 m0, 18432
s_nop 0
buffer_load_dwordx4 v9, s[4:7], s35 offen sc1 lds
buffer_load_dwordx4 v9, s[4:7], s35 offen offset:1024 sc1 lds
s_add_u32 s35, s34, 7360512
s_mov_b32 m0, 20480
s_nop 0
buffer_load_dwordx4 v9, s[4:7], s35 offen sc1 lds
buffer_load_dwordx4 v9, s[4:7], s35 offen offset:1024 sc1 lds
s_add_u32 s35, s34, 7362560
s_mov_b32 m0, 22528
s_nop 0
buffer_load_dwordx4 v9, s[4:7], s35 offen sc1 lds
buffer_load_dwordx4 v9, s[4:7], s35 offen offset:1024 sc1 lds
s_add_u32 s35, s34, 7364608
s_mov_b32 m0, 24576
s_nop 0
buffer_load_dwordx4 v9, s[4:7], s35 offen sc1 lds
buffer_load_dwordx4 v9, s[4:7], s35 offen offset:1024 sc1 lds
s_add_u32 s35, s34, 7366656
s_mov_b32 m0, 26624
s_nop 0
buffer_load_dwordx4 v9, s[4:7], s35 offen sc1 lds
buffer_load_dwordx4 v9, s[4:7], s35 offen offset:1024 sc1 lds
s_add_u32 s35, s34, 7368704
buffer_load_dwordx4 a[56:59], v9, s[4:7], s35 offen sc1
buffer_load_dwordx4 a[60:63], v9, s[4:7], s35 offen offset:1024 sc1
s_add_u32 s35, s34, 7370752
buffer_load_dwordx4 a[64:67], v9, s[4:7], s35 offen sc1
buffer_load_dwordx4 a[68:71], v9, s[4:7], s35 offen offset:1024 sc1
s_add_u32 s35, s34, 7372800
buffer_load_dwordx4 a[72:75], v9, s[4:7], s35 offen sc1
buffer_load_dwordx4 a[76:79], v9, s[4:7], s35 offen offset:1024 sc1
s_add_u32 s35, s34, 7374848
buffer_load_dwordx4 a[80:83], v9, s[4:7], s35 offen sc1
buffer_load_dwordx4 a[84:87], v9, s[4:7], s35 offen offset:1024 sc1
s_add_u32 s35, s34, 7376896
buffer_load_dwordx4 a[88:91], v9, s[4:7], s35 offen sc1
buffer_load_dwordx4 a[92:95], v9, s[4:7], s35 offen offset:1024 sc1
s_add_u32 s35, s34, 7378944
buffer_load_dwordx4 a[96:99], v9, s[4:7], s35 offen sc1
buffer_load_dwordx4 a[100:103], v9, s[4:7], s35 offen offset:1024 sc1
s_add_u32 s35, s34, 7380992
buffer_load_dwordx4 a[104:107], v9, s[4:7], s35 offen sc1
buffer_load_dwordx4 a[108:111], v9, s[4:7], s35 offen offset:1024 sc1
s_add_u32 s35, s34, 7383040
s_mov_b32 m0, 28672
s_nop 0
buffer_load_dwordx4 v9, s[4:7], s35 offen sc1 lds
buffer_load_dwordx4 v9, s[4:7], s35 offen offset:1024 sc1 lds
s_add_u32 s35, s34, 7385088
s_mov_b32 m0, 30720
s_nop 0
buffer_load_dwordx4 v9, s[4:7], s35 offen sc1 lds
buffer_load_dwordx4 v9, s[4:7], s35 offen offset:1024 sc1 lds
s_add_u32 s35, s34, 7387136
s_mov_b32 m0, 32768
s_nop 0
buffer_load_dwordx4 v9, s[4:7], s35 offen sc1 lds
buffer_load_dwordx4 v9, s[4:7], s35 offen offset:1024 sc1 lds
s_add_u32 s35, s34, 7389184
s_mov_b32 m0, 34816
s_nop 0
buffer_load_dwordx4 v9, s[4:7], s35 offen sc1 lds
buffer_load_dwordx4 v9, s[4:7], s35 offen offset:1024 sc1 lds
s_add_u32 s35, s34, 7391232
s_mov_b32 m0, 36864
s_nop 0
buffer_load_dwordx4 v9, s[4:7], s35 offen sc1 lds
buffer_load_dwordx4 v9, s[4:7], s35 offen offset:1024 sc1 lds
s_add_u32 s35, s34, 7393280
s_mov_b32 m0, 38912
s_nop 0
buffer_load_dwordx4 v9, s[4:7], s35 offen sc1 lds
buffer_load_dwordx4 v9, s[4:7], s35 offen offset:1024 sc1 lds
s_add_u32 s35, s34, 7395328
s_mov_b32 m0, 40960
s_nop 0
buffer_load_dwordx4 v9, s[4:7], s35 offen sc1 lds
buffer_load_dwordx4 v9, s[4:7], s35 offen offset:1024 sc1 lds
s_add_u32 s35, s34, 7397376
buffer_load_dwordx4 a[112:115], v9, s[4:7], s35 offen sc1
buffer_load_dwordx4 a[116:119], v9, s[4:7], s35 offen offset:1024 sc1
s_add_u32 s35, s34, 7399424
buffer_load_dwordx4 a[120:123], v9, s[4:7], s35 offen sc1
buffer_load_dwordx4 a[124:127], v9, s[4:7], s35 offen offset:1024 sc1
s_waitcnt vmcnt(40)
s_add_u32 s35, s34, 7401472
buffer_load_dwordx4 a[128:131], v9, s[4:7], s35 offen sc1
buffer_load_dwordx4 a[132:135], v9, s[4:7], s35 offen offset:1024 sc1
s_add_u32 s35, s34, 7403520
buffer_load_dwordx4 a[136:139], v9, s[4:7], s35 offen sc1
buffer_load_dwordx4 a[140:143], v9, s[4:7], s35 offen offset:1024 sc1
s_add_u32 s35, s34, 7405568
buffer_load_dwordx4 a[144:147], v9, s[4:7], s35 offen sc1
buffer_load_dwordx4 a[148:151], v9, s[4:7], s35 offen offset:1024 sc1
s_add_u32 s35, s34, 7407616
buffer_load_dwordx4 a[152:155], v9, s[4:7], s35 offen sc1
buffer_load_dwordx4 a[156:159], v9, s[4:7], s35 offen offset:1024 sc1
s_add_u32 s35, s34, 7409664
buffer_load_dwordx4 a[160:163], v9, s[4:7], s35 offen sc1
buffer_load_dwordx4 a[164:167], v9, s[4:7], s35 offen offset:1024 sc1
s_add_u32 s35, s34, 7411712
buffer_load_dwordx4 a[168:171], v9, s[4:7], s35 offen sc1
buffer_load_dwordx4 a[172:175], v9, s[4:7], s35 offen offset:1024 sc1
s_add_u32 s35, s34, 7413760
buffer_load_dwordx4 a[176:179], v9, s[4:7], s35 offen sc1
buffer_load_dwordx4 a[180:183], v9, s[4:7], s35 offen offset:1024 sc1
s_add_u32 s35, s34, 7415808
buffer_load_dwordx4 a[184:187], v9, s[4:7], s35 offen sc1
buffer_load_dwordx4 a[188:191], v9, s[4:7], s35 offen offset:1024 sc1
s_add_u32 s35, s34, 7417856
buffer_load_dwordx4 a[192:195], v9, s[4:7], s35 offen sc1
buffer_load_dwordx4 a[196:199], v9, s[4:7], s35 offen offset:1024 sc1
s_add_u32 s35, s34, 7419904
buffer_load_dwordx4 a[200:203], v9, s[4:7], s35 offen sc1
buffer_load_dwordx4 a[204:207], v9, s[4:7], s35 offen offset:1024 sc1
s_waitcnt vmcnt(40)
s_add_u32 s35, s34, 7421952
buffer_load_dwordx4 a[208:211], v9, s[4:7], s35 offen sc1
buffer_load_dwordx4 a[212:215], v9, s[4:7], s35 offen offset:1024 sc1
s_add_u32 s35, s34, 7424000
buffer_load_dwordx4 a[216:219], v9, s[4:7], s35 offen sc1
buffer_load_dwordx4 a[220:223], v9, s[4:7], s35 offen offset:1024 sc1
s_add_u32 s35, s34, 7426048
s_mov_b32 m0, 0
s_nop 0
buffer_load_dwordx4 v9, s[4:7], s35 offen sc1 lds
buffer_load_dwordx4 v9, s[4:7], s35 offen offset:1024 sc1 lds
s_add_u32 s35, s34, 7428096
s_mov_b32 m0, 2048
s_nop 0
buffer_load_dwordx4 v9, s[4:7], s35 offen sc1 lds
buffer_load_dwordx4 v9, s[4:7], s35 offen offset:1024 sc1 lds
s_add_u32 s35, s34, 7430144
s_mov_b32 m0, 4096
s_nop 0
buffer_load_dwordx4 v9, s[4:7], s35 offen sc1 lds
buffer_load_dwordx4 v9, s[4:7], s35 offen offset:1024 sc1 lds
s_add_u32 s35, s34, 7432192
s_mov_b32 m0, 6144
s_nop 0
buffer_load_dwordx4 v9, s[4:7], s35 offen sc1 lds
buffer_load_dwordx4 v9, s[4:7], s35 offen offset:1024 sc1 lds
s_add_u32 s35, s34, 7434240
s_mov_b32 m0, 8192
s_nop 0
buffer_load_dwordx4 v9, s[4:7], s35 offen sc1 lds
buffer_load_dwordx4 v9, s[4:7], s35 offen offset:1024 sc1 lds
s_add_u32 s35, s34, 7436288
s_mov_b32 m0, 10240
s_nop 0
buffer_load_dwordx4 v9, s[4:7], s35 offen sc1 lds
buffer_load_dwordx4 v9, s[4:7], s35 offen offset:1024 sc1 lds
s_add_u32 s35, s34, 7438336
s_mov_b32 m0, 12288
s_nop 0
buffer_load_dwordx4 v9, s[4:7], s35 offen sc1 lds
buffer_load_dwordx4 v9, s[4:7], s35 offen offset:1024 sc1 lds
s_add_u32 s35, s34, 7440384
buffer_load_dwordx4 a[224:227], v9, s[4:7], s35 offen sc1
buffer_load_dwordx4 a[228:231], v9, s[4:7], s35 offen offset:1024 sc1
s_waitcnt vmcnt(40)
s_add_u32 s35, s34, 7442432
buffer_load_dwordx4 a[232:235], v9, s[4:7], s35 offen sc1
buffer_load_dwordx4 a[236:239], v9, s[4:7], s35 offen offset:1024 sc1
s_add_u32 s35, s34, 7444480
buffer_load_dwordx4 a[240:243], v9, s[4:7], s35 offen sc1
buffer_load_dwordx4 a[244:247], v9, s[4:7], s35 offen offset:1024 sc1
s_add_u32 s35, s34, 7446528
buffer_load_dwordx4 a[248:251], v9, s[4:7], s35 offen sc1
buffer_load_dwordx4 a[252:255], v9, s[4:7], s35 offen offset:1024 sc1
s_add_u32 s35, s34, 7448576
buffer_load_dwordx4 v[204:207], v9, s[4:7], s35 offen sc1
buffer_load_dwordx4 v[208:211], v9, s[4:7], s35 offen offset:1024 sc1
s_add_u32 s35, s34, 7450624
buffer_load_dwordx4 v[212:215], v9, s[4:7], s35 offen sc1
buffer_load_dwordx4 v[216:219], v9, s[4:7], s35 offen offset:1024 sc1
s_add_u32 s35, s34, 7452672
buffer_load_dwordx4 v[220:223], v9, s[4:7], s35 offen sc1
buffer_load_dwordx4 v[224:227], v9, s[4:7], s35 offen offset:1024 sc1
s_mov_b32 s34, 71343104
v_and_b32 v3, 31, v0
v_lshlrev_b32 v3, 2, v3
s_and_b32 s35, s8, 3
s_lshl_b32 s35, s35, 7
s_add_u32 s34, s34, s35
TB_143:
buffer_load_dword v5, v3, s[4:7], s34 offen sc1
s_sub_u32 s38, s38, 1
s_cmp_gt_i32 s38, 0
s_cbranch_scc0 TBD_144
s_waitcnt vmcnt(0)
v_cmp_eq_u32 vcc, 0, v5
s_cbranch_vccz TBD_144
s_sleep 4
s_branch TB_143
TBD_144:
v_cmp_lt_u32 vcc, 1, v5
s_nop 0
s_or_b32 s66, vcc_lo, vcc_hi
v_mov_b32 v4, s66
v_mov_b32 v3, 151552
ds_write_b32 v3, v4
s_waitcnt lgkmcnt(0)
s_barrier
v_mov_b32 v3, 151552
ds_read_b32 v4, v3
s_waitcnt lgkmcnt(0)
v_readfirstlane_b32 s66, v4
s_waitcnt vmcnt(0)
v_mov_b32 v92, 0
v_mov_b32 v93, 0
v_mov_b32 v94, 0
v_mov_b32 v95, 0
v_mov_b32 v96, 0
v_mov_b32 v97, 0
v_mov_b32 v98, 0
v_mov_b32 v99, 0
v_mov_b32 v100, 0
v_mov_b32 v101, 0
v_mov_b32 v102, 0
v_mov_b32 v103, 0
v_mov_b32 v104, 0
v_mov_b32 v105, 0
v_mov_b32 v106, 0
v_mov_b32 v107, 0
v_mov_b32 v108, 0
v_mov_b32 v109, 0
v_mov_b32 v110, 0
v_mov_b32 v111, 0
v_mov_b32 v112, 0
v_mov_b32 v113, 0
v_mov_b32 v114, 0
v_mov_b32 v115, 0
v_mov_b32 v116, 0
v_mov_b32 v117, 0
v_mov_b32 v118, 0
v_mov_b32 v119, 0
v_mov_b32 v120, 0
v_mov_b32 v121, 0
v_mov_b32 v122, 0
v_mov_b32 v123, 0
s_lshl_b32 s26, s10, 13
s_add_u32 s26, s26, 54525952
s_add_u32 s27, s26, 4096
LOOP_145:
s_barrier
buffer_load_dwordx4 v[16:19], v9, s[4:7], s26 offen offset:0 sc1
ds_read_b128 v[44:47], v14 offset:0
ds_read_b128 v[48:51], v14 offset:1024
ds_read_b128 v[60:63], v14 offset:14336
ds_read_b128 v[64:67], v14 offset:15360
ds_read_b128 v[76:79], v14 offset:28672
ds_read_b128 v[80:83], v14 offset:29696
ds_read_b128 v[52:55], v14 offset:2048
ds_read_b128 v[56:59], v14 offset:3072
ds_read_b128 v[68:71], v14 offset:16384
ds_read_b128 v[72:75], v14 offset:17408
ds_read_b128 v[84:87], v14 offset:30720
s_barrier
buffer_load_dwordx4 v[20:23], v9, s[4:7], s26 offen offset:1024
ds_read_b128 v[88:91], v14 offset:31744
s_add_u32 s39, s10, 1
s_mov_b64 s[50:51], -1
v_mov_b32 v10, s39
s_and_b32 s34, s10, 3
s_lshl_b32 s28, s34, 14
s_add_u32 s28, s28, 55312384
s_add_u32 s32, s26, 8192
s_add_u32 s33, s26, 16384
s_min_u32 s37, s10, 63
s_mul_i32 s37, s37, 458752
s_barrier
buffer_load_dwordx4 v[24:27], v9, s[4:7], s26 offen offset:2048
s_add_u32 s37, s37, s40
s_lshl1_add_u32 s64, s56, s37
s_lshl1_add_u32 s65, s57, s37
s_lshl1_add_u32 s54, s58, s37
s_lshl1_add_u32 s55, s59, s37
s_add_u32 s20, s28, s56
s_add_u32 s21, s28, s57
s_add_u32 s22, s28, s58
s_add_u32 s23, s28, s59
s_barrier
buffer_load_dwordx4 v[28:31], v9, s[4:7], s26 offen offset:3072
s_waitcnt vmcnt(3)
v_smfmac_f32_16x16x64_bf16 v[92:95], v[16:19], a[0:7], v8
buffer_load_dwordx4 v[32:35], v9, s[4:7], s27 offen offset:0
v_cmp_eq_u32 vcc, -1, v16
v_smfmac_f32_16x16x64_bf16 v[96:99], v[16:19], a[56:63], v8
v_smfmac_f32_16x16x64_bf16 v[100:103], v[16:19], a[112:119], v8
s_cbranch_vccnz RT_149
BK_150:
s_waitcnt lgkmcnt(10)
v_smfmac_f32_16x16x64_bf16 v[104:107], v[16:19], v[44:51], v8
buffer_load_dwordx4 v[36:39], v9, s[4:7], s27 offen offset:1024
s_waitcnt lgkmcnt(8)
v_smfmac_f32_16x16x64_bf16 v[108:111], v[16:19], v[60:67], v8
s_waitcnt lgkmcnt(6)
v_smfmac_f32_16x16x64_bf16 v[112:115], v[16:19], v[76:83], v8
s_waitcnt vmcnt(4)
v_smfmac_f32_16x16x64_bf16 v[92:95], v[20:23], a[8:15], v8
buffer_load_dwordx4 v[40:43], v9, s[4:7], s27 offen offset:2048
ds_read_b128 v[44:47], v14 offset:4096
v_smfmac_f32_16x16x64_bf16 v[96:99], v[20:23], a[64:71], v8
ds_read_b128 v[48:51], v14 offset:5120
v_smfmac_f32_16x16x64_bf16 v[100:103], v[20:23], a[120:127], v8
buffer_load_dwordx4 v[136:139], v9, s[4:7], s64 offen offset:0 sc1
ds_read_b128 v[60:63], v14 offset:18432
s_waitcnt lgkmcnt(7)
v_smfmac_f32_16x16x64_bf16 v[104:107], v[20:23], v[52:59], v8
ds_read_b128 v[64:67], v14 offset:19456
s_waitcnt lgkmcnt(6)
v_smfmac_f32_16x16x64_bf16 v[108:111], v[20:23], v[68:75], v8
buffer_load_dwordx4 v[140:143], v9, s[4:7], s64 offen offset:1024 sc1
ds_read_b128 v[76:79], v14 offset:32768
s_waitcnt lgkmcnt(5)
v_smfmac_f32_16x16x64_bf16 v[112:115], v[20:23], v[84:91], v8
ds_read_b128 v[80:83], v14 offset:33792
s_waitcnt vmcnt(6)
v_smfmac_f32_16x16x64_bf16 v[92:95], v[24:27], a[16:23], v8
buffer_load_dwordx4 v[144:147], v9, s[4:7], s64 offen offset:2048 sc1
ds_read_b128 v[52:55], v14 offset:6144
v_smfmac_f32_16x16x64_bf16 v[96:99], v[24:27], a[72:79], v8
ds_read_b128 v[56:59], v14 offset:7168
v_smfmac_f32_16x16x64_bf16 v[100:103], v[24:27], a[128:135], v8
buffer_load_dwordx4 v[148:151], v9, s[4:7], s64 offen offset:3072 sc1
ds_read_b128 v[68:71], v14 offset:20480
s_waitcnt lgkmcnt(7)
v_smfmac_f32_16x16x64_bf16 v[104:107], v[24:27], v[44:51], v8
ds_read_b128 v[72:75], v14 offset:21504
s_waitcnt lgkmcnt(6)
v_smfmac_f32_16x16x64_bf16 v[108:111], v[24:27], v[60:67], v8
buffer_load_dwordx4 v[152:155], v9, s[4:7], s65 offen offset:0 sc1
ds_read_b128 v[84:87], v14 offset:34816
s_waitcnt lgkmcnt(5)
v_smfmac_f32_16x16x64_bf16 v[112:115], v[24:27], v[76:83], v8
ds_read_b128 v[88:91], v14 offset:35840
s_waitcnt vmcnt(8)
v_smfmac_f32_16x16x64_bf16 v[92:95], v[28:31], a[24:31], v8
buffer_load_dwordx4 v[156:159], v9, s[4:7], s65 offen offset:1024 sc1
ds_read_b128 v[44:47], v14 offset:8192
v_smfmac_f32_16x16x64_bf16 v[96:99], v[28:31], a[80:87], v8
ds_read_b128 v[48:51], v14 offset:9216
v_smfmac_f32_16x16x64_bf16 v[100:103], v[28:31], a[136:143], v8
buffer_load_dwordx4 v[160:163], v9, s[4:7], s65 offen offset:2048 sc1
ds_read_b128 v[60:63], v14 offset:22528
s_waitcnt lgkmcnt(7)
v_smfmac_f32_16x16x64_bf16 v[104:107], v[28:31], v[52:59], v8
ds_read_b128 v[64:67], v14 offset:23552
s_waitcnt lgkmcnt(6)
v_smfmac_f32_16x16x64_bf16 v[108:111], v[28:31], v[68:75], v8
buffer_load_dwordx4 v[164:167], v9, s[4:7], s65 offen offset:3072 sc1
ds_read_b128 v[76:79], v14 offset:36864
s_waitcnt lgkmcnt(5)
v_smfmac_f32_16x16x64_bf16 v[112:115], v[28:31], v[84:91], v8
ds_read_b128 v[80:83], v14 offset:37888
s_waitcnt vmcnt(10)
v_smfmac_f32_16x16x64_bf16 v[92:95], v[32:35], a[32:39], v8
buffer_load_dwordx4 v[168:171], v9, s[4:7], s54 offen offset:0 sc1
ds_read_b128 v[52:55], v14 offset:10240
v_smfmac_f32_16x16x64_bf16 v[96:99], v[32:35], a[88:95], v8
ds_read_b128 v[56:59], v14 offset:11264
v_smfmac_f32_16x16x64_bf16 v[100:103], v[32:35], a[144:151], v8
buffer_load_dwordx4 v[172:175], v9, s[4:7], s54 offen offset:1024 sc1
ds_read_b128 v[68:71], v14 offset:24576
s_waitcnt lgkmcnt(7)
v_smfmac_f32_16x16x64_bf16 v[104:107], v[32:35], v[44:51], v8
ds_read_b128 v[72:75], v14 offset:25600
s_waitcnt lgkmcnt(6)
v_smfmac_f32_16x16x64_bf16 v[108:111], v[32:35], v[60:67], v8
buffer_load_dwordx4 v[176:179], v9, s[4:7], s54 offen offset:2048 sc1
ds_read_b128 v[84:87], v14 offset:38912
s_waitcnt lgkmcnt(5)
v_smfmac_f32_16x16x64_bf16 v[112:115], v[32:35], v[76:83], v8
ds_read_b128 v[88:91], v14 offset:39936
s_waitcnt vmcnt(12)
v_smfmac_f32_16x16x64_bf16 v[92:95], v[36:39], a[40:47], v8
buffer_load_dwordx4 v[180:183], v9, s[4:7], s54 offen offset:3072 sc1
ds_read_b128 v[44:47], v14 offset:12288
v_smfmac_f32_16x16x64_bf16 v[96:99], v[36:39], a[96:103], v8
ds_read_b128 v[48:51], v14 offset:13312
v_smfmac_f32_16x16x64_bf16 v[100:103], v[36:39], a[152:159], v8
buffer_load_dwordx4 v[184:187], v9, s[4:7], s55 offen offset:0 sc1
ds_read_b128 v[60:63], v14 offset:26624
s_waitcnt lgkmcnt(7)
v_smfmac_f32_16x16x64_bf16 v[104:107], v[36:39], v[52:59], v8
ds_read_b128 v[64:67], v14 offset:27648
s_waitcnt lgkmcnt(6)
v_smfmac_f32_16x16x64_bf16 v[108:111], v[36:39], v[68:75], v8
buffer_load_dwordx4 v[188:191], v9, s[4:7], s55 offen offset:1024 sc1
ds_read_b128 v[76:79], v14 offset:40960
s_waitcnt lgkmcnt(5)
v_smfmac_f32_16x16x64_bf16 v[112:115], v[36:39], v[84:91], v8
ds_read_b128 v[80:83], v14 offset:41984
s_waitcnt vmcnt(14)
v_smfmac_f32_16x16x64_bf16 v[92:95], v[40:43], a[48:55], v8
buffer_load_dwordx4 v[192:195], v9, s[4:7], s55 offen offset:2048 sc1
v_smfmac_f32_16x16x64_bf16 v[96:99], v[40:43], a[104:111], v8
v_smfmac_f32_16x16x64_bf16 v[100:103], v[40:43], a[160:167], v8
buffer_load_dwordx4 v[196:199], v9, s[4:7], s55 offen offset:3072 sc1
s_waitcnt lgkmcnt(4)
v_smfmac_f32_16x16x64_bf16 v[104:107], v[40:43], v[44:51], v8
s_waitcnt lgkmcnt(2)
v_smfmac_f32_16x16x64_bf16 v[108:111], v[40:43], v[60:67], v8
s_waitcnt lgkmcnt(0)
v_smfmac_f32_16x16x64_bf16 v[112:115], v[40:43], v[76:83], v8
JOIN_148:
v_smfmac_f32_16x16x64_bf16 v[116:119], v[16:19], a[168:175], v8
v_add_f32 v92, v92, v94
v_smfmac_f32_16x16x64_bf16 v[116:119], v[20:23], a[176:183], v8
v_add_f32 v93, v93, v95
v_cmp_u_f32 vcc, v92, v93
v_smfmac_f32_16x16x64_bf16 v[116:119], v[24:27], a[184:191], v8
v_cvt_pk_bf16_f32 v124, v92, v93
v_smfmac_f32_16x16x64_bf16 v[116:119], v[28:31], a[192:199], v8
v_add_f32 v96, v96, v98
v_add_f32 v97, v97, v99
v_smfmac_f32_16x16x64_bf16 v[116:119], v[32:35], a[200:207], v8
s_and_b64 vcc, vcc, s[50:51]
s_cbranch_scc1 FAIL_147
v_cvt_pk_bf16_f32 v125, v96, v97
v_smfmac_f32_16x16x64_bf16 v[116:119], v[36:39], a[208:215], v8
v_add_f32 v100, v100, v102
v_add_f32 v101, v101, v103
v_smfmac_f32_16x16x64_bf16 v[116:119], v[40:43], a[216:223], v8
v_cvt_pk_bf16_f32 v126, v100, v101
v_smfmac_f32_16x16x64_bf16 v[120:123], v[16:19], a[224:231], v8
v_add_f32 v104, v104, v106
v_add_f32 v105, v105, v107
v_smfmac_f32_16x16x64_bf16 v[120:123], v[20:23], a[232:239], v8
v_cvt_pk_bf16_f32 v127, v104, v105
v_smfmac_f32_16x16x64_bf16 v[120:123], v[24:27], a[240:247], v8
v_add_f32 v108, v108, v110
v_add_f32 v109, v109, v111
v_smfmac_f32_16x16x64_bf16 v[120:123], v[28:31], a[248:255], v8
v_cvt_pk_bf16_f32 v128, v108, v109
v_smfmac_f32_16x16x64_bf16 v[120:123], v[32:35], v[204:211], v8
v_add_f32 v112, v112, v114
v_add_f32 v113, v113, v115
v_smfmac_f32_16x16x64_bf16 v[120:123], v[36:39], v[212:219], v8
v_cvt_pk_bf16_f32 v129, v112, v113
v_smfmac_f32_16x16x64_bf16 v[120:123], v[40:43], v[220:227], v8
v_add_f32 v116, v116, v118
v_add_f32 v117, v117, v119
v_cvt_pk_bf16_f32 v130, v116, v117
s_nop 4
v_add_f32 v120, v120, v122
v_add_f32 v121, v121, v123
v_cvt_pk_bf16_f32 v131, v120, v121
ds_write_b128 v132, v[124:127] offset:0
ds_write_b128 v132, v[128:131] offset:4096
s_cmp_eq_u32 s10, 0
s_cbranch_scc1 Y0_151
YB_154:
buffer_store_dword v13, v201, s[4:7], s33 offen
buffer_load_dword v36, v11, s[4:7], s43 offen sc1
v_mov_b32 v92, 0
v_mov_b32 v93, 0
v_mov_b32 v94, 0
v_mov_b32 v95, 0
v_mov_b32 v96, 0
v_mov_b32 v97, 0
s_add_u32 s10, s10, 1
s_lshl_b32 s26, s10, 13
s_add_u32 s26, s26, 54525952
s_add_u32 s27, s26, 4096
buffer_load_dword v37, v11, s[4:7], s43 offen sc1
s_waitcnt lgkmcnt(0)
buffer_load_dword v38, v11, s[4:7], s43 offen sc1
v_mov_b32 v76, 0
v_mov_b32 v77, 0
v_mov_b32 v78, 0
v_mov_b32 v79, 0
buffer_load_dword v39, v11, s[4:7], s43 offen sc1
v_mov_b32 v98, 0
v_mov_b32 v99, 0
v_mov_b32 v100, 0
v_mov_b32 v101, 0
v_mov_b32 v102, 0
v_mov_b32 v103, 0
buffer_load_dword v40, v11, s[4:7], s43 offen sc1
v_mov_b32 v104, 0
v_mov_b32 v105, 0
v_mov_b32 v106, 0
v_mov_b32 v107, 0
v_mov_b32 v108, 0
v_mov_b32 v109, 0
buffer_load_dword v41, v11, s[4:7], s43 offen sc1
v_mov_b32 v110, 0
v_mov_b32 v111, 0
v_mov_b32 v112, 0
v_mov_b32 v113, 0
v_mov_b32 v114, 0
v_mov_b32 v115, 0
buffer_load_dword v42, v11, s[4:7], s43 offen sc1
v_mov_b32 v116, 0
v_mov_b32 v117, 0
v_mov_b32 v118, 0
v_mov_b32 v119, 0
v_mov_b32 v120, 0
v_mov_b32 v121, 0
PL_155:
s_waitcnt vmcnt(6)
v_cmp_gt_u32 vcc, s39, v36
buffer_load_dword v36, v11, s[4:7], s43 offen sc1
s_cbranch_vccz GO_156
s_waitcnt vmcnt(6)
v_cmp_gt_u32 vcc, s39, v37
buffer_load_dword v37, v11, s[4:7], s43 offen sc1
s_cbranch_vccz GO_156
s_waitcnt vmcnt(6)
v_cmp_gt_u32 vcc, s39, v38
buffer_load_dword v38, v11, s[4:7], s43 offen sc1
s_cbranch_vccz GO_156
s_waitcnt vmcnt(6)
v_cmp_gt_u32 vcc, s39, v39
buffer_load_dword v39, v11, s[4:7], s43 offen sc1
s_cbranch_vccz GO_156
s_waitcnt vmcnt(6)
v_cmp_gt_u32 vcc, s39, v40
buffer_load_dword v40, v11, s[4:7], s43 offen sc1
s_cbranch_vccz GO_156
s_waitcnt vmcnt(6)
v_cmp_gt_u32 vcc, s39, v41
buffer_load_dword v41, v11, s[4:7], s43 offen sc1
s_cbranch_vccz GO_156
s_waitcnt vmcnt(6)
v_cmp_gt_u32 vcc, s39, v42
buffer_load_dword v42, v11, s[4:7], s43 offen sc1
s_cbranch_vccz GO_156
s_sub_u32 s38, s38, 1
s_cmp_gt_i32 s38, 0
s_cbranch_scc1 PL_155
GO_156:
buffer_load_dwordx4 v[16:19], v9, s[4:7], s28 offen offset:0 sc1
buffer_load_dwordx4 v[20:23], v9, s[4:7], s28 offen offset:1024 sc1
buffer_load_dwordx4 v[24:27], v9, s[4:7], s20 offen offset:2048 sc1
buffer_load_dwordx4 v[28:31], v9, s[4:7], s20 offen offset:3072 sc1
buffer_load_dwordx4 v[32:35], v9, s[4:7], s21 offen offset:2048 sc1
buffer_load_dwordx4 v[36:39], v9, s[4:7], s21 offen offset:3072 sc1
buffer_load_dwordx4 v[40:43], v9, s[4:7], s22 offen offset:2048 sc1
buffer_load_dwordx4 v[44:47], v9, s[4:7], s22 offen offset:3072 sc1
buffer_load_dwordx4 v[48:51], v9, s[4:7], s23 offen offset:2048 sc1
buffer_load_dwordx4 v[52:55], v9, s[4:7], s23 offen offset:3072 sc1
s_barrier
ds_read_b128 v[60:63], v132 offset:0
ds_read_b128 v[64:67], v132 offset:1024
ds_read_b128 v[68:71], v132 offset:2048
ds_read_b128 v[72:75], v132 offset:3072
PB_160:
v_mov_b32 v122, 0
v_mov_b32 v123, 0
s_waitcnt vmcnt(9) lgkmcnt(0)
v_smfmac_f32_16x16x64_bf16 v[76:79], v[16:19], v[60:67], v8
s_waitcnt vmcnt(8)
v_max3_u32 v3, v16, v17, v20
v_max_u32 v3, v3, v21
v_smfmac_f32_16x16x64_bf16 v[76:79], v[20:23], v[68:75], v8
s_waitcnt vmcnt(7)
v_cmp_eq_u32 vcc, -1, v3
v_smfmac_f32_16x16x64_bf16 v[76:79], v[24:27], v[136:143], v8
s_waitcnt vmcnt(6)
v_smfmac_f32_16x16x64_bf16 v[76:79], v[28:31], v[144:151], v8
s_cbranch_vccnz PR_159
buffer_store_dword v10, v12, s[4:7], s43 offen
s_waitcnt vmcnt(6)
v_smfmac_f32_16x16x64_bf16 v[76:79], v[32:35], v[152:159], v8
s_waitcnt vmcnt(5)
v_smfmac_f32_16x16x64_bf16 v[76:79], v[36:39], v[160:167], v8
s_waitcnt vmcnt(4)
v_smfmac_f32_16x16x64_bf16 v[76:79], v[40:43], v[168:175], v8
s_waitcnt vmcnt(3)
v_smfmac_f32_16x16x64_bf16 v[76:79], v[44:47], v[176:183], v8
s_waitcnt vmcnt(2)
v_smfmac_f32_16x16x64_bf16 v[76:79], v[48:51], v[184:191], v8
s_waitcnt vmcnt(1)
v_smfmac_f32_16x16x64_bf16 v[76:79], v[52:55], v[192:199], v8
v_mov_b32 v7, 0
v_mov_b32 v7, 0
v_mov_b32 v7, 0
v_mov_b32 v7, 0
v_mov_b32 v7, 0
v_mov_b32 v7, 0
v_mov_b32 v7, 0
s_nop 0
v_add_f32 v76, v76, v78
v_add_f32 v77, v77, v79
v_cvt_pk_bf16_f32 v3, v76, v77
v_cmpx_o_f32 vcc, v76, v77
buffer_store_short v3, v200, s[4:7], s32 offen
buffer_store_short_d16_hi v3, v200, s[4:7], s32 offen offset:16
s_mov_b64 exec, -1
s_cmp_lg_u64 vcc, -1
s_cbranch_scc1 PF_158
PD_157:
s_cmp_lg_u32 s66, 0
s_cbranch_scc1 SL_161
SB_162:
s_cmp_ge_u32 s10, 63
s_cbranch_scc1 END_146
buffer_load_dword v36, v133, s[4:7], s43 offen sc1
buffer_load_dword v37, v133, s[4:7], s43 offen sc1
PL_163:
s_waitcnt vmcnt(1)
v_cmp_gt_u32 vcc, s39, v36
buffer_load_dword v36, v133, s[4:7], s43 offen sc1
s_cbranch_vccz LOOP_145
s_waitcnt vmcnt(1)
v_cmp_gt_u32 vcc, s39, v37
buffer_load_dword v37, v133, s[4:7], s43 offen sc1
s_cbranch_vccz LOOP_145
s_sub_u32 s38, s38, 1
s_cmp_gt_i32 s38, 0
s_cbranch_scc1 PL_163
GO_164:
s_branch LOOP_145
END_146:
s_add_u32 s32, s32, 2097152
buffer_store_short v3, v200, s[4:7], s32 offen sc1
buffer_store_short_d16_hi v3, v200, s[4:7], s32 offen offset:16 sc1
s_endpgm
RT_149:
buffer_load_dwordx4 v[16:19], v9, s[4:7], s26 offen offset:0 sc1
buffer_load_dwordx4 v[20:23], v9, s[4:7], s26 offen offset:1024 sc1
buffer_load_dwordx4 v[24:27], v9, s[4:7], s26 offen offset:2048 sc1
buffer_load_dwordx4 v[28:31], v9, s[4:7], s26 offen offset:3072 sc1
buffer_load_dwordx4 v[32:35], v9, s[4:7], s27 offen offset:0 sc1
s_sub_u32 s38, s38, 1
s_cmp_gt_i32 s38, 0
s_cbranch_scc0 END_146
v_mov_b32 v92, 0
v_mov_b32 v93, 0
v_mov_b32 v94, 0
v_mov_b32 v95, 0
v_mov_b32 v96, 0
v_mov_b32 v97, 0
v_mov_b32 v98, 0
v_mov_b32 v99, 0
v_mov_b32 v100, 0
v_mov_b32 v101, 0
v_mov_b32 v102, 0
v_mov_b32 v103, 0
s_waitcnt vmcnt(0)
v_cmp_eq_u32 vcc, -1, v16
s_cbranch_vccnz RT_149
v_smfmac_f32_16x16x64_bf16 v[92:95], v[16:19], a[0:7], v8
v_smfmac_f32_16x16x64_bf16 v[96:99], v[16:19], a[56:63], v8
v_smfmac_f32_16x16x64_bf16 v[100:103], v[16:19], a[112:119], v8
s_branch BK_150
FAIL_147:
s_mov_b64 s[50:51], 0
FAIL_147b:
buffer_load_dwordx4 v[16:19], v9, s[4:7], s26 offen offset:0 sc1
buffer_load_dwordx4 v[20:23], v9, s[4:7], s26 offen offset:1024 sc1
buffer_load_dwordx4 v[24:27], v9, s[4:7], s26 offen offset:2048 sc1
buffer_load_dwordx4 v[28:31], v9, s[4:7], s26 offen offset:3072 sc1
buffer_load_dwordx4 v[32:35], v9, s[4:7], s27 offen offset:0 sc1
buffer_load_dwordx4 v[36:39], v9, s[4:7], s27 offen offset:1024 sc1
buffer_load_dwordx4 v[40:43], v9, s[4:7], s27 offen offset:2048 sc1
s_sub_u32 s38, s38, 1
s_cmp_gt_i32 s38, 0
s_cbranch_scc0 END_146
v_mov_b32 v92, 0
v_mov_b32 v93, 0
v_mov_b32 v94, 0
v_mov_b32 v95, 0
v_mov_b32 v96, 0
v_mov_b32 v97, 0
v_mov_b32 v98, 0
v_mov_b32 v99, 0
v_mov_b32 v100, 0
v_mov_b32 v101, 0
v_mov_b32 v102, 0
v_mov_b32 v103, 0
v_mov_b32 v104, 0
v_mov_b32 v105, 0
v_mov_b32 v106, 0
v_mov_b32 v107, 0
v_mov_b32 v108, 0
v_mov_b32 v109, 0
v_mov_b32 v110, 0
v_mov_b32 v111, 0
v_mov_b32 v112, 0
v_mov_b32 v113, 0
v_mov_b32 v114, 0
v_mov_b32 v115, 0
v_mov_b32 v116, 0
v_mov_b32 v117, 0
v_mov_b32 v118, 0
v_mov_b32 v119, 0
v_mov_b32 v120, 0
v_mov_b32 v121, 0
v_mov_b32 v122, 0
v_mov_b32 v123, 0
ds_read_b128 v[44:47], v14 offset:0
ds_read_b128 v[48:51], v14 offset:1024
ds_read_b128 v[60:63], v14 offset:14336
ds_read_b128 v[64:67], v14 offset:15360
ds_read_b128 v[76:79], v14 offset:28672
ds_read_b128 v[80:83], v14 offset:29696
ds_read_b128 v[52:55], v14 offset:2048
ds_read_b128 v[56:59], v14 offset:3072
ds_read_b128 v[68:71], v14 offset:16384
ds_read_b128 v[72:75], v14 offset:17408
ds_read_b128 v[84:87], v14 offset:30720
ds_read_b128 v[88:91], v14 offset:31744
s_waitcnt vmcnt(0)
v_max3_u32 v3, v16, v17, v18
v_max3_u32 v3, v3, v19, v20
v_max3_u32 v3, v3, v21, v22
v_max3_u32 v3, v3, v23, v24
v_max3_u32 v3, v3, v25, v26
v_max3_u32 v3, v3, v27, v28
v_max3_u32 v3, v3, v29, v30
v_max3_u32 v3, v3, v31, v32
v_max3_u32 v3, v3, v33, v34
v_max3_u32 v3, v3, v35, v36
v_max3_u32 v3, v3, v37, v38
v_max3_u32 v3, v3, v39, v40
v_max3_u32 v3, v3, v41, v42
v_max_u32 v3, v3, v43
v_cmp_eq_u32 vcc, -1, v3
s_cbranch_vccnz FAIL_147b
s_waitcnt lgkmcnt(6)
v_smfmac_f32_16x16x64_bf16 v[92:95], v[16:19], a[0:7], v8
v_smfmac_f32_16x16x64_bf16 v[96:99], v[16:19], a[56:63], v8
v_smfmac_f32_16x16x64_bf16 v[100:103], v[16:19], a[112:119], v8
v_smfmac_f32_16x16x64_bf16 v[104:107], v[16:19], v[44:51], v8
v_smfmac_f32_16x16x64_bf16 v[108:111], v[16:19], v[60:67], v8
v_smfmac_f32_16x16x64_bf16 v[112:115], v[16:19], v[76:83], v8
ds_read_b128 v[44:47], v14 offset:4096
ds_read_b128 v[48:51], v14 offset:5120
ds_read_b128 v[60:63], v14 offset:18432
ds_read_b128 v[64:67], v14 offset:19456
ds_read_b128 v[76:79], v14 offset:32768
ds_read_b128 v[80:83], v14 offset:33792
s_waitcnt lgkmcnt(6)
v_smfmac_f32_16x16x64_bf16 v[92:95], v[20:23], a[8:15], v8
v_smfmac_f32_16x16x64_bf16 v[96:99], v[20:23], a[64:71], v8
v_smfmac_f32_16x16x64_bf16 v[100:103], v[20:23], a[120:127], v8
v_smfmac_f32_16x16x64_bf16 v[104:107], v[20:23], v[52:59], v8
v_smfmac_f32_16x16x64_bf16 v[108:111], v[20:23], v[68:75], v8
v_smfmac_f32_16x16x64_bf16 v[112:115], v[20:23], v[84:91], v8
ds_read_b128 v[52:55], v14 offset:6144
ds_read_b128 v[56:59], v14 offset:7168
ds_read_b128 v[68:71], v14 offset:20480
ds_read_b128 v[72:75], v14 offset:21504
ds_read_b128 v[84:87], v14 offset:34816
ds_read_b128 v[88:91], v14 offset:35840
s_waitcnt lgkmcnt(6)
v_smfmac_f32_16x16x64_bf16 v[92:95], v[24:27], a[16:23], v8
v_smfmac_f32_16x16x64_bf16 v[96:99], v[24:27], a[72:79], v8
v_smfmac_f32_16x16x64_bf16 v[100:103], v[24:27], a[128:135], v8
v_smfmac_f32_16x16x64_bf16 v[104:107], v[24:27], v[44:51], v8
v_smfmac_f32_16x16x64_bf16 v[108:111], v[24:27], v[60:67], v8
v_smfmac_f32_16x16x64_bf16 v[112:115], v[24:27], v[76:83], v8
ds_read_b128 v[44:47], v14 offset:8192
ds_read_b128 v[48:51], v14 offset:9216
ds_read_b128 v[60:63], v14 offset:22528
ds_read_b128 v[64:67], v14 offset:23552
ds_read_b128 v[76:79], v14 offset:36864
ds_read_b128 v[80:83], v14 offset:37888
s_waitcnt lgkmcnt(6)
v_smfmac_f32_16x16x64_bf16 v[92:95], v[28:31], a[24:31], v8
v_smfmac_f32_16x16x64_bf16 v[96:99], v[28:31], a[80:87], v8
v_smfmac_f32_16x16x64_bf16 v[100:103], v[28:31], a[136:143], v8
v_smfmac_f32_16x16x64_bf16 v[104:107], v[28:31], v[52:59], v8
v_smfmac_f32_16x16x64_bf16 v[108:111], v[28:31], v[68:75], v8
v_smfmac_f32_16x16x64_bf16 v[112:115], v[28:31], v[84:91], v8
ds_read_b128 v[52:55], v14 offset:10240
ds_read_b128 v[56:59], v14 offset:11264
ds_read_b128 v[68:71], v14 offset:24576
ds_read_b128 v[72:75], v14 offset:25600
ds_read_b128 v[84:87], v14 offset:38912
ds_read_b128 v[88:91], v14 offset:39936
s_waitcnt lgkmcnt(6)
v_smfmac_f32_16x16x64_bf16 v[92:95], v[32:35], a[32:39], v8
v_smfmac_f32_16x16x64_bf16 v[96:99], v[32:35], a[88:95], v8
v_smfmac_f32_16x16x64_bf16 v[100:103], v[32:35], a[144:151], v8
v_smfmac_f32_16x16x64_bf16 v[104:107], v[32:35], v[44:51], v8
v_smfmac_f32_16x16x64_bf16 v[108:111], v[32:35], v[60:67], v8
v_smfmac_f32_16x16x64_bf16 v[112:115], v[32:35], v[76:83], v8
ds_read_b128 v[44:47], v14 offset:12288
ds_read_b128 v[48:51], v14 offset:13312
ds_read_b128 v[60:63], v14 offset:26624
ds_read_b128 v[64:67], v14 offset:27648
ds_read_b128 v[76:79], v14 offset:40960
ds_read_b128 v[80:83], v14 offset:41984
s_waitcnt lgkmcnt(6)
v_smfmac_f32_16x16x64_bf16 v[92:95], v[36:39], a[40:47], v8
v_smfmac_f32_16x16x64_bf16 v[96:99], v[36:39], a[96:103], v8
v_smfmac_f32_16x16x64_bf16 v[100:103], v[36:39], a[152:159], v8
v_smfmac_f32_16x16x64_bf16 v[104:107], v[36:39], v[52:59], v8
v_smfmac_f32_16x16x64_bf16 v[108:111], v[36:39], v[68:75], v8
v_smfmac_f32_16x16x64_bf16 v[112:115], v[36:39], v[84:91], v8
s_waitcnt lgkmcnt(0)
v_smfmac_f32_16x16x64_bf16 v[92:95], v[40:43], a[48:55], v8
v_smfmac_f32_16x16x64_bf16 v[96:99], v[40:43], a[104:111], v8
v_smfmac_f32_16x16x64_bf16 v[100:103], v[40:43], a[160:167], v8
v_smfmac_f32_16x16x64_bf16 v[104:107], v[40:43], v[44:51], v8
v_smfmac_f32_16x16x64_bf16 v[108:111], v[40:43], v[60:67], v8
v_smfmac_f32_16x16x64_bf16 v[112:115], v[40:43], v[76:83], v8
s_nop 7
s_branch JOIN_148
Y0_151:
v_mov_b32 v3, 0
s_mov_b32 s34, 71319552
YL_152:
buffer_load_dword v4, v3, s[4:7], s34 offen sc1
s_sub_u32 s38, s38, 1
s_cmp_gt_i32 s38, 0
s_cbranch_scc0 YD_153
s_waitcnt vmcnt(0)
v_cmp_gt_u32 vcc, 16, v4
s_cbranch_vccz YD_153
s_sleep 6
s_branch YL_152
YD_153:
buffer_load_dwordx4 v[136:139], v9, s[4:7], s64 offen offset:0 sc1
buffer_load_dwordx4 v[140:143], v9, s[4:7], s64 offen offset:1024 sc1
buffer_load_dwordx4 v[144:147], v9, s[4:7], s64 offen offset:2048 sc1
buffer_load_dwordx4 v[148:151], v9, s[4:7], s64 offen offset:3072 sc1
buffer_load_dwordx4 v[152:155], v9, s[4:7], s65 offen offset:0 sc1
buffer_load_dwordx4 v[156:159], v9, s[4:7], s65 offen offset:1024 sc1
buffer_load_dwordx4 v[160:163], v9, s[4:7], s65 offen offset:2048 sc1
buffer_load_dwordx4 v[164:167], v9, s[4:7], s65 offen offset:3072 sc1
buffer_load_dwordx4 v[168:171], v9, s[4:7], s54 offen offset:0 sc1
buffer_load_dwordx4 v[172:175], v9, s[4:7], s54 offen offset:1024 sc1
buffer_load_dwordx4 v[176:179], v9, s[4:7], s54 offen offset:2048 sc1
buffer_load_dwordx4 v[180:183], v9, s[4:7], s54 offen offset:3072 sc1
buffer_load_dwordx4 v[184:187], v9, s[4:7], s55 offen offset:0 sc1
buffer_load_dwordx4 v[188:191], v9, s[4:7], s55 offen offset:1024 sc1
buffer_load_dwordx4 v[192:195], v9, s[4:7], s55 offen offset:2048 sc1
buffer_load_dwordx4 v[196:199], v9, s[4:7], s55 offen offset:3072 sc1
s_branch YB_154
PR_159:
buffer_load_dwordx4 v[16:19], v9, s[4:7], s28 offen offset:0 sc1
buffer_load_dwordx4 v[20:23], v9, s[4:7], s28 offen offset:1024 sc1
buffer_load_dwordx4 v[24:27], v9, s[4:7], s20 offen offset:2048 sc1
buffer_load_dwordx4 v[28:31], v9, s[4:7], s20 offen offset:3072 sc1
buffer_load_dwordx4 v[32:35], v9, s[4:7], s21 offen offset:2048 sc1
buffer_load_dwordx4 v[36:39], v9, s[4:7], s21 offen offset:3072 sc1
buffer_load_dwordx4 v[40:43], v9, s[4:7], s22 offen offset:2048 sc1
buffer_load_dwordx4 v[44:47], v9, s[4:7], s22 offen offset:3072 sc1
buffer_load_dwordx4 v[48:51], v9, s[4:7], s23 offen offset:2048 sc1
buffer_load_dwordx4 v[52:55], v9, s[4:7], s23 offen offset:3072 sc1
v_mov_b32 v76, 0
v_mov_b32 v77, 0
v_mov_b32 v78, 0
v_mov_b32 v79, 0
s_sub_u32 s38, s38, 1
s_cmp_gt_i32 s38, 0
s_cbranch_scc1 PB_160
s_branch PD_157
SL_161:
buffer_store_short v3, v200, s[4:7], s32 offen sc1
buffer_store_short_d16_hi v3, v200, s[4:7], s32 offen offset:16 sc1
buffer_store_dword v10, v12, s[4:7], s43 offen sc1
buffer_store_dword v13, v201, s[4:7], s33 offen sc1
s_branch SB_162
PF_158:
buffer_load_dwordx4 v[16:19], v9, s[4:7], s28 offen offset:0 sc1
buffer_load_dwordx4 v[20:23], v9, s[4:7], s28 offen offset:1024 sc1
buffer_load_dwordx4 v[24:27], v9, s[4:7], s20 offen offset:2048 sc1
buffer_load_dwordx4 v[28:31], v9, s[4:7], s20 offen offset:3072 sc1
buffer_load_dwordx4 v[32:35], v9, s[4:7], s21 offen offset:2048 sc1
buffer_load_dwordx4 v[36:39], v9, s[4:7], s21 offen offset:3072 sc1
buffer_load_dwordx4 v[40:43], v9, s[4:7], s22 offen offset:2048 sc1
buffer_load_dwordx4 v[44:47], v9, s[4:7], s22 offen offset:3072 sc1
buffer_load_dwordx4 v[48:51], v9, s[4:7], s23 offen offset:2048 sc1
buffer_load_dwordx4 v[52:55], v9, s[4:7], s23 offen offset:3072 sc1
s_sub_u32 s38, s38, 1
s_cmp_gt_i32 s38, 0
s_cbranch_scc0 PD_157
v_mov_b32 v76, 0
v_mov_b32 v77, 0
v_mov_b32 v78, 0
v_mov_b32 v79, 0
s_waitcnt vmcnt(0)
v_max3_u32 v3, v16, v17, v18
v_max3_u32 v3, v3, v19, v20
v_max3_u32 v3, v3, v21, v22
v_max3_u32 v3, v3, v23, v24
v_max3_u32 v3, v3, v25, v26
v_max3_u32 v3, v3, v27, v28
v_max3_u32 v3, v3, v29, v30
v_max3_u32 v3, v3, v31, v32
v_max3_u32 v3, v3, v33, v34
v_max3_u32 v3, v3, v35, v36
v_max3_u32 v3, v3, v37, v38
v_max3_u32 v3, v3, v39, v40
v_max3_u32 v3, v3, v41, v42
v_max3_u32 v3, v3, v43, v44
v_max3_u32 v3, v3, v45, v46
v_max3_u32 v3, v3, v47, v48
v_max3_u32 v3, v3, v49, v50
v_max3_u32 v3, v3, v51, v52
v_max3_u32 v3, v3, v53, v54
v_max_u32 v3, v3, v55
v_cmp_eq_u32 vcc, -1, v3
s_cbranch_vccnz PF_158
v_smfmac_f32_16x16x64_bf16 v[76:79], v[16:19], v[60:67], v8
v_smfmac_f32_16x16x64_bf16 v[76:79], v[20:23], v[68:75], v8
v_smfmac_f32_16x16x64_bf16 v[76:79], v[24:27], v[136:143], v8
v_smfmac_f32_16x16x64_bf16 v[76:79], v[28:31], v[144:151], v8
v_smfmac_f32_16x16x64_bf16 v[76:79], v[32:35], v[152:159], v8
v_smfmac_f32_16x16x64_bf16 v[76:79], v[36:39], v[160:167], v8
v_smfmac_f32_16x16x64_bf16 v[76:79], v[40:43], v[168:175], v8
v_smfmac_f32_16x16x64_bf16 v[76:79], v[44:47], v[176:183], v8
v_smfmac_f32_16x16x64_bf16 v[76:79], v[48:51], v[184:191], v8
v_smfmac_f32_16x16x64_bf16 v[76:79], v[52:55], v[192:199], v8
s_nop 7
v_add_f32 v76, v76, v78
v_add_f32 v77, v77, v79
v_cvt_pk_bf16_f32 v3, v76, v77
buffer_store_short v3, v200, s[4:7], s32 offen
buffer_store_short_d16_hi v3, v200, s[4:7], s32 offen offset:16
s_branch PD_157
VO1:
v_and_b32 v0, 63, v0
v_lshrrev_b32 v1, 4, v0
v_and_b32 v2, 15, v0
v_lshlrev_b32 v9, 4, v0
v_add_u32 v14, 43008, v9
v_bfe_u32 v3, v2, 1, 1
v_lshrrev_b32 v4, 2, v2
v_lshlrev_b32 v4, 1, v4
v_and_b32 v5, 1, v2
v_add_u32 v4, v4, v5
v_mul_u32_u24 v8, 0xaaaa, v3
v_add_u32 v8, 0x4444, v8
v_mov_b32 v13, -1
s_mov_b32 s43, 71303168
v_add_u32 v132, 143360, v9
s_add_u32 s24, s11, 14
v_lshrrev_b32 v5, 3, v2
v_lshlrev_b32 v5, 5, v5
v_lshl_add_u32 v5, v1, 6, v5
v_and_b32 v6, 7, v2
v_lshl_add_u32 v5, v6, 1, v5
s_lshl_b32 s35, s24, 8
v_add_u32 v200, s35, v5
v_lshlrev_b32 v5, 2, v0
v_add_u32 v201, s35, v5
s_lshl_b32 s40, s24, 14
s_add_u32 s40, s40, 16777216
s_add_u32 s56, s24, 0
s_and_b32 s56, s56, 3
s_lshl_b32 s56, s56, 11
s_add_u32 s57, s24, 1
s_and_b32 s57, s57, 3
s_lshl_b32 s57, s57, 11
s_add_u32 s58, s24, 2
s_and_b32 s58, s58, 3
s_lshl_b32 s58, s58, 11
s_add_u32 s59, s24, 3
s_and_b32 s59, s59, 3
s_lshl_b32 s59, s59, 11
v_bfe_u32 v5, v0, 2, 1
v_lshl_add_u32 v5, v1, 1, v5
v_mul_u32_u24 v5, 896, v5
v_bfe_u32 v6, v0, 3, 1
v_lshl_add_u32 v5, v6, 6, v5
v_and_b32 v6, 3, v0
v_lshl_add_u32 v5, v6, 2, v5
s_lshr_b32 s35, s24, 2
s_lshl_b32 s35, s35, 7
s_and_b32 s36, s24, 3
s_lshl_b32 s36, s36, 4
s_add_u32 s35, s35, s36
buffer_load_dword v6, v5, s[16:19], s35 offen
s_waitcnt vmcnt(0)
s_mov_b32 s35, 54525952
buffer_store_dword v6, v201, s[4:7], s35 offen sc1
s_mov_b32 s35, 54534144
buffer_store_dword v13, v201, s[4:7], s35 offen sc1
s_mov_b32 s35, 54542336
buffer_store_dword v13, v201, s[4:7], s35 offen sc1
v_mul_u32_u24 v12, 640, v0
s_lshl_b32 s35, s11, 2
s_add_u32 s35, s35, 4224
v_add_u32 v12, s35, v12
v_mov_b32 v7, 1073741824
v_cmp_gt_u32 vcc, 4, v0
s_nop 1
v_cndmask_b32 v12, v7, v12, vcc
s_mov_b32 s10, 0
s_mov_b32 s38, 200000
s_mov_b32 s68, 0
s_mov_b32 s69, 0
s_mov_b32 s70, 0
s_mov_b32 s71, 0
s_waitcnt vmcnt(0) lgkmcnt(0)
s_barrier
s_mov_b32 s34, 71343104
v_min_u32 v3, 27, v0
v_lshlrev_b32 v3, 14, v3
s_mul_i32 s34, s11, 458752
s_add_u32 s34, s34, 7340032
buffer_load_dword v4, v3, s[4:7], s34 offen sc1
s_waitcnt vmcnt(0)
v_min_u32 v3, 13, v2
v_lshlrev_b32 v3, 2, v3
v_lshl_add_u32 v3, v1, 8, v3
v_add_u32 v3, 18560, v3
s_mov_b32 s41, 71319552
s_mov_b64 vcc, -1
s_mul_i32 s34, s11, 458752
s_and_b32 s36, vcc_lo, 4294967295
s_cbranch_scc0 RD_168
RL_167:
buffer_load_dword v4, v3, s[4:7], s41 offen sc1
s_sub_u32 s38, s38, 1
s_cmp_gt_i32 s38, 0
s_cbranch_scc0 RD_168
s_waitcnt vmcnt(0)
v_cmp_ne_u32 vcc, 1, v4
s_nop 0
s_and_b32 s36, vcc_lo, 4294967295
s_cbranch_scc0 RD_168
s_sleep 2
s_branch RL_167
RD_168:
s_and_b32 s36, vcc_hi, 4294967295
s_cbranch_scc0 RD_170
RL_169:
buffer_load_dword v4, v3, s[4:7], s41 offen sc1
s_sub_u32 s38, s38, 1
s_cmp_gt_i32 s38, 0
s_cbranch_scc0 RD_170
s_waitcnt vmcnt(0)
v_cmp_ne_u32 vcc, 1, v4
s_nop 0
s_and_b32 s36, vcc_hi, 4294967295
s_cbranch_scc0 RD_170
s_sleep 2
s_branch RL_169
RD_170:
s_add_u32 s35, s34, 7456768
buffer_load_dwordx4 a[0:3], v9, s[4:7], s35 offen sc1
buffer_load_dwordx4 a[4:7], v9, s[4:7], s35 offen offset:1024 sc1
s_add_u32 s35, s34, 7458816
buffer_load_dwordx4 a[8:11], v9, s[4:7], s35 offen sc1
buffer_load_dwordx4 a[12:15], v9, s[4:7], s35 offen offset:1024 sc1
s_add_u32 s35, s34, 7454720
buffer_load_dwordx4 a[16:19], v9, s[4:7], s35 offen sc1
buffer_load_dwordx4 a[20:23], v9, s[4:7], s35 offen offset:1024 sc1
s_add_u32 s35, s34, 7460864
buffer_load_dwordx4 a[24:27], v9, s[4:7], s35 offen sc1
buffer_load_dwordx4 a[28:31], v9, s[4:7], s35 offen offset:1024 sc1
s_add_u32 s35, s34, 7464960
buffer_load_dwordx4 a[32:35], v9, s[4:7], s35 offen sc1
buffer_load_dwordx4 a[36:39], v9, s[4:7], s35 offen offset:1024 sc1
s_add_u32 s35, s34, 7467008
buffer_load_dwordx4 a[40:43], v9, s[4:7], s35 offen sc1
buffer_load_dwordx4 a[44:47], v9, s[4:7], s35 offen offset:1024 sc1
s_add_u32 s35, s34, 7462912
buffer_load_dwordx4 a[48:51], v9, s[4:7], s35 offen sc1
buffer_load_dwordx4 a[52:55], v9, s[4:7], s35 offen offset:1024 sc1
s_add_u32 s35, s34, 7471104
s_mov_b32 m0, 57344
s_nop 0
buffer_load_dwordx4 v9, s[4:7], s35 offen sc1 lds
buffer_load_dwordx4 v9, s[4:7], s35 offen offset:1024 sc1 lds
s_add_u32 s35, s34, 7473152
s_mov_b32 m0, 59392
s_nop 0
buffer_load_dwordx4 v9, s[4:7], s35 offen sc1 lds
buffer_load_dwordx4 v9, s[4:7], s35 offen offset:1024 sc1 lds
s_add_u32 s35, s34, 7469056
s_mov_b32 m0, 61440
s_nop 0
buffer_load_dwordx4 v9, s[4:7], s35 offen sc1 lds
buffer_load_dwordx4 v9, s[4:7], s35 offen offset:1024 sc1 lds
s_add_u32 s35, s34, 7475200
s_mov_b32 m0, 63488
s_nop 0
buffer_load_dwordx4 v9, s[4:7], s35 offen sc1 lds
buffer_load_dwordx4 v9, s[4:7], s35 offen offset:1024 sc1 lds
s_add_u32 s35, s34, 7479296
s_mov_b32 m0, 65536
s_nop 0
buffer_load_dwordx4 v9, s[4:7], s35 offen sc1 lds
buffer_load_dwordx4 v9, s[4:7], s35 offen offset:1024 sc1 lds
s_add_u32 s35, s34, 7481344
s_mov_b32 m0, 67584
s_nop 0
buffer_load_dwordx4 v9, s[4:7], s35 offen sc1 lds
buffer_load_dwordx4 v9, s[4:7], s35 offen offset:1024 sc1 lds
s_add_u32 s35, s34, 7477248
s_mov_b32 m0, 69632
s_nop 0
buffer_load_dwordx4 v9, s[4:7], s35 offen sc1 lds
buffer_load_dwordx4 v9, s[4:7], s35 offen offset:1024 sc1 lds
s_add_u32 s35, s34, 7485440
buffer_load_dwordx4 a[56:59], v9, s[4:7], s35 offen sc1
buffer_load_dwordx4 a[60:63], v9, s[4:7], s35 offen offset:1024 sc1
s_add_u32 s35, s34, 7487488
buffer_load_dwordx4 a[64:67], v9, s[4:7], s35 offen sc1
buffer_load_dwordx4 a[68:71], v9, s[4:7], s35 offen offset:1024 sc1
s_add_u32 s35, s34, 7483392
buffer_load_dwordx4 a[72:75], v9, s[4:7], s35 offen sc1
buffer_load_dwordx4 a[76:79], v9, s[4:7], s35 offen offset:1024 sc1
s_add_u32 s35, s34, 7489536
buffer_load_dwordx4 a[80:83], v9, s[4:7], s35 offen sc1
buffer_load_dwordx4 a[84:87], v9, s[4:7], s35 offen offset:1024 sc1
s_add_u32 s35, s34, 7493632
buffer_load_dwordx4 a[88:91], v9, s[4:7], s35 offen sc1
buffer_load_dwordx4 a[92:95], v9, s[4:7], s35 offen offset:1024 sc1
s_add_u32 s35, s34, 7495680
buffer_load_dwordx4 a[96:99], v9, s[4:7], s35 offen sc1
buffer_load_dwordx4 a[100:103], v9, s[4:7], s35 offen offset:1024 sc1
s_add_u32 s35, s34, 7491584
buffer_load_dwordx4 a[104:107], v9, s[4:7], s35 offen sc1
buffer_load_dwordx4 a[108:111], v9, s[4:7], s35 offen offset:1024 sc1
s_add_u32 s35, s34, 7499776
s_mov_b32 m0, 71680
s_nop 0
buffer_load_dwordx4 v9, s[4:7], s35 offen sc1 lds
buffer_load_dwordx4 v9, s[4:7], s35 offen offset:1024 sc1 lds
s_add_u32 s35, s34, 7501824
s_mov_b32 m0, 73728
s_nop 0
buffer_load_dwordx4 v9, s[4:7], s35 offen sc1 lds
buffer_load_dwordx4 v9, s[4:7], s35 offen offset:1024 sc1 lds
s_add_u32 s35, s34, 7497728
s_mov_b32 m0, 75776
s_nop 0
buffer_load_dwordx4 v9, s[4:7], s35 offen sc1 lds
buffer_load_dwordx4 v9, s[4:7], s35 offen offset:1024 sc1 lds
s_add_u32 s35, s34, 7503872
s_mov_b32 m0, 77824
s_nop 0
buffer_load_dwordx4 v9, s[4:7], s35 offen sc1 lds
buffer_load_dwordx4 v9, s[4:7], s35 offen offset:1024 sc1 lds
s_add_u32 s35, s34, 7507968
s_mov_b32 m0, 79872
s_nop 0
buffer_load_dwordx4 v9, s[4:7], s35 offen sc1 lds
buffer_load_dwordx4 v9, s[4:7], s35 offen offset:1024 sc1 lds
s_add_u32 s35, s34, 7510016
s_mov_b32 m0, 81920
s_nop 0
buffer_load_dwordx4 v9, s[4:7], s35 offen sc1 lds
buffer_load_dwordx4 v9, s[4:7], s35 offen offset:1024 sc1 lds
s_add_u32 s35, s34, 7505920
s_mov_b32 m0, 83968
s_nop 0
buffer_load_dwordx4 v9, s[4:7], s35 offen sc1 lds
buffer_load_dwordx4 v9, s[4:7], s35 offen offset:1024 sc1 lds
s_add_u32 s35, s34, 7514112
buffer_load_dwordx4 a[112:115], v9, s[4:7], s35 offen sc1
buffer_load_dwordx4 a[116:119], v9, s[4:7], s35 offen offset:1024 sc1
s_add_u32 s35, s34, 7516160
buffer_load_dwordx4 a[120:123], v9, s[4:7], s35 offen sc1
buffer_load_dwordx4 a[124:127], v9, s[4:7], s35 offen offset:1024 sc1
s_waitcnt vmcnt(40)
s_add_u32 s35, s34, 7512064
buffer_load_dwordx4 a[128:131], v9, s[4:7], s35 offen sc1
buffer_load_dwordx4 a[132:135], v9, s[4:7], s35 offen offset:1024 sc1
s_add_u32 s35, s34, 7518208
buffer_load_dwordx4 a[136:139], v9, s[4:7], s35 offen sc1
buffer_load_dwordx4 a[140:143], v9, s[4:7], s35 offen offset:1024 sc1
s_add_u32 s35, s34, 7522304
buffer_load_dwordx4 a[144:147], v9, s[4:7], s35 offen sc1
buffer_load_dwordx4 a[148:151], v9, s[4:7], s35 offen offset:1024 sc1
s_add_u32 s35, s34, 7524352
buffer_load_dwordx4 a[152:155], v9, s[4:7], s35 offen sc1
buffer_load_dwordx4 a[156:159], v9, s[4:7], s35 offen offset:1024 sc1
s_add_u32 s35, s34, 7520256
buffer_load_dwordx4 a[160:163], v9, s[4:7], s35 offen sc1
buffer_load_dwordx4 a[164:167], v9, s[4:7], s35 offen offset:1024 sc1
s_add_u32 s35, s34, 7528448
buffer_load_dwordx4 a[168:171], v9, s[4:7], s35 offen sc1
buffer_load_dwordx4 a[172:175], v9, s[4:7], s35 offen offset:1024 sc1
s_add_u32 s35, s34, 7530496
buffer_load_dwordx4 a[176:179], v9, s[4:7], s35 offen sc1
buffer_load_dwordx4 a[180:183], v9, s[4:7], s35 offen offset:1024 sc1
s_add_u32 s35, s34, 7526400
buffer_load_dwordx4 a[184:187], v9, s[4:7], s35 offen sc1
buffer_load_dwordx4 a[188:191], v9, s[4:7], s35 offen offset:1024 sc1
s_add_u32 s35, s34, 7532544
buffer_load_dwordx4 a[192:195], v9, s[4:7], s35 offen sc1
buffer_load_dwordx4 a[196:199], v9, s[4:7], s35 offen offset:1024 sc1
s_add_u32 s35, s34, 7536640
buffer_load_dwordx4 a[200:203], v9, s[4:7], s35 offen sc1
buffer_load_dwordx4 a[204:207], v9, s[4:7], s35 offen offset:1024 sc1
s_waitcnt vmcnt(40)
s_add_u32 s35, s34, 7538688
buffer_load_dwordx4 a[208:211], v9, s[4:7], s35 offen sc1
buffer_load_dwordx4 a[212:215], v9, s[4:7], s35 offen offset:1024 sc1
s_add_u32 s35, s34, 7534592
buffer_load_dwordx4 a[216:219], v9, s[4:7], s35 offen sc1
buffer_load_dwordx4 a[220:223], v9, s[4:7], s35 offen offset:1024 sc1
s_add_u32 s35, s34, 7542784
s_mov_b32 m0, 43008
s_nop 0
buffer_load_dwordx4 v9, s[4:7], s35 offen sc1 lds
buffer_load_dwordx4 v9, s[4:7], s35 offen offset:1024 sc1 lds
s_add_u32 s35, s34, 7544832
s_mov_b32 m0, 45056
s_nop 0
buffer_load_dwordx4 v9, s[4:7], s35 offen sc1 lds
buffer_load_dwordx4 v9, s[4:7], s35 offen offset:1024 sc1 lds
s_add_u32 s35, s34, 7540736
s_mov_b32 m0, 47104
s_nop 0
buffer_load_dwordx4 v9, s[4:7], s35 offen sc1 lds
buffer_load_dwordx4 v9, s[4:7], s35 offen offset:1024 sc1 lds
s_add_u32 s35, s34, 7546880
s_mov_b32 m0, 49152
s_nop 0
buffer_load_dwordx4 v9, s[4:7], s35 offen sc1 lds
buffer_load_dwordx4 v9, s[4:7], s35 offen offset:1024 sc1 lds
s_add_u32 s35, s34, 7550976
s_mov_b32 m0, 51200
s_nop 0
buffer_load_dwordx4 v9, s[4:7], s35 offen sc1 lds
buffer_load_dwordx4 v9, s[4:7], s35 offen offset:1024 sc1 lds
s_add_u32 s35, s34, 7553024
s_mov_b32 m0, 53248
s_nop 0
buffer_load_dwordx4 v9, s[4:7], s35 offen sc1 lds
buffer_load_dwordx4 v9, s[4:7], s35 offen offset:1024 sc1 lds
s_add_u32 s35, s34, 7548928
s_mov_b32 m0, 55296
s_nop 0
buffer_load_dwordx4 v9, s[4:7], s35 offen sc1 lds
buffer_load_dwordx4 v9, s[4:7], s35 offen offset:1024 sc1 lds
s_add_u32 s35, s34, 7557120
buffer_load_dwordx4 a[224:227], v9, s[4:7], s35 offen sc1
buffer_load_dwordx4 a[228:231], v9, s[4:7], s35 offen offset:1024 sc1
s_waitcnt vmcnt(40)
s_add_u32 s35, s34, 7559168
buffer_load_dwordx4 a[232:235], v9, s[4:7], s35 offen sc1
buffer_load_dwordx4 a[236:239], v9, s[4:7], s35 offen offset:1024 sc1
s_add_u32 s35, s34, 7555072
buffer_load_dwordx4 a[240:243], v9, s[4:7], s35 offen sc1
buffer_load_dwordx4 a[244:247], v9, s[4:7], s35 offen offset:1024 sc1
s_add_u32 s35, s34, 7561216
buffer_load_dwordx4 a[248:251], v9, s[4:7], s35 offen sc1
buffer_load_dwordx4 a[252:255], v9, s[4:7], s35 offen offset:1024 sc1
s_add_u32 s35, s34, 7565312
buffer_load_dwordx4 v[204:207], v9, s[4:7], s35 offen sc1
buffer_load_dwordx4 v[208:211], v9, s[4:7], s35 offen offset:1024 sc1
s_add_u32 s35, s34, 7567360
buffer_load_dwordx4 v[212:215], v9, s[4:7], s35 offen sc1
buffer_load_dwordx4 v[216:219], v9, s[4:7], s35 offen offset:1024 sc1
s_add_u32 s35, s34, 7563264
buffer_load_dwordx4 v[220:223], v9, s[4:7], s35 offen sc1
buffer_load_dwordx4 v[224:227], v9, s[4:7], s35 offen offset:1024 sc1
s_mov_b32 s34, 71343104
s_barrier
v_mov_b32 v3, 151552
ds_read_b32 v4, v3
s_waitcnt lgkmcnt(0)
v_readfirstlane_b32 s66, v4
s_waitcnt vmcnt(0)
v_mov_b32 v92, 0
v_mov_b32 v93, 0
v_mov_b32 v94, 0
v_mov_b32 v95, 0
v_mov_b32 v96, 0
v_mov_b32 v97, 0
v_mov_b32 v98, 0
v_mov_b32 v99, 0
v_mov_b32 v100, 0
v_mov_b32 v101, 0
v_mov_b32 v102, 0
v_mov_b32 v103, 0
v_mov_b32 v104, 0
v_mov_b32 v105, 0
v_mov_b32 v106, 0
v_mov_b32 v107, 0
v_mov_b32 v108, 0
v_mov_b32 v109, 0
v_mov_b32 v110, 0
v_mov_b32 v111, 0
v_mov_b32 v112, 0
v_mov_b32 v113, 0
v_mov_b32 v114, 0
v_mov_b32 v115, 0
v_mov_b32 v116, 0
v_mov_b32 v117, 0
v_mov_b32 v118, 0
v_mov_b32 v119, 0
v_mov_b32 v120, 0
v_mov_b32 v121, 0
v_mov_b32 v122, 0
v_mov_b32 v123, 0
s_lshl_b32 s26, s10, 13
s_add_u32 s26, s26, 54525952
s_add_u32 s27, s26, 4096
LOOP_173:
s_barrier
buffer_load_dwordx4 v[16:19], v9, s[4:7], s26 offen offset:1024 sc1
ds_read_b128 v[44:47], v14 offset:0
ds_read_b128 v[48:51], v14 offset:1024
ds_read_b128 v[60:63], v14 offset:14336
ds_read_b128 v[64:67], v14 offset:15360
ds_read_b128 v[76:79], v14 offset:28672
ds_read_b128 v[80:83], v14 offset:29696
ds_read_b128 v[52:55], v14 offset:2048
ds_read_b128 v[56:59], v14 offset:3072
ds_read_b128 v[68:71], v14 offset:16384
ds_read_b128 v[72:75], v14 offset:17408
ds_read_b128 v[84:87], v14 offset:30720
s_barrier
buffer_load_dwordx4 v[20:23], v9, s[4:7], s26 offen offset:2048
ds_read_b128 v[88:91], v14 offset:31744
s_add_u32 s39, s10, 1
s_mov_b64 s[50:51], -1
v_mov_b32 v10, s39
s_and_b32 s34, s10, 3
s_lshl_b32 s28, s34, 14
s_add_u32 s28, s28, 55312384
s_add_u32 s32, s26, 8192
s_add_u32 s33, s26, 16384
s_min_u32 s37, s10, 63
s_mul_i32 s37, s37, 458752
s_barrier
buffer_load_dwordx4 v[24:27], v9, s[4:7], s26 offen offset:0
s_add_u32 s37, s37, s40
s_lshl1_add_u32 s64, s56, s37
s_lshl1_add_u32 s65, s57, s37
s_lshl1_add_u32 s54, s58, s37
s_lshl1_add_u32 s55, s59, s37
s_add_u32 s20, s28, s56
s_add_u32 s21, s28, s57
s_add_u32 s22, s28, s58
s_add_u32 s23, s28, s59
s_barrier
buffer_load_dwordx4 v[28:31], v9, s[4:7], s26 offen offset:3072
s_waitcnt vmcnt(3)
v_smfmac_f32_16x16x64_bf16 v[92:95], v[16:19], a[0:7], v8
buffer_load_dwordx4 v[32:35], v9, s[4:7], s27 offen offset:1024
v_cmp_eq_u32 vcc, -1, v16
v_smfmac_f32_16x16x64_bf16 v[96:99], v[16:19], a[56:63], v8
v_smfmac_f32_16x16x64_bf16 v[100:103], v[16:19], a[112:119], v8
s_cbranch_vccnz RT_177
BK_178:
s_waitcnt lgkmcnt(10)
v_smfmac_f32_16x16x64_bf16 v[104:107], v[16:19], v[44:51], v8
buffer_load_dwordx4 v[36:39], v9, s[4:7], s27 offen offset:2048
s_waitcnt lgkmcnt(8)
v_smfmac_f32_16x16x64_bf16 v[108:111], v[16:19], v[60:67], v8
s_waitcnt lgkmcnt(6)
v_smfmac_f32_16x16x64_bf16 v[112:115], v[16:19], v[76:83], v8
s_waitcnt vmcnt(4)
v_smfmac_f32_16x16x64_bf16 v[92:95], v[20:23], a[8:15], v8
buffer_load_dwordx4 v[40:43], v9, s[4:7], s27 offen offset:0
ds_read_b128 v[44:47], v14 offset:4096
v_smfmac_f32_16x16x64_bf16 v[96:99], v[20:23], a[64:71], v8
ds_read_b128 v[48:51], v14 offset:5120
v_smfmac_f32_16x16x64_bf16 v[100:103], v[20:23], a[120:127], v8
buffer_load_dwordx4 v[136:139], v9, s[4:7], s64 offen offset:0 sc1
ds_read_b128 v[60:63], v14 offset:18432
s_waitcnt lgkmcnt(7)
v_smfmac_f32_16x16x64_bf16 v[104:107], v[20:23], v[52:59], v8
ds_read_b128 v[64:67], v14 offset:19456
s_waitcnt lgkmcnt(6)
v_smfmac_f32_16x16x64_bf16 v[108:111], v[20:23], v[68:75], v8
buffer_load_dwordx4 v[140:143], v9, s[4:7], s64 offen offset:1024 sc1
ds_read_b128 v[76:79], v14 offset:32768
s_waitcnt lgkmcnt(5)
v_smfmac_f32_16x16x64_bf16 v[112:115], v[20:23], v[84:91], v8
ds_read_b128 v[80:83], v14 offset:33792
s_waitcnt vmcnt(6)
v_smfmac_f32_16x16x64_bf16 v[92:95], v[24:27], a[16:23], v8
buffer_load_dwordx4 v[144:147], v9, s[4:7], s64 offen offset:2048 sc1
ds_read_b128 v[52:55], v14 offset:6144
v_smfmac_f32_16x16x64_bf16 v[96:99], v[24:27], a[72:79], v8
ds_read_b128 v[56:59], v14 offset:7168
v_smfmac_f32_16x16x64_bf16 v[100:103], v[24:27], a[128:135], v8
buffer_load_dwordx4 v[148:151], v9, s[4:7], s64 offen offset:3072 sc1
ds_read_b128 v[68:71], v14 offset:20480
s_waitcnt lgkmcnt(7)
v_smfmac_f32_16x16x64_bf16 v[104:107], v[24:27], v[44:51], v8
ds_read_b128 v[72:75], v14 offset:21504
s_waitcnt lgkmcnt(6)
v_smfmac_f32_16x16x64_bf16 v[108:111], v[24:27], v[60:67], v8
buffer_load_dwordx4 v[152:155], v9, s[4:7], s65 offen offset:0 sc1
ds_read_b128 v[84:87], v14 offset:34816
s_waitcnt lgkmcnt(5)
v_smfmac_f32_16x16x64_bf16 v[112:115], v[24:27], v[76:83], v8
ds_read_b128 v[88:91], v14 offset:35840
s_waitcnt vmcnt(8)
v_smfmac_f32_16x16x64_bf16 v[92:95], v[28:31], a[24:31], v8
buffer_load_dwordx4 v[156:159], v9, s[4:7], s65 offen offset:1024 sc1
ds_read_b128 v[44:47], v14 offset:8192
v_smfmac_f32_16x16x64_bf16 v[96:99], v[28:31], a[80:87], v8
ds_read_b128 v[48:51], v14 offset:9216
v_smfmac_f32_16x16x64_bf16 v[100:103], v[28:31], a[136:143], v8
buffer_load_dwordx4 v[160:163], v9, s[4:7], s65 offen offset:2048 sc1
ds_read_b128 v[60:63], v14 offset:22528
s_waitcnt lgkmcnt(7)
v_smfmac_f32_16x16x64_bf16 v[104:107], v[28:31], v[52:59], v8
ds_read_b128 v[64:67], v14 offset:23552
s_waitcnt lgkmcnt(6)
v_smfmac_f32_16x16x64_bf16 v[108:111], v[28:31], v[68:75], v8
buffer_load_dwordx4 v[164:167], v9, s[4:7], s65 offen offset:3072 sc1
ds_read_b128 v[76:79], v14 offset:36864
s_waitcnt lgkmcnt(5)
v_smfmac_f32_16x16x64_bf16 v[112:115], v[28:31], v[84:91], v8
ds_read_b128 v[80:83], v14 offset:37888
s_waitcnt vmcnt(10)
v_smfmac_f32_16x16x64_bf16 v[92:95], v[32:35], a[32:39], v8
buffer_load_dwordx4 v[168:171], v9, s[4:7], s54 offen offset:0 sc1
ds_read_b128 v[52:55], v14 offset:10240
v_smfmac_f32_16x16x64_bf16 v[96:99], v[32:35], a[88:95], v8
ds_read_b128 v[56:59], v14 offset:11264
v_smfmac_f32_16x16x64_bf16 v[100:103], v[32:35], a[144:151], v8
buffer_load_dwordx4 v[172:175], v9, s[4:7], s54 offen offset:1024 sc1
ds_read_b128 v[68:71], v14 offset:24576
s_waitcnt lgkmcnt(7)
v_smfmac_f32_16x16x64_bf16 v[104:107], v[32:35], v[44:51], v8
ds_read_b128 v[72:75], v14 offset:25600
s_waitcnt lgkmcnt(6)
v_smfmac_f32_16x16x64_bf16 v[108:111], v[32:35], v[60:67], v8
buffer_load_dwordx4 v[176:179], v9, s[4:7], s54 offen offset:2048 sc1
ds_read_b128 v[84:87], v14 offset:38912
s_waitcnt lgkmcnt(5)
v_smfmac_f32_16x16x64_bf16 v[112:115], v[32:35], v[76:83], v8
ds_read_b128 v[88:91], v14 offset:39936
s_waitcnt vmcnt(12)
v_smfmac_f32_16x16x64_bf16 v[92:95], v[36:39], a[40:47], v8
buffer_load_dwordx4 v[180:183], v9, s[4:7], s54 offen offset:3072 sc1
ds_read_b128 v[44:47], v14 offset:12288
v_smfmac_f32_16x16x64_bf16 v[96:99], v[36:39], a[96:103], v8
ds_read_b128 v[48:51], v14 offset:13312
v_smfmac_f32_16x16x64_bf16 v[100:103], v[36:39], a[152:159], v8
buffer_load_dwordx4 v[184:187], v9, s[4:7], s55 offen offset:0 sc1
ds_read_b128 v[60:63], v14 offset:26624
s_waitcnt lgkmcnt(7)
v_smfmac_f32_16x16x64_bf16 v[104:107], v[36:39], v[52:59], v8
ds_read_b128 v[64:67], v14 offset:27648
s_waitcnt lgkmcnt(6)
v_smfmac_f32_16x16x64_bf16 v[108:111], v[36:39], v[68:75], v8
buffer_load_dwordx4 v[188:191], v9, s[4:7], s55 offen offset:1024 sc1
ds_read_b128 v[76:79], v14 offset:40960
s_waitcnt lgkmcnt(5)
v_smfmac_f32_16x16x64_bf16 v[112:115], v[36:39], v[84:91], v8
ds_read_b128 v[80:83], v14 offset:41984
s_waitcnt vmcnt(14)
v_smfmac_f32_16x16x64_bf16 v[92:95], v[40:43], a[48:55], v8
buffer_load_dwordx4 v[192:195], v9, s[4:7], s55 offen offset:2048 sc1
v_smfmac_f32_16x16x64_bf16 v[96:99], v[40:43], a[104:111], v8
v_smfmac_f32_16x16x64_bf16 v[100:103], v[40:43], a[160:167], v8
buffer_load_dwordx4 v[196:199], v9, s[4:7], s55 offen offset:3072 sc1
s_waitcnt lgkmcnt(4)
v_smfmac_f32_16x16x64_bf16 v[104:107], v[40:43], v[44:51], v8
s_waitcnt lgkmcnt(2)
v_smfmac_f32_16x16x64_bf16 v[108:111], v[40:43], v[60:67], v8
s_waitcnt lgkmcnt(0)
v_smfmac_f32_16x16x64_bf16 v[112:115], v[40:43], v[76:83], v8
JOIN_176:
v_smfmac_f32_16x16x64_bf16 v[116:119], v[16:19], a[168:175], v8
v_add_f32 v92, v92, v94
v_smfmac_f32_16x16x64_bf16 v[116:119], v[20:23], a[176:183], v8
v_add_f32 v93, v93, v95
v_cmp_u_f32 vcc, v92, v93
v_smfmac_f32_16x16x64_bf16 v[116:119], v[24:27], a[184:191], v8
v_cvt_pk_bf16_f32 v124, v92, v93
v_smfmac_f32_16x16x64_bf16 v[116:119], v[28:31], a[192:199], v8
v_add_f32 v96, v96, v98
v_add_f32 v97, v97, v99
v_smfmac_f32_16x16x64_bf16 v[116:119], v[32:35], a[200:207], v8
s_and_b64 vcc, vcc, s[50:51]
s_cbranch_scc1 FAIL_175
v_cvt_pk_bf16_f32 v125, v96, v97
v_smfmac_f32_16x16x64_bf16 v[116:119], v[36:39], a[208:215], v8
v_add_f32 v100, v100, v102
v_add_f32 v101, v101, v103
v_smfmac_f32_16x16x64_bf16 v[116:119], v[40:43], a[216:223], v8
v_cvt_pk_bf16_f32 v126, v100, v101
v_smfmac_f32_16x16x64_bf16 v[120:123], v[16:19], a[224:231], v8
v_add_f32 v104, v104, v106
v_add_f32 v105, v105, v107
v_smfmac_f32_16x16x64_bf16 v[120:123], v[20:23], a[232:239], v8
v_cvt_pk_bf16_f32 v127, v104, v105
v_smfmac_f32_16x16x64_bf16 v[120:123], v[24:27], a[240:247], v8
v_add_f32 v108, v108, v110
v_add_f32 v109, v109, v111
v_smfmac_f32_16x16x64_bf16 v[120:123], v[28:31], a[248:255], v8
v_cvt_pk_bf16_f32 v128, v108, v109
v_smfmac_f32_16x16x64_bf16 v[120:123], v[32:35], v[204:211], v8
v_add_f32 v112, v112, v114
v_add_f32 v113, v113, v115
v_smfmac_f32_16x16x64_bf16 v[120:123], v[36:39], v[212:219], v8
v_cvt_pk_bf16_f32 v129, v112, v113
v_smfmac_f32_16x16x64_bf16 v[120:123], v[40:43], v[220:227], v8
v_add_f32 v116, v116, v118
v_add_f32 v117, v117, v119
v_cvt_pk_bf16_f32 v130, v116, v117
s_nop 4
v_add_f32 v120, v120, v122
v_add_f32 v121, v121, v123
v_cvt_pk_bf16_f32 v131, v120, v121
ds_write_b128 v132, v[124:127] offset:1024
ds_write_b128 v132, v[128:131] offset:5120
s_cmp_eq_u32 s10, 0
s_cbranch_scc1 Y0_179
YB_182:
v_mov_b32 v92, 0
v_mov_b32 v93, 0
v_mov_b32 v94, 0
v_mov_b32 v95, 0
v_mov_b32 v96, 0
v_mov_b32 v97, 0
s_add_u32 s10, s10, 1
s_lshl_b32 s26, s10, 13
s_add_u32 s26, s26, 54525952
s_add_u32 s27, s26, 4096
s_waitcnt lgkmcnt(0)
v_mov_b32 v76, 0
v_mov_b32 v77, 0
v_mov_b32 v78, 0
v_mov_b32 v79, 0
buffer_store_dword v13, v201, s[4:7], s33 offen
v_mov_b32 v98, 0
v_mov_b32 v99, 0
v_mov_b32 v100, 0
v_mov_b32 v101, 0
v_mov_b32 v102, 0
v_mov_b32 v103, 0
v_mov_b32 v104, 0
v_mov_b32 v105, 0
v_mov_b32 v106, 0
v_mov_b32 v107, 0
v_mov_b32 v108, 0
v_mov_b32 v109, 0
v_mov_b32 v110, 0
v_mov_b32 v111, 0
v_mov_b32 v112, 0
v_mov_b32 v113, 0
v_mov_b32 v114, 0
v_mov_b32 v115, 0
v_mov_b32 v116, 0
v_mov_b32 v117, 0
v_mov_b32 v118, 0
v_mov_b32 v119, 0
v_mov_b32 v120, 0
v_mov_b32 v121, 0
v_mov_b32 v122, 0
v_mov_b32 v123, 0
s_barrier
buffer_load_dwordx4 v[16:19], v9, s[4:7], s28 offen offset:0 sc1
buffer_load_dwordx4 v[20:23], v9, s[4:7], s28 offen offset:1024 sc1
buffer_load_dwordx4 v[24:27], v9, s[4:7], s20 offen offset:2048 sc1
buffer_load_dwordx4 v[28:31], v9, s[4:7], s20 offen offset:3072 sc1
buffer_load_dwordx4 v[32:35], v9, s[4:7], s21 offen offset:2048 sc1
buffer_load_dwordx4 v[36:39], v9, s[4:7], s21 offen offset:3072 sc1
buffer_load_dwordx4 v[40:43], v9, s[4:7], s22 offen offset:2048 sc1
buffer_load_dwordx4 v[44:47], v9, s[4:7], s22 offen offset:3072 sc1
buffer_load_dwordx4 v[48:51], v9, s[4:7], s23 offen offset:2048 sc1
buffer_load_dwordx4 v[52:55], v9, s[4:7], s23 offen offset:3072 sc1
ds_read_b128 v[60:63], v132 offset:4096
ds_read_b128 v[64:67], v132 offset:5120
ds_read_b128 v[68:71], v132 offset:6144
ds_read_b128 v[72:75], v132 offset:7168
PB_186:
s_waitcnt vmcnt(9) lgkmcnt(0)
v_smfmac_f32_16x16x64_bf16 v[76:79], v[16:19], v[60:67], v8
s_waitcnt vmcnt(8)
v_max3_u32 v3, v16, v17, v20
v_max_u32 v3, v3, v21
v_smfmac_f32_16x16x64_bf16 v[76:79], v[20:23], v[68:75], v8
s_waitcnt vmcnt(7)
v_cmp_eq_u32 vcc, -1, v3
v_smfmac_f32_16x16x64_bf16 v[76:79], v[24:27], v[136:143], v8
s_waitcnt vmcnt(6)
v_smfmac_f32_16x16x64_bf16 v[76:79], v[28:31], v[144:151], v8
s_cbranch_vccnz PR_185
s_waitcnt vmcnt(5)
v_smfmac_f32_16x16x64_bf16 v[76:79], v[32:35], v[152:159], v8
s_waitcnt vmcnt(4)
v_smfmac_f32_16x16x64_bf16 v[76:79], v[36:39], v[160:167], v8
s_waitcnt vmcnt(3)
v_smfmac_f32_16x16x64_bf16 v[76:79], v[40:43], v[168:175], v8
s_waitcnt vmcnt(2)
v_smfmac_f32_16x16x64_bf16 v[76:79], v[44:47], v[176:183], v8
s_waitcnt vmcnt(1)
v_smfmac_f32_16x16x64_bf16 v[76:79], v[48:51], v[184:191], v8
s_waitcnt vmcnt(0)
v_smfmac_f32_16x16x64_bf16 v[76:79], v[52:55], v[192:199], v8
v_mov_b32 v7, 0
v_mov_b32 v7, 0
v_mov_b32 v7, 0
v_mov_b32 v7, 0
v_mov_b32 v7, 0
v_mov_b32 v7, 0
v_mov_b32 v7, 0
s_nop 0
v_add_f32 v76, v76, v78
v_add_f32 v77, v77, v79
v_cvt_pk_bf16_f32 v3, v76, v77
v_cmpx_o_f32 vcc, v76, v77
buffer_store_short v3, v200, s[4:7], s32 offen
buffer_store_short_d16_hi v3, v200, s[4:7], s32 offen offset:16
s_mov_b64 exec, -1
s_cmp_lg_u64 vcc, -1
s_cbranch_scc1 PF_184
PD_183:
s_cmp_lg_u32 s66, 0
s_cbranch_scc1 SL_187
SB_188:
s_cmp_ge_u32 s10, 63
s_cbranch_scc1 END_174
s_branch LOOP_173
END_174:
s_add_u32 s32, s32, 2097152
buffer_store_short v3, v200, s[4:7], s32 offen sc1
buffer_store_short_d16_hi v3, v200, s[4:7], s32 offen offset:16 sc1
s_endpgm
RT_177:
buffer_load_dwordx4 v[16:19], v9, s[4:7], s26 offen offset:1024 sc1
buffer_load_dwordx4 v[20:23], v9, s[4:7], s26 offen offset:2048 sc1
buffer_load_dwordx4 v[24:27], v9, s[4:7], s26 offen offset:0 sc1
buffer_load_dwordx4 v[28:31], v9, s[4:7], s26 offen offset:3072 sc1
buffer_load_dwordx4 v[32:35], v9, s[4:7], s27 offen offset:1024 sc1
s_sub_u32 s38, s38, 1
s_cmp_gt_i32 s38, 0
s_cbranch_scc0 END_174
v_mov_b32 v92, 0
v_mov_b32 v93, 0
v_mov_b32 v94, 0
v_mov_b32 v95, 0
v_mov_b32 v96, 0
v_mov_b32 v97, 0
v_mov_b32 v98, 0
v_mov_b32 v99, 0
v_mov_b32 v100, 0
v_mov_b32 v101, 0
v_mov_b32 v102, 0
v_mov_b32 v103, 0
s_waitcnt vmcnt(0)
v_cmp_eq_u32 vcc, -1, v16
s_cbranch_vccnz RT_177
v_smfmac_f32_16x16x64_bf16 v[92:95], v[16:19], a[0:7], v8
v_smfmac_f32_16x16x64_bf16 v[96:99], v[16:19], a[56:63], v8
v_smfmac_f32_16x16x64_bf16 v[100:103], v[16:19], a[112:119], v8
s_branch BK_178
FAIL_175:
s_mov_b64 s[50:51], 0
FAIL_175b:
buffer_load_dwordx4 v[16:19], v9, s[4:7], s26 offen offset:1024 sc1
buffer_load_dwordx4 v[20:23], v9, s[4:7], s26 offen offset:2048 sc1
buffer_load_dwordx4 v[24:27], v9, s[4:7], s26 offen offset:0 sc1
buffer_load_dwordx4 v[28:31], v9, s[4:7], s26 offen offset:3072 sc1
buffer_load_dwordx4 v[32:35], v9, s[4:7], s27 offen offset:1024 sc1
buffer_load_dwordx4 v[36:39], v9, s[4:7], s27 offen offset:2048 sc1
buffer_load_dwordx4 v[40:43], v9, s[4:7], s27 offen offset:0 sc1
s_sub_u32 s38, s38, 1
s_cmp_gt_i32 s38, 0
s_cbranch_scc0 END_174
v_mov_b32 v92, 0
v_mov_b32 v93, 0
v_mov_b32 v94, 0
v_mov_b32 v95, 0
v_mov_b32 v96, 0
v_mov_b32 v97, 0
v_mov_b32 v98, 0
v_mov_b32 v99, 0
v_mov_b32 v100, 0
v_mov_b32 v101, 0
v_mov_b32 v102, 0
v_mov_b32 v103, 0
v_mov_b32 v104, 0
v_mov_b32 v105, 0
v_mov_b32 v106, 0
v_mov_b32 v107, 0
v_mov_b32 v108, 0
v_mov_b32 v109, 0
v_mov_b32 v110, 0
v_mov_b32 v111, 0
v_mov_b32 v112, 0
v_mov_b32 v113, 0
v_mov_b32 v114, 0
v_mov_b32 v115, 0
v_mov_b32 v116, 0
v_mov_b32 v117, 0
v_mov_b32 v118, 0
v_mov_b32 v119, 0
v_mov_b32 v120, 0
v_mov_b32 v121, 0
v_mov_b32 v122, 0
v_mov_b32 v123, 0
ds_read_b128 v[44:47], v14 offset:0
ds_read_b128 v[48:51], v14 offset:1024
ds_read_b128 v[60:63], v14 offset:14336
ds_read_b128 v[64:67], v14 offset:15360
ds_read_b128 v[76:79], v14 offset:28672
ds_read_b128 v[80:83], v14 offset:29696
ds_read_b128 v[52:55], v14 offset:2048
ds_read_b128 v[56:59], v14 offset:3072
ds_read_b128 v[68:71], v14 offset:16384
ds_read_b128 v[72:75], v14 offset:17408
ds_read_b128 v[84:87], v14 offset:30720
ds_read_b128 v[88:91], v14 offset:31744
s_waitcnt vmcnt(0)
v_max3_u32 v3, v16, v17, v18
v_max3_u32 v3, v3, v19, v20
v_max3_u32 v3, v3, v21, v22
v_max3_u32 v3, v3, v23, v24
v_max3_u32 v3, v3, v25, v26
v_max3_u32 v3, v3, v27, v28
v_max3_u32 v3, v3, v29, v30
v_max3_u32 v3, v3, v31, v32
v_max3_u32 v3, v3, v33, v34
v_max3_u32 v3, v3, v35, v36
v_max3_u32 v3, v3, v37, v38
v_max3_u32 v3, v3, v39, v40
v_max3_u32 v3, v3, v41, v42
v_max_u32 v3, v3, v43
v_cmp_eq_u32 vcc, -1, v3
s_cbranch_vccnz FAIL_175b
s_waitcnt lgkmcnt(6)
v_smfmac_f32_16x16x64_bf16 v[92:95], v[16:19], a[0:7], v8
v_smfmac_f32_16x16x64_bf16 v[96:99], v[16:19], a[56:63], v8
v_smfmac_f32_16x16x64_bf16 v[100:103], v[16:19], a[112:119], v8
v_smfmac_f32_16x16x64_bf16 v[104:107], v[16:19], v[44:51], v8
v_smfmac_f32_16x16x64_bf16 v[108:111], v[16:19], v[60:67], v8
v_smfmac_f32_16x16x64_bf16 v[112:115], v[16:19], v[76:83], v8
ds_read_b128 v[44:47], v14 offset:4096
ds_read_b128 v[48:51], v14 offset:5120
ds_read_b128 v[60:63], v14 offset:18432
ds_read_b128 v[64:67], v14 offset:19456
ds_read_b128 v[76:79], v14 offset:32768
ds_read_b128 v[80:83], v14 offset:33792
s_waitcnt lgkmcnt(6)
v_smfmac_f32_16x16x64_bf16 v[92:95], v[20:23], a[8:15], v8
v_smfmac_f32_16x16x64_bf16 v[96:99], v[20:23], a[64:71], v8
v_smfmac_f32_16x16x64_bf16 v[100:103], v[20:23], a[120:127], v8
v_smfmac_f32_16x16x64_bf16 v[104:107], v[20:23], v[52:59], v8
v_smfmac_f32_16x16x64_bf16 v[108:111], v[20:23], v[68:75], v8
v_smfmac_f32_16x16x64_bf16 v[112:115], v[20:23], v[84:91], v8
ds_read_b128 v[52:55], v14 offset:6144
ds_read_b128 v[56:59], v14 offset:7168
ds_read_b128 v[68:71], v14 offset:20480
ds_read_b128 v[72:75], v14 offset:21504
ds_read_b128 v[84:87], v14 offset:34816
ds_read_b128 v[88:91], v14 offset:35840
s_waitcnt lgkmcnt(6)
v_smfmac_f32_16x16x64_bf16 v[92:95], v[24:27], a[16:23], v8
v_smfmac_f32_16x16x64_bf16 v[96:99], v[24:27], a[72:79], v8
v_smfmac_f32_16x16x64_bf16 v[100:103], v[24:27], a[128:135], v8
v_smfmac_f32_16x16x64_bf16 v[104:107], v[24:27], v[44:51], v8
v_smfmac_f32_16x16x64_bf16 v[108:111], v[24:27], v[60:67], v8
v_smfmac_f32_16x16x64_bf16 v[112:115], v[24:27], v[76:83], v8
ds_read_b128 v[44:47], v14 offset:8192
ds_read_b128 v[48:51], v14 offset:9216
ds_read_b128 v[60:63], v14 offset:22528
ds_read_b128 v[64:67], v14 offset:23552
ds_read_b128 v[76:79], v14 offset:36864
ds_read_b128 v[80:83], v14 offset:37888
s_waitcnt lgkmcnt(6)
v_smfmac_f32_16x16x64_bf16 v[92:95], v[28:31], a[24:31], v8
v_smfmac_f32_16x16x64_bf16 v[96:99], v[28:31], a[80:87], v8
v_smfmac_f32_16x16x64_bf16 v[100:103], v[28:31], a[136:143], v8
v_smfmac_f32_16x16x64_bf16 v[104:107], v[28:31], v[52:59], v8
v_smfmac_f32_16x16x64_bf16 v[108:111], v[28:31], v[68:75], v8
v_smfmac_f32_16x16x64_bf16 v[112:115], v[28:31], v[84:91], v8
ds_read_b128 v[52:55], v14 offset:10240
ds_read_b128 v[56:59], v14 offset:11264
ds_read_b128 v[68:71], v14 offset:24576
ds_read_b128 v[72:75], v14 offset:25600
ds_read_b128 v[84:87], v14 offset:38912
ds_read_b128 v[88:91], v14 offset:39936
s_waitcnt lgkmcnt(6)
v_smfmac_f32_16x16x64_bf16 v[92:95], v[32:35], a[32:39], v8
v_smfmac_f32_16x16x64_bf16 v[96:99], v[32:35], a[88:95], v8
v_smfmac_f32_16x16x64_bf16 v[100:103], v[32:35], a[144:151], v8
v_smfmac_f32_16x16x64_bf16 v[104:107], v[32:35], v[44:51], v8
v_smfmac_f32_16x16x64_bf16 v[108:111], v[32:35], v[60:67], v8
v_smfmac_f32_16x16x64_bf16 v[112:115], v[32:35], v[76:83], v8
ds_read_b128 v[44:47], v14 offset:12288
ds_read_b128 v[48:51], v14 offset:13312
ds_read_b128 v[60:63], v14 offset:26624
ds_read_b128 v[64:67], v14 offset:27648
ds_read_b128 v[76:79], v14 offset:40960
ds_read_b128 v[80:83], v14 offset:41984
s_waitcnt lgkmcnt(6)
v_smfmac_f32_16x16x64_bf16 v[92:95], v[36:39], a[40:47], v8
v_smfmac_f32_16x16x64_bf16 v[96:99], v[36:39], a[96:103], v8
v_smfmac_f32_16x16x64_bf16 v[100:103], v[36:39], a[152:159], v8
v_smfmac_f32_16x16x64_bf16 v[104:107], v[36:39], v[52:59], v8
v_smfmac_f32_16x16x64_bf16 v[108:111], v[36:39], v[68:75], v8
v_smfmac_f32_16x16x64_bf16 v[112:115], v[36:39], v[84:91], v8
s_waitcnt lgkmcnt(0)
v_smfmac_f32_16x16x64_bf16 v[92:95], v[40:43], a[48:55], v8
v_smfmac_f32_16x16x64_bf16 v[96:99], v[40:43], a[104:111], v8
v_smfmac_f32_16x16x64_bf16 v[100:103], v[40:43], a[160:167], v8
v_smfmac_f32_16x16x64_bf16 v[104:107], v[40:43], v[44:51], v8
v_smfmac_f32_16x16x64_bf16 v[108:111], v[40:43], v[60:67], v8
v_smfmac_f32_16x16x64_bf16 v[112:115], v[40:43], v[76:83], v8
s_nop 7
s_branch JOIN_176
Y0_179:
v_mov_b32 v3, 0
s_mov_b32 s34, 71319552
YL_180:
buffer_load_dword v4, v3, s[4:7], s34 offen sc1
s_sub_u32 s38, s38, 1
s_cmp_gt_i32 s38, 0
s_cbranch_scc0 YD_181
s_waitcnt vmcnt(0)
v_cmp_gt_u32 vcc, 16, v4
s_cbranch_vccz YD_181
s_sleep 6
s_branch YL_180
YD_181:
buffer_load_dwordx4 v[136:139], v9, s[4:7], s64 offen offset:0 sc1
buffer_load_dwordx4 v[140:143], v9, s[4:7], s64 offen offset:1024 sc1
buffer_load_dwordx4 v[144:147], v9, s[4:7], s64 offen offset:2048 sc1
buffer_load_dwordx4 v[148:151], v9, s[4:7], s64 offen offset:3072 sc1
buffer_load_dwordx4 v[152:155], v9, s[4:7], s65 offen offset:0 sc1
buffer_load_dwordx4 v[156:159], v9, s[4:7], s65 offen offset:1024 sc1
buffer_load_dwordx4 v[160:163], v9, s[4:7], s65 offen offset:2048 sc1
buffer_load_dwordx4 v[164:167], v9, s[4:7], s65 offen offset:3072 sc1
buffer_load_dwordx4 v[168:171], v9, s[4:7], s54 offen offset:0 sc1
buffer_load_dwordx4 v[172:175], v9, s[4:7], s54 offen offset:1024 sc1
buffer_load_dwordx4 v[176:179], v9, s[4:7], s54 offen offset:2048 sc1
buffer_load_dwordx4 v[180:183], v9, s[4:7], s54 offen offset:3072 sc1
buffer_load_dwordx4 v[184:187], v9, s[4:7], s55 offen offset:0 sc1
buffer_load_dwordx4 v[188:191], v9, s[4:7], s55 offen offset:1024 sc1
buffer_load_dwordx4 v[192:195], v9, s[4:7], s55 offen offset:2048 sc1
buffer_load_dwordx4 v[196:199], v9, s[4:7], s55 offen offset:3072 sc1
s_branch YB_182
PR_185:
buffer_load_dwordx4 v[16:19], v9, s[4:7], s28 offen offset:0 sc1
buffer_load_dwordx4 v[20:23], v9, s[4:7], s28 offen offset:1024 sc1
buffer_load_dwordx4 v[24:27], v9, s[4:7], s20 offen offset:2048 sc1
buffer_load_dwordx4 v[28:31], v9, s[4:7], s20 offen offset:3072 sc1
buffer_load_dwordx4 v[32:35], v9, s[4:7], s21 offen offset:2048 sc1
buffer_load_dwordx4 v[36:39], v9, s[4:7], s21 offen offset:3072 sc1
buffer_load_dwordx4 v[40:43], v9, s[4:7], s22 offen offset:2048 sc1
buffer_load_dwordx4 v[44:47], v9, s[4:7], s22 offen offset:3072 sc1
buffer_load_dwordx4 v[48:51], v9, s[4:7], s23 offen offset:2048 sc1
buffer_load_dwordx4 v[52:55], v9, s[4:7], s23 offen offset:3072 sc1
v_mov_b32 v76, 0
v_mov_b32 v77, 0
v_mov_b32 v78, 0
v_mov_b32 v79, 0
s_sub_u32 s38, s38, 1
s_cmp_gt_i32 s38, 0
s_cbranch_scc1 PB_186
s_branch PD_183
SL_187:
buffer_store_short v3, v200, s[4:7], s32 offen sc1
buffer_store_short_d16_hi v3, v200, s[4:7], s32 offen offset:16 sc1
buffer_store_dword v13, v201, s[4:7], s33 offen sc1
s_branch SB_188
PF_184:
buffer_load_dwordx4 v[16:19], v9, s[4:7], s28 offen offset:0 sc1
buffer_load_dwordx4 v[20:23], v9, s[4:7], s28 offen offset:1024 sc1
buffer_load_dwordx4 v[24:27], v9, s[4:7], s20 offen offset:2048 sc1
buffer_load_dwordx4 v[28:31], v9, s[4:7], s20 offen offset:3072 sc1
buffer_load_dwordx4 v[32:35], v9, s[4:7], s21 offen offset:2048 sc1
buffer_load_dwordx4 v[36:39], v9, s[4:7], s21 offen offset:3072 sc1
buffer_load_dwordx4 v[40:43], v9, s[4:7], s22 offen offset:2048 sc1
buffer_load_dwordx4 v[44:47], v9, s[4:7], s22 offen offset:3072 sc1
buffer_load_dwordx4 v[48:51], v9, s[4:7], s23 offen offset:2048 sc1
buffer_load_dwordx4 v[52:55], v9, s[4:7], s23 offen offset:3072 sc1
s_sub_u32 s38, s38, 1
s_cmp_gt_i32 s38, 0
s_cbranch_scc0 PD_183
v_mov_b32 v76, 0
v_mov_b32 v77, 0
v_mov_b32 v78, 0
v_mov_b32 v79, 0
s_waitcnt vmcnt(0)
v_max3_u32 v3, v16, v17, v18
v_max3_u32 v3, v3, v19, v20
v_max3_u32 v3, v3, v21, v22
v_max3_u32 v3, v3, v23, v24
v_max3_u32 v3, v3, v25, v26
v_max3_u32 v3, v3, v27, v28
v_max3_u32 v3, v3, v29, v30
v_max3_u32 v3, v3, v31, v32
v_max3_u32 v3, v3, v33, v34
v_max3_u32 v3, v3, v35, v36
v_max3_u32 v3, v3, v37, v38
v_max3_u32 v3, v3, v39, v40
v_max3_u32 v3, v3, v41, v42
v_max3_u32 v3, v3, v43, v44
v_max3_u32 v3, v3, v45, v46
v_max3_u32 v3, v3, v47, v48
v_max3_u32 v3, v3, v49, v50
v_max3_u32 v3, v3, v51, v52
v_max3_u32 v3, v3, v53, v54
v_max_u32 v3, v3, v55
v_cmp_eq_u32 vcc, -1, v3
s_cbranch_vccnz PF_184
v_smfmac_f32_16x16x64_bf16 v[76:79], v[16:19], v[60:67], v8
v_smfmac_f32_16x16x64_bf16 v[76:79], v[20:23], v[68:75], v8
v_smfmac_f32_16x16x64_bf16 v[76:79], v[24:27], v[136:143], v8
v_smfmac_f32_16x16x64_bf16 v[76:79], v[28:31], v[144:151], v8
v_smfmac_f32_16x16x64_bf16 v[76:79], v[32:35], v[152:159], v8
v_smfmac_f32_16x16x64_bf16 v[76:79], v[36:39], v[160:167], v8
v_smfmac_f32_16x16x64_bf16 v[76:79], v[40:43], v[168:175], v8
v_smfmac_f32_16x16x64_bf16 v[76:79], v[44:47], v[176:183], v8
v_smfmac_f32_16x16x64_bf16 v[76:79], v[48:51], v[184:191], v8
v_smfmac_f32_16x16x64_bf16 v[76:79], v[52:55], v[192:199], v8
s_nop 7
v_add_f32 v76, v76, v78
v_add_f32 v77, v77, v79
v_cvt_pk_bf16_f32 v3, v76, v77
buffer_store_short v3, v200, s[4:7], s32 offen
buffer_store_short_d16_hi v3, v200, s[4:7], s32 offen offset:16
s_branch PD_183
VO2:
v_and_b32 v0, 63, v0
v_lshrrev_b32 v1, 4, v0
v_and_b32 v2, 15, v0
v_lshlrev_b32 v9, 4, v0
v_add_u32 v14, 86016, v9
v_bfe_u32 v3, v2, 1, 1
v_lshrrev_b32 v4, 2, v2
v_lshlrev_b32 v4, 1, v4
v_and_b32 v5, 1, v2
v_add_u32 v4, v4, v5
v_mul_u32_u24 v8, 0xaaaa, v3
v_add_u32 v8, 0x4444, v8
v_mov_b32 v13, -1
s_mov_b32 s43, 71303168
v_add_u32 v116, 143360, v9
s_mov_b32 s10, 0
s_mov_b32 s38, 200000
s_mov_b32 s68, 0
s_mov_b32 s69, 0
s_mov_b32 s70, 0
s_mov_b32 s71, 0
s_waitcnt vmcnt(0) lgkmcnt(0)
s_barrier
s_mov_b32 s34, 71343104
v_min_u32 v3, 27, v0
v_lshlrev_b32 v3, 14, v3
s_mul_i32 s34, s11, 458752
s_add_u32 s34, s34, 7340032
buffer_load_dword v4, v3, s[4:7], s34 offen sc1
s_waitcnt vmcnt(0)
v_min_u32 v3, 13, v2
v_lshlrev_b32 v3, 2, v3
v_lshl_add_u32 v3, v1, 8, v3
v_add_u32 v3, 19584, v3
s_mov_b32 s41, 71319552
s_mov_b64 vcc, -1
s_mul_i32 s34, s11, 458752
s_and_b32 s36, vcc_lo, 4294967295
s_cbranch_scc0 RD_192
RL_191:
buffer_load_dword v4, v3, s[4:7], s41 offen sc1
s_sub_u32 s38, s38, 1
s_cmp_gt_i32 s38, 0
s_cbranch_scc0 RD_192
s_waitcnt vmcnt(0)
v_cmp_ne_u32 vcc, 1, v4
s_nop 0
s_and_b32 s36, vcc_lo, 4294967295
s_cbranch_scc0 RD_192
s_sleep 2
s_branch RL_191
RD_192:
s_and_b32 s36, vcc_hi, 4294967295
s_cbranch_scc0 RD_194
RL_193:
buffer_load_dword v4, v3, s[4:7], s41 offen sc1
s_sub_u32 s38, s38, 1
s_cmp_gt_i32 s38, 0
s_cbranch_scc0 RD_194
s_waitcnt vmcnt(0)
v_cmp_ne_u32 vcc, 1, v4
s_nop 0
s_and_b32 s36, vcc_hi, 4294967295
s_cbranch_scc0 RD_194
s_sleep 2
s_branch RL_193
RD_194:
s_add_u32 s35, s34, 7573504
buffer_load_dwordx4 a[0:3], v9, s[4:7], s35 offen sc1
buffer_load_dwordx4 a[4:7], v9, s[4:7], s35 offen offset:1024 sc1
s_add_u32 s35, s34, 7569408
buffer_load_dwordx4 a[8:11], v9, s[4:7], s35 offen sc1
buffer_load_dwordx4 a[12:15], v9, s[4:7], s35 offen offset:1024 sc1
s_add_u32 s35, s34, 7571456
buffer_load_dwordx4 a[16:19], v9, s[4:7], s35 offen sc1
buffer_load_dwordx4 a[20:23], v9, s[4:7], s35 offen offset:1024 sc1
s_add_u32 s35, s34, 7575552
buffer_load_dwordx4 a[24:27], v9, s[4:7], s35 offen sc1
buffer_load_dwordx4 a[28:31], v9, s[4:7], s35 offen offset:1024 sc1
s_add_u32 s35, s34, 7581696
buffer_load_dwordx4 a[32:35], v9, s[4:7], s35 offen sc1
buffer_load_dwordx4 a[36:39], v9, s[4:7], s35 offen offset:1024 sc1
s_add_u32 s35, s34, 7577600
buffer_load_dwordx4 a[40:43], v9, s[4:7], s35 offen sc1
buffer_load_dwordx4 a[44:47], v9, s[4:7], s35 offen offset:1024 sc1
s_add_u32 s35, s34, 7579648
buffer_load_dwordx4 a[48:51], v9, s[4:7], s35 offen sc1
buffer_load_dwordx4 a[52:55], v9, s[4:7], s35 offen offset:1024 sc1
s_add_u32 s35, s34, 7587840
s_mov_b32 m0, 86016
s_nop 0
buffer_load_dwordx4 v9, s[4:7], s35 offen sc1 lds
buffer_load_dwordx4 v9, s[4:7], s35 offen offset:1024 sc1 lds
s_add_u32 s35, s34, 7583744
s_mov_b32 m0, 88064
s_nop 0
buffer_load_dwordx4 v9, s[4:7], s35 offen sc1 lds
buffer_load_dwordx4 v9, s[4:7], s35 offen offset:1024 sc1 lds
s_add_u32 s35, s34, 7585792
s_mov_b32 m0, 90112
s_nop 0
buffer_load_dwordx4 v9, s[4:7], s35 offen sc1 lds
buffer_load_dwordx4 v9, s[4:7], s35 offen offset:1024 sc1 lds
s_add_u32 s35, s34, 7589888
s_mov_b32 m0, 92160
s_nop 0
buffer_load_dwordx4 v9, s[4:7], s35 offen sc1 lds
buffer_load_dwordx4 v9, s[4:7], s35 offen offset:1024 sc1 lds
s_add_u32 s35, s34, 7596032
s_mov_b32 m0, 94208
s_nop 0
buffer_load_dwordx4 v9, s[4:7], s35 offen sc1 lds
buffer_load_dwordx4 v9, s[4:7], s35 offen offset:1024 sc1 lds
s_add_u32 s35, s34, 7591936
s_mov_b32 m0, 96256
s_nop 0
buffer_load_dwordx4 v9, s[4:7], s35 offen sc1 lds
buffer_load_dwordx4 v9, s[4:7], s35 offen offset:1024 sc1 lds
s_add_u32 s35, s34, 7593984
s_mov_b32 m0, 98304
s_nop 0
buffer_load_dwordx4 v9, s[4:7], s35 offen sc1 lds
buffer_load_dwordx4 v9, s[4:7], s35 offen offset:1024 sc1 lds
s_add_u32 s35, s34, 7602176
buffer_load_dwordx4 a[56:59], v9, s[4:7], s35 offen sc1
buffer_load_dwordx4 a[60:63], v9, s[4:7], s35 offen offset:1024 sc1
s_add_u32 s35, s34, 7598080
buffer_load_dwordx4 a[64:67], v9, s[4:7], s35 offen sc1
buffer_load_dwordx4 a[68:71], v9, s[4:7], s35 offen offset:1024 sc1
s_add_u32 s35, s34, 7600128
buffer_load_dwordx4 a[72:75], v9, s[4:7], s35 offen sc1
buffer_load_dwordx4 a[76:79], v9, s[4:7], s35 offen offset:1024 sc1
s_add_u32 s35, s34, 7604224
buffer_load_dwordx4 a[80:83], v9, s[4:7], s35 offen sc1
buffer_load_dwordx4 a[84:87], v9, s[4:7], s35 offen offset:1024 sc1
s_add_u32 s35, s34, 7610368
buffer_load_dwordx4 a[88:91], v9, s[4:7], s35 offen sc1
buffer_load_dwordx4 a[92:95], v9, s[4:7], s35 offen offset:1024 sc1
s_add_u32 s35, s34, 7606272
buffer_load_dwordx4 a[96:99], v9, s[4:7], s35 offen sc1
buffer_load_dwordx4 a[100:103], v9, s[4:7], s35 offen offset:1024 sc1
s_add_u32 s35, s34, 7608320
buffer_load_dwordx4 a[104:107], v9, s[4:7], s35 offen sc1
buffer_load_dwordx4 a[108:111], v9, s[4:7], s35 offen offset:1024 sc1
s_add_u32 s35, s34, 7616512
s_mov_b32 m0, 100352
s_nop 0
buffer_load_dwordx4 v9, s[4:7], s35 offen sc1 lds
buffer_load_dwordx4 v9, s[4:7], s35 offen offset:1024 sc1 lds
s_add_u32 s35, s34, 7612416
s_mov_b32 m0, 102400
s_nop 0
buffer_load_dwordx4 v9, s[4:7], s35 offen sc1 lds
buffer_load_dwordx4 v9, s[4:7], s35 offen offset:1024 sc1 lds
s_add_u32 s35, s34, 7614464
s_mov_b32 m0, 104448
s_nop 0
buffer_load_dwordx4 v9, s[4:7], s35 offen sc1 lds
buffer_load_dwordx4 v9, s[4:7], s35 offen offset:1024 sc1 lds
s_add_u32 s35, s34, 7618560
s_mov_b32 m0, 106496
s_nop 0
buffer_load_dwordx4 v9, s[4:7], s35 offen sc1 lds
buffer_load_dwordx4 v9, s[4:7], s35 offen offset:1024 sc1 lds
s_add_u32 s35, s34, 7624704
s_mov_b32 m0, 108544
s_nop 0
buffer_load_dwordx4 v9, s[4:7], s35 offen sc1 lds
buffer_load_dwordx4 v9, s[4:7], s35 offen offset:1024 sc1 lds
s_add_u32 s35, s34, 7620608
s_mov_b32 m0, 110592
s_nop 0
buffer_load_dwordx4 v9, s[4:7], s35 offen sc1 lds
buffer_load_dwordx4 v9, s[4:7], s35 offen offset:1024 sc1 lds
s_add_u32 s35, s34, 7622656
s_mov_b32 m0, 112640
s_nop 0
buffer_load_dwordx4 v9, s[4:7], s35 offen sc1 lds
buffer_load_dwordx4 v9, s[4:7], s35 offen offset:1024 sc1 lds
s_add_u32 s35, s34, 7630848
buffer_load_dwordx4 a[112:115], v9, s[4:7], s35 offen sc1
buffer_load_dwordx4 a[116:119], v9, s[4:7], s35 offen offset:1024 sc1
s_add_u32 s35, s34, 7626752
buffer_load_dwordx4 a[120:123], v9, s[4:7], s35 offen sc1
buffer_load_dwordx4 a[124:127], v9, s[4:7], s35 offen offset:1024 sc1
s_waitcnt vmcnt(40)
s_add_u32 s35, s34, 7628800
buffer_load_dwordx4 a[128:131], v9, s[4:7], s35 offen sc1
buffer_load_dwordx4 a[132:135], v9, s[4:7], s35 offen offset:1024 sc1
s_add_u32 s35, s34, 7632896
buffer_load_dwordx4 a[136:139], v9, s[4:7], s35 offen sc1
buffer_load_dwordx4 a[140:143], v9, s[4:7], s35 offen offset:1024 sc1
s_add_u32 s35, s34, 7639040
buffer_load_dwordx4 a[144:147], v9, s[4:7], s35 offen sc1
buffer_load_dwordx4 a[148:151], v9, s[4:7], s35 offen offset:1024 sc1
s_add_u32 s35, s34, 7634944
buffer_load_dwordx4 a[152:155], v9, s[4:7], s35 offen sc1
buffer_load_dwordx4 a[156:159], v9, s[4:7], s35 offen offset:1024 sc1
s_add_u32 s35, s34, 7636992
buffer_load_dwordx4 a[160:163], v9, s[4:7], s35 offen sc1
buffer_load_dwordx4 a[164:167], v9, s[4:7], s35 offen offset:1024 sc1
s_add_u32 s35, s34, 7645184
buffer_load_dwordx4 a[224:227], v9, s[4:7], s35 offen sc1
buffer_load_dwordx4 a[228:231], v9, s[4:7], s35 offen offset:1024 sc1
s_add_u32 s35, s34, 7641088
buffer_load_dwordx4 a[232:235], v9, s[4:7], s35 offen sc1
buffer_load_dwordx4 a[236:239], v9, s[4:7], s35 offen offset:1024 sc1
s_add_u32 s35, s34, 7643136
buffer_load_dwordx4 a[240:243], v9, s[4:7], s35 offen sc1
buffer_load_dwordx4 a[244:247], v9, s[4:7], s35 offen offset:1024 sc1
s_add_u32 s35, s34, 7647232
buffer_load_dwordx4 a[248:251], v9, s[4:7], s35 offen sc1
buffer_load_dwordx4 a[252:255], v9, s[4:7], s35 offen offset:1024 sc1
s_add_u32 s35, s34, 7653376
buffer_load_dwordx4 v[120:123], v9, s[4:7], s35 offen sc1
buffer_load_dwordx4 v[124:127], v9, s[4:7], s35 offen offset:1024 sc1
s_waitcnt vmcnt(40)
s_add_u32 s35, s34, 7649280
buffer_load_dwordx4 v[128:131], v9, s[4:7], s35 offen sc1
buffer_load_dwordx4 v[132:135], v9, s[4:7], s35 offen offset:1024 sc1
s_add_u32 s35, s34, 7651328
buffer_load_dwordx4 v[136:139], v9, s[4:7], s35 offen sc1
buffer_load_dwordx4 v[140:143], v9, s[4:7], s35 offen offset:1024 sc1
s_add_u32 s35, s34, 7659520
buffer_load_dwordx4 a[168:171], v9, s[4:7], s35 offen sc1
buffer_load_dwordx4 a[172:175], v9, s[4:7], s35 offen offset:1024 sc1
s_add_u32 s35, s34, 7655424
buffer_load_dwordx4 a[176:179], v9, s[4:7], s35 offen sc1
buffer_load_dwordx4 a[180:183], v9, s[4:7], s35 offen offset:1024 sc1
s_add_u32 s35, s34, 7657472
buffer_load_dwordx4 a[184:187], v9, s[4:7], s35 offen sc1
buffer_load_dwordx4 a[188:191], v9, s[4:7], s35 offen offset:1024 sc1
s_add_u32 s35, s34, 7661568
buffer_load_dwordx4 a[192:195], v9, s[4:7], s35 offen sc1
buffer_load_dwordx4 a[196:199], v9, s[4:7], s35 offen offset:1024 sc1
s_add_u32 s35, s34, 7667712
buffer_load_dwordx4 a[200:203], v9, s[4:7], s35 offen sc1
buffer_load_dwordx4 a[204:207], v9, s[4:7], s35 offen offset:1024 sc1
s_add_u32 s35, s34, 7663616
buffer_load_dwordx4 a[208:211], v9, s[4:7], s35 offen sc1
buffer_load_dwordx4 a[212:215], v9, s[4:7], s35 offen offset:1024 sc1
s_add_u32 s35, s34, 7665664
buffer_load_dwordx4 a[216:219], v9, s[4:7], s35 offen sc1
buffer_load_dwordx4 a[220:223], v9, s[4:7], s35 offen offset:1024 sc1
s_add_u32 s35, s34, 7673856
buffer_load_dwordx4 v[144:147], v9, s[4:7], s35 offen sc1
buffer_load_dwordx4 v[148:151], v9, s[4:7], s35 offen offset:1024 sc1
s_waitcnt vmcnt(40)
s_add_u32 s35, s34, 7669760
buffer_load_dwordx4 v[152:155], v9, s[4:7], s35 offen sc1
buffer_load_dwordx4 v[156:159], v9, s[4:7], s35 offen offset:1024 sc1
s_add_u32 s35, s34, 7671808
buffer_load_dwordx4 v[160:163], v9, s[4:7], s35 offen sc1
buffer_load_dwordx4 v[164:167], v9, s[4:7], s35 offen offset:1024 sc1
s_add_u32 s35, s34, 7675904
buffer_load_dwordx4 v[168:171], v9, s[4:7], s35 offen sc1
buffer_load_dwordx4 v[172:175], v9, s[4:7], s35 offen offset:1024 sc1
s_add_u32 s35, s34, 7682048
buffer_load_dwordx4 v[176:179], v9, s[4:7], s35 offen sc1
buffer_load_dwordx4 v[180:183], v9, s[4:7], s35 offen offset:1024 sc1
s_add_u32 s35, s34, 7677952
buffer_load_dwordx4 v[184:187], v9, s[4:7], s35 offen sc1
buffer_load_dwordx4 v[188:191], v9, s[4:7], s35 offen offset:1024 sc1
s_add_u32 s35, s34, 7680000
buffer_load_dwordx4 v[192:195], v9, s[4:7], s35 offen sc1
buffer_load_dwordx4 v[196:199], v9, s[4:7], s35 offen offset:1024 sc1
s_mov_b32 s34, 71343104
s_barrier
v_mov_b32 v3, 151552
ds_read_b32 v4, v3
s_waitcnt lgkmcnt(0)
v_readfirstlane_b32 s66, v4
s_waitcnt vmcnt(0)
v_mov_b32 v76, 0
v_mov_b32 v77, 0
v_mov_b32 v78, 0
v_mov_b32 v79, 0
v_mov_b32 v80, 0
v_mov_b32 v81, 0
v_mov_b32 v82, 0
v_mov_b32 v83, 0
v_mov_b32 v84, 0
v_mov_b32 v85, 0
v_mov_b32 v86, 0
v_mov_b32 v87, 0
v_mov_b32 v88, 0
v_mov_b32 v89, 0
v_mov_b32 v90, 0
v_mov_b32 v91, 0
v_mov_b32 v92, 0
v_mov_b32 v93, 0
v_mov_b32 v94, 0
v_mov_b32 v95, 0
v_mov_b32 v96, 0
v_mov_b32 v97, 0
v_mov_b32 v98, 0
v_mov_b32 v99, 0
v_mov_b32 v100, 0
v_mov_b32 v101, 0
v_mov_b32 v102, 0
v_mov_b32 v103, 0
v_mov_b32 v104, 0
v_mov_b32 v105, 0
v_mov_b32 v106, 0
v_mov_b32 v107, 0
s_lshl_b32 s26, s10, 13
s_add_u32 s26, s26, 54525952
s_add_u32 s27, s26, 4096
LOOP_197:
s_barrier
buffer_load_dwordx4 v[16:19], v9, s[4:7], s26 offen offset:2048 sc1
ds_read_b128 v[44:47], v14 offset:0
ds_read_b128 v[48:51], v14 offset:1024
ds_read_b128 v[60:63], v14 offset:14336
ds_read_b128 v[64:67], v14 offset:15360
ds_read_b128 v[52:55], v14 offset:2048
s_barrier
buffer_load_dwordx4 v[20:23], v9, s[4:7], s26 offen offset:0
ds_read_b128 v[56:59], v14 offset:3072
ds_read_b128 v[68:71], v14 offset:16384
ds_read_b128 v[72:75], v14 offset:17408
s_add_u32 s39, s10, 1
s_mov_b64 s[50:51], -1
s_barrier
buffer_load_dwordx4 v[24:27], v9, s[4:7], s26 offen offset:1024
v_mov_b32 v10, s39
s_and_b32 s34, s10, 3
s_lshl_b32 s28, s34, 14
s_barrier
buffer_load_dwordx4 v[28:31], v9, s[4:7], s26 offen offset:3072
s_waitcnt vmcnt(3)
v_smfmac_f32_16x16x64_bf16 v[76:79], v[16:19], a[0:7], v8
buffer_load_dwordx4 v[32:35], v9, s[4:7], s27 offen offset:2048
v_cmp_eq_u32 vcc, -1, v16
v_smfmac_f32_16x16x64_bf16 v[80:83], v[16:19], a[56:63], v8
v_smfmac_f32_16x16x64_bf16 v[84:87], v[16:19], a[112:119], v8
s_cbranch_vccnz RT_201
BK_202:
v_smfmac_f32_16x16x64_bf16 v[88:91], v[16:19], a[168:175], v8
buffer_load_dwordx4 v[36:39], v9, s[4:7], s27 offen offset:0
s_waitcnt lgkmcnt(6)
v_smfmac_f32_16x16x64_bf16 v[92:95], v[16:19], v[44:51], v8
s_waitcnt lgkmcnt(4)
v_smfmac_f32_16x16x64_bf16 v[96:99], v[16:19], v[60:67], v8
s_waitcnt vmcnt(4)
v_smfmac_f32_16x16x64_bf16 v[76:79], v[20:23], a[8:15], v8
buffer_load_dwordx4 v[40:43], v9, s[4:7], s27 offen offset:1024
v_smfmac_f32_16x16x64_bf16 v[80:83], v[20:23], a[64:71], v8
ds_read_b128 v[44:47], v14 offset:4096
v_smfmac_f32_16x16x64_bf16 v[84:87], v[20:23], a[120:127], v8
ds_read_b128 v[48:51], v14 offset:5120
v_smfmac_f32_16x16x64_bf16 v[88:91], v[20:23], a[176:183], v8
ds_read_b128 v[60:63], v14 offset:18432
s_waitcnt lgkmcnt(5)
v_smfmac_f32_16x16x64_bf16 v[92:95], v[20:23], v[52:59], v8
ds_read_b128 v[64:67], v14 offset:19456
s_waitcnt lgkmcnt(4)
v_smfmac_f32_16x16x64_bf16 v[96:99], v[20:23], v[68:75], v8
s_waitcnt vmcnt(4)
v_smfmac_f32_16x16x64_bf16 v[76:79], v[24:27], a[16:23], v8
ds_read_b128 v[52:55], v14 offset:6144
v_smfmac_f32_16x16x64_bf16 v[80:83], v[24:27], a[72:79], v8
ds_read_b128 v[56:59], v14 offset:7168
v_smfmac_f32_16x16x64_bf16 v[84:87], v[24:27], a[128:135], v8
ds_read_b128 v[68:71], v14 offset:20480
v_smfmac_f32_16x16x64_bf16 v[88:91], v[24:27], a[184:191], v8
ds_read_b128 v[72:75], v14 offset:21504
s_waitcnt lgkmcnt(6)
v_smfmac_f32_16x16x64_bf16 v[92:95], v[24:27], v[44:51], v8
s_waitcnt lgkmcnt(4)
v_smfmac_f32_16x16x64_bf16 v[96:99], v[24:27], v[60:67], v8
s_waitcnt vmcnt(3)
v_smfmac_f32_16x16x64_bf16 v[76:79], v[28:31], a[24:31], v8
ds_read_b128 v[44:47], v14 offset:8192
v_smfmac_f32_16x16x64_bf16 v[80:83], v[28:31], a[80:87], v8
ds_read_b128 v[48:51], v14 offset:9216
v_smfmac_f32_16x16x64_bf16 v[84:87], v[28:31], a[136:143], v8
ds_read_b128 v[60:63], v14 offset:22528
v_smfmac_f32_16x16x64_bf16 v[88:91], v[28:31], a[192:199], v8
ds_read_b128 v[64:67], v14 offset:23552
s_waitcnt lgkmcnt(6)
v_smfmac_f32_16x16x64_bf16 v[92:95], v[28:31], v[52:59], v8
s_waitcnt lgkmcnt(4)
v_smfmac_f32_16x16x64_bf16 v[96:99], v[28:31], v[68:75], v8
s_waitcnt vmcnt(2)
v_smfmac_f32_16x16x64_bf16 v[76:79], v[32:35], a[32:39], v8
ds_read_b128 v[52:55], v14 offset:10240
v_smfmac_f32_16x16x64_bf16 v[80:83], v[32:35], a[88:95], v8
ds_read_b128 v[56:59], v14 offset:11264
v_smfmac_f32_16x16x64_bf16 v[84:87], v[32:35], a[144:151], v8
ds_read_b128 v[68:71], v14 offset:24576
v_smfmac_f32_16x16x64_bf16 v[88:91], v[32:35], a[200:207], v8
ds_read_b128 v[72:75], v14 offset:25600
s_waitcnt lgkmcnt(6)
v_smfmac_f32_16x16x64_bf16 v[92:95], v[32:35], v[44:51], v8
s_waitcnt lgkmcnt(4)
v_smfmac_f32_16x16x64_bf16 v[96:99], v[32:35], v[60:67], v8
s_waitcnt vmcnt(1)
v_smfmac_f32_16x16x64_bf16 v[76:79], v[36:39], a[40:47], v8
ds_read_b128 v[44:47], v14 offset:12288
v_smfmac_f32_16x16x64_bf16 v[80:83], v[36:39], a[96:103], v8
ds_read_b128 v[48:51], v14 offset:13312
v_smfmac_f32_16x16x64_bf16 v[84:87], v[36:39], a[152:159], v8
ds_read_b128 v[60:63], v14 offset:26624
v_smfmac_f32_16x16x64_bf16 v[88:91], v[36:39], a[208:215], v8
ds_read_b128 v[64:67], v14 offset:27648
s_waitcnt lgkmcnt(6)
v_smfmac_f32_16x16x64_bf16 v[92:95], v[36:39], v[52:59], v8
s_waitcnt lgkmcnt(4)
v_smfmac_f32_16x16x64_bf16 v[96:99], v[36:39], v[68:75], v8
s_waitcnt vmcnt(0)
v_smfmac_f32_16x16x64_bf16 v[76:79], v[40:43], a[48:55], v8
v_smfmac_f32_16x16x64_bf16 v[80:83], v[40:43], a[104:111], v8
v_smfmac_f32_16x16x64_bf16 v[84:87], v[40:43], a[160:167], v8
v_smfmac_f32_16x16x64_bf16 v[88:91], v[40:43], a[216:223], v8
s_waitcnt lgkmcnt(2)
v_smfmac_f32_16x16x64_bf16 v[92:95], v[40:43], v[44:51], v8
s_waitcnt lgkmcnt(0)
v_smfmac_f32_16x16x64_bf16 v[96:99], v[40:43], v[60:67], v8
JOIN_200:
v_smfmac_f32_16x16x64_bf16 v[100:103], v[16:19], a[224:231], v8
v_add_f32 v76, v76, v78
v_smfmac_f32_16x16x64_bf16 v[100:103], v[20:23], a[232:239], v8
v_add_f32 v77, v77, v79
v_cmp_u_f32 vcc, v76, v77
v_smfmac_f32_16x16x64_bf16 v[100:103], v[24:27], a[240:247], v8
v_cvt_pk_bf16_f32 v108, v76, v77
v_smfmac_f32_16x16x64_bf16 v[100:103], v[28:31], a[248:255], v8
v_add_f32 v80, v80, v82
v_add_f32 v81, v81, v83
v_smfmac_f32_16x16x64_bf16 v[100:103], v[32:35], v[120:127], v8
s_and_b64 vcc, vcc, s[50:51]
s_cbranch_scc1 FAIL_199
v_cvt_pk_bf16_f32 v109, v80, v81
v_smfmac_f32_16x16x64_bf16 v[100:103], v[36:39], v[128:135], v8
v_add_f32 v84, v84, v86
v_add_f32 v85, v85, v87
v_smfmac_f32_16x16x64_bf16 v[100:103], v[40:43], v[136:143], v8
v_cvt_pk_bf16_f32 v110, v84, v85
v_smfmac_f32_16x16x64_bf16 v[104:107], v[16:19], v[144:151], v8
v_add_f32 v88, v88, v90
v_add_f32 v89, v89, v91
v_smfmac_f32_16x16x64_bf16 v[104:107], v[20:23], v[152:159], v8
v_cvt_pk_bf16_f32 v111, v88, v89
v_smfmac_f32_16x16x64_bf16 v[104:107], v[24:27], v[160:167], v8
v_add_f32 v92, v92, v94
v_add_f32 v93, v93, v95
v_smfmac_f32_16x16x64_bf16 v[104:107], v[28:31], v[168:175], v8
v_cvt_pk_bf16_f32 v112, v92, v93
v_smfmac_f32_16x16x64_bf16 v[104:107], v[32:35], v[176:183], v8
v_add_f32 v96, v96, v98
v_add_f32 v97, v97, v99
v_smfmac_f32_16x16x64_bf16 v[104:107], v[36:39], v[184:191], v8
v_cvt_pk_bf16_f32 v113, v96, v97
v_smfmac_f32_16x16x64_bf16 v[104:107], v[40:43], v[192:199], v8
v_add_f32 v100, v100, v102
v_add_f32 v101, v101, v103
v_cvt_pk_bf16_f32 v114, v100, v101
s_nop 4
v_add_f32 v104, v104, v106
v_add_f32 v105, v105, v107
v_cvt_pk_bf16_f32 v115, v104, v105
ds_write_b128 v116, v[108:111] offset:2048
ds_write_b128 v116, v[112:115] offset:6144
v_mov_b32 v76, 0
v_mov_b32 v77, 0
v_mov_b32 v78, 0
v_mov_b32 v79, 0
v_mov_b32 v80, 0
v_mov_b32 v81, 0
s_add_u32 s10, s10, 1
s_lshl_b32 s26, s10, 13
s_add_u32 s26, s26, 54525952
s_add_u32 s27, s26, 4096
s_waitcnt lgkmcnt(0)
v_mov_b32 v82, 0
v_mov_b32 v83, 0
v_mov_b32 v84, 0
v_mov_b32 v85, 0
v_mov_b32 v86, 0
v_mov_b32 v87, 0
v_mov_b32 v88, 0
v_mov_b32 v89, 0
v_mov_b32 v90, 0
v_mov_b32 v91, 0
v_mov_b32 v92, 0
v_mov_b32 v93, 0
v_mov_b32 v94, 0
v_mov_b32 v95, 0
v_mov_b32 v96, 0
v_mov_b32 v97, 0
v_mov_b32 v98, 0
v_mov_b32 v99, 0
v_mov_b32 v100, 0
v_mov_b32 v101, 0
v_mov_b32 v102, 0
v_mov_b32 v103, 0
v_mov_b32 v104, 0
v_mov_b32 v105, 0
v_mov_b32 v106, 0
v_mov_b32 v107, 0
s_barrier
s_cmp_ge_u32 s10, 63
s_cbranch_scc1 END_198
s_branch LOOP_197
END_198:
s_endpgm
RT_201:
buffer_load_dwordx4 v[16:19], v9, s[4:7], s26 offen offset:2048 sc1
buffer_load_dwordx4 v[20:23], v9, s[4:7], s26 offen offset:0 sc1
buffer_load_dwordx4 v[24:27], v9, s[4:7], s26 offen offset:1024 sc1
buffer_load_dwordx4 v[28:31], v9, s[4:7], s26 offen offset:3072 sc1
buffer_load_dwordx4 v[32:35], v9, s[4:7], s27 offen offset:2048 sc1
s_sub_u32 s38, s38, 1
s_cmp_gt_i32 s38, 0
s_cbranch_scc0 END_198
v_mov_b32 v76, 0
v_mov_b32 v77, 0
v_mov_b32 v78, 0
v_mov_b32 v79, 0
v_mov_b32 v80, 0
v_mov_b32 v81, 0
v_mov_b32 v82, 0
v_mov_b32 v83, 0
v_mov_b32 v84, 0
v_mov_b32 v85, 0
v_mov_b32 v86, 0
v_mov_b32 v87, 0
s_waitcnt vmcnt(0)
v_cmp_eq_u32 vcc, -1, v16
s_cbranch_vccnz RT_201
v_smfmac_f32_16x16x64_bf16 v[76:79], v[16:19], a[0:7], v8
v_smfmac_f32_16x16x64_bf16 v[80:83], v[16:19], a[56:63], v8
v_smfmac_f32_16x16x64_bf16 v[84:87], v[16:19], a[112:119], v8
s_branch BK_202
FAIL_199:
s_mov_b64 s[50:51], 0
FAIL_199b:
buffer_load_dwordx4 v[16:19], v9, s[4:7], s26 offen offset:2048 sc1
buffer_load_dwordx4 v[20:23], v9, s[4:7], s26 offen offset:0 sc1
buffer_load_dwordx4 v[24:27], v9, s[4:7], s26 offen offset:1024 sc1
buffer_load_dwordx4 v[28:31], v9, s[4:7], s26 offen offset:3072 sc1
buffer_load_dwordx4 v[32:35], v9, s[4:7], s27 offen offset:2048 sc1
buffer_load_dwordx4 v[36:39], v9, s[4:7], s27 offen offset:0 sc1
buffer_load_dwordx4 v[40:43], v9, s[4:7], s27 offen offset:1024 sc1
s_sub_u32 s38, s38, 1
s_cmp_gt_i32 s38, 0
s_cbranch_scc0 END_198
v_mov_b32 v76, 0
v_mov_b32 v77, 0
v_mov_b32 v78, 0
v_mov_b32 v79, 0
v_mov_b32 v80, 0
v_mov_b32 v81, 0
v_mov_b32 v82, 0
v_mov_b32 v83, 0
v_mov_b32 v84, 0
v_mov_b32 v85, 0
v_mov_b32 v86, 0
v_mov_b32 v87, 0
v_mov_b32 v88, 0
v_mov_b32 v89, 0
v_mov_b32 v90, 0
v_mov_b32 v91, 0
v_mov_b32 v92, 0
v_mov_b32 v93, 0
v_mov_b32 v94, 0
v_mov_b32 v95, 0
v_mov_b32 v96, 0
v_mov_b32 v97, 0
v_mov_b32 v98, 0
v_mov_b32 v99, 0
v_mov_b32 v100, 0
v_mov_b32 v101, 0
v_mov_b32 v102, 0
v_mov_b32 v103, 0
v_mov_b32 v104, 0
v_mov_b32 v105, 0
v_mov_b32 v106, 0
v_mov_b32 v107, 0
ds_read_b128 v[44:47], v14 offset:0
ds_read_b128 v[48:51], v14 offset:1024
ds_read_b128 v[60:63], v14 offset:14336
ds_read_b128 v[64:67], v14 offset:15360
ds_read_b128 v[52:55], v14 offset:2048
ds_read_b128 v[56:59], v14 offset:3072
ds_read_b128 v[68:71], v14 offset:16384
ds_read_b128 v[72:75], v14 offset:17408
s_waitcnt vmcnt(0)
v_max3_u32 v3, v16, v17, v18
v_max3_u32 v3, v3, v19, v20
v_max3_u32 v3, v3, v21, v22
v_max3_u32 v3, v3, v23, v24
v_max3_u32 v3, v3, v25, v26
v_max3_u32 v3, v3, v27, v28
v_max3_u32 v3, v3, v29, v30
v_max3_u32 v3, v3, v31, v32
v_max3_u32 v3, v3, v33, v34
v_max3_u32 v3, v3, v35, v36
v_max3_u32 v3, v3, v37, v38
v_max3_u32 v3, v3, v39, v40
v_max3_u32 v3, v3, v41, v42
v_max_u32 v3, v3, v43
v_cmp_eq_u32 vcc, -1, v3
s_cbranch_vccnz FAIL_199b
s_waitcnt lgkmcnt(4)
v_smfmac_f32_16x16x64_bf16 v[76:79], v[16:19], a[0:7], v8
v_smfmac_f32_16x16x64_bf16 v[80:83], v[16:19], a[56:63], v8
v_smfmac_f32_16x16x64_bf16 v[84:87], v[16:19], a[112:119], v8
v_smfmac_f32_16x16x64_bf16 v[88:91], v[16:19], a[168:175], v8
v_smfmac_f32_16x16x64_bf16 v[92:95], v[16:19], v[44:51], v8
v_smfmac_f32_16x16x64_bf16 v[96:99], v[16:19], v[60:67], v8
ds_read_b128 v[44:47], v14 offset:4096
ds_read_b128 v[48:51], v14 offset:5120
ds_read_b128 v[60:63], v14 offset:18432
ds_read_b128 v[64:67], v14 offset:19456
s_waitcnt lgkmcnt(4)
v_smfmac_f32_16x16x64_bf16 v[76:79], v[20:23], a[8:15], v8
v_smfmac_f32_16x16x64_bf16 v[80:83], v[20:23], a[64:71], v8
v_smfmac_f32_16x16x64_bf16 v[84:87], v[20:23], a[120:127], v8
v_smfmac_f32_16x16x64_bf16 v[88:91], v[20:23], a[176:183], v8
v_smfmac_f32_16x16x64_bf16 v[92:95], v[20:23], v[52:59], v8
v_smfmac_f32_16x16x64_bf16 v[96:99], v[20:23], v[68:75], v8
ds_read_b128 v[52:55], v14 offset:6144
ds_read_b128 v[56:59], v14 offset:7168
ds_read_b128 v[68:71], v14 offset:20480
ds_read_b128 v[72:75], v14 offset:21504
s_waitcnt lgkmcnt(4)
v_smfmac_f32_16x16x64_bf16 v[76:79], v[24:27], a[16:23], v8
v_smfmac_f32_16x16x64_bf16 v[80:83], v[24:27], a[72:79], v8
v_smfmac_f32_16x16x64_bf16 v[84:87], v[24:27], a[128:135], v8
v_smfmac_f32_16x16x64_bf16 v[88:91], v[24:27], a[184:191], v8
v_smfmac_f32_16x16x64_bf16 v[92:95], v[24:27], v[44:51], v8
v_smfmac_f32_16x16x64_bf16 v[96:99], v[24:27], v[60:67], v8
ds_read_b128 v[44:47], v14 offset:8192
ds_read_b128 v[48:51], v14 offset:9216
ds_read_b128 v[60:63], v14 offset:22528
ds_read_b128 v[64:67], v14 offset:23552
s_waitcnt lgkmcnt(4)
v_smfmac_f32_16x16x64_bf16 v[76:79], v[28:31], a[24:31], v8
v_smfmac_f32_16x16x64_bf16 v[80:83], v[28:31], a[80:87], v8
v_smfmac_f32_16x16x64_bf16 v[84:87], v[28:31], a[136:143], v8
v_smfmac_f32_16x16x64_bf16 v[88:91], v[28:31], a[192:199], v8
v_smfmac_f32_16x16x64_bf16 v[92:95], v[28:31], v[52:59], v8
v_smfmac_f32_16x16x64_bf16 v[96:99], v[28:31], v[68:75], v8
ds_read_b128 v[52:55], v14 offset:10240
ds_read_b128 v[56:59], v14 offset:11264
ds_read_b128 v[68:71], v14 offset:24576
ds_read_b128 v[72:75], v14 offset:25600
s_waitcnt lgkmcnt(4)
v_smfmac_f32_16x16x64_bf16 v[76:79], v[32:35], a[32:39], v8
v_smfmac_f32_16x16x64_bf16 v[80:83], v[32:35], a[88:95], v8
v_smfmac_f32_16x16x64_bf16 v[84:87], v[32:35], a[144:151], v8
v_smfmac_f32_16x16x64_bf16 v[88:91], v[32:35], a[200:207], v8
v_smfmac_f32_16x16x64_bf16 v[92:95], v[32:35], v[44:51], v8
v_smfmac_f32_16x16x64_bf16 v[96:99], v[32:35], v[60:67], v8
ds_read_b128 v[44:47], v14 offset:12288
ds_read_b128 v[48:51], v14 offset:13312
ds_read_b128 v[60:63], v14 offset:26624
ds_read_b128 v[64:67], v14 offset:27648
s_waitcnt lgkmcnt(4)
v_smfmac_f32_16x16x64_bf16 v[76:79], v[36:39], a[40:47], v8
v_smfmac_f32_16x16x64_bf16 v[80:83], v[36:39], a[96:103], v8
v_smfmac_f32_16x16x64_bf16 v[84:87], v[36:39], a[152:159], v8
v_smfmac_f32_16x16x64_bf16 v[88:91], v[36:39], a[208:215], v8
v_smfmac_f32_16x16x64_bf16 v[92:95], v[36:39], v[52:59], v8
v_smfmac_f32_16x16x64_bf16 v[96:99], v[36:39], v[68:75], v8
s_waitcnt lgkmcnt(0)
v_smfmac_f32_16x16x64_bf16 v[76:79], v[40:43], a[48:55], v8
v_smfmac_f32_16x16x64_bf16 v[80:83], v[40:43], a[104:111], v8
v_smfmac_f32_16x16x64_bf16 v[84:87], v[40:43], a[160:167], v8
v_smfmac_f32_16x16x64_bf16 v[88:91], v[40:43], a[216:223], v8
v_smfmac_f32_16x16x64_bf16 v[92:95], v[40:43], v[44:51], v8
v_smfmac_f32_16x16x64_bf16 v[96:99], v[40:43], v[60:67], v8
s_nop 7
s_branch JOIN_200
VO3:
v_and_b32 v0, 63, v0
v_lshrrev_b32 v1, 4, v0
v_and_b32 v2, 15, v0
v_lshlrev_b32 v9, 4, v0
v_add_u32 v14, 114688, v9
v_bfe_u32 v3, v2, 1, 1
v_lshrrev_b32 v4, 2, v2
v_lshlrev_b32 v4, 1, v4
v_and_b32 v5, 1, v2
v_add_u32 v4, v4, v5
v_mul_u32_u24 v8, 0xaaaa, v3
v_add_u32 v8, 0x4444, v8
v_mov_b32 v13, -1
s_mov_b32 s43, 71303168
v_add_u32 v116, 143360, v9
s_mov_b32 s10, 0
s_mov_b32 s38, 200000
s_mov_b32 s68, 0
s_mov_b32 s69, 0
s_mov_b32 s70, 0
s_mov_b32 s71, 0
s_waitcnt vmcnt(0) lgkmcnt(0)
s_barrier
s_mov_b32 s34, 71343104
v_min_u32 v3, 27, v0
v_lshlrev_b32 v3, 14, v3
s_mul_i32 s34, s11, 458752
s_add_u32 s34, s34, 7340032
buffer_load_dword v4, v3, s[4:7], s34 offen sc1
s_waitcnt vmcnt(0)
v_min_u32 v3, 13, v2
v_lshlrev_b32 v3, 2, v3
v_lshl_add_u32 v3, v1, 8, v3
v_add_u32 v3, 20608, v3
s_mov_b32 s41, 71319552
s_mov_b64 vcc, -1
s_mul_i32 s34, s11, 458752
s_and_b32 s36, vcc_lo, 4294967295
s_cbranch_scc0 RD_206
RL_205:
buffer_load_dword v4, v3, s[4:7], s41 offen sc1
s_sub_u32 s38, s38, 1
s_cmp_gt_i32 s38, 0
s_cbranch_scc0 RD_206
s_waitcnt vmcnt(0)
v_cmp_ne_u32 vcc, 1, v4
s_nop 0
s_and_b32 s36, vcc_lo, 4294967295
s_cbranch_scc0 RD_206
s_sleep 2
s_branch RL_205
RD_206:
s_and_b32 s36, vcc_hi, 4294967295
s_cbranch_scc0 RD_208
RL_207:
buffer_load_dword v4, v3, s[4:7], s41 offen sc1
s_sub_u32 s38, s38, 1
s_cmp_gt_i32 s38, 0
s_cbranch_scc0 RD_208
s_waitcnt vmcnt(0)
v_cmp_ne_u32 vcc, 1, v4
s_nop 0
s_and_b32 s36, vcc_hi, 4294967295
s_cbranch_scc0 RD_208
s_sleep 2
s_branch RL_207
RD_208:
s_add_u32 s35, s34, 7686144
buffer_load_dwordx4 a[0:3], v9, s[4:7], s35 offen sc1
buffer_load_dwordx4 a[4:7], v9, s[4:7], s35 offen offset:1024 sc1
s_add_u32 s35, s34, 7684096
buffer_load_dwordx4 a[8:11], v9, s[4:7], s35 offen sc1
buffer_load_dwordx4 a[12:15], v9, s[4:7], s35 offen offset:1024 sc1
s_add_u32 s35, s34, 7688192
buffer_load_dwordx4 a[16:19], v9, s[4:7], s35 offen sc1
buffer_load_dwordx4 a[20:23], v9, s[4:7], s35 offen offset:1024 sc1
s_add_u32 s35, s34, 7690240
buffer_load_dwordx4 a[24:27], v9, s[4:7], s35 offen sc1
buffer_load_dwordx4 a[28:31], v9, s[4:7], s35 offen offset:1024 sc1
s_add_u32 s35, s34, 7692288
buffer_load_dwordx4 a[32:35], v9, s[4:7], s35 offen sc1
buffer_load_dwordx4 a[36:39], v9, s[4:7], s35 offen offset:1024 sc1
s_add_u32 s35, s34, 7696384
buffer_load_dwordx4 a[40:43], v9, s[4:7], s35 offen sc1
buffer_load_dwordx4 a[44:47], v9, s[4:7], s35 offen offset:1024 sc1
s_add_u32 s35, s34, 7694336
buffer_load_dwordx4 a[48:51], v9, s[4:7], s35 offen sc1
buffer_load_dwordx4 a[52:55], v9, s[4:7], s35 offen offset:1024 sc1
s_add_u32 s35, s34, 7700480
s_mov_b32 m0, 114688
s_nop 0
buffer_load_dwordx4 v9, s[4:7], s35 offen sc1 lds
buffer_load_dwordx4 v9, s[4:7], s35 offen offset:1024 sc1 lds
s_add_u32 s35, s34, 7698432
s_mov_b32 m0, 116736
s_nop 0
buffer_load_dwordx4 v9, s[4:7], s35 offen sc1 lds
buffer_load_dwordx4 v9, s[4:7], s35 offen offset:1024 sc1 lds
s_add_u32 s35, s34, 7702528
s_mov_b32 m0, 118784
s_nop 0
buffer_load_dwordx4 v9, s[4:7], s35 offen sc1 lds
buffer_load_dwordx4 v9, s[4:7], s35 offen offset:1024 sc1 lds
s_add_u32 s35, s34, 7704576
s_mov_b32 m0, 120832
s_nop 0
buffer_load_dwordx4 v9, s[4:7], s35 offen sc1 lds
buffer_load_dwordx4 v9, s[4:7], s35 offen offset:1024 sc1 lds
s_add_u32 s35, s34, 7706624
s_mov_b32 m0, 122880
s_nop 0
buffer_load_dwordx4 v9, s[4:7], s35 offen sc1 lds
buffer_load_dwordx4 v9, s[4:7], s35 offen offset:1024 sc1 lds
s_add_u32 s35, s34, 7710720
s_mov_b32 m0, 124928
s_nop 0
buffer_load_dwordx4 v9, s[4:7], s35 offen sc1 lds
buffer_load_dwordx4 v9, s[4:7], s35 offen offset:1024 sc1 lds
s_add_u32 s35, s34, 7708672
s_mov_b32 m0, 126976
s_nop 0
buffer_load_dwordx4 v9, s[4:7], s35 offen sc1 lds
buffer_load_dwordx4 v9, s[4:7], s35 offen offset:1024 sc1 lds
s_add_u32 s35, s34, 7714816
buffer_load_dwordx4 a[56:59], v9, s[4:7], s35 offen sc1
buffer_load_dwordx4 a[60:63], v9, s[4:7], s35 offen offset:1024 sc1
s_add_u32 s35, s34, 7712768
buffer_load_dwordx4 a[64:67], v9, s[4:7], s35 offen sc1
buffer_load_dwordx4 a[68:71], v9, s[4:7], s35 offen offset:1024 sc1
s_add_u32 s35, s34, 7716864
buffer_load_dwordx4 a[72:75], v9, s[4:7], s35 offen sc1
buffer_load_dwordx4 a[76:79], v9, s[4:7], s35 offen offset:1024 sc1
s_add_u32 s35, s34, 7718912
buffer_load_dwordx4 a[80:83], v9, s[4:7], s35 offen sc1
buffer_load_dwordx4 a[84:87], v9, s[4:7], s35 offen offset:1024 sc1
s_add_u32 s35, s34, 7720960
buffer_load_dwordx4 a[88:91], v9, s[4:7], s35 offen sc1
buffer_load_dwordx4 a[92:95], v9, s[4:7], s35 offen offset:1024 sc1
s_add_u32 s35, s34, 7725056
buffer_load_dwordx4 a[96:99], v9, s[4:7], s35 offen sc1
buffer_load_dwordx4 a[100:103], v9, s[4:7], s35 offen offset:1024 sc1
s_add_u32 s35, s34, 7723008
buffer_load_dwordx4 a[104:107], v9, s[4:7], s35 offen sc1
buffer_load_dwordx4 a[108:111], v9, s[4:7], s35 offen offset:1024 sc1
s_add_u32 s35, s34, 7729152
s_mov_b32 m0, 129024
s_nop 0
buffer_load_dwordx4 v9, s[4:7], s35 offen sc1 lds
buffer_load_dwordx4 v9, s[4:7], s35 offen offset:1024 sc1 lds
s_add_u32 s35, s34, 7727104
s_mov_b32 m0, 131072
s_nop 0
buffer_load_dwordx4 v9, s[4:7], s35 offen sc1 lds
buffer_load_dwordx4 v9, s[4:7], s35 offen offset:1024 sc1 lds
s_add_u32 s35, s34, 7731200
s_mov_b32 m0, 133120
s_nop 0
buffer_load_dwordx4 v9, s[4:7], s35 offen sc1 lds
buffer_load_dwordx4 v9, s[4:7], s35 offen offset:1024 sc1 lds
s_add_u32 s35, s34, 7733248
s_mov_b32 m0, 135168
s_nop 0
buffer_load_dwordx4 v9, s[4:7], s35 offen sc1 lds
buffer_load_dwordx4 v9, s[4:7], s35 offen offset:1024 sc1 lds
s_add_u32 s35, s34, 7735296
s_mov_b32 m0, 137216
s_nop 0
buffer_load_dwordx4 v9, s[4:7], s35 offen sc1 lds
buffer_load_dwordx4 v9, s[4:7], s35 offen offset:1024 sc1 lds
s_add_u32 s35, s34, 7739392
s_mov_b32 m0, 139264
s_nop 0
buffer_load_dwordx4 v9, s[4:7], s35 offen sc1 lds
buffer_load_dwordx4 v9, s[4:7], s35 offen offset:1024 sc1 lds
s_add_u32 s35, s34, 7737344
s_mov_b32 m0, 141312
s_nop 0
buffer_load_dwordx4 v9, s[4:7], s35 offen sc1 lds
buffer_load_dwordx4 v9, s[4:7], s35 offen offset:1024 sc1 lds
s_add_u32 s35, s34, 7743488
buffer_load_dwordx4 a[112:115], v9, s[4:7], s35 offen sc1
buffer_load_dwordx4 a[116:119], v9, s[4:7], s35 offen offset:1024 sc1
s_add_u32 s35, s34, 7741440
buffer_load_dwordx4 a[120:123], v9, s[4:7], s35 offen sc1
buffer_load_dwordx4 a[124:127], v9, s[4:7], s35 offen offset:1024 sc1
s_waitcnt vmcnt(40)
s_add_u32 s35, s34, 7745536
buffer_load_dwordx4 a[128:131], v9, s[4:7], s35 offen sc1
buffer_load_dwordx4 a[132:135], v9, s[4:7], s35 offen offset:1024 sc1
s_add_u32 s35, s34, 7747584
buffer_load_dwordx4 a[136:139], v9, s[4:7], s35 offen sc1
buffer_load_dwordx4 a[140:143], v9, s[4:7], s35 offen offset:1024 sc1
s_add_u32 s35, s34, 7749632
buffer_load_dwordx4 a[144:147], v9, s[4:7], s35 offen sc1
buffer_load_dwordx4 a[148:151], v9, s[4:7], s35 offen offset:1024 sc1
s_add_u32 s35, s34, 7753728
buffer_load_dwordx4 a[152:155], v9, s[4:7], s35 offen sc1
buffer_load_dwordx4 a[156:159], v9, s[4:7], s35 offen offset:1024 sc1
s_add_u32 s35, s34, 7751680
buffer_load_dwordx4 a[160:163], v9, s[4:7], s35 offen sc1
buffer_load_dwordx4 a[164:167], v9, s[4:7], s35 offen offset:1024 sc1
s_add_u32 s35, s34, 7757824
buffer_load_dwordx4 a[224:227], v9, s[4:7], s35 offen sc1
buffer_load_dwordx4 a[228:231], v9, s[4:7], s35 offen offset:1024 sc1
s_add_u32 s35, s34, 7755776
buffer_load_dwordx4 a[232:235], v9, s[4:7], s35 offen sc1
buffer_load_dwordx4 a[236:239], v9, s[4:7], s35 offen offset:1024 sc1
s_add_u32 s35, s34, 7759872
buffer_load_dwordx4 a[240:243], v9, s[4:7], s35 offen sc1
buffer_load_dwordx4 a[244:247], v9, s[4:7], s35 offen offset:1024 sc1
s_add_u32 s35, s34, 7761920
buffer_load_dwordx4 a[248:251], v9, s[4:7], s35 offen sc1
buffer_load_dwordx4 a[252:255], v9, s[4:7], s35 offen offset:1024 sc1
s_add_u32 s35, s34, 7763968
buffer_load_dwordx4 v[120:123], v9, s[4:7], s35 offen sc1
buffer_load_dwordx4 v[124:127], v9, s[4:7], s35 offen offset:1024 sc1
s_waitcnt vmcnt(40)
s_add_u32 s35, s34, 7768064
buffer_load_dwordx4 v[128:131], v9, s[4:7], s35 offen sc1
buffer_load_dwordx4 v[132:135], v9, s[4:7], s35 offen offset:1024 sc1
s_add_u32 s35, s34, 7766016
buffer_load_dwordx4 v[136:139], v9, s[4:7], s35 offen sc1
buffer_load_dwordx4 v[140:143], v9, s[4:7], s35 offen offset:1024 sc1
s_add_u32 s35, s34, 7772160
buffer_load_dwordx4 a[168:171], v9, s[4:7], s35 offen sc1
buffer_load_dwordx4 a[172:175], v9, s[4:7], s35 offen offset:1024 sc1
s_add_u32 s35, s34, 7770112
buffer_load_dwordx4 a[176:179], v9, s[4:7], s35 offen sc1
buffer_load_dwordx4 a[180:183], v9, s[4:7], s35 offen offset:1024 sc1
s_add_u32 s35, s34, 7774208
buffer_load_dwordx4 a[184:187], v9, s[4:7], s35 offen sc1
buffer_load_dwordx4 a[188:191], v9, s[4:7], s35 offen offset:1024 sc1
s_add_u32 s35, s34, 7776256
buffer_load_dwordx4 a[192:195], v9, s[4:7], s35 offen sc1
buffer_load_dwordx4 a[196:199], v9, s[4:7], s35 offen offset:1024 sc1
s_add_u32 s35, s34, 7778304
buffer_load_dwordx4 a[200:203], v9, s[4:7], s35 offen sc1
buffer_load_dwordx4 a[204:207], v9, s[4:7], s35 offen offset:1024 sc1
s_add_u32 s35, s34, 7782400
buffer_load_dwordx4 a[208:211], v9, s[4:7], s35 offen sc1
buffer_load_dwordx4 a[212:215], v9, s[4:7], s35 offen offset:1024 sc1
s_add_u32 s35, s34, 7780352
buffer_load_dwordx4 a[216:219], v9, s[4:7], s35 offen sc1
buffer_load_dwordx4 a[220:223], v9, s[4:7], s35 offen offset:1024 sc1
s_add_u32 s35, s34, 7786496
buffer_load_dwordx4 v[144:147], v9, s[4:7], s35 offen sc1
buffer_load_dwordx4 v[148:151], v9, s[4:7], s35 offen offset:1024 sc1
s_waitcnt vmcnt(40)
s_add_u32 s35, s34, 7784448
buffer_load_dwordx4 v[152:155], v9, s[4:7], s35 offen sc1
buffer_load_dwordx4 v[156:159], v9, s[4:7], s35 offen offset:1024 sc1
s_add_u32 s35, s34, 7788544
buffer_load_dwordx4 v[160:163], v9, s[4:7], s35 offen sc1
buffer_load_dwordx4 v[164:167], v9, s[4:7], s35 offen offset:1024 sc1
s_add_u32 s35, s34, 7790592
buffer_load_dwordx4 v[168:171], v9, s[4:7], s35 offen sc1
buffer_load_dwordx4 v[172:175], v9, s[4:7], s35 offen offset:1024 sc1
s_add_u32 s35, s34, 7792640
buffer_load_dwordx4 v[176:179], v9, s[4:7], s35 offen sc1
buffer_load_dwordx4 v[180:183], v9, s[4:7], s35 offen offset:1024 sc1
s_add_u32 s35, s34, 7796736
buffer_load_dwordx4 v[184:187], v9, s[4:7], s35 offen sc1
buffer_load_dwordx4 v[188:191], v9, s[4:7], s35 offen offset:1024 sc1
s_add_u32 s35, s34, 7794688
buffer_load_dwordx4 v[192:195], v9, s[4:7], s35 offen sc1
buffer_load_dwordx4 v[196:199], v9, s[4:7], s35 offen offset:1024 sc1
s_mov_b32 s34, 71343104
s_barrier
v_mov_b32 v3, 151552
ds_read_b32 v4, v3
s_waitcnt lgkmcnt(0)
v_readfirstlane_b32 s66, v4
s_waitcnt vmcnt(0)
v_mov_b32 v76, 0
v_mov_b32 v77, 0
v_mov_b32 v78, 0
v_mov_b32 v79, 0
v_mov_b32 v80, 0
v_mov_b32 v81, 0
v_mov_b32 v82, 0
v_mov_b32 v83, 0
v_mov_b32 v84, 0
v_mov_b32 v85, 0
v_mov_b32 v86, 0
v_mov_b32 v87, 0
v_mov_b32 v88, 0
v_mov_b32 v89, 0
v_mov_b32 v90, 0
v_mov_b32 v91, 0
v_mov_b32 v92, 0
v_mov_b32 v93, 0
v_mov_b32 v94, 0
v_mov_b32 v95, 0
v_mov_b32 v96, 0
v_mov_b32 v97, 0
v_mov_b32 v98, 0
v_mov_b32 v99, 0
v_mov_b32 v100, 0
v_mov_b32 v101, 0
v_mov_b32 v102, 0
v_mov_b32 v103, 0
v_mov_b32 v104, 0
v_mov_b32 v105, 0
v_mov_b32 v106, 0
v_mov_b32 v107, 0
s_lshl_b32 s26, s10, 13
s_add_u32 s26, s26, 54525952
s_add_u32 s27, s26, 4096
LOOP_211:
s_barrier
buffer_load_dwordx4 v[16:19], v9, s[4:7], s26 offen offset:1024 sc1
ds_read_b128 v[44:47], v14 offset:0
ds_read_b128 v[48:51], v14 offset:1024
ds_read_b128 v[60:63], v14 offset:14336
ds_read_b128 v[64:67], v14 offset:15360
ds_read_b128 v[52:55], v14 offset:2048
s_barrier
buffer_load_dwordx4 v[20:23], v9, s[4:7], s26 offen offset:0
ds_read_b128 v[56:59], v14 offset:3072
ds_read_b128 v[68:71], v14 offset:16384
ds_read_b128 v[72:75], v14 offset:17408
s_add_u32 s39, s10, 1
s_mov_b64 s[50:51], -1
s_barrier
buffer_load_dwordx4 v[24:27], v9, s[4:7], s26 offen offset:2048
v_mov_b32 v10, s39
s_and_b32 s34, s10, 3
s_lshl_b32 s28, s34, 14
s_barrier
buffer_load_dwordx4 v[28:31], v9, s[4:7], s26 offen offset:3072
s_waitcnt vmcnt(3)
v_smfmac_f32_16x16x64_bf16 v[76:79], v[16:19], a[0:7], v8
buffer_load_dwordx4 v[32:35], v9, s[4:7], s27 offen offset:0
v_cmp_eq_u32 vcc, -1, v16
v_smfmac_f32_16x16x64_bf16 v[80:83], v[16:19], a[56:63], v8
v_smfmac_f32_16x16x64_bf16 v[84:87], v[16:19], a[112:119], v8
s_cbranch_vccnz RT_215
BK_216:
v_smfmac_f32_16x16x64_bf16 v[88:91], v[16:19], a[168:175], v8
buffer_load_dwordx4 v[36:39], v9, s[4:7], s27 offen offset:2048
s_waitcnt lgkmcnt(6)
v_smfmac_f32_16x16x64_bf16 v[92:95], v[16:19], v[44:51], v8
s_waitcnt lgkmcnt(4)
v_smfmac_f32_16x16x64_bf16 v[96:99], v[16:19], v[60:67], v8
s_waitcnt vmcnt(4)
v_smfmac_f32_16x16x64_bf16 v[76:79], v[20:23], a[8:15], v8
buffer_load_dwordx4 v[40:43], v9, s[4:7], s27 offen offset:1024
v_smfmac_f32_16x16x64_bf16 v[80:83], v[20:23], a[64:71], v8
ds_read_b128 v[44:47], v14 offset:4096
v_smfmac_f32_16x16x64_bf16 v[84:87], v[20:23], a[120:127], v8
ds_read_b128 v[48:51], v14 offset:5120
v_smfmac_f32_16x16x64_bf16 v[88:91], v[20:23], a[176:183], v8
ds_read_b128 v[60:63], v14 offset:18432
s_waitcnt lgkmcnt(5)
v_smfmac_f32_16x16x64_bf16 v[92:95], v[20:23], v[52:59], v8
ds_read_b128 v[64:67], v14 offset:19456
s_waitcnt lgkmcnt(4)
v_smfmac_f32_16x16x64_bf16 v[96:99], v[20:23], v[68:75], v8
s_waitcnt vmcnt(4)
v_smfmac_f32_16x16x64_bf16 v[76:79], v[24:27], a[16:23], v8
ds_read_b128 v[52:55], v14 offset:6144
v_smfmac_f32_16x16x64_bf16 v[80:83], v[24:27], a[72:79], v8
ds_read_b128 v[56:59], v14 offset:7168
v_smfmac_f32_16x16x64_bf16 v[84:87], v[24:27], a[128:135], v8
ds_read_b128 v[68:71], v14 offset:20480
v_smfmac_f32_16x16x64_bf16 v[88:91], v[24:27], a[184:191], v8
ds_read_b128 v[72:75], v14 offset:21504
s_waitcnt lgkmcnt(6)
v_smfmac_f32_16x16x64_bf16 v[92:95], v[24:27], v[44:51], v8
s_waitcnt lgkmcnt(4)
v_smfmac_f32_16x16x64_bf16 v[96:99], v[24:27], v[60:67], v8
s_waitcnt vmcnt(3)
v_smfmac_f32_16x16x64_bf16 v[76:79], v[28:31], a[24:31], v8
ds_read_b128 v[44:47], v14 offset:8192
v_smfmac_f32_16x16x64_bf16 v[80:83], v[28:31], a[80:87], v8
ds_read_b128 v[48:51], v14 offset:9216
v_smfmac_f32_16x16x64_bf16 v[84:87], v[28:31], a[136:143], v8
ds_read_b128 v[60:63], v14 offset:22528
v_smfmac_f32_16x16x64_bf16 v[88:91], v[28:31], a[192:199], v8
ds_read_b128 v[64:67], v14 offset:23552
s_waitcnt lgkmcnt(6)
v_smfmac_f32_16x16x64_bf16 v[92:95], v[28:31], v[52:59], v8
s_waitcnt lgkmcnt(4)
v_smfmac_f32_16x16x64_bf16 v[96:99], v[28:31], v[68:75], v8
s_waitcnt vmcnt(2)
v_smfmac_f32_16x16x64_bf16 v[76:79], v[32:35], a[32:39], v8
ds_read_b128 v[52:55], v14 offset:10240
v_smfmac_f32_16x16x64_bf16 v[80:83], v[32:35], a[88:95], v8
ds_read_b128 v[56:59], v14 offset:11264
v_smfmac_f32_16x16x64_bf16 v[84:87], v[32:35], a[144:151], v8
ds_read_b128 v[68:71], v14 offset:24576
v_smfmac_f32_16x16x64_bf16 v[88:91], v[32:35], a[200:207], v8
ds_read_b128 v[72:75], v14 offset:25600
s_waitcnt lgkmcnt(6)
v_smfmac_f32_16x16x64_bf16 v[92:95], v[32:35], v[44:51], v8
s_waitcnt lgkmcnt(4)
v_smfmac_f32_16x16x64_bf16 v[96:99], v[32:35], v[60:67], v8
s_waitcnt vmcnt(1)
v_smfmac_f32_16x16x64_bf16 v[76:79], v[36:39], a[40:47], v8
ds_read_b128 v[44:47], v14 offset:12288
v_smfmac_f32_16x16x64_bf16 v[80:83], v[36:39], a[96:103], v8
ds_read_b128 v[48:51], v14 offset:13312
v_smfmac_f32_16x16x64_bf16 v[84:87], v[36:39], a[152:159], v8
ds_read_b128 v[60:63], v14 offset:26624
v_smfmac_f32_16x16x64_bf16 v[88:91], v[36:39], a[208:215], v8
ds_read_b128 v[64:67], v14 offset:27648
s_waitcnt lgkmcnt(6)
v_smfmac_f32_16x16x64_bf16 v[92:95], v[36:39], v[52:59], v8
s_waitcnt lgkmcnt(4)
v_smfmac_f32_16x16x64_bf16 v[96:99], v[36:39], v[68:75], v8
s_waitcnt vmcnt(0)
v_smfmac_f32_16x16x64_bf16 v[76:79], v[40:43], a[48:55], v8
v_smfmac_f32_16x16x64_bf16 v[80:83], v[40:43], a[104:111], v8
v_smfmac_f32_16x16x64_bf16 v[84:87], v[40:43], a[160:167], v8
v_smfmac_f32_16x16x64_bf16 v[88:91], v[40:43], a[216:223], v8
s_waitcnt lgkmcnt(2)
v_smfmac_f32_16x16x64_bf16 v[92:95], v[40:43], v[44:51], v8
s_waitcnt lgkmcnt(0)
v_smfmac_f32_16x16x64_bf16 v[96:99], v[40:43], v[60:67], v8
JOIN_214:
v_smfmac_f32_16x16x64_bf16 v[100:103], v[16:19], a[224:231], v8
v_add_f32 v76, v76, v78
v_smfmac_f32_16x16x64_bf16 v[100:103], v[20:23], a[232:239], v8
v_add_f32 v77, v77, v79
v_cmp_u_f32 vcc, v76, v77
v_smfmac_f32_16x16x64_bf16 v[100:103], v[24:27], a[240:247], v8
v_cvt_pk_bf16_f32 v108, v76, v77
v_smfmac_f32_16x16x64_bf16 v[100:103], v[28:31], a[248:255], v8
v_add_f32 v80, v80, v82
v_add_f32 v81, v81, v83
v_smfmac_f32_16x16x64_bf16 v[100:103], v[32:35], v[120:127], v8
s_and_b64 vcc, vcc, s[50:51]
s_cbranch_scc1 FAIL_213
v_cvt_pk_bf16_f32 v109, v80, v81
v_smfmac_f32_16x16x64_bf16 v[100:103], v[36:39], v[128:135], v8
v_add_f32 v84, v84, v86
v_add_f32 v85, v85, v87
v_smfmac_f32_16x16x64_bf16 v[100:103], v[40:43], v[136:143], v8
v_cvt_pk_bf16_f32 v110, v84, v85
v_smfmac_f32_16x16x64_bf16 v[104:107], v[16:19], v[144:151], v8
v_add_f32 v88, v88, v90
v_add_f32 v89, v89, v91
v_smfmac_f32_16x16x64_bf16 v[104:107], v[20:23], v[152:159], v8
v_cvt_pk_bf16_f32 v111, v88, v89
v_smfmac_f32_16x16x64_bf16 v[104:107], v[24:27], v[160:167], v8
v_add_f32 v92, v92, v94
v_add_f32 v93, v93, v95
v_smfmac_f32_16x16x64_bf16 v[104:107], v[28:31], v[168:175], v8
v_cvt_pk_bf16_f32 v112, v92, v93
v_smfmac_f32_16x16x64_bf16 v[104:107], v[32:35], v[176:183], v8
v_add_f32 v96, v96, v98
v_add_f32 v97, v97, v99
v_smfmac_f32_16x16x64_bf16 v[104:107], v[36:39], v[184:191], v8
v_cvt_pk_bf16_f32 v113, v96, v97
v_smfmac_f32_16x16x64_bf16 v[104:107], v[40:43], v[192:199], v8
v_add_f32 v100, v100, v102
v_add_f32 v101, v101, v103
v_cvt_pk_bf16_f32 v114, v100, v101
s_nop 4
v_add_f32 v104, v104, v106
v_add_f32 v105, v105, v107
v_cvt_pk_bf16_f32 v115, v104, v105
ds_write_b128 v116, v[108:111] offset:3072
ds_write_b128 v116, v[112:115] offset:7168
v_mov_b32 v5, 32256
buffer_load_dword v6, v5, s[4:7], s26 offen sc1
v_mov_b32 v76, 0
v_mov_b32 v77, 0
v_mov_b32 v78, 0
v_mov_b32 v79, 0
v_mov_b32 v80, 0
v_mov_b32 v81, 0
s_add_u32 s10, s10, 1
s_lshl_b32 s26, s10, 13
s_add_u32 s26, s26, 54525952
s_add_u32 s27, s26, 4096
s_waitcnt lgkmcnt(0)
v_mov_b32 v82, 0
v_mov_b32 v83, 0
v_mov_b32 v84, 0
v_mov_b32 v85, 0
v_mov_b32 v86, 0
v_mov_b32 v87, 0
v_mov_b32 v88, 0
v_mov_b32 v89, 0
v_mov_b32 v90, 0
v_mov_b32 v91, 0
v_mov_b32 v92, 0
v_mov_b32 v93, 0
v_mov_b32 v94, 0
v_mov_b32 v95, 0
v_mov_b32 v96, 0
v_mov_b32 v97, 0
v_mov_b32 v98, 0
v_mov_b32 v99, 0
v_mov_b32 v100, 0
v_mov_b32 v101, 0
v_mov_b32 v102, 0
v_mov_b32 v103, 0
v_mov_b32 v104, 0
v_mov_b32 v105, 0
v_mov_b32 v106, 0
v_mov_b32 v107, 0
s_barrier
s_cmp_ge_u32 s10, 63
s_cbranch_scc1 END_212
s_branch LOOP_211
END_212:
s_endpgm
RT_215:
buffer_load_dwordx4 v[16:19], v9, s[4:7], s26 offen offset:1024 sc1
buffer_load_dwordx4 v[20:23], v9, s[4:7], s26 offen offset:0 sc1
buffer_load_dwordx4 v[24:27], v9, s[4:7], s26 offen offset:2048 sc1
buffer_load_dwordx4 v[28:31], v9, s[4:7], s26 offen offset:3072 sc1
buffer_load_dwordx4 v[32:35], v9, s[4:7], s27 offen offset:0 sc1
s_sub_u32 s38, s38, 1
s_cmp_gt_i32 s38, 0
s_cbranch_scc0 END_212
v_mov_b32 v76, 0
v_mov_b32 v77, 0
v_mov_b32 v78, 0
v_mov_b32 v79, 0
v_mov_b32 v80, 0
v_mov_b32 v81, 0
v_mov_b32 v82, 0
v_mov_b32 v83, 0
v_mov_b32 v84, 0
v_mov_b32 v85, 0
v_mov_b32 v86, 0
v_mov_b32 v87, 0
s_waitcnt vmcnt(0)
v_cmp_eq_u32 vcc, -1, v16
s_cbranch_vccnz RT_215
v_smfmac_f32_16x16x64_bf16 v[76:79], v[16:19], a[0:7], v8
v_smfmac_f32_16x16x64_bf16 v[80:83], v[16:19], a[56:63], v8
v_smfmac_f32_16x16x64_bf16 v[84:87], v[16:19], a[112:119], v8
s_branch BK_216
FAIL_213:
s_mov_b64 s[50:51], 0
FAIL_213b:
buffer_load_dwordx4 v[16:19], v9, s[4:7], s26 offen offset:1024 sc1
buffer_load_dwordx4 v[20:23], v9, s[4:7], s26 offen offset:0 sc1
buffer_load_dwordx4 v[24:27], v9, s[4:7], s26 offen offset:2048 sc1
buffer_load_dwordx4 v[28:31], v9, s[4:7], s26 offen offset:3072 sc1
buffer_load_dwordx4 v[32:35], v9, s[4:7], s27 offen offset:0 sc1
buffer_load_dwordx4 v[36:39], v9, s[4:7], s27 offen offset:2048 sc1
buffer_load_dwordx4 v[40:43], v9, s[4:7], s27 offen offset:1024 sc1
s_sub_u32 s38, s38, 1
s_cmp_gt_i32 s38, 0
s_cbranch_scc0 END_212
v_mov_b32 v76, 0
v_mov_b32 v77, 0
v_mov_b32 v78, 0
v_mov_b32 v79, 0
v_mov_b32 v80, 0
v_mov_b32 v81, 0
v_mov_b32 v82, 0
v_mov_b32 v83, 0
v_mov_b32 v84, 0
v_mov_b32 v85, 0
v_mov_b32 v86, 0
v_mov_b32 v87, 0
v_mov_b32 v88, 0
v_mov_b32 v89, 0
v_mov_b32 v90, 0
v_mov_b32 v91, 0
v_mov_b32 v92, 0
v_mov_b32 v93, 0
v_mov_b32 v94, 0
v_mov_b32 v95, 0
v_mov_b32 v96, 0
v_mov_b32 v97, 0
v_mov_b32 v98, 0
v_mov_b32 v99, 0
v_mov_b32 v100, 0
v_mov_b32 v101, 0
v_mov_b32 v102, 0
v_mov_b32 v103, 0
v_mov_b32 v104, 0
v_mov_b32 v105, 0
v_mov_b32 v106, 0
v_mov_b32 v107, 0
ds_read_b128 v[44:47], v14 offset:0
ds_read_b128 v[48:51], v14 offset:1024
ds_read_b128 v[60:63], v14 offset:14336
ds_read_b128 v[64:67], v14 offset:15360
ds_read_b128 v[52:55], v14 offset:2048
ds_read_b128 v[56:59], v14 offset:3072
ds_read_b128 v[68:71], v14 offset:16384
ds_read_b128 v[72:75], v14 offset:17408
s_waitcnt vmcnt(0)
v_max3_u32 v3, v16, v17, v18
v_max3_u32 v3, v3, v19, v20
v_max3_u32 v3, v3, v21, v22
v_max3_u32 v3, v3, v23, v24
v_max3_u32 v3, v3, v25, v26
v_max3_u32 v3, v3, v27, v28
v_max3_u32 v3, v3, v29, v30
v_max3_u32 v3, v3, v31, v32
v_max3_u32 v3, v3, v33, v34
v_max3_u32 v3, v3, v35, v36
v_max3_u32 v3, v3, v37, v38
v_max3_u32 v3, v3, v39, v40
v_max3_u32 v3, v3, v41, v42
v_max_u32 v3, v3, v43
v_cmp_eq_u32 vcc, -1, v3
s_cbranch_vccnz FAIL_213b
s_waitcnt lgkmcnt(4)
v_smfmac_f32_16x16x64_bf16 v[76:79], v[16:19], a[0:7], v8
v_smfmac_f32_16x16x64_bf16 v[80:83], v[16:19], a[56:63], v8
v_smfmac_f32_16x16x64_bf16 v[84:87], v[16:19], a[112:119], v8
v_smfmac_f32_16x16x64_bf16 v[88:91], v[16:19], a[168:175], v8
v_smfmac_f32_16x16x64_bf16 v[92:95], v[16:19], v[44:51], v8
v_smfmac_f32_16x16x64_bf16 v[96:99], v[16:19], v[60:67], v8
ds_read_b128 v[44:47], v14 offset:4096
ds_read_b128 v[48:51], v14 offset:5120
ds_read_b128 v[60:63], v14 offset:18432
ds_read_b128 v[64:67], v14 offset:19456
s_waitcnt lgkmcnt(4)
v_smfmac_f32_16x16x64_bf16 v[76:79], v[20:23], a[8:15], v8
v_smfmac_f32_16x16x64_bf16 v[80:83], v[20:23], a[64:71], v8
v_smfmac_f32_16x16x64_bf16 v[84:87], v[20:23], a[120:127], v8
v_smfmac_f32_16x16x64_bf16 v[88:91], v[20:23], a[176:183], v8
v_smfmac_f32_16x16x64_bf16 v[92:95], v[20:23], v[52:59], v8
v_smfmac_f32_16x16x64_bf16 v[96:99], v[20:23], v[68:75], v8
ds_read_b128 v[52:55], v14 offset:6144
ds_read_b128 v[56:59], v14 offset:7168
ds_read_b128 v[68:71], v14 offset:20480
ds_read_b128 v[72:75], v14 offset:21504
s_waitcnt lgkmcnt(4)
v_smfmac_f32_16x16x64_bf16 v[76:79], v[24:27], a[16:23], v8
v_smfmac_f32_16x16x64_bf16 v[80:83], v[24:27], a[72:79], v8
v_smfmac_f32_16x16x64_bf16 v[84:87], v[24:27], a[128:135], v8
v_smfmac_f32_16x16x64_bf16 v[88:91], v[24:27], a[184:191], v8
v_smfmac_f32_16x16x64_bf16 v[92:95], v[24:27], v[44:51], v8
v_smfmac_f32_16x16x64_bf16 v[96:99], v[24:27], v[60:67], v8
ds_read_b128 v[44:47], v14 offset:8192
ds_read_b128 v[48:51], v14 offset:9216
ds_read_b128 v[60:63], v14 offset:22528
ds_read_b128 v[64:67], v14 offset:23552
s_waitcnt lgkmcnt(4)
v_smfmac_f32_16x16x64_bf16 v[76:79], v[28:31], a[24:31], v8
v_smfmac_f32_16x16x64_bf16 v[80:83], v[28:31], a[80:87], v8
v_smfmac_f32_16x16x64_bf16 v[84:87], v[28:31], a[136:143], v8
v_smfmac_f32_16x16x64_bf16 v[88:91], v[28:31], a[192:199], v8
v_smfmac_f32_16x16x64_bf16 v[92:95], v[28:31], v[52:59], v8
v_smfmac_f32_16x16x64_bf16 v[96:99], v[28:31], v[68:75], v8
ds_read_b128 v[52:55], v14 offset:10240
ds_read_b128 v[56:59], v14 offset:11264
ds_read_b128 v[68:71], v14 offset:24576
ds_read_b128 v[72:75], v14 offset:25600
s_waitcnt lgkmcnt(4)
v_smfmac_f32_16x16x64_bf16 v[76:79], v[32:35], a[32:39], v8
v_smfmac_f32_16x16x64_bf16 v[80:83], v[32:35], a[88:95], v8
v_smfmac_f32_16x16x64_bf16 v[84:87], v[32:35], a[144:151], v8
v_smfmac_f32_16x16x64_bf16 v[88:91], v[32:35], a[200:207], v8
v_smfmac_f32_16x16x64_bf16 v[92:95], v[32:35], v[44:51], v8
v_smfmac_f32_16x16x64_bf16 v[96:99], v[32:35], v[60:67], v8
ds_read_b128 v[44:47], v14 offset:12288
ds_read_b128 v[48:51], v14 offset:13312
ds_read_b128 v[60:63], v14 offset:26624
ds_read_b128 v[64:67], v14 offset:27648
s_waitcnt lgkmcnt(4)
v_smfmac_f32_16x16x64_bf16 v[76:79], v[36:39], a[40:47], v8
v_smfmac_f32_16x16x64_bf16 v[80:83], v[36:39], a[96:103], v8
v_smfmac_f32_16x16x64_bf16 v[84:87], v[36:39], a[152:159], v8
v_smfmac_f32_16x16x64_bf16 v[88:91], v[36:39], a[208:215], v8
v_smfmac_f32_16x16x64_bf16 v[92:95], v[36:39], v[52:59], v8
v_smfmac_f32_16x16x64_bf16 v[96:99], v[36:39], v[68:75], v8
s_waitcnt lgkmcnt(0)
v_smfmac_f32_16x16x64_bf16 v[76:79], v[40:43], a[48:55], v8
v_smfmac_f32_16x16x64_bf16 v[80:83], v[40:43], a[104:111], v8
v_smfmac_f32_16x16x64_bf16 v[84:87], v[40:43], a[160:167], v8
v_smfmac_f32_16x16x64_bf16 v[88:91], v[40:43], a[216:223], v8
v_smfmac_f32_16x16x64_bf16 v[92:95], v[40:43], v[44:51], v8
v_smfmac_f32_16x16x64_bf16 v[96:99], v[40:43], v[60:67], v8
s_nop 7
s_branch JOIN_214
EN0:
v_and_b32 v0, 63, v0
v_lshlrev_b32 v6, 4, v0
v_lshlrev_b32 v7, 7, v0
s_mov_b32 s43, 71303168
s_mov_b32 s10, 0
s_mov_b32 s38, 200000
s_mov_b32 s68, 0
s_mov_b32 s69, 0
s_mov_b32 s70, 0
s_mov_b32 s71, 0
s_and_b32 s35, s8, 3
s_mul_i32 s35, s35, 640
s_add_u32 s35, s35, 4224
v_min_u32 v8, 13, v0
v_lshlrev_b32 v8, 2, v8
v_add_u32 v8, s35, v8
s_mov_b32 s36, 14
v_mul_u32_u24 v9, 640, v0
s_lshl_b32 s35, s36, 2
s_add_u32 s35, s35, 4224
v_add_u32 v9, s35, v9
v_mov_b32 v5, 1073741824
v_cmp_gt_u32 vcc, 4, v0
s_nop 1
v_cndmask_b32 v9, v5, v9, vcc
v_lshlrev_b32 v28, 2, v0
v_mov_b32 v29, 1
s_mov_b32 s21, 71319552
s_mov_b32 s20, -1
s_waitcnt vmcnt(0) lgkmcnt(0)
s_barrier
s_mov_b32 s34, 71343104
v_lshlrev_b32 v1, 7, v0
s_lshl_b32 s35, s8, 2
v_add_u32 v1, s35, v1
v_mov_b32 v2, 1073741824
v_cmp_gt_u32 vcc, 4, v0
s_nop 1
v_cndmask_b32 v1, v2, v1, vcc
s_add_u32 s35, s66, 1
v_mov_b32 v2, s35
buffer_store_dword v2, v1, s[4:7], s34 offen sc1
v_and_b32 v1, 31, v0
v_lshlrev_b32 v1, 2, v1
s_and_b32 s35, s8, 3
s_lshl_b32 s35, s35, 7
s_add_u32 s34, s34, s35
TB_217:
buffer_load_dword v3, v1, s[4:7], s34 offen sc1
s_sub_u32 s38, s38, 1
s_cmp_gt_i32 s38, 0
s_cbranch_scc0 TBD_218
s_waitcnt vmcnt(0)
v_cmp_eq_u32 vcc, 0, v3
s_cbranch_vccz TBD_218
s_sleep 4
s_branch TB_217
TBD_218:
v_cmp_lt_u32 vcc, 1, v3
s_nop 0
s_or_b32 s66, vcc_lo, vcc_hi
v_mov_b32 v2, s66
v_mov_b32 v1, 151552
ds_write_b32 v1, v2
s_waitcnt lgkmcnt(0)
s_barrier
v_mov_b32 v1, 151552
ds_read_b32 v2, v1
s_waitcnt lgkmcnt(0)
v_readfirstlane_b32 s66, v2
v_mov_b32 v1, 0
s_cmp_eq_u32 s11, 14
s_cselect_b32 s36, 16, 4
YL_219:
buffer_load_dword v2, v1, s[4:7], s21 offen sc1
s_sub_u32 s38, s38, 1
s_cmp_gt_i32 s38, 0
s_cbranch_scc0 YD_220
s_waitcnt vmcnt(0)
v_cmp_gt_u32 vcc, s36, v2
s_cbranch_vccz YD_220
s_sleep 16
s_branch YL_219
YD_220:
s_mov_b32 s35, 50331648
buffer_load_dword v10, v7, s[4:7], s35 offen sc1
s_mov_b32 s35, 50364416
buffer_load_dword v10, v7, s[4:7], s35 offen sc1
s_mov_b32 s35, 50397184
buffer_load_dword v10, v7, s[4:7], s35 offen sc1
s_sub_u32 s36, 15, s11
s_lshl_b32 s36, s36, 15
s_add_u32 s35, s36, 54525952
buffer_load_dword v10, v7, s[4:7], s35 offen sc1
s_add_u32 s35, s36, 55312384
buffer_load_dword v10, v7, s[4:7], s35 offen sc1
v_mov_b32 v11, 0
s_cmp_lg_u32 s11, 14
s_cbranch_scc1 E1_224
LOOP_221:
s_lshl_b32 s26, s10, 13
s_add_u32 s32, s26, 56623104
s_add_u32 s26, s26, 54525952
AR_225:
buffer_load_dwordx4 v[12:15], v6, s[4:7], s26 offen offset:0 sc1
buffer_load_dwordx4 v[16:19], v6, s[4:7], s26 offen offset:1024 sc1
buffer_load_dwordx4 v[20:23], v6, s[4:7], s26 offen offset:2048 sc1
buffer_load_dwordx4 v[24:27], v6, s[4:7], s26 offen offset:3072 sc1
s_sub_u32 s38, s38, 1
s_cmp_gt_i32 s38, 0
s_cbranch_scc0 END_222
s_waitcnt vmcnt(0)
v_max_u32 v1, v12, v13
v_max3_u32 v1, v1, v14, v15
v_max3_u32 v1, v1, v16, v17
v_max3_u32 v1, v1, v18, v19
v_max3_u32 v1, v1, v20, v21
v_max3_u32 v1, v1, v22, v23
v_max3_u32 v1, v1, v24, v25
v_max3_u32 v1, v1, v26, v27
v_cmp_eq_u32 vcc, -1, v1
s_cbranch_vccnz AR_225
buffer_store_dwordx4 v[12:15], v6, s[4:7], s32 offen offset:0 sc1
buffer_store_dwordx4 v[16:19], v6, s[4:7], s32 offen offset:1024 sc1
buffer_store_dwordx4 v[20:23], v6, s[4:7], s32 offen offset:2048 sc1
buffer_store_dwordx4 v[24:27], v6, s[4:7], s32 offen offset:3072 sc1
s_cmp_gt_u32 s10, 6
s_cbranch_scc1 GS_226
v_mov_b32 v2, 1073741824
v_cmp_gt_u32 vcc, 8, v0
s_nop 1
v_cndmask_b32 v2, v2, v7, vcc
s_add_u32 s35, s10, 1
v_mov_b32 v3, s35
s_add_u32 s35, s21, 22528
buffer_store_dword v3, v2, s[4:7], s35 offen sc1
GS_226:
s_cmp_ge_u32 s10, 62
s_cbranch_scc1 END_222
s_add_u32 s10, s10, 1
PL_223:
buffer_load_dword v11, v8, s[4:7], s43 offen sc1
s_sub_u32 s38, s38, 1
s_cmp_gt_i32 s38, 0
s_cbranch_scc0 END_222
s_waitcnt vmcnt(0)
v_cmp_gt_u32 vcc, s10, v11
s_cbranch_vccz LOOP_221
s_sleep 2
s_branch PL_223
E1_224:
PF_227:
s_cmp_ge_u32 s10, 60
s_cbranch_scc1 END_222
s_add_u32 s37, s10, 3
s_min_u32 s37, s37, 63
s_mul_i32 s64, s37, 458752
s_add_u32 s64, s64, 16777216
s_lshl_b32 s41, s10, 13
s_add_u32 s41, s41, 54566912
buffer_load_dword v10, v7, s[4:7], s41 offen sc1
s_lshl_b32 s41, s37, 15
s_add_u32 s41, s41, 50331648
buffer_load_dword v10, v7, s[4:7], s41 offen sc1
s_add_u32 s41, s64, 57344
buffer_load_dword v10, v7, s[4:7], s41 offen sc1
s_add_u32 s41, s64, 122880
buffer_load_dword v10, v7, s[4:7], s41 offen sc1
s_add_u32 s41, s64, 188416
buffer_load_dword v10, v7, s[4:7], s41 offen sc1
s_add_u32 s10, s10, 1
s_sub_u32 s36, s10, 1
s_max_i32 s36, s36, 0
s_waitcnt vmcnt(5)
v_cmp_gt_u32 vcc, s36, v11
buffer_load_dword v11, v8, s[4:7], s43 offen sc1
s_cbranch_vccz PF_227
SP_228:
s_sub_u32 s38, s38, 1
s_cmp_gt_i32 s38, 0
s_cbranch_scc0 END_222
s_waitcnt vmcnt(0)
v_cmp_gt_u32 vcc, s36, v11
s_cbranch_vccz PF_227
s_sleep 4
buffer_load_dword v11, v8, s[4:7], s43 offen sc1
s_branch SP_228
END_222:
s_endpgm
EN1:
v_and_b32 v0, 63, v0
v_lshlrev_b32 v6, 4, v0
v_lshlrev_b32 v7, 7, v0
s_mov_b32 s43, 71303168
s_mov_b32 s10, 0
s_mov_b32 s38, 200000
s_mov_b32 s68, 0
s_mov_b32 s69, 0
s_mov_b32 s70, 0
s_mov_b32 s71, 0
s_and_b32 s35, s8, 3
s_mul_i32 s35, s35, 640
s_add_u32 s35, s35, 4224
v_min_u32 v8, 13, v0
v_lshlrev_b32 v8, 2, v8
v_add_u32 v8, s35, v8
s_mov_b32 s36, 14
v_mul_u32_u24 v9, 640, v0
s_lshl_b32 s35, s36, 2
s_add_u32 s35, s35, 4224
v_add_u32 v9, s35, v9
v_mov_b32 v5, 1073741824
v_cmp_gt_u32 vcc, 4, v0
s_nop 1
v_cndmask_b32 v9, v5, v9, vcc
v_lshlrev_b32 v28, 2, v0
v_mov_b32 v29, 1
s_mov_b32 s21, 71319552
s_mov_b32 s20, -1
s_cmp_lg_u32 s11, 14
s_cbranch_scc1 SK_229
GL_230:
buffer_load_dword v11, v28, s[4:7], s21 offen offset:0 sc1
s_waitcnt vmcnt(0)
v_cmp_gt_u32 vcc, 16, v11
s_nop 0
s_ff1_i32_b64 s20, vcc
s_cmp_lt_i32 s20, 0
s_cselect_b32 s20, 64, s20
s_sub_u32 s20, s20, 1
s_max_i32 s35, s20, 0
v_mov_b32 v1, s35
buffer_store_dword v1, v9, s[4:7], s43 offen sc1
s_sub_u32 s38, s38, 1
s_cmp_gt_i32 s38, 0
s_cbranch_scc0 GD_231
s_cmp_lt_i32 s20, -1
s_cbranch_scc1 GL_230
GD_231:
SK_229:
s_waitcnt vmcnt(0) lgkmcnt(0)
s_barrier
s_mov_b32 s34, 71343104
s_barrier
v_mov_b32 v1, 151552
ds_read_b32 v2, v1
s_waitcnt lgkmcnt(0)
v_readfirstlane_b32 s66, v2
v_mov_b32 v1, 0
s_cmp_eq_u32 s11, 14
s_cselect_b32 s36, 16, 4
YL_234:
buffer_load_dword v2, v1, s[4:7], s21 offen sc1
s_sub_u32 s38, s38, 1
s_cmp_gt_i32 s38, 0
s_cbranch_scc0 YD_235
s_waitcnt vmcnt(0)
v_cmp_gt_u32 vcc, s36, v2
s_cbranch_vccz YD_235
s_sleep 16
s_branch YL_234
YD_235:
s_mov_b32 s35, 50339840
buffer_load_dword v10, v7, s[4:7], s35 offen sc1
s_mov_b32 s35, 50372608
buffer_load_dword v10, v7, s[4:7], s35 offen sc1
s_mov_b32 s35, 50405376
buffer_load_dword v10, v7, s[4:7], s35 offen sc1
s_sub_u32 s36, 15, s11
s_lshl_b32 s36, s36, 15
s_add_u32 s35, s36, 54534144
buffer_load_dword v10, v7, s[4:7], s35 offen sc1
s_add_u32 s35, s36, 55320576
buffer_load_dword v10, v7, s[4:7], s35 offen sc1
v_mov_b32 v11, 0
s_cmp_lg_u32 s11, 14
s_cbranch_scc1 E1_239
LOOP_236:
s_lshl_b32 s26, s10, 13
s_add_u32 s32, s26, 56627200
s_add_u32 s26, s26, 54530048
AR_240:
buffer_load_dwordx4 v[12:15], v6, s[4:7], s26 offen offset:0 sc1
buffer_load_dwordx4 v[16:19], v6, s[4:7], s26 offen offset:1024 sc1
buffer_load_dwordx4 v[20:23], v6, s[4:7], s26 offen offset:2048 sc1
s_sub_u32 s38, s38, 1
s_cmp_gt_i32 s38, 0
s_cbranch_scc0 END_237
s_waitcnt vmcnt(0)
v_max_u32 v1, v12, v13
v_max3_u32 v1, v1, v14, v15
v_max3_u32 v1, v1, v16, v17
v_max3_u32 v1, v1, v18, v19
v_max3_u32 v1, v1, v20, v21
v_max3_u32 v1, v1, v22, v23
v_cmp_eq_u32 vcc, -1, v1
s_cbranch_vccnz AR_240
buffer_store_dwordx4 v[12:15], v6, s[4:7], s32 offen offset:0 sc1
buffer_store_dwordx4 v[16:19], v6, s[4:7], s32 offen offset:1024 sc1
buffer_store_dwordx4 v[20:23], v6, s[4:7], s32 offen offset:2048 sc1
s_cmp_ge_u32 s10, 62
s_cbranch_scc1 END_237
s_add_u32 s36, s10, 1
s_min_u32 s36, s36, 63
s_cmp_ge_i32 s20, 63
s_cbranch_scc1 GD_242
GL_241:
buffer_load_dword v11, v28, s[4:7], s21 offen offset:0 sc1
s_waitcnt vmcnt(0)
v_cmp_gt_u32 vcc, 16, v11
s_nop 0
s_ff1_i32_b64 s20, vcc
s_cmp_lt_i32 s20, 0
s_cselect_b32 s20, 64, s20
s_sub_u32 s20, s20, 1
s_max_i32 s35, s20, 0
v_mov_b32 v1, s35
buffer_store_dword v1, v9, s[4:7], s43 offen
s_cmp_lg_u32 s66, 0
s_cbranch_scc1 SL_243
SB_244:
s_sub_u32 s38, s38, 1
s_cmp_gt_i32 s38, 0
s_cbranch_scc0 GD_242
s_cmp_lt_i32 s20, s36
s_cbranch_scc1 GL_241
GD_242:
s_add_u32 s10, s10, 1
PL_238:
buffer_load_dword v11, v8, s[4:7], s43 offen sc1
s_sub_u32 s38, s38, 1
s_cmp_gt_i32 s38, 0
s_cbranch_scc0 END_237
s_waitcnt vmcnt(0)
v_cmp_gt_u32 vcc, s10, v11
s_cbranch_vccz LOOP_236
s_sleep 2
s_branch PL_238
E1_239:
PF_245:
s_cmp_ge_u32 s10, 60
s_cbranch_scc1 END_237
s_add_u32 s37, s10, 3
s_min_u32 s37, s37, 63
s_mul_i32 s64, s37, 458752
s_add_u32 s64, s64, 16777216
s_lshl_b32 s41, s37, 15
s_add_u32 s41, s41, 50339840
buffer_load_dword v10, v7, s[4:7], s41 offen sc1
s_add_u32 s41, s64, 40960
buffer_load_dword v10, v7, s[4:7], s41 offen sc1
s_add_u32 s41, s64, 106496
buffer_load_dword v10, v7, s[4:7], s41 offen sc1
s_add_u32 s41, s64, 172032
buffer_load_dword v10, v7, s[4:7], s41 offen sc1
s_add_u32 s10, s10, 1
s_sub_u32 s36, s10, 1
s_max_i32 s36, s36, 0
s_waitcnt vmcnt(4)
v_cmp_gt_u32 vcc, s36, v11
buffer_load_dword v11, v8, s[4:7], s43 offen sc1
s_cbranch_vccz PF_245
SP_246:
s_sub_u32 s38, s38, 1
s_cmp_gt_i32 s38, 0
s_cbranch_scc0 END_237
s_waitcnt vmcnt(0)
v_cmp_gt_u32 vcc, s36, v11
s_cbranch_vccz PF_245
s_sleep 4
buffer_load_dword v11, v8, s[4:7], s43 offen sc1
s_branch SP_246
END_237:
s_endpgm
SL_243:
buffer_store_dword v1, v9, s[4:7], s43 offen sc1
s_branch SB_244
EN2:
v_and_b32 v0, 63, v0
v_lshlrev_b32 v6, 4, v0
v_lshlrev_b32 v7, 7, v0
s_mov_b32 s43, 71303168
s_mov_b32 s10, 0
s_mov_b32 s38, 200000
s_mov_b32 s68, 0
s_mov_b32 s69, 0
s_mov_b32 s70, 0
s_mov_b32 s71, 0
s_and_b32 s35, s8, 3
s_mul_i32 s35, s35, 640
s_add_u32 s35, s35, 4224
v_min_u32 v8, 13, v0
v_lshlrev_b32 v8, 2, v8
v_add_u32 v8, s35, v8
s_mov_b32 s36, 14
v_mul_u32_u24 v9, 640, v0
s_lshl_b32 s35, s36, 2
s_add_u32 s35, s35, 4224
v_add_u32 v9, s35, v9
v_mov_b32 v5, 1073741824
v_cmp_gt_u32 vcc, 4, v0
s_nop 1
v_cndmask_b32 v9, v5, v9, vcc
v_lshlrev_b32 v28, 2, v0
v_mov_b32 v29, 1
s_mov_b32 s21, 71319552
s_mov_b32 s20, -1
s_waitcnt vmcnt(0) lgkmcnt(0)
s_barrier
s_mov_b32 s34, 71343104
s_barrier
v_mov_b32 v1, 151552
ds_read_b32 v2, v1
s_waitcnt lgkmcnt(0)
v_readfirstlane_b32 s66, v2
v_mov_b32 v1, 0
s_cmp_eq_u32 s11, 14
s_cselect_b32 s36, 16, 4
YL_249:
buffer_load_dword v2, v1, s[4:7], s21 offen sc1
s_sub_u32 s38, s38, 1
s_cmp_gt_i32 s38, 0
s_cbranch_scc0 YD_250
s_waitcnt vmcnt(0)
v_cmp_gt_u32 vcc, s36, v2
s_cbranch_vccz YD_250
s_sleep 16
s_branch YL_249
YD_250:
s_mov_b32 s35, 50348032
buffer_load_dword v10, v7, s[4:7], s35 offen sc1
s_mov_b32 s35, 50380800
buffer_load_dword v10, v7, s[4:7], s35 offen sc1
s_mov_b32 s35, 50413568
buffer_load_dword v10, v7, s[4:7], s35 offen sc1
s_sub_u32 s36, 15, s11
s_lshl_b32 s36, s36, 15
s_add_u32 s35, s36, 54542336
buffer_load_dword v10, v7, s[4:7], s35 offen sc1
s_add_u32 s35, s36, 55328768
buffer_load_dword v10, v7, s[4:7], s35 offen sc1
v_mov_b32 v11, 0
s_cmp_lg_u32 s11, 14
s_cbranch_scc1 E1_254
s_branch END_252
E1_254:
PF_256:
s_cmp_ge_u32 s10, 60
s_cbranch_scc1 END_252
s_add_u32 s37, s10, 3
s_min_u32 s37, s37, 63
s_mul_i32 s64, s37, 458752
s_add_u32 s64, s64, 16777216
s_lshl_b32 s41, s37, 15
s_add_u32 s41, s41, 50348032
buffer_load_dword v10, v7, s[4:7], s41 offen sc1
s_add_u32 s41, s64, 24576
buffer_load_dword v10, v7, s[4:7], s41 offen sc1
s_add_u32 s41, s64, 90112
buffer_load_dword v10, v7, s[4:7], s41 offen sc1
s_add_u32 s41, s64, 155648
buffer_load_dword v10, v7, s[4:7], s41 offen sc1
s_add_u32 s10, s10, 1
s_sub_u32 s36, s10, 1
s_max_i32 s36, s36, 0
s_waitcnt vmcnt(4)
v_cmp_gt_u32 vcc, s36, v11
buffer_load_dword v11, v8, s[4:7], s43 offen sc1
s_cbranch_vccz PF_256
SP_257:
s_sub_u32 s38, s38, 1
s_cmp_gt_i32 s38, 0
s_cbranch_scc0 END_252
s_waitcnt vmcnt(0)
v_cmp_gt_u32 vcc, s36, v11
s_cbranch_vccz PF_256
s_sleep 4
buffer_load_dword v11, v8, s[4:7], s43 offen sc1
s_branch SP_257
END_252:
s_endpgm
EN3:
v_and_b32 v0, 63, v0
v_lshlrev_b32 v6, 4, v0
v_lshlrev_b32 v7, 7, v0
s_mov_b32 s43, 71303168
s_mov_b32 s10, 0
s_mov_b32 s38, 200000
s_mov_b32 s68, 0
s_mov_b32 s69, 0
s_mov_b32 s70, 0
s_mov_b32 s71, 0
s_and_b32 s35, s8, 3
s_mul_i32 s35, s35, 640
s_add_u32 s35, s35, 4224
v_min_u32 v8, 13, v0
v_lshlrev_b32 v8, 2, v8
v_add_u32 v8, s35, v8
s_mov_b32 s36, 14
v_mul_u32_u24 v9, 640, v0
s_lshl_b32 s35, s36, 2
s_add_u32 s35, s35, 4224
v_add_u32 v9, s35, v9
v_mov_b32 v5, 1073741824
v_cmp_gt_u32 vcc, 4, v0
s_nop 1
v_cndmask_b32 v9, v5, v9, vcc
v_lshlrev_b32 v28, 2, v0
v_mov_b32 v29, 1
s_mov_b32 s21, 71319552
s_mov_b32 s20, -1
s_waitcnt vmcnt(0) lgkmcnt(0)
s_barrier
s_mov_b32 s34, 71343104
s_barrier
v_mov_b32 v1, 151552
ds_read_b32 v2, v1
s_waitcnt lgkmcnt(0)
v_readfirstlane_b32 s66, v2
v_mov_b32 v1, 0
s_cmp_eq_u32 s11, 14
s_cselect_b32 s36, 16, 4
YL_260:
buffer_load_dword v2, v1, s[4:7], s21 offen sc1
s_sub_u32 s38, s38, 1
s_cmp_gt_i32 s38, 0
s_cbranch_scc0 YD_261
s_waitcnt vmcnt(0)
v_cmp_gt_u32 vcc, s36, v2
s_cbranch_vccz YD_261
s_sleep 16
s_branch YL_260
YD_261:
s_mov_b32 s35, 50356224
buffer_load_dword v10, v7, s[4:7], s35 offen sc1
s_mov_b32 s35, 50388992
buffer_load_dword v10, v7, s[4:7], s35 offen sc1
s_mov_b32 s35, 50421760
buffer_load_dword v10, v7, s[4:7], s35 offen sc1
s_sub_u32 s36, 15, s11
s_lshl_b32 s36, s36, 15
s_add_u32 s35, s36, 54550528
buffer_load_dword v10, v7, s[4:7], s35 offen sc1
s_add_u32 s35, s36, 55336960
buffer_load_dword v10, v7, s[4:7], s35 offen sc1
v_mov_b32 v11, 0
s_cmp_lg_u32 s11, 14
s_cbranch_scc1 E1_265
s_branch END_263
E1_265:
PF_267:
s_cmp_ge_u32 s10, 60
s_cbranch_scc1 END_263
s_add_u32 s37, s10, 3
s_min_u32 s37, s37, 63
s_mul_i32 s64, s37, 458752
s_add_u32 s64, s64, 16777216
s_lshl_b32 s41, s37, 15
s_add_u32 s41, s41, 50356224
buffer_load_dword v10, v7, s[4:7], s41 offen sc1
s_add_u32 s41, s64, 8192
buffer_load_dword v10, v7, s[4:7], s41 offen sc1
s_add_u32 s41, s64, 73728
buffer_load_dword v10, v7, s[4:7], s41 offen sc1
s_add_u32 s41, s64, 139264
buffer_load_dword v10, v7, s[4:7], s41 offen sc1
s_add_u32 s10, s10, 1
s_sub_u32 s36, s10, 1
s_max_i32 s36, s36, 0
s_waitcnt vmcnt(4)
v_cmp_gt_u32 vcc, s36, v11
buffer_load_dword v11, v8, s[4:7], s43 offen sc1
s_cbranch_vccz PF_267
SP_268:
s_sub_u32 s38, s38, 1
s_cmp_gt_i32 s38, 0
s_cbranch_scc0 END_263
s_waitcnt vmcnt(0)
v_cmp_gt_u32 vcc, s36, v11
s_cbranch_vccz PF_267
s_sleep 4
buffer_load_dword v11, v8, s[4:7], s43 offen sc1
s_branch SP_268
END_263:
s_endpgm
.section .rodata,"a"
.p2align 6
.amdhsa_kernel parallel_sum__memory_aug_recurrent_mem_tr__dense_activation_squared_relu__prompt_kernel
  .amdhsa_next_free_vgpr 512
  .amdhsa_next_free_sgpr 102
  .amdhsa_accum_offset 256
  .amdhsa_group_segment_fixed_size 0
  .amdhsa_kernarg_size 120
  .amdhsa_user_sgpr_count 2
  .amdhsa_user_sgpr_kernarg_segment_ptr 1
  .amdhsa_system_sgpr_workgroup_id_x 1
.end_amdhsa_kernel
```
